```python
import torch

def _softmax(x, axis=-1):
    return torch.softmax(x, dim=axis)

def _gelu(x):
    return torch.nn.functional.gelu(x, approximate='tanh')

def _silu(x):
    return torch.nn.functional.silu(x)

def _sigmoid(x):
    return torch.sigmoid(x)

def _layernorm(x, axis=-1, eps=1e-05):
    m = x.mean(dim=axis, keepdim=True)
    v = x.var(dim=axis, keepdim=True, unbiased=False)
    return (x - m) / torch.sqrt(v + eps)

def _scatter_add(tgt, idx, src, axis=0):
    return tgt.clone().index_add_(axis, idx, src)

def _segment_sum(src, seg, n):
    out = torch.zeros((n,) + src.shape[1:], dtype=src.dtype)
    return out.index_add_(0, seg, src)

def _pad(x, pw):
    flat = tuple((v for pair in reversed(pw) for v in pair))
    return torch.nn.functional.pad(x, flat)
kernel_name = 'concat_heads__sliding_block__memory_aug_recurrent_mem_tr__prompt'

def setup_inputs():

    _w = lambda a: (lambda t: t.to(torch.bfloat16) if t.is_floating_point() else t)(torch.as_tensor(a))

    def _A_setup():
        B, S, D = (1, 2048, 512)
        return {'x': _w((lambda *s: torch.randn(*s, dtype=torch.bfloat16) * 0.2)(B, S, D)), 'wqkv': _w((lambda *s: torch.randn(*s, dtype=torch.bfloat16) * 0.2)(D, 3 * D)), 'wo': _w((lambda *s: torch.randn(*s, dtype=torch.bfloat16) * 0.05)(D, D))}
    _A_in = _A_setup()

    def _B_setup():
        B, S, Dm = (1, 2048, 512)
        H, Dh = (32, 128)
        M, seg = (8, 32)
        seg = min(seg, S)
        S = S // seg * seg
        return {'x': _w((lambda *s: torch.randn(*s, dtype=torch.bfloat16) * 0.05)(B, S, Dm)), 'mem0': _w((lambda *s: torch.randn(*s, dtype=torch.bfloat16) * 1.6)(B, M, Dm)), 'Wq': _w((lambda *s: torch.randn(*s, dtype=torch.bfloat16) * 0.8)(Dm, H, Dh) * Dm ** (-0.5)), 'Wk': _w((lambda *s: torch.randn(*s, dtype=torch.bfloat16) * 0.8)(Dm, H, Dh) * Dm ** (-0.5)), 'Wv': _w((lambda *s: torch.randn(*s, dtype=torch.bfloat16) * 1.6)(Dm, H, Dh) * Dm ** (-0.5)), 'Wo': _w((lambda *s: torch.randn(*s, dtype=torch.bfloat16) * 1.6)(H, Dh, Dm) * (H * Dh) ** (-0.5)), 'seg_len': seg}
    _B_in = _B_setup()
    return {'A_x': _A_in['x'], 'A_wqkv': _A_in['wqkv'], 'A_wo': _A_in['wo'], 'B_x': _B_in['x'], 'B_mem0': _B_in['mem0'], 'B_Wq': _B_in['Wq'], 'B_Wk': _B_in['Wk'], 'B_Wv': _B_in['Wv'], 'B_Wo': _B_in['Wo'], 'B_seg_len': _B_in['seg_len']}

def reference(A_x, A_wqkv, A_wo, B_x, B_mem0, B_Wq, B_Wk, B_Wv, B_Wo, B_seg_len):

    def _A_ref(x, wqkv, wo):
        B, S, D = x.shape
        H = 32
        Dh = D // H
        W = 256
        qkv = (lambda x, *d: x.permute(*d))((x @ wqkv).reshape(B, S, 3, H, Dh), 2, 0, 3, 1, 4)
        q, k, v = (qkv[0], qkv[1], qkv[2])
        scores = torch.einsum('bhqd,bhkd->bhqk', q, k) * Dh ** (-0.5)
        idx = torch.arange(S)
        mask = (idx[:, None] - idx[None, :] >= 0) & (idx[:, None] - idx[None, :] < W)
        scores = torch.where(mask[None, None], scores, -1000000000.0)
        p = _softmax(scores, axis=-1)
        o = torch.einsum('bhqk,bhkd->bhqd', p, v)
        return (lambda x, *d: x.permute(*d))(o, 0, 2, 1, 3).reshape(B, S, D) @ wo

    def _B_ref(x, mem0, Wq, Wk, Wv, Wo, seg_len):
        B, S, Dm = x.shape
        H, Dh = (Wq.shape[1], Wq.shape[2])
        M = mem0.shape[1]
        scale = Dh ** (-0.5)
        n_seg = S // seg_len
        L = M + seg_len
        idx = torch.arange(L)
        mask = (idx[:, None] < M) | (idx[:, None] >= idx[None, :])
        mem = mem0
        outs = []
        for s in range(n_seg):
            xs = x[:, s * seg_len:(s + 1) * seg_len, :].clone()
            h = torch.concatenate([mem, xs], axis=1)
            q = torch.einsum('btd,dhe->bhte', h, Wq)
            k = torch.einsum('btd,dhe->bhte', h, Wk)
            v = torch.einsum('btd,dhe->bhte', h, Wv)
            scores = torch.einsum('bhqe,bhke->bhqk', q, k) * scale
            scores = torch.where(mask[None, None], scores, -1000000000.0)
            p = _softmax(scores, axis=-1)
            o = torch.einsum('bhqk,bhke->bhqe', p, v)
            o = torch.einsum('bhte,hed->btd', o, Wo)
            mem = o[:, :M, :].clone()
            outs.append(o[:, M:, :])
        return torch.concatenate(outs, axis=1)
    a = _A_ref(A_x, A_wqkv, A_wo)
    b = _B_ref(B_x, B_mem0, B_Wq, B_Wk, B_Wv, B_Wo, B_seg_len)
    return torch.concatenate([a, b], axis=-1)
```

```asm
; @launch grid=(256,1,1) block=(256,1,1) lds=163840
.amdgcn_target "amdgcn-amd-amdhsa--gfx950"
.text
.globl concat_heads__sliding_block__memory_aug_recurrent_mem_tr__prompt_kernel
.p2align 8
.type concat_heads__sliding_block__memory_aug_recurrent_mem_tr__prompt_kernel,@function
concat_heads__sliding_block__memory_aug_recurrent_mem_tr__prompt_kernel:
    s_cmp_ge_u32 s2, 256
    s_cbranch_scc1 L_end
    s_load_dwordx16 s[72:87], s[0:1], 0
    s_load_dwordx8 s[88:95], s[0:1], 64
    s_load_dwordx2 s[96:97], s[0:1], 96
    s_waitcnt lgkmcnt(0)
    s_mov_b32 s8, s72
    s_mov_b32 s9, s73
    s_mov_b32 s10, 2097152
    s_mov_b32 s11, 0x20000
    s_mov_b32 s12, s74
    s_mov_b32 s13, s75
    s_mov_b32 s14, 1572864
    s_mov_b32 s15, 0x20000
    s_mov_b32 s16, s76
    s_mov_b32 s17, s77
    s_mov_b32 s18, 524288
    s_mov_b32 s19, 0x20000
    s_mov_b32 s20, s78
    s_mov_b32 s21, s79
    s_mov_b32 s22, 2097152
    s_mov_b32 s23, 0x20000
    s_mov_b32 s24, s80
    s_mov_b32 s25, s81
    s_mov_b32 s26, 8192
    s_mov_b32 s27, 0x20000
    s_mov_b32 s28, s82
    s_mov_b32 s29, s83
    s_mov_b32 s30, 4194304
    s_mov_b32 s31, 0x20000
    s_mov_b32 s32, s84
    s_mov_b32 s33, s85
    s_mov_b32 s34, 4194304
    s_mov_b32 s35, 0x20000
    s_mov_b32 s36, s86
    s_mov_b32 s37, s87
    s_mov_b32 s38, 4194304
    s_mov_b32 s39, 0x20000
    s_mov_b32 s40, s88
    s_mov_b32 s41, s89
    s_mov_b32 s42, 4194304
    s_mov_b32 s43, 0x20000
    s_mov_b32 s44, s92
    s_mov_b32 s45, s93
    s_mov_b32 s46, 4194304
    s_mov_b32 s47, 0x20000
    s_mov_b32 s48, s94
    s_mov_b32 s49, s95
    s_mov_b32 s50, 256
    s_mov_b32 s51, 0x20000
    s_mov_b32 s52, s96
    s_mov_b32 s53, s97
    s_mov_b32 s54, 268435456
    s_mov_b32 s55, 0x20000
    v_lshrrev_b32 v1, 6, v0
    s_nop 0
    v_readfirstlane_b32 s56, v1
    s_nop 0
    s_cmp_lg_u32 s56, 0
    s_cbranch_scc1 L_role_wait
    s_getreg_b32 s62, hwreg(HW_REG_XCC_ID)
    s_and_b32 s62, s62, 15
    s_mov_b64 exec, 1
    v_mov_b32 v5, 64
    s_cmp_lg_u32 s62, 0
    s_cbranch_scc1 L_role_tot
    v_mov_b32 v5, 1
    v_mov_b32 v3, 0
    buffer_atomic_add v5, v3, s[48:51], 0 offen sc0
    s_waitcnt vmcnt(0)
L_role_tot:
    v_mov_b32 v4, 1
    v_mov_b32 v3, 4
    buffer_atomic_add v4, v3, s[48:51], 0 offen
    v_mov_b32 v3, 139264
    ds_write_b32 v3, v5
    s_mov_b64 exec, -1
    s_waitcnt lgkmcnt(0)
L_role_wait:
    s_barrier
    v_mov_b32 v3, 139264
    ds_read_b32 v4, v3
    s_waitcnt lgkmcnt(0)
    v_readfirstlane_b32 s75, v4
    s_barrier
    s_cmp_ge_u32 s75, 32
    s_cbranch_scc1 L_worker
    s_mov_b32 s57, s75
L_head:
    s_mov_b32 s4, 0x33333333
    s_mov_b32 s5, 0x33333333
    s_mov_b32 s6, 0xcccccccc
    s_mov_b32 s7, 0xcccccccc
    v_and_b32 v120, 63, v0
    v_and_b32 v121, 15, v120
    v_lshrrev_b32 v122, 4, v120
    v_mov_b32 v21, -1
    v_and_b32 v123, 2, v121
    v_cmp_eq_u32 vcc, 0, v123
    v_mov_b32 v124, 0xeeeeeeee
    v_mov_b32 v125, 0x44444444
    v_cndmask_b32 v1, v124, v125, vcc
    v_lshrrev_b32 v123, 2, v121
    v_and_b32 v124, 3, v121
    v_and_b32 v125, 1, v124
    v_lshlrev_b32 v125, 4, v125
    v_mov_b32 v126, 0x3f80
    v_lshlrev_b32 v126, v125, v126
    v_cmp_eq_u32 vcc, v123, v122
    s_nop 1
    v_cndmask_b32 v126, 0, v126, vcc
    v_cmp_gt_u32 vcc, 2, v124
    s_nop 1
    v_cndmask_b32 v2, 0, v126, vcc
    v_cndmask_b32 v3, v126, 0, vcc
    v_and_b32 v125, 1, v121
    v_lshlrev_b32 v125, 4, v125
    v_mov_b32 v126, 0x3f80
    v_lshlrev_b32 v126, v125, v126
    v_lshrrev_b32 v123, 1, v121
    v_cmp_eq_u32 vcc, 0, v123
    s_nop 1
    v_cndmask_b32 v4, 0, v126, vcc
    v_cmp_eq_u32 vcc, 1, v123
    s_nop 1
    v_cndmask_b32 v5, 0, v126, vcc
    v_cmp_eq_u32 vcc, 2, v123
    s_nop 1
    v_cndmask_b32 v6, 0, v126, vcc
    v_cmp_eq_u32 vcc, 3, v123
    s_nop 1
    v_cndmask_b32 v7, 0, v126, vcc
    v_lshlrev_b32 v123, 4, v120
    v_add_u32 v8, 131072, v123
    s_lshl_b32 s62, s56, 15
    v_add_u32 v9, s62, v123
    s_lshl_b32 s62, s56, 11
    v_add_u32 v10, s62, v8
    v_lshrrev_b32 v123, 2, v121
    v_and_b32 v124, 3, v121
    s_lshl_b32 s62, s56, 16
    s_lshl_b32 s63, s57, 6
    s_add_u32 s62, s62, s63
    v_lshlrev_b32 v125, 13, v123
    v_lshlrev_b32 v126, 11, v122
    v_lshlrev_b32 v127, 4, v124
    v_add3_u32 v11, v125, v126, v127
    v_add_u32 v11, s62, v11
    s_lshl_b32 s62, s57, 13
    s_lshl_b32 s63, s56, 11
    s_add_u32 s62, s62, s63
    v_lshlrev_b32 v125, 6, v123
    v_lshlrev_b32 v126, 8, v122
    v_add3_u32 v12, v125, v126, v127
    v_add_u32 v12, s62, v12
    s_lshl_b32 s62, s57, 8
    s_lshl_b32 s63, s56, 6
    s_add_u32 s62, s62, s63
    v_lshlrev_b32 v125, 5, v122
    v_lshlrev_b32 v126, 2, v121
    v_add3_u32 v13, v125, v126, s62
    v_lshlrev_b32 v126, 4, v120
    s_lshl_b32 s62, s57, 14
    s_lshl_b32 s63, s56, 12
    s_add_u32 s62, s62, s63
    v_add_u32 v14, s62, v126
    s_add_u32 s63, s63, 147456
    v_add_u32 v15, s63, v126
    v_lshlrev_b32 v125, 3, v123
    v_add_u32 v125, v125, v124
    v_lshlrev_b32 v127, 4, v120
    s_lshl_b32 s62, s57, 12
    s_lshl_b32 s63, s56, 10
    s_add_u32 s62, s62, s63
    v_add_u32 v17, s62, v127
    v_and_b32 v125, 1, v121
    v_lshl_add_u32 v125, v123, 1, v125
    v_lshlrev_b32 v127, 8, v125
    v_lshlrev_b32 v126, 4, v122
    s_lshl_b32 s62, s57, 11
    s_lshl_b32 s63, s56, 6
    s_add_u32 s62, s62, s63
    v_add3_u32 v16, v127, v126, s62
    v_lshrrev_b32 v126, 1, v122
    v_lshlrev_b32 v126, 8, v126
    v_and_b32 v127, 1, v122
    v_lshlrev_b32 v127, 5, v127
    v_and_b32 v125, 1, v121
    v_lshlrev_b32 v125, 4, v125
    v_lshl_add_u32 v125, v123, 6, v125
    v_add3_u32 v20, v125, v126, v127
    s_lshl_b32 s62, s56, 9
    s_add_u32 s62, s62, 145408
    v_add_u32 v20, s62, v20
    v_lshlrev_b32 v125, 4, v120
    s_lshl_b32 s62, s56, 10
    s_add_u32 s62, s62, 139232
    v_add_u32 v18, s62, v125
    v_add_u32 v19, 139264, v125
    s_lshl_b32 s62, s56, 2
    s_add_u32 s62, s62, 143328
    v_add_u32 v119, s62, v125
    v_and_b32 v120, 63, v0
    v_and_b32 v121, 15, v120
    v_lshrrev_b32 v122, 4, v120
    v_xor_b32 v123, 0, v121
    v_lshlrev_b32 v123, 4, v123
    v_add_u32 v124, 0, v122
    v_lshlrev_b32 v124, 13, v124
    s_lshl_b32 s62, s56, 17
    s_lshl_b32 s63, s57, 8
    s_add_u32 s62, s62, s63
    v_add3_u32 v24, v123, v124, s62
    v_lshrrev_b32 v36, 6, v123
    v_lshlrev_b32 v36, 1, v36
    v_xor_b32 v123, 4, v121
    v_lshlrev_b32 v123, 4, v123
    v_add_u32 v124, 4, v122
    v_lshlrev_b32 v124, 13, v124
    s_lshl_b32 s62, s56, 17
    s_lshl_b32 s63, s57, 8
    s_add_u32 s62, s62, s63
    v_add3_u32 v25, v123, v124, s62
    v_lshrrev_b32 v37, 6, v123
    v_lshlrev_b32 v37, 1, v37
    v_xor_b32 v123, 8, v121
    v_lshlrev_b32 v123, 4, v123
    v_add_u32 v124, 8, v122
    v_lshlrev_b32 v124, 13, v124
    s_lshl_b32 s62, s56, 17
    s_lshl_b32 s63, s57, 8
    s_add_u32 s62, s62, s63
    v_add3_u32 v26, v123, v124, s62
    v_lshrrev_b32 v38, 6, v123
    v_lshlrev_b32 v38, 1, v38
    v_xor_b32 v123, 12, v121
    v_lshlrev_b32 v123, 4, v123
    v_add_u32 v124, 12, v122
    v_lshlrev_b32 v124, 13, v124
    s_lshl_b32 s62, s56, 17
    s_lshl_b32 s63, s57, 8
    s_add_u32 s62, s62, s63
    v_add3_u32 v27, v123, v124, s62
    v_lshrrev_b32 v39, 6, v123
    v_lshlrev_b32 v39, 1, v39
    v_xor_b32 v123, 0, v121
    v_lshrrev_b32 v125, 3, v123
    v_and_b32 v123, 7, v123
    v_lshlrev_b32 v123, 4, v123
    v_lshl_add_u32 v123, v125, 8, v123
    v_add_u32 v124, 0, v122
    v_lshlrev_b32 v124, 10, v124
    s_lshl_b32 s62, s56, 14
    s_lshl_b32 s63, s57, 17
    s_add_u32 s62, s62, s63
    v_add3_u32 v28, v123, v124, s62
    v_xor_b32 v123, 1, v121
    v_lshrrev_b32 v125, 3, v123
    v_and_b32 v123, 7, v123
    v_lshlrev_b32 v123, 4, v123
    v_lshl_add_u32 v123, v125, 8, v123
    v_add_u32 v124, 4, v122
    v_lshlrev_b32 v124, 10, v124
    s_lshl_b32 s62, s56, 14
    s_lshl_b32 s63, s57, 17
    s_add_u32 s62, s62, s63
    v_add3_u32 v29, v123, v124, s62
    v_xor_b32 v123, 8, v121
    v_lshrrev_b32 v125, 3, v123
    v_and_b32 v123, 7, v123
    v_lshlrev_b32 v123, 4, v123
    v_lshl_add_u32 v123, v125, 8, v123
    v_add_u32 v124, 8, v122
    v_lshlrev_b32 v124, 10, v124
    s_lshl_b32 s62, s56, 14
    s_lshl_b32 s63, s57, 17
    s_add_u32 s62, s62, s63
    v_add3_u32 v30, v123, v124, s62
    v_xor_b32 v123, 9, v121
    v_lshrrev_b32 v125, 3, v123
    v_and_b32 v123, 7, v123
    v_lshlrev_b32 v123, 4, v123
    v_lshl_add_u32 v123, v125, 8, v123
    v_add_u32 v124, 12, v122
    v_lshlrev_b32 v124, 10, v124
    s_lshl_b32 s62, s56, 14
    s_lshl_b32 s63, s57, 17
    s_add_u32 s62, s62, s63
    v_add3_u32 v31, v123, v124, s62
    v_lshrrev_b32 v123, 2, v121
    v_and_b32 v124, 3, v121
    v_lshrrev_b32 v125, 1, v122
    v_lshlrev_b32 v125, 4, v125
    v_and_b32 v126, 1, v122
    v_lshlrev_b32 v126, 1, v126
    v_lshlrev_b32 v127, 2, v123
    v_add3_u32 v125, v125, v126, v127
    s_lshl_b32 s62, s56, 2
    v_add_u32 v126, s62, v124
    v_xor_b32 v126, v126, v127
    v_lshlrev_b32 v126, 4, v126
    v_lshl_add_u32 v32, v125, 8, v126
    v_add_u32 v32, 131072, v32
    v_and_b32 v126, 1, v122
    v_lshrrev_b32 v127, 1, v123
    v_lshrrev_b32 v125, 1, v122
    v_lshlrev_b32 v125, 4, v125
    v_lshl_add_u32 v125, v126, 2, v125
    v_lshl_add_u32 v125, v127, 3, v125
    v_and_b32 v34, 1, v123
    v_add_u32 v125, v125, v34
    s_and_b32 s62, s56, 1
    s_lshl_b32 s62, s62, 3
    v_lshlrev_b32 v34, 1, v124
    v_add_u32 v34, s62, v34
    v_lshl_add_u32 v126, v127, 3, v126
    v_xor_b32 v34, v34, v126
    v_lshlrev_b32 v34, 4, v34
    v_lshl_add_u32 v33, v125, 8, v34
    v_add_u32 v33, 131072, v33
    v_xor_b32 v34, 16, v33
    v_subrev_u32 v76, 131072, v32
    v_add_u32 v77, 65536, v76
    v_subrev_u32 v78, 131072, v33
    v_add_u32 v79, 65536, v78
    v_subrev_u32 v80, 131072, v34
    v_add_u32 v81, 65536, v80
    s_lshl_b32 s62, s56, 12
    s_add_u32 m0, s62, 131072
    s_mov_b32 s63, 0
    buffer_load_dwordx4 v24, s[32:35], s63 offen lds
    s_lshl_b32 s62, s56, 12
    s_add_u32 m0, s62, 132096
    s_mov_b32 s63, 0
    buffer_load_dwordx4 v25, s[32:35], s63 offen lds
    s_lshl_b32 s62, s56, 12
    s_add_u32 m0, s62, 133120
    s_mov_b32 s63, 0
    buffer_load_dwordx4 v26, s[32:35], s63 offen lds
    s_lshl_b32 s62, s56, 12
    s_add_u32 m0, s62, 134144
    s_mov_b32 s63, 0
    buffer_load_dwordx4 v27, s[32:35], s63 offen lds
    s_lshl_b32 s62, s56, 12
    s_add_u32 m0, s62, 147456
    s_mov_b32 s63, 524288
    buffer_load_dwordx4 v24, s[32:35], s63 offen lds
    s_lshl_b32 s62, s56, 12
    s_add_u32 m0, s62, 148480
    s_mov_b32 s63, 524288
    buffer_load_dwordx4 v25, s[32:35], s63 offen lds
    s_lshl_b32 s62, s56, 12
    s_add_u32 m0, s62, 149504
    s_mov_b32 s63, 524288
    buffer_load_dwordx4 v26, s[32:35], s63 offen lds
    s_lshl_b32 s62, s56, 12
    s_add_u32 m0, s62, 150528
    s_mov_b32 s63, 524288
    buffer_load_dwordx4 v27, s[32:35], s63 offen lds
    s_lshl_b32 s62, s56, 12
    s_add_u32 m0, s62, 0
    s_mov_b32 s63, 1048576
    buffer_load_dwordx4 v24, s[32:35], s63 offen lds
    s_lshl_b32 s62, s56, 12
    s_add_u32 m0, s62, 1024
    s_mov_b32 s63, 1048576
    buffer_load_dwordx4 v25, s[32:35], s63 offen lds
    s_lshl_b32 s62, s56, 12
    s_add_u32 m0, s62, 2048
    s_mov_b32 s63, 1048576
    buffer_load_dwordx4 v26, s[32:35], s63 offen lds
    s_lshl_b32 s62, s56, 12
    s_add_u32 m0, s62, 3072
    s_mov_b32 s63, 1048576
    buffer_load_dwordx4 v27, s[32:35], s63 offen lds
    s_lshl_b32 s62, s56, 12
    s_add_u32 m0, s62, 32768
    s_mov_b32 s63, 1572864
    buffer_load_dwordx4 v24, s[32:35], s63 offen lds
    s_lshl_b32 s62, s56, 12
    s_add_u32 m0, s62, 33792
    s_mov_b32 s63, 1572864
    buffer_load_dwordx4 v25, s[32:35], s63 offen lds
    s_lshl_b32 s62, s56, 12
    s_add_u32 m0, s62, 34816
    s_mov_b32 s63, 1572864
    buffer_load_dwordx4 v26, s[32:35], s63 offen lds
    s_lshl_b32 s62, s56, 12
    s_add_u32 m0, s62, 35840
    s_mov_b32 s63, 1572864
    buffer_load_dwordx4 v27, s[32:35], s63 offen lds
    s_lshl_b32 s62, s56, 12
    s_add_u32 m0, s62, 65536
    s_mov_b32 s63, 2097152
    buffer_load_dwordx4 v24, s[32:35], s63 offen lds
    s_lshl_b32 s62, s56, 12
    s_add_u32 m0, s62, 66560
    s_mov_b32 s63, 2097152
    buffer_load_dwordx4 v25, s[32:35], s63 offen lds
    s_lshl_b32 s62, s56, 12
    s_add_u32 m0, s62, 67584
    s_mov_b32 s63, 2097152
    buffer_load_dwordx4 v26, s[32:35], s63 offen lds
    s_lshl_b32 s62, s56, 12
    s_add_u32 m0, s62, 68608
    s_mov_b32 s63, 2097152
    buffer_load_dwordx4 v27, s[32:35], s63 offen lds
    s_lshl_b32 s62, s56, 12
    s_add_u32 m0, s62, 98304
    s_mov_b32 s63, 2621440
    buffer_load_dwordx4 v24, s[32:35], s63 offen lds
    s_lshl_b32 s62, s56, 12
    s_add_u32 m0, s62, 99328
    s_mov_b32 s63, 2621440
    buffer_load_dwordx4 v25, s[32:35], s63 offen lds
    s_lshl_b32 s62, s56, 12
    s_add_u32 m0, s62, 100352
    s_mov_b32 s63, 2621440
    buffer_load_dwordx4 v26, s[32:35], s63 offen lds
    s_lshl_b32 s62, s56, 12
    s_add_u32 m0, s62, 101376
    s_mov_b32 s63, 2621440
    buffer_load_dwordx4 v27, s[32:35], s63 offen lds
    s_waitcnt vmcnt(20)
    s_barrier
    s_cmp_lg_u32 s56, 0
    s_cbranch_scc1 L_wn_2
    ds_read_b64_tr_b16 a[0:1], v32 offset:0
    ds_read_b64_tr_b16 a[2:3], v32 offset:256
    ds_read_b64_tr_b16 a[4:5], v32 offset:8192
    ds_read_b64_tr_b16 a[6:7], v32 offset:8448
    ds_read_b64_tr_b16 a[16:17], v32 offset:8
    ds_read_b64_tr_b16 a[18:19], v32 offset:264
    ds_read_b64_tr_b16 a[20:21], v32 offset:8200
    ds_read_b64_tr_b16 a[22:23], v32 offset:8456
    s_branch L_wv_1
L_wn_2:
    s_cmp_lg_u32 s56, 1
    s_cbranch_scc1 L_wn_3
    ds_read_b64_tr_b16 a[120:121], v32 offset:0
    ds_read_b64_tr_b16 a[122:123], v32 offset:256
    ds_read_b64_tr_b16 a[124:125], v32 offset:8192
    ds_read_b64_tr_b16 a[126:127], v32 offset:8448
    ds_read_b64_tr_b16 a[192:193], v32 offset:8
    ds_read_b64_tr_b16 a[194:195], v32 offset:264
    ds_read_b64_tr_b16 a[196:197], v32 offset:8200
    ds_read_b64_tr_b16 a[198:199], v32 offset:8456
    s_branch L_wv_1
L_wn_3:
    s_cmp_lg_u32 s56, 2
    s_cbranch_scc1 L_wn_4
    ds_read_b64_tr_b16 a[96:97], v32 offset:0
    ds_read_b64_tr_b16 a[98:99], v32 offset:256
    ds_read_b64_tr_b16 a[100:101], v32 offset:8192
    ds_read_b64_tr_b16 a[102:103], v32 offset:8448
    ds_read_b64_tr_b16 a[168:169], v32 offset:8
    ds_read_b64_tr_b16 a[170:171], v32 offset:264
    ds_read_b64_tr_b16 a[172:173], v32 offset:8200
    ds_read_b64_tr_b16 a[174:175], v32 offset:8456
    s_branch L_wv_1
L_wn_4:
    ds_read_b64_tr_b16 a[72:73], v32 offset:0
    ds_read_b64_tr_b16 a[74:75], v32 offset:256
    ds_read_b64_tr_b16 a[76:77], v32 offset:8192
    ds_read_b64_tr_b16 a[78:79], v32 offset:8448
    ds_read_b64_tr_b16 a[144:145], v32 offset:8
    ds_read_b64_tr_b16 a[146:147], v32 offset:264
    ds_read_b64_tr_b16 a[148:149], v32 offset:8200
    ds_read_b64_tr_b16 a[150:151], v32 offset:8456
L_wv_1:
    s_waitcnt lgkmcnt(0)
    s_barrier
    s_lshl_b32 s62, s56, 12
    s_add_u32 m0, s62, 131072
    s_mov_b32 s63, 3145728
    buffer_load_dwordx4 v24, s[32:35], s63 offen lds
    s_lshl_b32 s62, s56, 12
    s_add_u32 m0, s62, 132096
    s_mov_b32 s63, 3145728
    buffer_load_dwordx4 v25, s[32:35], s63 offen lds
    s_lshl_b32 s62, s56, 12
    s_add_u32 m0, s62, 133120
    s_mov_b32 s63, 3145728
    buffer_load_dwordx4 v26, s[32:35], s63 offen lds
    s_lshl_b32 s62, s56, 12
    s_add_u32 m0, s62, 134144
    s_mov_b32 s63, 3145728
    buffer_load_dwordx4 v27, s[32:35], s63 offen lds
    s_waitcnt vmcnt(20)
    s_barrier
    s_cmp_lg_u32 s56, 0
    s_cbranch_scc1 L_wn_7
    ds_read_b64_tr_b16 a[40:41], v32 offset:16384
    ds_read_b64_tr_b16 a[42:43], v32 offset:16640
    ds_read_b64_tr_b16 a[44:45], v32 offset:24576
    ds_read_b64_tr_b16 a[46:47], v32 offset:24832
    ds_read_b64_tr_b16 a[48:49], v32 offset:16392
    ds_read_b64_tr_b16 a[50:51], v32 offset:16648
    ds_read_b64_tr_b16 a[52:53], v32 offset:24584
    ds_read_b64_tr_b16 a[54:55], v32 offset:24840
    s_branch L_wv_6
L_wn_7:
    s_cmp_lg_u32 s56, 1
    s_cbranch_scc1 L_wn_8
    ds_read_b64_tr_b16 a[136:137], v32 offset:16384
    ds_read_b64_tr_b16 a[138:139], v32 offset:16640
    ds_read_b64_tr_b16 a[140:141], v32 offset:24576
    ds_read_b64_tr_b16 a[142:143], v32 offset:24832
    ds_read_b64_tr_b16 a[208:209], v32 offset:16392
    ds_read_b64_tr_b16 a[210:211], v32 offset:16648
    ds_read_b64_tr_b16 a[212:213], v32 offset:24584
    ds_read_b64_tr_b16 a[214:215], v32 offset:24840
    s_branch L_wv_6
L_wn_8:
    s_cmp_lg_u32 s56, 2
    s_cbranch_scc1 L_wn_9
    ds_read_b64_tr_b16 a[112:113], v32 offset:16384
    ds_read_b64_tr_b16 a[114:115], v32 offset:16640
    ds_read_b64_tr_b16 a[116:117], v32 offset:24576
    ds_read_b64_tr_b16 a[118:119], v32 offset:24832
    ds_read_b64_tr_b16 a[184:185], v32 offset:16392
    ds_read_b64_tr_b16 a[186:187], v32 offset:16648
    ds_read_b64_tr_b16 a[188:189], v32 offset:24584
    ds_read_b64_tr_b16 a[190:191], v32 offset:24840
    s_branch L_wv_6
L_wn_9:
    ds_read_b64_tr_b16 a[88:89], v32 offset:16384
    ds_read_b64_tr_b16 a[90:91], v32 offset:16640
    ds_read_b64_tr_b16 a[92:93], v32 offset:24576
    ds_read_b64_tr_b16 a[94:95], v32 offset:24832
    ds_read_b64_tr_b16 a[160:161], v32 offset:16392
    ds_read_b64_tr_b16 a[162:163], v32 offset:16648
    ds_read_b64_tr_b16 a[164:165], v32 offset:24584
    ds_read_b64_tr_b16 a[166:167], v32 offset:24840
L_wv_6:
    s_waitcnt lgkmcnt(0)
    s_barrier
    s_lshl_b32 s62, s56, 12
    s_add_u32 m0, s62, 147456
    s_mov_b32 s63, 3670016
    buffer_load_dwordx4 v24, s[32:35], s63 offen lds
    s_lshl_b32 s62, s56, 12
    s_add_u32 m0, s62, 148480
    s_mov_b32 s63, 3670016
    buffer_load_dwordx4 v25, s[32:35], s63 offen lds
    s_lshl_b32 s62, s56, 12
    s_add_u32 m0, s62, 149504
    s_mov_b32 s63, 3670016
    buffer_load_dwordx4 v26, s[32:35], s63 offen lds
    s_lshl_b32 s62, s56, 12
    s_add_u32 m0, s62, 150528
    s_mov_b32 s63, 3670016
    buffer_load_dwordx4 v27, s[32:35], s63 offen lds
    s_waitcnt vmcnt(20)
    s_barrier
    s_cmp_lg_u32 s56, 0
    s_cbranch_scc1 L_wn_12
    ds_read_b64_tr_b16 a[72:73], v76 offset:0
    ds_read_b64_tr_b16 a[74:75], v76 offset:256
    ds_read_b64_tr_b16 a[76:77], v76 offset:8192
    ds_read_b64_tr_b16 a[78:79], v76 offset:8448
    ds_read_b64_tr_b16 a[144:145], v76 offset:8
    ds_read_b64_tr_b16 a[146:147], v76 offset:264
    ds_read_b64_tr_b16 a[148:149], v76 offset:8200
    ds_read_b64_tr_b16 a[150:151], v76 offset:8456
    s_branch L_wv_11
L_wn_12:
    s_cmp_lg_u32 s56, 1
    s_cbranch_scc1 L_wn_13
    ds_read_b64_tr_b16 a[0:1], v76 offset:0
    ds_read_b64_tr_b16 a[2:3], v76 offset:256
    ds_read_b64_tr_b16 a[4:5], v76 offset:8192
    ds_read_b64_tr_b16 a[6:7], v76 offset:8448
    ds_read_b64_tr_b16 a[16:17], v76 offset:8
    ds_read_b64_tr_b16 a[18:19], v76 offset:264
    ds_read_b64_tr_b16 a[20:21], v76 offset:8200
    ds_read_b64_tr_b16 a[22:23], v76 offset:8456
    s_branch L_wv_11
L_wn_13:
    s_cmp_lg_u32 s56, 2
    s_cbranch_scc1 L_wn_14
    ds_read_b64_tr_b16 a[120:121], v76 offset:0
    ds_read_b64_tr_b16 a[122:123], v76 offset:256
    ds_read_b64_tr_b16 a[124:125], v76 offset:8192
    ds_read_b64_tr_b16 a[126:127], v76 offset:8448
    ds_read_b64_tr_b16 a[192:193], v76 offset:8
    ds_read_b64_tr_b16 a[194:195], v76 offset:264
    ds_read_b64_tr_b16 a[196:197], v76 offset:8200
    ds_read_b64_tr_b16 a[198:199], v76 offset:8456
    s_branch L_wv_11
L_wn_14:
    ds_read_b64_tr_b16 a[96:97], v76 offset:0
    ds_read_b64_tr_b16 a[98:99], v76 offset:256
    ds_read_b64_tr_b16 a[100:101], v76 offset:8192
    ds_read_b64_tr_b16 a[102:103], v76 offset:8448
    ds_read_b64_tr_b16 a[168:169], v76 offset:8
    ds_read_b64_tr_b16 a[170:171], v76 offset:264
    ds_read_b64_tr_b16 a[172:173], v76 offset:8200
    ds_read_b64_tr_b16 a[174:175], v76 offset:8456
L_wv_11:
    s_waitcnt lgkmcnt(0)
    s_barrier
    s_lshl_b32 s62, s56, 12
    s_add_u32 m0, s62, 0
    s_mov_b32 s63, 0
    buffer_load_dwordx4 v28, s[40:43], s63 offen lds
    s_lshl_b32 s62, s56, 12
    s_add_u32 m0, s62, 1024
    s_mov_b32 s63, 0
    buffer_load_dwordx4 v29, s[40:43], s63 offen lds
    s_lshl_b32 s62, s56, 12
    s_add_u32 m0, s62, 2048
    s_mov_b32 s63, 0
    buffer_load_dwordx4 v30, s[40:43], s63 offen lds
    s_lshl_b32 s62, s56, 12
    s_add_u32 m0, s62, 3072
    s_mov_b32 s63, 0
    buffer_load_dwordx4 v31, s[40:43], s63 offen lds
    s_waitcnt vmcnt(20)
    s_barrier
    s_cmp_lg_u32 s56, 0
    s_cbranch_scc1 L_wn_17
    ds_read_b64_tr_b16 a[88:89], v76 offset:32768
    ds_read_b64_tr_b16 a[90:91], v76 offset:33024
    ds_read_b64_tr_b16 a[92:93], v76 offset:40960
    ds_read_b64_tr_b16 a[94:95], v76 offset:41216
    ds_read_b64_tr_b16 a[160:161], v76 offset:32776
    ds_read_b64_tr_b16 a[162:163], v76 offset:33032
    ds_read_b64_tr_b16 a[164:165], v76 offset:40968
    ds_read_b64_tr_b16 a[166:167], v76 offset:41224
    s_branch L_wv_16
L_wn_17:
    s_cmp_lg_u32 s56, 1
    s_cbranch_scc1 L_wn_18
    ds_read_b64_tr_b16 a[40:41], v76 offset:32768
    ds_read_b64_tr_b16 a[42:43], v76 offset:33024
    ds_read_b64_tr_b16 a[44:45], v76 offset:40960
    ds_read_b64_tr_b16 a[46:47], v76 offset:41216
    ds_read_b64_tr_b16 a[48:49], v76 offset:32776
    ds_read_b64_tr_b16 a[50:51], v76 offset:33032
    ds_read_b64_tr_b16 a[52:53], v76 offset:40968
    ds_read_b64_tr_b16 a[54:55], v76 offset:41224
    s_branch L_wv_16
L_wn_18:
    s_cmp_lg_u32 s56, 2
    s_cbranch_scc1 L_wn_19
    ds_read_b64_tr_b16 a[136:137], v76 offset:32768
    ds_read_b64_tr_b16 a[138:139], v76 offset:33024
    ds_read_b64_tr_b16 a[140:141], v76 offset:40960
    ds_read_b64_tr_b16 a[142:143], v76 offset:41216
    ds_read_b64_tr_b16 a[208:209], v76 offset:32776
    ds_read_b64_tr_b16 a[210:211], v76 offset:33032
    ds_read_b64_tr_b16 a[212:213], v76 offset:40968
    ds_read_b64_tr_b16 a[214:215], v76 offset:41224
    s_branch L_wv_16
L_wn_19:
    ds_read_b64_tr_b16 a[112:113], v76 offset:32768
    ds_read_b64_tr_b16 a[114:115], v76 offset:33024
    ds_read_b64_tr_b16 a[116:117], v76 offset:40960
    ds_read_b64_tr_b16 a[118:119], v76 offset:41216
    ds_read_b64_tr_b16 a[184:185], v76 offset:32776
    ds_read_b64_tr_b16 a[186:187], v76 offset:33032
    ds_read_b64_tr_b16 a[188:189], v76 offset:40968
    ds_read_b64_tr_b16 a[190:191], v76 offset:41224
L_wv_16:
    s_waitcnt lgkmcnt(0)
    s_barrier
    s_lshl_b32 s62, s56, 12
    s_add_u32 m0, s62, 32768
    s_mov_b32 s63, 512
    buffer_load_dwordx4 v28, s[40:43], s63 offen lds
    s_lshl_b32 s62, s56, 12
    s_add_u32 m0, s62, 33792
    s_mov_b32 s63, 512
    buffer_load_dwordx4 v29, s[40:43], s63 offen lds
    s_lshl_b32 s62, s56, 12
    s_add_u32 m0, s62, 34816
    s_mov_b32 s63, 512
    buffer_load_dwordx4 v30, s[40:43], s63 offen lds
    s_lshl_b32 s62, s56, 12
    s_add_u32 m0, s62, 35840
    s_mov_b32 s63, 512
    buffer_load_dwordx4 v31, s[40:43], s63 offen lds
    s_waitcnt vmcnt(20)
    s_barrier
    s_cmp_lg_u32 s56, 0
    s_cbranch_scc1 L_wn_22
    ds_read_b64_tr_b16 a[96:97], v77 offset:0
    ds_read_b64_tr_b16 a[98:99], v77 offset:256
    ds_read_b64_tr_b16 a[100:101], v77 offset:8192
    ds_read_b64_tr_b16 a[102:103], v77 offset:8448
    ds_read_b64_tr_b16 a[168:169], v77 offset:8
    ds_read_b64_tr_b16 a[170:171], v77 offset:264
    ds_read_b64_tr_b16 a[172:173], v77 offset:8200
    ds_read_b64_tr_b16 a[174:175], v77 offset:8456
    s_branch L_wv_21
L_wn_22:
    s_cmp_lg_u32 s56, 1
    s_cbranch_scc1 L_wn_23
    ds_read_b64_tr_b16 a[72:73], v77 offset:0
    ds_read_b64_tr_b16 a[74:75], v77 offset:256
    ds_read_b64_tr_b16 a[76:77], v77 offset:8192
    ds_read_b64_tr_b16 a[78:79], v77 offset:8448
    ds_read_b64_tr_b16 a[144:145], v77 offset:8
    ds_read_b64_tr_b16 a[146:147], v77 offset:264
    ds_read_b64_tr_b16 a[148:149], v77 offset:8200
    ds_read_b64_tr_b16 a[150:151], v77 offset:8456
    s_branch L_wv_21
L_wn_23:
    s_cmp_lg_u32 s56, 2
    s_cbranch_scc1 L_wn_24
    ds_read_b64_tr_b16 a[0:1], v77 offset:0
    ds_read_b64_tr_b16 a[2:3], v77 offset:256
    ds_read_b64_tr_b16 a[4:5], v77 offset:8192
    ds_read_b64_tr_b16 a[6:7], v77 offset:8448
    ds_read_b64_tr_b16 a[16:17], v77 offset:8
    ds_read_b64_tr_b16 a[18:19], v77 offset:264
    ds_read_b64_tr_b16 a[20:21], v77 offset:8200
    ds_read_b64_tr_b16 a[22:23], v77 offset:8456
    s_branch L_wv_21
L_wn_24:
    ds_read_b64_tr_b16 a[120:121], v77 offset:0
    ds_read_b64_tr_b16 a[122:123], v77 offset:256
    ds_read_b64_tr_b16 a[124:125], v77 offset:8192
    ds_read_b64_tr_b16 a[126:127], v77 offset:8448
    ds_read_b64_tr_b16 a[192:193], v77 offset:8
    ds_read_b64_tr_b16 a[194:195], v77 offset:264
    ds_read_b64_tr_b16 a[196:197], v77 offset:8200
    ds_read_b64_tr_b16 a[198:199], v77 offset:8456
L_wv_21:
    s_waitcnt lgkmcnt(0)
    s_barrier
    s_lshl_b32 s62, s56, 12
    s_add_u32 m0, s62, 65536
    s_mov_b32 s63, 128
    buffer_load_dwordx4 v28, s[40:43], s63 offen lds
    s_lshl_b32 s62, s56, 12
    s_add_u32 m0, s62, 66560
    s_mov_b32 s63, 128
    buffer_load_dwordx4 v29, s[40:43], s63 offen lds
    s_lshl_b32 s62, s56, 12
    s_add_u32 m0, s62, 67584
    s_mov_b32 s63, 128
    buffer_load_dwordx4 v30, s[40:43], s63 offen lds
    s_lshl_b32 s62, s56, 12
    s_add_u32 m0, s62, 68608
    s_mov_b32 s63, 128
    buffer_load_dwordx4 v31, s[40:43], s63 offen lds
    s_waitcnt vmcnt(20)
    s_barrier
    s_cmp_lg_u32 s56, 0
    s_cbranch_scc1 L_wn_27
    ds_read_b64_tr_b16 a[112:113], v77 offset:32768
    ds_read_b64_tr_b16 a[114:115], v77 offset:33024
    ds_read_b64_tr_b16 a[116:117], v77 offset:40960
    ds_read_b64_tr_b16 a[118:119], v77 offset:41216
    ds_read_b64_tr_b16 a[184:185], v77 offset:32776
    ds_read_b64_tr_b16 a[186:187], v77 offset:33032
    ds_read_b64_tr_b16 a[188:189], v77 offset:40968
    ds_read_b64_tr_b16 a[190:191], v77 offset:41224
    s_branch L_wv_26
L_wn_27:
    s_cmp_lg_u32 s56, 1
    s_cbranch_scc1 L_wn_28
    ds_read_b64_tr_b16 a[88:89], v77 offset:32768
    ds_read_b64_tr_b16 a[90:91], v77 offset:33024
    ds_read_b64_tr_b16 a[92:93], v77 offset:40960
    ds_read_b64_tr_b16 a[94:95], v77 offset:41216
    ds_read_b64_tr_b16 a[160:161], v77 offset:32776
    ds_read_b64_tr_b16 a[162:163], v77 offset:33032
    ds_read_b64_tr_b16 a[164:165], v77 offset:40968
    ds_read_b64_tr_b16 a[166:167], v77 offset:41224
    s_branch L_wv_26
L_wn_28:
    s_cmp_lg_u32 s56, 2
    s_cbranch_scc1 L_wn_29
    ds_read_b64_tr_b16 a[40:41], v77 offset:32768
    ds_read_b64_tr_b16 a[42:43], v77 offset:33024
    ds_read_b64_tr_b16 a[44:45], v77 offset:40960
    ds_read_b64_tr_b16 a[46:47], v77 offset:41216
    ds_read_b64_tr_b16 a[48:49], v77 offset:32776
    ds_read_b64_tr_b16 a[50:51], v77 offset:33032
    ds_read_b64_tr_b16 a[52:53], v77 offset:40968
    ds_read_b64_tr_b16 a[54:55], v77 offset:41224
    s_branch L_wv_26
L_wn_29:
    ds_read_b64_tr_b16 a[136:137], v77 offset:32768
    ds_read_b64_tr_b16 a[138:139], v77 offset:33024
    ds_read_b64_tr_b16 a[140:141], v77 offset:40960
    ds_read_b64_tr_b16 a[142:143], v77 offset:41216
    ds_read_b64_tr_b16 a[208:209], v77 offset:32776
    ds_read_b64_tr_b16 a[210:211], v77 offset:33032
    ds_read_b64_tr_b16 a[212:213], v77 offset:40968
    ds_read_b64_tr_b16 a[214:215], v77 offset:41224
L_wv_26:
    s_waitcnt lgkmcnt(0)
    s_barrier
    s_lshl_b32 s62, s56, 12
    s_add_u32 m0, s62, 98304
    s_mov_b32 s63, 640
    buffer_load_dwordx4 v28, s[40:43], s63 offen lds
    s_lshl_b32 s62, s56, 12
    s_add_u32 m0, s62, 99328
    s_mov_b32 s63, 640
    buffer_load_dwordx4 v29, s[40:43], s63 offen lds
    s_lshl_b32 s62, s56, 12
    s_add_u32 m0, s62, 100352
    s_mov_b32 s63, 640
    buffer_load_dwordx4 v30, s[40:43], s63 offen lds
    s_lshl_b32 s62, s56, 12
    s_add_u32 m0, s62, 101376
    s_mov_b32 s63, 640
    buffer_load_dwordx4 v31, s[40:43], s63 offen lds
    s_waitcnt vmcnt(20)
    s_barrier
    s_cmp_lg_u32 s56, 0
    s_cbranch_scc1 L_wn_32
    ds_read_b64_tr_b16 a[120:121], v32 offset:0
    ds_read_b64_tr_b16 a[122:123], v32 offset:256
    ds_read_b64_tr_b16 a[124:125], v32 offset:8192
    ds_read_b64_tr_b16 a[126:127], v32 offset:8448
    ds_read_b64_tr_b16 a[192:193], v32 offset:8
    ds_read_b64_tr_b16 a[194:195], v32 offset:264
    ds_read_b64_tr_b16 a[196:197], v32 offset:8200
    ds_read_b64_tr_b16 a[198:199], v32 offset:8456
    s_branch L_wv_31
L_wn_32:
    s_cmp_lg_u32 s56, 1
    s_cbranch_scc1 L_wn_33
    ds_read_b64_tr_b16 a[96:97], v32 offset:0
    ds_read_b64_tr_b16 a[98:99], v32 offset:256
    ds_read_b64_tr_b16 a[100:101], v32 offset:8192
    ds_read_b64_tr_b16 a[102:103], v32 offset:8448
    ds_read_b64_tr_b16 a[168:169], v32 offset:8
    ds_read_b64_tr_b16 a[170:171], v32 offset:264
    ds_read_b64_tr_b16 a[172:173], v32 offset:8200
    ds_read_b64_tr_b16 a[174:175], v32 offset:8456
    s_branch L_wv_31
L_wn_33:
    s_cmp_lg_u32 s56, 2
    s_cbranch_scc1 L_wn_34
    ds_read_b64_tr_b16 a[72:73], v32 offset:0
    ds_read_b64_tr_b16 a[74:75], v32 offset:256
    ds_read_b64_tr_b16 a[76:77], v32 offset:8192
    ds_read_b64_tr_b16 a[78:79], v32 offset:8448
    ds_read_b64_tr_b16 a[144:145], v32 offset:8
    ds_read_b64_tr_b16 a[146:147], v32 offset:264
    ds_read_b64_tr_b16 a[148:149], v32 offset:8200
    ds_read_b64_tr_b16 a[150:151], v32 offset:8456
    s_branch L_wv_31
L_wn_34:
    ds_read_b64_tr_b16 a[0:1], v32 offset:0
    ds_read_b64_tr_b16 a[2:3], v32 offset:256
    ds_read_b64_tr_b16 a[4:5], v32 offset:8192
    ds_read_b64_tr_b16 a[6:7], v32 offset:8448
    ds_read_b64_tr_b16 a[16:17], v32 offset:8
    ds_read_b64_tr_b16 a[18:19], v32 offset:264
    ds_read_b64_tr_b16 a[20:21], v32 offset:8200
    ds_read_b64_tr_b16 a[22:23], v32 offset:8456
L_wv_31:
    s_waitcnt lgkmcnt(0)
    s_barrier
    s_lshl_b32 s62, s56, 12
    s_add_u32 m0, s62, 131072
    s_mov_b32 s63, 65536
    buffer_load_dwordx4 v28, s[40:43], s63 offen lds
    s_lshl_b32 s62, s56, 12
    s_add_u32 m0, s62, 132096
    s_mov_b32 s63, 65536
    buffer_load_dwordx4 v29, s[40:43], s63 offen lds
    s_lshl_b32 s62, s56, 12
    s_add_u32 m0, s62, 133120
    s_mov_b32 s63, 65536
    buffer_load_dwordx4 v30, s[40:43], s63 offen lds
    s_lshl_b32 s62, s56, 12
    s_add_u32 m0, s62, 134144
    s_mov_b32 s63, 65536
    buffer_load_dwordx4 v31, s[40:43], s63 offen lds
    s_waitcnt vmcnt(20)
    s_barrier
    s_cmp_lg_u32 s56, 0
    s_cbranch_scc1 L_wn_37
    ds_read_b64_tr_b16 a[136:137], v32 offset:16384
    ds_read_b64_tr_b16 a[138:139], v32 offset:16640
    ds_read_b64_tr_b16 a[140:141], v32 offset:24576
    ds_read_b64_tr_b16 a[142:143], v32 offset:24832
    ds_read_b64_tr_b16 a[208:209], v32 offset:16392
    ds_read_b64_tr_b16 a[210:211], v32 offset:16648
    ds_read_b64_tr_b16 a[212:213], v32 offset:24584
    ds_read_b64_tr_b16 a[214:215], v32 offset:24840
    s_branch L_wv_36
L_wn_37:
    s_cmp_lg_u32 s56, 1
    s_cbranch_scc1 L_wn_38
    ds_read_b64_tr_b16 a[112:113], v32 offset:16384
    ds_read_b64_tr_b16 a[114:115], v32 offset:16640
    ds_read_b64_tr_b16 a[116:117], v32 offset:24576
    ds_read_b64_tr_b16 a[118:119], v32 offset:24832
    ds_read_b64_tr_b16 a[184:185], v32 offset:16392
    ds_read_b64_tr_b16 a[186:187], v32 offset:16648
    ds_read_b64_tr_b16 a[188:189], v32 offset:24584
    ds_read_b64_tr_b16 a[190:191], v32 offset:24840
    s_branch L_wv_36
L_wn_38:
    s_cmp_lg_u32 s56, 2
    s_cbranch_scc1 L_wn_39
    ds_read_b64_tr_b16 a[88:89], v32 offset:16384
    ds_read_b64_tr_b16 a[90:91], v32 offset:16640
    ds_read_b64_tr_b16 a[92:93], v32 offset:24576
    ds_read_b64_tr_b16 a[94:95], v32 offset:24832
    ds_read_b64_tr_b16 a[160:161], v32 offset:16392
    ds_read_b64_tr_b16 a[162:163], v32 offset:16648
    ds_read_b64_tr_b16 a[164:165], v32 offset:24584
    ds_read_b64_tr_b16 a[166:167], v32 offset:24840
    s_branch L_wv_36
L_wn_39:
    ds_read_b64_tr_b16 a[40:41], v32 offset:16384
    ds_read_b64_tr_b16 a[42:43], v32 offset:16640
    ds_read_b64_tr_b16 a[44:45], v32 offset:24576
    ds_read_b64_tr_b16 a[46:47], v32 offset:24832
    ds_read_b64_tr_b16 a[48:49], v32 offset:16392
    ds_read_b64_tr_b16 a[50:51], v32 offset:16648
    ds_read_b64_tr_b16 a[52:53], v32 offset:24584
    ds_read_b64_tr_b16 a[54:55], v32 offset:24840
L_wv_36:
    s_waitcnt lgkmcnt(0)
    s_barrier
    s_lshl_b32 s62, s56, 12
    s_add_u32 m0, s62, 147456
    s_mov_b32 s63, 66048
    buffer_load_dwordx4 v28, s[40:43], s63 offen lds
    s_lshl_b32 s62, s56, 12
    s_add_u32 m0, s62, 148480
    s_mov_b32 s63, 66048
    buffer_load_dwordx4 v29, s[40:43], s63 offen lds
    s_lshl_b32 s62, s56, 12
    s_add_u32 m0, s62, 149504
    s_mov_b32 s63, 66048
    buffer_load_dwordx4 v30, s[40:43], s63 offen lds
    s_lshl_b32 s62, s56, 12
    s_add_u32 m0, s62, 150528
    s_mov_b32 s63, 66048
    buffer_load_dwordx4 v31, s[40:43], s63 offen lds
    s_waitcnt vmcnt(20)
    s_barrier
    s_lshr_b32 s62, s56, 1
    s_cmp_lg_u32 s62, 0
    s_cbranch_scc1 L_wskip_41
    ds_read_b64_tr_b16 v[168:169], v78 offset:0
    ds_read_b64_tr_b16 v[170:171], v78 offset:512
    ds_read_b64_tr_b16 v[172:173], v78 offset:8192
    ds_read_b64_tr_b16 v[174:175], v78 offset:8704
    ds_read_b64_tr_b16 v[176:177], v78 offset:8
    ds_read_b64_tr_b16 v[178:179], v78 offset:520
    ds_read_b64_tr_b16 v[180:181], v78 offset:8200
    ds_read_b64_tr_b16 v[182:183], v78 offset:8712
    ds_read_b64_tr_b16 v[56:57], v80 offset:0
    ds_read_b64_tr_b16 v[58:59], v80 offset:512
    ds_read_b64_tr_b16 v[60:61], v80 offset:8192
    ds_read_b64_tr_b16 v[62:63], v80 offset:8704
    ds_read_b64_tr_b16 v[200:201], v80 offset:8
    ds_read_b64_tr_b16 v[202:203], v80 offset:520
    ds_read_b64_tr_b16 v[204:205], v80 offset:8200
    ds_read_b64_tr_b16 v[206:207], v80 offset:8712
    s_waitcnt lgkmcnt(0)
    ds_write_b128 v9, v[56:59] offset:24576
    ds_write_b128 v9, v[60:63] offset:25600
L_wskip_41:
    s_barrier
    s_lshl_b32 s62, s56, 12
    s_add_u32 m0, s62, 0
    s_mov_b32 s63, 65664
    buffer_load_dwordx4 v28, s[40:43], s63 offen lds
    s_lshl_b32 s62, s56, 12
    s_add_u32 m0, s62, 1024
    s_mov_b32 s63, 65664
    buffer_load_dwordx4 v29, s[40:43], s63 offen lds
    s_lshl_b32 s62, s56, 12
    s_add_u32 m0, s62, 2048
    s_mov_b32 s63, 65664
    buffer_load_dwordx4 v30, s[40:43], s63 offen lds
    s_lshl_b32 s62, s56, 12
    s_add_u32 m0, s62, 3072
    s_mov_b32 s63, 65664
    buffer_load_dwordx4 v31, s[40:43], s63 offen lds
    s_waitcnt vmcnt(20)
    s_barrier
    s_lshr_b32 s62, s56, 1
    s_cmp_lg_u32 s62, 1
    s_cbranch_scc1 L_wskip_42
    ds_read_b64_tr_b16 v[168:169], v78 offset:32768
    ds_read_b64_tr_b16 v[170:171], v78 offset:33280
    ds_read_b64_tr_b16 v[172:173], v78 offset:40960
    ds_read_b64_tr_b16 v[174:175], v78 offset:41472
    ds_read_b64_tr_b16 v[176:177], v78 offset:32776
    ds_read_b64_tr_b16 v[178:179], v78 offset:33288
    ds_read_b64_tr_b16 v[180:181], v78 offset:40968
    ds_read_b64_tr_b16 v[182:183], v78 offset:41480
    ds_read_b64_tr_b16 v[56:57], v80 offset:32768
    ds_read_b64_tr_b16 v[58:59], v80 offset:33280
    ds_read_b64_tr_b16 v[60:61], v80 offset:40960
    ds_read_b64_tr_b16 v[62:63], v80 offset:41472
    ds_read_b64_tr_b16 v[200:201], v80 offset:32776
    ds_read_b64_tr_b16 v[202:203], v80 offset:33288
    ds_read_b64_tr_b16 v[204:205], v80 offset:40968
    ds_read_b64_tr_b16 v[206:207], v80 offset:41480
    s_waitcnt lgkmcnt(0)
    ds_write_b128 v9, v[56:59] offset:24576
    ds_write_b128 v9, v[60:63] offset:25600
L_wskip_42:
    s_barrier
    s_lshl_b32 s62, s56, 12
    s_add_u32 m0, s62, 32768
    s_mov_b32 s63, 66176
    buffer_load_dwordx4 v28, s[40:43], s63 offen lds
    s_lshl_b32 s62, s56, 12
    s_add_u32 m0, s62, 33792
    s_mov_b32 s63, 66176
    buffer_load_dwordx4 v29, s[40:43], s63 offen lds
    s_lshl_b32 s62, s56, 12
    s_add_u32 m0, s62, 34816
    s_mov_b32 s63, 66176
    buffer_load_dwordx4 v30, s[40:43], s63 offen lds
    s_lshl_b32 s62, s56, 12
    s_add_u32 m0, s62, 35840
    s_mov_b32 s63, 66176
    buffer_load_dwordx4 v31, s[40:43], s63 offen lds
    s_waitcnt vmcnt(20)
    s_barrier
    s_lshr_b32 s62, s56, 1
    s_cmp_lg_u32 s62, 0
    s_cbranch_scc1 L_wskip_43
    ds_read_b64_tr_b16 v[208:209], v79 offset:0
    ds_read_b64_tr_b16 v[210:211], v79 offset:512
    ds_read_b64_tr_b16 v[212:213], v79 offset:8192
    ds_read_b64_tr_b16 v[214:215], v79 offset:8704
    ds_read_b64_tr_b16 v[48:49], v79 offset:8
    ds_read_b64_tr_b16 v[50:51], v79 offset:520
    ds_read_b64_tr_b16 v[52:53], v79 offset:8200
    ds_read_b64_tr_b16 v[54:55], v79 offset:8712
    ds_read_b64_tr_b16 v[232:233], v81 offset:0
    ds_read_b64_tr_b16 v[234:235], v81 offset:512
    ds_read_b64_tr_b16 v[236:237], v81 offset:8192
    ds_read_b64_tr_b16 v[238:239], v81 offset:8704
    ds_read_b64_tr_b16 v[240:241], v81 offset:8
    ds_read_b64_tr_b16 v[242:243], v81 offset:520
    ds_read_b64_tr_b16 v[244:245], v81 offset:8200
    ds_read_b64_tr_b16 v[246:247], v81 offset:8712
    s_waitcnt lgkmcnt(0)
    ds_write_b128 v9, v[48:51] offset:28672
    ds_write_b128 v9, v[52:55] offset:29696
L_wskip_43:
    s_barrier
    s_lshl_b32 s62, s56, 12
    s_add_u32 m0, s62, 65536
    s_mov_b32 s63, 0
    buffer_load_dwordx4 v24, s[36:39], s63 offen lds
    s_lshl_b32 s62, s56, 12
    s_add_u32 m0, s62, 66560
    s_mov_b32 s63, 0
    buffer_load_dwordx4 v25, s[36:39], s63 offen lds
    s_lshl_b32 s62, s56, 12
    s_add_u32 m0, s62, 67584
    s_mov_b32 s63, 0
    buffer_load_dwordx4 v26, s[36:39], s63 offen lds
    s_lshl_b32 s62, s56, 12
    s_add_u32 m0, s62, 68608
    s_mov_b32 s63, 0
    buffer_load_dwordx4 v27, s[36:39], s63 offen lds
    s_waitcnt vmcnt(20)
    s_barrier
    s_lshr_b32 s62, s56, 1
    s_cmp_lg_u32 s62, 1
    s_cbranch_scc1 L_wskip_44
    ds_read_b64_tr_b16 v[208:209], v79 offset:32768
    ds_read_b64_tr_b16 v[210:211], v79 offset:33280
    ds_read_b64_tr_b16 v[212:213], v79 offset:40960
    ds_read_b64_tr_b16 v[214:215], v79 offset:41472
    ds_read_b64_tr_b16 v[48:49], v79 offset:32776
    ds_read_b64_tr_b16 v[50:51], v79 offset:33288
    ds_read_b64_tr_b16 v[52:53], v79 offset:40968
    ds_read_b64_tr_b16 v[54:55], v79 offset:41480
    ds_read_b64_tr_b16 v[232:233], v81 offset:32768
    ds_read_b64_tr_b16 v[234:235], v81 offset:33280
    ds_read_b64_tr_b16 v[236:237], v81 offset:40960
    ds_read_b64_tr_b16 v[238:239], v81 offset:41472
    ds_read_b64_tr_b16 v[240:241], v81 offset:32776
    ds_read_b64_tr_b16 v[242:243], v81 offset:33288
    ds_read_b64_tr_b16 v[244:245], v81 offset:40968
    ds_read_b64_tr_b16 v[246:247], v81 offset:41480
    s_waitcnt lgkmcnt(0)
    ds_write_b128 v9, v[48:51] offset:28672
    ds_write_b128 v9, v[52:55] offset:29696
L_wskip_44:
    s_barrier
    s_lshl_b32 s62, s56, 12
    s_add_u32 m0, s62, 98304
    s_mov_b32 s63, 524288
    buffer_load_dwordx4 v24, s[36:39], s63 offen lds
    s_lshl_b32 s62, s56, 12
    s_add_u32 m0, s62, 99328
    s_mov_b32 s63, 524288
    buffer_load_dwordx4 v25, s[36:39], s63 offen lds
    s_lshl_b32 s62, s56, 12
    s_add_u32 m0, s62, 100352
    s_mov_b32 s63, 524288
    buffer_load_dwordx4 v26, s[36:39], s63 offen lds
    s_lshl_b32 s62, s56, 12
    s_add_u32 m0, s62, 101376
    s_mov_b32 s63, 524288
    buffer_load_dwordx4 v27, s[36:39], s63 offen lds
    s_waitcnt vmcnt(20)
    s_barrier
    s_lshr_b32 s62, s56, 1
    s_cmp_lg_u32 s62, 0
    s_cbranch_scc1 L_wskip_45
    ds_read_b64_tr_b16 v[40:41], v33 offset:0
    ds_read_b64_tr_b16 v[42:43], v33 offset:512
    ds_read_b64_tr_b16 v[44:45], v33 offset:8192
    ds_read_b64_tr_b16 v[46:47], v33 offset:8704
    ds_read_b64_tr_b16 v[184:185], v33 offset:8
    ds_read_b64_tr_b16 v[186:187], v33 offset:520
    ds_read_b64_tr_b16 v[188:189], v33 offset:8200
    ds_read_b64_tr_b16 v[190:191], v33 offset:8712
    ds_read_b64_tr_b16 v[192:193], v34 offset:0
    ds_read_b64_tr_b16 v[194:195], v34 offset:512
    ds_read_b64_tr_b16 v[196:197], v34 offset:8192
    ds_read_b64_tr_b16 v[198:199], v34 offset:8704
    ds_read_b64_tr_b16 v[64:65], v34 offset:8
    ds_read_b64_tr_b16 v[66:67], v34 offset:520
    ds_read_b64_tr_b16 v[68:69], v34 offset:8200
    ds_read_b64_tr_b16 v[70:71], v34 offset:8712
    s_waitcnt lgkmcnt(0)
    ds_write_b128 v9, v[40:43] offset:22528
    ds_write_b128 v9, v[44:47] offset:23552
    ds_write_b128 v9, v[64:67] offset:26624
    ds_write_b128 v9, v[68:71] offset:27648
L_wskip_45:
    s_barrier
    s_lshl_b32 s62, s56, 12
    s_add_u32 m0, s62, 131072
    s_mov_b32 s63, 1048576
    buffer_load_dwordx4 v24, s[36:39], s63 offen lds
    s_lshl_b32 s62, s56, 12
    s_add_u32 m0, s62, 132096
    s_mov_b32 s63, 1048576
    buffer_load_dwordx4 v25, s[36:39], s63 offen lds
    s_lshl_b32 s62, s56, 12
    s_add_u32 m0, s62, 133120
    s_mov_b32 s63, 1048576
    buffer_load_dwordx4 v26, s[36:39], s63 offen lds
    s_lshl_b32 s62, s56, 12
    s_add_u32 m0, s62, 134144
    s_mov_b32 s63, 1048576
    buffer_load_dwordx4 v27, s[36:39], s63 offen lds
    s_waitcnt vmcnt(20)
    s_barrier
    s_lshr_b32 s62, s56, 1
    s_cmp_lg_u32 s62, 1
    s_cbranch_scc1 L_wskip_46
    ds_read_b64_tr_b16 v[40:41], v33 offset:16384
    ds_read_b64_tr_b16 v[42:43], v33 offset:16896
    ds_read_b64_tr_b16 v[44:45], v33 offset:24576
    ds_read_b64_tr_b16 v[46:47], v33 offset:25088
    ds_read_b64_tr_b16 v[184:185], v33 offset:16392
    ds_read_b64_tr_b16 v[186:187], v33 offset:16904
    ds_read_b64_tr_b16 v[188:189], v33 offset:24584
    ds_read_b64_tr_b16 v[190:191], v33 offset:25096
    ds_read_b64_tr_b16 v[192:193], v34 offset:16384
    ds_read_b64_tr_b16 v[194:195], v34 offset:16896
    ds_read_b64_tr_b16 v[196:197], v34 offset:24576
    ds_read_b64_tr_b16 v[198:199], v34 offset:25088
    ds_read_b64_tr_b16 v[64:65], v34 offset:16392
    ds_read_b64_tr_b16 v[66:67], v34 offset:16904
    ds_read_b64_tr_b16 v[68:69], v34 offset:24584
    ds_read_b64_tr_b16 v[70:71], v34 offset:25096
    s_waitcnt lgkmcnt(0)
    ds_write_b128 v9, v[40:43] offset:22528
    ds_write_b128 v9, v[44:47] offset:23552
    ds_write_b128 v9, v[64:67] offset:26624
    ds_write_b128 v9, v[68:71] offset:27648
L_wskip_46:
    s_barrier
    s_lshl_b32 s62, s56, 12
    s_add_u32 m0, s62, 147456
    s_mov_b32 s63, 1572864
    buffer_load_dwordx4 v24, s[36:39], s63 offen lds
    s_lshl_b32 s62, s56, 12
    s_add_u32 m0, s62, 148480
    s_mov_b32 s63, 1572864
    buffer_load_dwordx4 v25, s[36:39], s63 offen lds
    s_lshl_b32 s62, s56, 12
    s_add_u32 m0, s62, 149504
    s_mov_b32 s63, 1572864
    buffer_load_dwordx4 v26, s[36:39], s63 offen lds
    s_lshl_b32 s62, s56, 12
    s_add_u32 m0, s62, 150528
    s_mov_b32 s63, 1572864
    buffer_load_dwordx4 v27, s[36:39], s63 offen lds
    s_waitcnt vmcnt(20)
    s_barrier
    s_lshr_b32 s62, s56, 1
    s_cmp_lg_u32 s62, 0
    s_cbranch_scc1 L_wskip_47
    ds_read_b64_tr_b16 v[216:217], v78 offset:0
    ds_read_b64_tr_b16 v[218:219], v78 offset:512
    ds_read_b64_tr_b16 v[220:221], v78 offset:8192
    ds_read_b64_tr_b16 v[222:223], v78 offset:8704
    ds_read_b64_tr_b16 v[224:225], v78 offset:8
    ds_read_b64_tr_b16 v[226:227], v78 offset:520
    ds_read_b64_tr_b16 v[228:229], v78 offset:8200
    ds_read_b64_tr_b16 v[230:231], v78 offset:8712
    ds_read_b64_tr_b16 v[56:57], v80 offset:0
    ds_read_b64_tr_b16 v[58:59], v80 offset:512
    ds_read_b64_tr_b16 v[60:61], v80 offset:8192
    ds_read_b64_tr_b16 v[62:63], v80 offset:8704
    ds_read_b64_tr_b16 v[248:249], v80 offset:8
    ds_read_b64_tr_b16 v[250:251], v80 offset:520
    ds_read_b64_tr_b16 v[252:253], v80 offset:8200
    ds_read_b64_tr_b16 v[254:255], v80 offset:8712
    s_waitcnt lgkmcnt(0)
    ds_write_b128 v9, v[56:59] offset:30720
    ds_write_b128 v9, v[60:63] offset:31744
L_wskip_47:
    s_barrier
    s_lshl_b32 s62, s56, 12
    s_add_u32 m0, s62, 0
    s_mov_b32 s63, 2097152
    buffer_load_dwordx4 v24, s[36:39], s63 offen lds
    s_lshl_b32 s62, s56, 12
    s_add_u32 m0, s62, 1024
    s_mov_b32 s63, 2097152
    buffer_load_dwordx4 v25, s[36:39], s63 offen lds
    s_lshl_b32 s62, s56, 12
    s_add_u32 m0, s62, 2048
    s_mov_b32 s63, 2097152
    buffer_load_dwordx4 v26, s[36:39], s63 offen lds
    s_lshl_b32 s62, s56, 12
    s_add_u32 m0, s62, 3072
    s_mov_b32 s63, 2097152
    buffer_load_dwordx4 v27, s[36:39], s63 offen lds
    s_waitcnt vmcnt(20)
    s_barrier
    s_lshr_b32 s62, s56, 1
    s_cmp_lg_u32 s62, 1
    s_cbranch_scc1 L_wskip_48
    ds_read_b64_tr_b16 v[216:217], v78 offset:32768
    ds_read_b64_tr_b16 v[218:219], v78 offset:33280
    ds_read_b64_tr_b16 v[220:221], v78 offset:40960
    ds_read_b64_tr_b16 v[222:223], v78 offset:41472
    ds_read_b64_tr_b16 v[224:225], v78 offset:32776
    ds_read_b64_tr_b16 v[226:227], v78 offset:33288
    ds_read_b64_tr_b16 v[228:229], v78 offset:40968
    ds_read_b64_tr_b16 v[230:231], v78 offset:41480
    ds_read_b64_tr_b16 v[56:57], v80 offset:32768
    ds_read_b64_tr_b16 v[58:59], v80 offset:33280
    ds_read_b64_tr_b16 v[60:61], v80 offset:40960
    ds_read_b64_tr_b16 v[62:63], v80 offset:41472
    ds_read_b64_tr_b16 v[248:249], v80 offset:32776
    ds_read_b64_tr_b16 v[250:251], v80 offset:33288
    ds_read_b64_tr_b16 v[252:253], v80 offset:40968
    ds_read_b64_tr_b16 v[254:255], v80 offset:41480
    s_waitcnt lgkmcnt(0)
    ds_write_b128 v9, v[56:59] offset:30720
    ds_write_b128 v9, v[60:63] offset:31744
L_wskip_48:
    s_barrier
    s_lshl_b32 s62, s56, 12
    s_add_u32 m0, s62, 32768
    s_mov_b32 s63, 2621440
    buffer_load_dwordx4 v24, s[36:39], s63 offen lds
    s_lshl_b32 s62, s56, 12
    s_add_u32 m0, s62, 33792
    s_mov_b32 s63, 2621440
    buffer_load_dwordx4 v25, s[36:39], s63 offen lds
    s_lshl_b32 s62, s56, 12
    s_add_u32 m0, s62, 34816
    s_mov_b32 s63, 2621440
    buffer_load_dwordx4 v26, s[36:39], s63 offen lds
    s_lshl_b32 s62, s56, 12
    s_add_u32 m0, s62, 35840
    s_mov_b32 s63, 2621440
    buffer_load_dwordx4 v27, s[36:39], s63 offen lds
    s_waitcnt vmcnt(20)
    s_barrier
    s_cmp_lg_u32 s56, 0
    s_cbranch_scc1 L_wn_50
    ds_read_b64_tr_b16 a[24:25], v77 offset:0
    ds_read_b64_tr_b16 a[26:27], v77 offset:256
    ds_read_b64_tr_b16 a[28:29], v77 offset:8192
    ds_read_b64_tr_b16 a[30:31], v77 offset:8448
    ds_read_b64_tr_b16 a[32:33], v77 offset:8
    ds_read_b64_tr_b16 a[34:35], v77 offset:264
    ds_read_b64_tr_b16 a[36:37], v77 offset:8200
    ds_read_b64_tr_b16 a[38:39], v77 offset:8456
    s_branch L_wv_49
L_wn_50:
    s_cmp_lg_u32 s56, 1
    s_cbranch_scc1 L_wn_51
    ds_read_b64_tr_b16 v[136:137], v77 offset:0
    ds_read_b64_tr_b16 v[138:139], v77 offset:256
    ds_read_b64_tr_b16 v[140:141], v77 offset:8192
    ds_read_b64_tr_b16 v[142:143], v77 offset:8448
    ds_read_b64_tr_b16 v[144:145], v77 offset:8
    ds_read_b64_tr_b16 v[146:147], v77 offset:264
    ds_read_b64_tr_b16 v[148:149], v77 offset:8200
    ds_read_b64_tr_b16 v[150:151], v77 offset:8456
    s_branch L_wv_49
L_wn_51:
    s_cmp_lg_u32 s56, 2
    s_cbranch_scc1 L_wn_52
    ds_read_b64_tr_b16 a[232:233], v77 offset:0
    ds_read_b64_tr_b16 a[234:235], v77 offset:256
    ds_read_b64_tr_b16 a[236:237], v77 offset:8192
    ds_read_b64_tr_b16 a[238:239], v77 offset:8448
    ds_read_b64_tr_b16 a[240:241], v77 offset:8
    ds_read_b64_tr_b16 a[242:243], v77 offset:264
    ds_read_b64_tr_b16 a[244:245], v77 offset:8200
    ds_read_b64_tr_b16 a[246:247], v77 offset:8456
    s_branch L_wv_49
L_wn_52:
    ds_read_b64_tr_b16 v[40:41], v77 offset:0
    ds_read_b64_tr_b16 v[42:43], v77 offset:256
    ds_read_b64_tr_b16 v[44:45], v77 offset:8192
    ds_read_b64_tr_b16 v[46:47], v77 offset:8448
    ds_read_b64_tr_b16 a[216:217], v77 offset:8
    ds_read_b64_tr_b16 a[218:219], v77 offset:264
    ds_read_b64_tr_b16 a[220:221], v77 offset:8200
    ds_read_b64_tr_b16 a[222:223], v77 offset:8456
    s_waitcnt lgkmcnt(0)
    ds_write_b128 v9, v[40:43] offset:18432
    ds_write_b128 v9, v[44:47] offset:19456
L_wv_49:
    s_waitcnt lgkmcnt(0)
    s_barrier
    s_lshl_b32 s62, s56, 12
    s_add_u32 m0, s62, 65536
    s_mov_b32 s63, 3145728
    buffer_load_dwordx4 v24, s[36:39], s63 offen lds
    s_lshl_b32 s62, s56, 12
    s_add_u32 m0, s62, 66560
    s_mov_b32 s63, 3145728
    buffer_load_dwordx4 v25, s[36:39], s63 offen lds
    s_lshl_b32 s62, s56, 12
    s_add_u32 m0, s62, 67584
    s_mov_b32 s63, 3145728
    buffer_load_dwordx4 v26, s[36:39], s63 offen lds
    s_lshl_b32 s62, s56, 12
    s_add_u32 m0, s62, 68608
    s_mov_b32 s63, 3145728
    buffer_load_dwordx4 v27, s[36:39], s63 offen lds
    s_waitcnt vmcnt(20)
    s_barrier
    s_cmp_lg_u32 s56, 0
    s_cbranch_scc1 L_wn_55
    ds_read_b64_tr_b16 a[64:65], v77 offset:32768
    ds_read_b64_tr_b16 a[66:67], v77 offset:33024
    ds_read_b64_tr_b16 a[68:69], v77 offset:40960
    ds_read_b64_tr_b16 a[70:71], v77 offset:41216
    ds_read_b64_tr_b16 v[48:49], v77 offset:32776
    ds_read_b64_tr_b16 v[50:51], v77 offset:33032
    ds_read_b64_tr_b16 v[52:53], v77 offset:40968
    ds_read_b64_tr_b16 v[54:55], v77 offset:41224
    s_waitcnt lgkmcnt(0)
    ds_write_b128 v9, v[48:51] offset:16384
    ds_write_b128 v9, v[52:55] offset:17408
    s_branch L_wv_54
L_wn_55:
    s_cmp_lg_u32 s56, 1
    s_cbranch_scc1 L_wn_56
    ds_read_b64_tr_b16 v[152:153], v77 offset:32768
    ds_read_b64_tr_b16 v[154:155], v77 offset:33024
    ds_read_b64_tr_b16 v[156:157], v77 offset:40960
    ds_read_b64_tr_b16 v[158:159], v77 offset:41216
    ds_read_b64_tr_b16 v[160:161], v77 offset:32776
    ds_read_b64_tr_b16 v[162:163], v77 offset:33032
    ds_read_b64_tr_b16 v[164:165], v77 offset:40968
    ds_read_b64_tr_b16 v[166:167], v77 offset:41224
    s_branch L_wv_54
L_wn_56:
    s_cmp_lg_u32 s56, 2
    s_cbranch_scc1 L_wn_57
    ds_read_b64_tr_b16 a[248:249], v77 offset:32768
    ds_read_b64_tr_b16 a[250:251], v77 offset:33024
    ds_read_b64_tr_b16 a[252:253], v77 offset:40960
    ds_read_b64_tr_b16 a[254:255], v77 offset:41216
    ds_read_b64_tr_b16 v[128:129], v77 offset:32776
    ds_read_b64_tr_b16 v[130:131], v77 offset:33032
    ds_read_b64_tr_b16 v[132:133], v77 offset:40968
    ds_read_b64_tr_b16 v[134:135], v77 offset:41224
    s_branch L_wv_54
L_wn_57:
    ds_read_b64_tr_b16 v[40:41], v77 offset:32768
    ds_read_b64_tr_b16 v[42:43], v77 offset:33024
    ds_read_b64_tr_b16 v[44:45], v77 offset:40960
    ds_read_b64_tr_b16 v[46:47], v77 offset:41216
    ds_read_b64_tr_b16 a[224:225], v77 offset:32776
    ds_read_b64_tr_b16 a[226:227], v77 offset:33032
    ds_read_b64_tr_b16 a[228:229], v77 offset:40968
    ds_read_b64_tr_b16 a[230:231], v77 offset:41224
    s_waitcnt lgkmcnt(0)
    ds_write_b128 v9, v[40:43] offset:20480
    ds_write_b128 v9, v[44:47] offset:21504
L_wv_54:
    s_waitcnt lgkmcnt(0)
    s_barrier
    s_lshl_b32 s62, s56, 12
    s_add_u32 m0, s62, 98304
    s_mov_b32 s63, 3670016
    buffer_load_dwordx4 v24, s[36:39], s63 offen lds
    s_lshl_b32 s62, s56, 12
    s_add_u32 m0, s62, 99328
    s_mov_b32 s63, 3670016
    buffer_load_dwordx4 v25, s[36:39], s63 offen lds
    s_lshl_b32 s62, s56, 12
    s_add_u32 m0, s62, 100352
    s_mov_b32 s63, 3670016
    buffer_load_dwordx4 v26, s[36:39], s63 offen lds
    s_lshl_b32 s62, s56, 12
    s_add_u32 m0, s62, 101376
    s_mov_b32 s63, 3670016
    buffer_load_dwordx4 v27, s[36:39], s63 offen lds
    s_waitcnt vmcnt(20)
    s_barrier
    s_cmp_lg_u32 s56, 0
    s_cbranch_scc1 L_wn_60
    ds_read_b64_tr_b16 v[40:41], v32 offset:0
    ds_read_b64_tr_b16 v[42:43], v32 offset:256
    ds_read_b64_tr_b16 v[44:45], v32 offset:8192
    ds_read_b64_tr_b16 v[46:47], v32 offset:8448
    ds_read_b64_tr_b16 a[216:217], v32 offset:8
    ds_read_b64_tr_b16 a[218:219], v32 offset:264
    ds_read_b64_tr_b16 a[220:221], v32 offset:8200
    ds_read_b64_tr_b16 a[222:223], v32 offset:8456
    s_waitcnt lgkmcnt(0)
    ds_write_b128 v9, v[40:43] offset:18432
    ds_write_b128 v9, v[44:47] offset:19456
    s_branch L_wv_59
L_wn_60:
    s_cmp_lg_u32 s56, 1
    s_cbranch_scc1 L_wn_61
    ds_read_b64_tr_b16 a[24:25], v32 offset:0
    ds_read_b64_tr_b16 a[26:27], v32 offset:256
    ds_read_b64_tr_b16 a[28:29], v32 offset:8192
    ds_read_b64_tr_b16 a[30:31], v32 offset:8448
    ds_read_b64_tr_b16 a[32:33], v32 offset:8
    ds_read_b64_tr_b16 a[34:35], v32 offset:264
    ds_read_b64_tr_b16 a[36:37], v32 offset:8200
    ds_read_b64_tr_b16 a[38:39], v32 offset:8456
    s_branch L_wv_59
L_wn_61:
    s_cmp_lg_u32 s56, 2
    s_cbranch_scc1 L_wn_62
    ds_read_b64_tr_b16 v[136:137], v32 offset:0
    ds_read_b64_tr_b16 v[138:139], v32 offset:256
    ds_read_b64_tr_b16 v[140:141], v32 offset:8192
    ds_read_b64_tr_b16 v[142:143], v32 offset:8448
    ds_read_b64_tr_b16 v[144:145], v32 offset:8
    ds_read_b64_tr_b16 v[146:147], v32 offset:264
    ds_read_b64_tr_b16 v[148:149], v32 offset:8200
    ds_read_b64_tr_b16 v[150:151], v32 offset:8456
    s_branch L_wv_59
L_wn_62:
    ds_read_b64_tr_b16 a[232:233], v32 offset:0
    ds_read_b64_tr_b16 a[234:235], v32 offset:256
    ds_read_b64_tr_b16 a[236:237], v32 offset:8192
    ds_read_b64_tr_b16 a[238:239], v32 offset:8448
    ds_read_b64_tr_b16 a[240:241], v32 offset:8
    ds_read_b64_tr_b16 a[242:243], v32 offset:264
    ds_read_b64_tr_b16 a[244:245], v32 offset:8200
    ds_read_b64_tr_b16 a[246:247], v32 offset:8456
L_wv_59:
    s_waitcnt lgkmcnt(0)
    s_barrier
    s_lshl_b32 s62, s56, 12
    s_add_u32 m0, s62, 131072
    s_mov_b32 s63, 0
    buffer_load_dwordx4 v24, s[28:31], s63 offen lds
    s_lshl_b32 s62, s56, 12
    s_add_u32 m0, s62, 132096
    s_mov_b32 s63, 0
    buffer_load_dwordx4 v25, s[28:31], s63 offen lds
    s_lshl_b32 s62, s56, 12
    s_add_u32 m0, s62, 133120
    s_mov_b32 s63, 0
    buffer_load_dwordx4 v26, s[28:31], s63 offen lds
    s_lshl_b32 s62, s56, 12
    s_add_u32 m0, s62, 134144
    s_mov_b32 s63, 0
    buffer_load_dwordx4 v27, s[28:31], s63 offen lds
    s_waitcnt vmcnt(20)
    s_barrier
    s_cmp_lg_u32 s56, 0
    s_cbranch_scc1 L_wn_65
    ds_read_b64_tr_b16 v[40:41], v32 offset:16384
    ds_read_b64_tr_b16 v[42:43], v32 offset:16640
    ds_read_b64_tr_b16 v[44:45], v32 offset:24576
    ds_read_b64_tr_b16 v[46:47], v32 offset:24832
    ds_read_b64_tr_b16 a[224:225], v32 offset:16392
    ds_read_b64_tr_b16 a[226:227], v32 offset:16648
    ds_read_b64_tr_b16 a[228:229], v32 offset:24584
    ds_read_b64_tr_b16 a[230:231], v32 offset:24840
    s_waitcnt lgkmcnt(0)
    ds_write_b128 v9, v[40:43] offset:20480
    ds_write_b128 v9, v[44:47] offset:21504
    s_branch L_wv_64
L_wn_65:
    s_cmp_lg_u32 s56, 1
    s_cbranch_scc1 L_wn_66
    ds_read_b64_tr_b16 a[64:65], v32 offset:16384
    ds_read_b64_tr_b16 a[66:67], v32 offset:16640
    ds_read_b64_tr_b16 a[68:69], v32 offset:24576
    ds_read_b64_tr_b16 a[70:71], v32 offset:24832
    ds_read_b64_tr_b16 v[48:49], v32 offset:16392
    ds_read_b64_tr_b16 v[50:51], v32 offset:16648
    ds_read_b64_tr_b16 v[52:53], v32 offset:24584
    ds_read_b64_tr_b16 v[54:55], v32 offset:24840
    s_waitcnt lgkmcnt(0)
    ds_write_b128 v9, v[48:51] offset:16384
    ds_write_b128 v9, v[52:55] offset:17408
    s_branch L_wv_64
L_wn_66:
    s_cmp_lg_u32 s56, 2
    s_cbranch_scc1 L_wn_67
    ds_read_b64_tr_b16 v[152:153], v32 offset:16384
    ds_read_b64_tr_b16 v[154:155], v32 offset:16640
    ds_read_b64_tr_b16 v[156:157], v32 offset:24576
    ds_read_b64_tr_b16 v[158:159], v32 offset:24832
    ds_read_b64_tr_b16 v[160:161], v32 offset:16392
    ds_read_b64_tr_b16 v[162:163], v32 offset:16648
    ds_read_b64_tr_b16 v[164:165], v32 offset:24584
    ds_read_b64_tr_b16 v[166:167], v32 offset:24840
    s_branch L_wv_64
L_wn_67:
    ds_read_b64_tr_b16 a[248:249], v32 offset:16384
    ds_read_b64_tr_b16 a[250:251], v32 offset:16640
    ds_read_b64_tr_b16 a[252:253], v32 offset:24576
    ds_read_b64_tr_b16 a[254:255], v32 offset:24832
    ds_read_b64_tr_b16 v[128:129], v32 offset:16392
    ds_read_b64_tr_b16 v[130:131], v32 offset:16648
    ds_read_b64_tr_b16 v[132:133], v32 offset:24584
    ds_read_b64_tr_b16 v[134:135], v32 offset:24840
L_wv_64:
    s_waitcnt lgkmcnt(0)
    s_barrier
    s_lshl_b32 s62, s56, 12
    s_add_u32 m0, s62, 147456
    s_mov_b32 s63, 524288
    buffer_load_dwordx4 v24, s[28:31], s63 offen lds
    s_lshl_b32 s62, s56, 12
    s_add_u32 m0, s62, 148480
    s_mov_b32 s63, 524288
    buffer_load_dwordx4 v25, s[28:31], s63 offen lds
    s_lshl_b32 s62, s56, 12
    s_add_u32 m0, s62, 149504
    s_mov_b32 s63, 524288
    buffer_load_dwordx4 v26, s[28:31], s63 offen lds
    s_lshl_b32 s62, s56, 12
    s_add_u32 m0, s62, 150528
    s_mov_b32 s63, 524288
    buffer_load_dwordx4 v27, s[28:31], s63 offen lds
    s_waitcnt vmcnt(20)
    s_barrier
    s_cmp_lg_u32 s56, 0
    s_cbranch_scc1 L_wn_70
    ds_read_b64_tr_b16 a[232:233], v76 offset:0
    ds_read_b64_tr_b16 a[234:235], v76 offset:256
    ds_read_b64_tr_b16 a[236:237], v76 offset:8192
    ds_read_b64_tr_b16 a[238:239], v76 offset:8448
    ds_read_b64_tr_b16 a[240:241], v76 offset:8
    ds_read_b64_tr_b16 a[242:243], v76 offset:264
    ds_read_b64_tr_b16 a[244:245], v76 offset:8200
    ds_read_b64_tr_b16 a[246:247], v76 offset:8456
    s_branch L_wv_69
L_wn_70:
    s_cmp_lg_u32 s56, 1
    s_cbranch_scc1 L_wn_71
    ds_read_b64_tr_b16 v[40:41], v76 offset:0
    ds_read_b64_tr_b16 v[42:43], v76 offset:256
    ds_read_b64_tr_b16 v[44:45], v76 offset:8192
    ds_read_b64_tr_b16 v[46:47], v76 offset:8448
    ds_read_b64_tr_b16 a[216:217], v76 offset:8
    ds_read_b64_tr_b16 a[218:219], v76 offset:264
    ds_read_b64_tr_b16 a[220:221], v76 offset:8200
    ds_read_b64_tr_b16 a[222:223], v76 offset:8456
    s_waitcnt lgkmcnt(0)
    ds_write_b128 v9, v[40:43] offset:18432
    ds_write_b128 v9, v[44:47] offset:19456
    s_branch L_wv_69
L_wn_71:
    s_cmp_lg_u32 s56, 2
    s_cbranch_scc1 L_wn_72
    ds_read_b64_tr_b16 a[24:25], v76 offset:0
    ds_read_b64_tr_b16 a[26:27], v76 offset:256
    ds_read_b64_tr_b16 a[28:29], v76 offset:8192
    ds_read_b64_tr_b16 a[30:31], v76 offset:8448
    ds_read_b64_tr_b16 a[32:33], v76 offset:8
    ds_read_b64_tr_b16 a[34:35], v76 offset:264
    ds_read_b64_tr_b16 a[36:37], v76 offset:8200
    ds_read_b64_tr_b16 a[38:39], v76 offset:8456
    s_branch L_wv_69
L_wn_72:
    ds_read_b64_tr_b16 v[136:137], v76 offset:0
    ds_read_b64_tr_b16 v[138:139], v76 offset:256
    ds_read_b64_tr_b16 v[140:141], v76 offset:8192
    ds_read_b64_tr_b16 v[142:143], v76 offset:8448
    ds_read_b64_tr_b16 v[144:145], v76 offset:8
    ds_read_b64_tr_b16 v[146:147], v76 offset:264
    ds_read_b64_tr_b16 v[148:149], v76 offset:8200
    ds_read_b64_tr_b16 v[150:151], v76 offset:8456
L_wv_69:
    s_waitcnt lgkmcnt(0)
    s_barrier
    s_waitcnt vmcnt(16)
    s_barrier
    s_cmp_lg_u32 s56, 0
    s_cbranch_scc1 L_wn_75
    ds_read_b64_tr_b16 a[248:249], v76 offset:32768
    ds_read_b64_tr_b16 a[250:251], v76 offset:33024
    ds_read_b64_tr_b16 a[252:253], v76 offset:40960
    ds_read_b64_tr_b16 a[254:255], v76 offset:41216
    ds_read_b64_tr_b16 v[128:129], v76 offset:32776
    ds_read_b64_tr_b16 v[130:131], v76 offset:33032
    ds_read_b64_tr_b16 v[132:133], v76 offset:40968
    ds_read_b64_tr_b16 v[134:135], v76 offset:41224
    s_branch L_wv_74
L_wn_75:
    s_cmp_lg_u32 s56, 1
    s_cbranch_scc1 L_wn_76
    ds_read_b64_tr_b16 v[40:41], v76 offset:32768
    ds_read_b64_tr_b16 v[42:43], v76 offset:33024
    ds_read_b64_tr_b16 v[44:45], v76 offset:40960
    ds_read_b64_tr_b16 v[46:47], v76 offset:41216
    ds_read_b64_tr_b16 a[224:225], v76 offset:32776
    ds_read_b64_tr_b16 a[226:227], v76 offset:33032
    ds_read_b64_tr_b16 a[228:229], v76 offset:40968
    ds_read_b64_tr_b16 a[230:231], v76 offset:41224
    s_waitcnt lgkmcnt(0)
    ds_write_b128 v9, v[40:43] offset:20480
    ds_write_b128 v9, v[44:47] offset:21504
    s_branch L_wv_74
L_wn_76:
    s_cmp_lg_u32 s56, 2
    s_cbranch_scc1 L_wn_77
    ds_read_b64_tr_b16 a[64:65], v76 offset:32768
    ds_read_b64_tr_b16 a[66:67], v76 offset:33024
    ds_read_b64_tr_b16 a[68:69], v76 offset:40960
    ds_read_b64_tr_b16 a[70:71], v76 offset:41216
    ds_read_b64_tr_b16 v[48:49], v76 offset:32776
    ds_read_b64_tr_b16 v[50:51], v76 offset:33032
    ds_read_b64_tr_b16 v[52:53], v76 offset:40968
    ds_read_b64_tr_b16 v[54:55], v76 offset:41224
    s_waitcnt lgkmcnt(0)
    ds_write_b128 v9, v[48:51] offset:16384
    ds_write_b128 v9, v[52:55] offset:17408
    s_branch L_wv_74
L_wn_77:
    ds_read_b64_tr_b16 v[152:153], v76 offset:32768
    ds_read_b64_tr_b16 v[154:155], v76 offset:33024
    ds_read_b64_tr_b16 v[156:157], v76 offset:40960
    ds_read_b64_tr_b16 v[158:159], v76 offset:41216
    ds_read_b64_tr_b16 v[160:161], v76 offset:32776
    ds_read_b64_tr_b16 v[162:163], v76 offset:33032
    ds_read_b64_tr_b16 v[164:165], v76 offset:40968
    ds_read_b64_tr_b16 v[166:167], v76 offset:41224
L_wv_74:
    s_waitcnt lgkmcnt(0)
    s_barrier
    s_waitcnt vmcnt(12)
    s_barrier
    s_cmp_lg_u32 s56, 0
    s_cbranch_scc1 L_wn_80
    ds_read_b64_tr_b16 v[136:137], v77 offset:0
    ds_read_b64_tr_b16 v[138:139], v77 offset:256
    ds_read_b64_tr_b16 v[140:141], v77 offset:8192
    ds_read_b64_tr_b16 v[142:143], v77 offset:8448
    ds_read_b64_tr_b16 v[144:145], v77 offset:8
    ds_read_b64_tr_b16 v[146:147], v77 offset:264
    ds_read_b64_tr_b16 v[148:149], v77 offset:8200
    ds_read_b64_tr_b16 v[150:151], v77 offset:8456
    s_branch L_wv_79
L_wn_80:
    s_cmp_lg_u32 s56, 1
    s_cbranch_scc1 L_wn_81
    ds_read_b64_tr_b16 a[232:233], v77 offset:0
    ds_read_b64_tr_b16 a[234:235], v77 offset:256
    ds_read_b64_tr_b16 a[236:237], v77 offset:8192
    ds_read_b64_tr_b16 a[238:239], v77 offset:8448
    ds_read_b64_tr_b16 a[240:241], v77 offset:8
    ds_read_b64_tr_b16 a[242:243], v77 offset:264
    ds_read_b64_tr_b16 a[244:245], v77 offset:8200
    ds_read_b64_tr_b16 a[246:247], v77 offset:8456
    s_branch L_wv_79
L_wn_81:
    s_cmp_lg_u32 s56, 2
    s_cbranch_scc1 L_wn_82
    ds_read_b64_tr_b16 v[40:41], v77 offset:0
    ds_read_b64_tr_b16 v[42:43], v77 offset:256
    ds_read_b64_tr_b16 v[44:45], v77 offset:8192
    ds_read_b64_tr_b16 v[46:47], v77 offset:8448
    ds_read_b64_tr_b16 a[216:217], v77 offset:8
    ds_read_b64_tr_b16 a[218:219], v77 offset:264
    ds_read_b64_tr_b16 a[220:221], v77 offset:8200
    ds_read_b64_tr_b16 a[222:223], v77 offset:8456
    s_waitcnt lgkmcnt(0)
    ds_write_b128 v9, v[40:43] offset:18432
    ds_write_b128 v9, v[44:47] offset:19456
    s_branch L_wv_79
L_wn_82:
    ds_read_b64_tr_b16 a[24:25], v77 offset:0
    ds_read_b64_tr_b16 a[26:27], v77 offset:256
    ds_read_b64_tr_b16 a[28:29], v77 offset:8192
    ds_read_b64_tr_b16 a[30:31], v77 offset:8448
    ds_read_b64_tr_b16 a[32:33], v77 offset:8
    ds_read_b64_tr_b16 a[34:35], v77 offset:264
    ds_read_b64_tr_b16 a[36:37], v77 offset:8200
    ds_read_b64_tr_b16 a[38:39], v77 offset:8456
L_wv_79:
    s_waitcnt lgkmcnt(0)
    s_barrier
    s_waitcnt vmcnt(8)
    s_barrier
    s_cmp_lg_u32 s56, 0
    s_cbranch_scc1 L_wn_85
    ds_read_b64_tr_b16 v[152:153], v77 offset:32768
    ds_read_b64_tr_b16 v[154:155], v77 offset:33024
    ds_read_b64_tr_b16 v[156:157], v77 offset:40960
    ds_read_b64_tr_b16 v[158:159], v77 offset:41216
    ds_read_b64_tr_b16 v[160:161], v77 offset:32776
    ds_read_b64_tr_b16 v[162:163], v77 offset:33032
    ds_read_b64_tr_b16 v[164:165], v77 offset:40968
    ds_read_b64_tr_b16 v[166:167], v77 offset:41224
    s_branch L_wv_84
L_wn_85:
    s_cmp_lg_u32 s56, 1
    s_cbranch_scc1 L_wn_86
    ds_read_b64_tr_b16 a[248:249], v77 offset:32768
    ds_read_b64_tr_b16 a[250:251], v77 offset:33024
    ds_read_b64_tr_b16 a[252:253], v77 offset:40960
    ds_read_b64_tr_b16 a[254:255], v77 offset:41216
    ds_read_b64_tr_b16 v[128:129], v77 offset:32776
    ds_read_b64_tr_b16 v[130:131], v77 offset:33032
    ds_read_b64_tr_b16 v[132:133], v77 offset:40968
    ds_read_b64_tr_b16 v[134:135], v77 offset:41224
    s_branch L_wv_84
L_wn_86:
    s_cmp_lg_u32 s56, 2
    s_cbranch_scc1 L_wn_87
    ds_read_b64_tr_b16 v[40:41], v77 offset:32768
    ds_read_b64_tr_b16 v[42:43], v77 offset:33024
    ds_read_b64_tr_b16 v[44:45], v77 offset:40960
    ds_read_b64_tr_b16 v[46:47], v77 offset:41216
    ds_read_b64_tr_b16 a[224:225], v77 offset:32776
    ds_read_b64_tr_b16 a[226:227], v77 offset:33032
    ds_read_b64_tr_b16 a[228:229], v77 offset:40968
    ds_read_b64_tr_b16 a[230:231], v77 offset:41224
    s_waitcnt lgkmcnt(0)
    ds_write_b128 v9, v[40:43] offset:20480
    ds_write_b128 v9, v[44:47] offset:21504
    s_branch L_wv_84
L_wn_87:
    ds_read_b64_tr_b16 a[64:65], v77 offset:32768
    ds_read_b64_tr_b16 a[66:67], v77 offset:33024
    ds_read_b64_tr_b16 a[68:69], v77 offset:40960
    ds_read_b64_tr_b16 a[70:71], v77 offset:41216
    ds_read_b64_tr_b16 v[48:49], v77 offset:32776
    ds_read_b64_tr_b16 v[50:51], v77 offset:33032
    ds_read_b64_tr_b16 v[52:53], v77 offset:40968
    ds_read_b64_tr_b16 v[54:55], v77 offset:41224
    s_waitcnt lgkmcnt(0)
    ds_write_b128 v9, v[48:51] offset:16384
    ds_write_b128 v9, v[52:55] offset:17408
L_wv_84:
    s_waitcnt lgkmcnt(0)
    s_barrier
    v_mov_b32 v122, 0
L_res_89:
    buffer_load_dwordx2 v[120:121], v122, s[48:51], 0 offen sc1
    s_waitcnt vmcnt(0)
    v_readfirstlane_b32 s73, v120
    v_readfirstlane_b32 s74, v121
    s_cmp_ge_u32 s73, 32
    s_cbranch_scc1 L_resf_90
    s_cmp_ge_u32 s74, 256
    s_cbranch_scc1 L_ress_91
    s_sleep 2
    s_branch L_res_89
L_ress_91:
    buffer_load_dword v120, v122, s[48:51], 0 offen sc1
    s_waitcnt vmcnt(0)
    v_readfirstlane_b32 s73, v120
    s_nop 0
    s_cmp_ge_u32 s73, 32
    s_cbranch_scc1 L_resf_90
    s_mov_b32 s68, 1
    s_branch L_resd_92
L_resf_90:
    s_mov_b32 s68, 0
L_resd_92:
    v_mov_b32 v120, -1
    v_mov_b32 v121, -1
    v_mov_b32 v122, -1
    v_mov_b32 v123, -1
    s_cmp_lg_u32 s68, 0
    s_cbranch_scc1 L_sslow_93
    s_mov_b32 s62, 75497472
    buffer_store_dwordx4 v[120:123], v12, s[52:55], s62 offen
    s_mov_b32 s62, 75498496
    buffer_store_dwordx4 v[120:123], v12, s[52:55], s62 offen
    s_mov_b64 exec, 0xf000f
    s_mov_b32 s62, 76546048
    buffer_store_dword v21, v13, s[52:55], s62 offen
    buffer_store_dword v21, v13, s[52:55], s62 offen offset:16
    s_mov_b32 s62, 76554240
    buffer_store_dword v21, v13, s[52:55], s62 offen
    buffer_store_dword v21, v13, s[52:55], s62 offen offset:16
    s_mov_b32 s62, 76562432
    buffer_store_dword v21, v13, s[52:55], s62 offen
    buffer_store_dword v21, v13, s[52:55], s62 offen offset:16
    s_mov_b32 s62, 76570624
    buffer_store_dword v21, v13, s[52:55], s62 offen
    buffer_store_dword v21, v13, s[52:55], s62 offen offset:16
    s_mov_b64 exec, -1
    s_branch L_sdone_94
L_sslow_93:
    s_mov_b32 s62, 75497472
    buffer_store_dwordx4 v[120:123], v12, s[52:55], s62 offen sc1
    s_mov_b32 s62, 75498496
    buffer_store_dwordx4 v[120:123], v12, s[52:55], s62 offen sc1
    s_mov_b64 exec, 0xf000f
    s_mov_b32 s62, 76546048
    buffer_store_dword v21, v13, s[52:55], s62 offen sc1
    buffer_store_dword v21, v13, s[52:55], s62 offen offset:16 sc1
    s_mov_b32 s62, 76554240
    buffer_store_dword v21, v13, s[52:55], s62 offen sc1
    buffer_store_dword v21, v13, s[52:55], s62 offen offset:16 sc1
    s_mov_b32 s62, 76562432
    buffer_store_dword v21, v13, s[52:55], s62 offen sc1
    buffer_store_dword v21, v13, s[52:55], s62 offen offset:16 sc1
    s_mov_b32 s62, 76570624
    buffer_store_dword v21, v13, s[52:55], s62 offen sc1
    buffer_store_dword v21, v13, s[52:55], s62 offen offset:16 sc1
    s_mov_b64 exec, -1
L_sdone_94:
    s_lshl_b32 s62, s57, 7
    s_add_u32 s62, s62, 95420416
    v_mov_b32 v23, s62
    v_mov_b32 v22, 0
    buffer_store_dword v22, v23, s[52:55], 0 offen sc1
    s_waitcnt vmcnt(0)
    s_barrier
    s_cmp_lg_u32 s56, 0
    s_cbranch_scc1 L_noarr_95
    v_mov_b32 v120, 1
    v_mov_b32 v121, 12
    s_mov_b64 exec, 1
    buffer_atomic_add v120, v121, s[48:51], 0 offen
    s_mov_b64 exec, -1
L_noarr_95:
    s_waitcnt vmcnt(4)
    s_barrier
    s_cmp_lg_u32 s56, 0
    s_cbranch_scc1 L_wn_97
    ds_read_b64_tr_b16 a[8:9], v32 offset:0
    ds_read_b64_tr_b16 a[10:11], v32 offset:256
    ds_read_b64_tr_b16 a[12:13], v32 offset:8192
    ds_read_b64_tr_b16 a[14:15], v32 offset:8448
    ds_read_b64_tr_b16 v[48:49], v32 offset:8
    ds_read_b64_tr_b16 v[50:51], v32 offset:264
    ds_read_b64_tr_b16 v[52:53], v32 offset:8200
    ds_read_b64_tr_b16 v[54:55], v32 offset:8456
    s_waitcnt lgkmcnt(0)
    ds_write_b128 v9, v[48:51] offset:0
    ds_write_b128 v9, v[52:55] offset:1024
    s_branch L_wv_96
L_wn_97:
    s_cmp_lg_u32 s56, 1
    s_cbranch_scc1 L_wn_98
    ds_read_b64_tr_b16 a[128:129], v32 offset:0
    ds_read_b64_tr_b16 a[130:131], v32 offset:256
    ds_read_b64_tr_b16 a[132:133], v32 offset:8192
    ds_read_b64_tr_b16 a[134:135], v32 offset:8448
    ds_read_b64_tr_b16 a[200:201], v32 offset:8
    ds_read_b64_tr_b16 a[202:203], v32 offset:264
    ds_read_b64_tr_b16 a[204:205], v32 offset:8200
    ds_read_b64_tr_b16 a[206:207], v32 offset:8456
    s_branch L_wv_96
L_wn_98:
    s_cmp_lg_u32 s56, 2
    s_cbranch_scc1 L_wn_99
    ds_read_b64_tr_b16 a[104:105], v32 offset:0
    ds_read_b64_tr_b16 a[106:107], v32 offset:256
    ds_read_b64_tr_b16 a[108:109], v32 offset:8192
    ds_read_b64_tr_b16 a[110:111], v32 offset:8448
    ds_read_b64_tr_b16 a[176:177], v32 offset:8
    ds_read_b64_tr_b16 a[178:179], v32 offset:264
    ds_read_b64_tr_b16 a[180:181], v32 offset:8200
    ds_read_b64_tr_b16 a[182:183], v32 offset:8456
    s_branch L_wv_96
L_wn_99:
    ds_read_b64_tr_b16 a[80:81], v32 offset:0
    ds_read_b64_tr_b16 a[82:83], v32 offset:256
    ds_read_b64_tr_b16 a[84:85], v32 offset:8192
    ds_read_b64_tr_b16 a[86:87], v32 offset:8448
    ds_read_b64_tr_b16 a[152:153], v32 offset:8
    ds_read_b64_tr_b16 a[154:155], v32 offset:264
    ds_read_b64_tr_b16 a[156:157], v32 offset:8200
    ds_read_b64_tr_b16 a[158:159], v32 offset:8456
L_wv_96:
    s_waitcnt lgkmcnt(0)
    s_barrier
    s_lshl_b32 s62, s56, 12
    s_add_u32 m0, s62, 131072
    s_mov_b32 s63, 1048576
    buffer_load_dwordx4 v24, s[28:31], s63 offen lds
    s_lshl_b32 s62, s56, 12
    s_add_u32 m0, s62, 132096
    s_mov_b32 s63, 1048576
    buffer_load_dwordx4 v25, s[28:31], s63 offen lds
    s_lshl_b32 s62, s56, 12
    s_add_u32 m0, s62, 133120
    s_mov_b32 s63, 1048576
    buffer_load_dwordx4 v26, s[28:31], s63 offen lds
    s_lshl_b32 s62, s56, 12
    s_add_u32 m0, s62, 134144
    s_mov_b32 s63, 1048576
    buffer_load_dwordx4 v27, s[28:31], s63 offen lds
    s_waitcnt vmcnt(4)
    s_barrier
    s_cmp_lg_u32 s56, 0
    s_cbranch_scc1 L_wn_102
    ds_read_b64_tr_b16 v[40:41], v32 offset:16384
    ds_read_b64_tr_b16 v[42:43], v32 offset:16640
    ds_read_b64_tr_b16 v[44:45], v32 offset:24576
    ds_read_b64_tr_b16 v[46:47], v32 offset:24832
    ds_read_b64_tr_b16 a[56:57], v32 offset:16392
    ds_read_b64_tr_b16 a[58:59], v32 offset:16648
    ds_read_b64_tr_b16 a[60:61], v32 offset:24584
    ds_read_b64_tr_b16 a[62:63], v32 offset:24840
    s_waitcnt lgkmcnt(0)
    ds_write_b128 v9, v[40:43] offset:2048
    ds_write_b128 v9, v[44:47] offset:3072
    s_branch L_wv_101
L_wn_102:
    s_cmp_lg_u32 s56, 1
    s_cbranch_scc1 L_wn_103
    ds_read_b64_tr_b16 v[40:41], v32 offset:16384
    ds_read_b64_tr_b16 v[42:43], v32 offset:16640
    ds_read_b64_tr_b16 v[44:45], v32 offset:24576
    ds_read_b64_tr_b16 v[46:47], v32 offset:24832
    ds_read_b64_tr_b16 v[48:49], v32 offset:16392
    ds_read_b64_tr_b16 v[50:51], v32 offset:16648
    ds_read_b64_tr_b16 v[52:53], v32 offset:24584
    ds_read_b64_tr_b16 v[54:55], v32 offset:24840
    s_waitcnt lgkmcnt(0)
    ds_write_b128 v9, v[40:43] offset:8192
    ds_write_b128 v9, v[44:47] offset:9216
    ds_write_b128 v9, v[48:51] offset:14336
    ds_write_b128 v9, v[52:55] offset:15360
    s_branch L_wv_101
L_wn_103:
    s_cmp_lg_u32 s56, 2
    s_cbranch_scc1 L_wn_104
    ds_read_b64_tr_b16 v[40:41], v32 offset:16384
    ds_read_b64_tr_b16 v[42:43], v32 offset:16640
    ds_read_b64_tr_b16 v[44:45], v32 offset:24576
    ds_read_b64_tr_b16 v[46:47], v32 offset:24832
    ds_read_b64_tr_b16 v[48:49], v32 offset:16392
    ds_read_b64_tr_b16 v[50:51], v32 offset:16648
    ds_read_b64_tr_b16 v[52:53], v32 offset:24584
    ds_read_b64_tr_b16 v[54:55], v32 offset:24840
    s_waitcnt lgkmcnt(0)
    ds_write_b128 v9, v[40:43] offset:6144
    ds_write_b128 v9, v[44:47] offset:7168
    ds_write_b128 v9, v[48:51] offset:12288
    ds_write_b128 v9, v[52:55] offset:13312
    s_branch L_wv_101
L_wn_104:
    ds_read_b64_tr_b16 v[40:41], v32 offset:16384
    ds_read_b64_tr_b16 v[42:43], v32 offset:16640
    ds_read_b64_tr_b16 v[44:45], v32 offset:24576
    ds_read_b64_tr_b16 v[46:47], v32 offset:24832
    ds_read_b64_tr_b16 v[48:49], v32 offset:16392
    ds_read_b64_tr_b16 v[50:51], v32 offset:16648
    ds_read_b64_tr_b16 v[52:53], v32 offset:24584
    ds_read_b64_tr_b16 v[54:55], v32 offset:24840
    s_waitcnt lgkmcnt(0)
    ds_write_b128 v9, v[40:43] offset:4096
    ds_write_b128 v9, v[44:47] offset:5120
    ds_write_b128 v9, v[48:51] offset:10240
    ds_write_b128 v9, v[52:55] offset:11264
L_wv_101:
    s_waitcnt lgkmcnt(0)
    s_barrier
    s_lshl_b32 s62, s56, 12
    s_add_u32 m0, s62, 147456
    s_mov_b32 s63, 1572864
    buffer_load_dwordx4 v24, s[28:31], s63 offen lds
    s_lshl_b32 s62, s56, 12
    s_add_u32 m0, s62, 148480
    s_mov_b32 s63, 1572864
    buffer_load_dwordx4 v25, s[28:31], s63 offen lds
    s_lshl_b32 s62, s56, 12
    s_add_u32 m0, s62, 149504
    s_mov_b32 s63, 1572864
    buffer_load_dwordx4 v26, s[28:31], s63 offen lds
    s_lshl_b32 s62, s56, 12
    s_add_u32 m0, s62, 150528
    s_mov_b32 s63, 1572864
    buffer_load_dwordx4 v27, s[28:31], s63 offen lds
    s_waitcnt vmcnt(4)
    s_barrier
    s_cmp_lg_u32 s56, 0
    s_cbranch_scc1 L_wn_107
    ds_read_b64_tr_b16 a[80:81], v32 offset:0
    ds_read_b64_tr_b16 a[82:83], v32 offset:256
    ds_read_b64_tr_b16 a[84:85], v32 offset:8192
    ds_read_b64_tr_b16 a[86:87], v32 offset:8448
    ds_read_b64_tr_b16 a[152:153], v32 offset:8
    ds_read_b64_tr_b16 a[154:155], v32 offset:264
    ds_read_b64_tr_b16 a[156:157], v32 offset:8200
    ds_read_b64_tr_b16 a[158:159], v32 offset:8456
    s_branch L_wv_106
L_wn_107:
    s_cmp_lg_u32 s56, 1
    s_cbranch_scc1 L_wn_108
    ds_read_b64_tr_b16 a[8:9], v32 offset:0
    ds_read_b64_tr_b16 a[10:11], v32 offset:256
    ds_read_b64_tr_b16 a[12:13], v32 offset:8192
    ds_read_b64_tr_b16 a[14:15], v32 offset:8448
    ds_read_b64_tr_b16 v[48:49], v32 offset:8
    ds_read_b64_tr_b16 v[50:51], v32 offset:264
    ds_read_b64_tr_b16 v[52:53], v32 offset:8200
    ds_read_b64_tr_b16 v[54:55], v32 offset:8456
    s_waitcnt lgkmcnt(0)
    ds_write_b128 v9, v[48:51] offset:0
    ds_write_b128 v9, v[52:55] offset:1024
    s_branch L_wv_106
L_wn_108:
    s_cmp_lg_u32 s56, 2
    s_cbranch_scc1 L_wn_109
    ds_read_b64_tr_b16 a[128:129], v32 offset:0
    ds_read_b64_tr_b16 a[130:131], v32 offset:256
    ds_read_b64_tr_b16 a[132:133], v32 offset:8192
    ds_read_b64_tr_b16 a[134:135], v32 offset:8448
    ds_read_b64_tr_b16 a[200:201], v32 offset:8
    ds_read_b64_tr_b16 a[202:203], v32 offset:264
    ds_read_b64_tr_b16 a[204:205], v32 offset:8200
    ds_read_b64_tr_b16 a[206:207], v32 offset:8456
    s_branch L_wv_106
L_wn_109:
    ds_read_b64_tr_b16 a[104:105], v32 offset:0
    ds_read_b64_tr_b16 a[106:107], v32 offset:256
    ds_read_b64_tr_b16 a[108:109], v32 offset:8192
    ds_read_b64_tr_b16 a[110:111], v32 offset:8448
    ds_read_b64_tr_b16 a[176:177], v32 offset:8
    ds_read_b64_tr_b16 a[178:179], v32 offset:264
    ds_read_b64_tr_b16 a[180:181], v32 offset:8200
    ds_read_b64_tr_b16 a[182:183], v32 offset:8456
L_wv_106:
    s_waitcnt lgkmcnt(0)
    s_barrier
    s_lshl_b32 s62, s56, 12
    s_add_u32 m0, s62, 131072
    s_mov_b32 s63, 2097152
    buffer_load_dwordx4 v24, s[28:31], s63 offen lds
    s_lshl_b32 s62, s56, 12
    s_add_u32 m0, s62, 132096
    s_mov_b32 s63, 2097152
    buffer_load_dwordx4 v25, s[28:31], s63 offen lds
    s_lshl_b32 s62, s56, 12
    s_add_u32 m0, s62, 133120
    s_mov_b32 s63, 2097152
    buffer_load_dwordx4 v26, s[28:31], s63 offen lds
    s_lshl_b32 s62, s56, 12
    s_add_u32 m0, s62, 134144
    s_mov_b32 s63, 2097152
    buffer_load_dwordx4 v27, s[28:31], s63 offen lds
    s_waitcnt vmcnt(4)
    s_barrier
    s_cmp_lg_u32 s56, 0
    s_cbranch_scc1 L_wn_112
    ds_read_b64_tr_b16 v[40:41], v32 offset:16384
    ds_read_b64_tr_b16 v[42:43], v32 offset:16640
    ds_read_b64_tr_b16 v[44:45], v32 offset:24576
    ds_read_b64_tr_b16 v[46:47], v32 offset:24832
    ds_read_b64_tr_b16 v[48:49], v32 offset:16392
    ds_read_b64_tr_b16 v[50:51], v32 offset:16648
    ds_read_b64_tr_b16 v[52:53], v32 offset:24584
    ds_read_b64_tr_b16 v[54:55], v32 offset:24840
    s_waitcnt lgkmcnt(0)
    ds_write_b128 v9, v[40:43] offset:4096
    ds_write_b128 v9, v[44:47] offset:5120
    ds_write_b128 v9, v[48:51] offset:10240
    ds_write_b128 v9, v[52:55] offset:11264
    s_branch L_wv_111
L_wn_112:
    s_cmp_lg_u32 s56, 1
    s_cbranch_scc1 L_wn_113
    ds_read_b64_tr_b16 v[40:41], v32 offset:16384
    ds_read_b64_tr_b16 v[42:43], v32 offset:16640
    ds_read_b64_tr_b16 v[44:45], v32 offset:24576
    ds_read_b64_tr_b16 v[46:47], v32 offset:24832
    ds_read_b64_tr_b16 a[56:57], v32 offset:16392
    ds_read_b64_tr_b16 a[58:59], v32 offset:16648
    ds_read_b64_tr_b16 a[60:61], v32 offset:24584
    ds_read_b64_tr_b16 a[62:63], v32 offset:24840
    s_waitcnt lgkmcnt(0)
    ds_write_b128 v9, v[40:43] offset:2048
    ds_write_b128 v9, v[44:47] offset:3072
    s_branch L_wv_111
L_wn_113:
    s_cmp_lg_u32 s56, 2
    s_cbranch_scc1 L_wn_114
    ds_read_b64_tr_b16 v[40:41], v32 offset:16384
    ds_read_b64_tr_b16 v[42:43], v32 offset:16640
    ds_read_b64_tr_b16 v[44:45], v32 offset:24576
    ds_read_b64_tr_b16 v[46:47], v32 offset:24832
    ds_read_b64_tr_b16 v[48:49], v32 offset:16392
    ds_read_b64_tr_b16 v[50:51], v32 offset:16648
    ds_read_b64_tr_b16 v[52:53], v32 offset:24584
    ds_read_b64_tr_b16 v[54:55], v32 offset:24840
    s_waitcnt lgkmcnt(0)
    ds_write_b128 v9, v[40:43] offset:8192
    ds_write_b128 v9, v[44:47] offset:9216
    ds_write_b128 v9, v[48:51] offset:14336
    ds_write_b128 v9, v[52:55] offset:15360
    s_branch L_wv_111
L_wn_114:
    ds_read_b64_tr_b16 v[40:41], v32 offset:16384
    ds_read_b64_tr_b16 v[42:43], v32 offset:16640
    ds_read_b64_tr_b16 v[44:45], v32 offset:24576
    ds_read_b64_tr_b16 v[46:47], v32 offset:24832
    ds_read_b64_tr_b16 v[48:49], v32 offset:16392
    ds_read_b64_tr_b16 v[50:51], v32 offset:16648
    ds_read_b64_tr_b16 v[52:53], v32 offset:24584
    ds_read_b64_tr_b16 v[54:55], v32 offset:24840
    s_waitcnt lgkmcnt(0)
    ds_write_b128 v9, v[40:43] offset:6144
    ds_write_b128 v9, v[44:47] offset:7168
    ds_write_b128 v9, v[48:51] offset:12288
    ds_write_b128 v9, v[52:55] offset:13312
L_wv_111:
    s_waitcnt lgkmcnt(0)
    s_barrier
    s_lshl_b32 s62, s56, 12
    s_add_u32 m0, s62, 147456
    s_mov_b32 s63, 2621440
    buffer_load_dwordx4 v24, s[28:31], s63 offen lds
    s_lshl_b32 s62, s56, 12
    s_add_u32 m0, s62, 148480
    s_mov_b32 s63, 2621440
    buffer_load_dwordx4 v25, s[28:31], s63 offen lds
    s_lshl_b32 s62, s56, 12
    s_add_u32 m0, s62, 149504
    s_mov_b32 s63, 2621440
    buffer_load_dwordx4 v26, s[28:31], s63 offen lds
    s_lshl_b32 s62, s56, 12
    s_add_u32 m0, s62, 150528
    s_mov_b32 s63, 2621440
    buffer_load_dwordx4 v27, s[28:31], s63 offen lds
    s_waitcnt vmcnt(4)
    s_barrier
    s_cmp_lg_u32 s56, 0
    s_cbranch_scc1 L_wn_117
    ds_read_b64_tr_b16 a[104:105], v32 offset:0
    ds_read_b64_tr_b16 a[106:107], v32 offset:256
    ds_read_b64_tr_b16 a[108:109], v32 offset:8192
    ds_read_b64_tr_b16 a[110:111], v32 offset:8448
    ds_read_b64_tr_b16 a[176:177], v32 offset:8
    ds_read_b64_tr_b16 a[178:179], v32 offset:264
    ds_read_b64_tr_b16 a[180:181], v32 offset:8200
    ds_read_b64_tr_b16 a[182:183], v32 offset:8456
    s_branch L_wv_116
L_wn_117:
    s_cmp_lg_u32 s56, 1
    s_cbranch_scc1 L_wn_118
    ds_read_b64_tr_b16 a[80:81], v32 offset:0
    ds_read_b64_tr_b16 a[82:83], v32 offset:256
    ds_read_b64_tr_b16 a[84:85], v32 offset:8192
    ds_read_b64_tr_b16 a[86:87], v32 offset:8448
    ds_read_b64_tr_b16 a[152:153], v32 offset:8
    ds_read_b64_tr_b16 a[154:155], v32 offset:264
    ds_read_b64_tr_b16 a[156:157], v32 offset:8200
    ds_read_b64_tr_b16 a[158:159], v32 offset:8456
    s_branch L_wv_116
L_wn_118:
    s_cmp_lg_u32 s56, 2
    s_cbranch_scc1 L_wn_119
    ds_read_b64_tr_b16 a[8:9], v32 offset:0
    ds_read_b64_tr_b16 a[10:11], v32 offset:256
    ds_read_b64_tr_b16 a[12:13], v32 offset:8192
    ds_read_b64_tr_b16 a[14:15], v32 offset:8448
    ds_read_b64_tr_b16 v[48:49], v32 offset:8
    ds_read_b64_tr_b16 v[50:51], v32 offset:264
    ds_read_b64_tr_b16 v[52:53], v32 offset:8200
    ds_read_b64_tr_b16 v[54:55], v32 offset:8456
    s_waitcnt lgkmcnt(0)
    ds_write_b128 v9, v[48:51] offset:0
    ds_write_b128 v9, v[52:55] offset:1024
    s_branch L_wv_116
L_wn_119:
    ds_read_b64_tr_b16 a[128:129], v32 offset:0
    ds_read_b64_tr_b16 a[130:131], v32 offset:256
    ds_read_b64_tr_b16 a[132:133], v32 offset:8192
    ds_read_b64_tr_b16 a[134:135], v32 offset:8448
    ds_read_b64_tr_b16 a[200:201], v32 offset:8
    ds_read_b64_tr_b16 a[202:203], v32 offset:264
    ds_read_b64_tr_b16 a[204:205], v32 offset:8200
    ds_read_b64_tr_b16 a[206:207], v32 offset:8456
L_wv_116:
    s_waitcnt lgkmcnt(0)
    s_barrier
    s_lshl_b32 s62, s56, 12
    s_add_u32 m0, s62, 131072
    s_mov_b32 s63, 3145728
    buffer_load_dwordx4 v24, s[28:31], s63 offen lds
    s_lshl_b32 s62, s56, 12
    s_add_u32 m0, s62, 132096
    s_mov_b32 s63, 3145728
    buffer_load_dwordx4 v25, s[28:31], s63 offen lds
    s_lshl_b32 s62, s56, 12
    s_add_u32 m0, s62, 133120
    s_mov_b32 s63, 3145728
    buffer_load_dwordx4 v26, s[28:31], s63 offen lds
    s_lshl_b32 s62, s56, 12
    s_add_u32 m0, s62, 134144
    s_mov_b32 s63, 3145728
    buffer_load_dwordx4 v27, s[28:31], s63 offen lds
    s_waitcnt vmcnt(4)
    s_barrier
    s_cmp_lg_u32 s56, 0
    s_cbranch_scc1 L_wn_122
    ds_read_b64_tr_b16 v[40:41], v32 offset:16384
    ds_read_b64_tr_b16 v[42:43], v32 offset:16640
    ds_read_b64_tr_b16 v[44:45], v32 offset:24576
    ds_read_b64_tr_b16 v[46:47], v32 offset:24832
    ds_read_b64_tr_b16 v[48:49], v32 offset:16392
    ds_read_b64_tr_b16 v[50:51], v32 offset:16648
    ds_read_b64_tr_b16 v[52:53], v32 offset:24584
    ds_read_b64_tr_b16 v[54:55], v32 offset:24840
    s_waitcnt lgkmcnt(0)
    ds_write_b128 v9, v[40:43] offset:6144
    ds_write_b128 v9, v[44:47] offset:7168
    ds_write_b128 v9, v[48:51] offset:12288
    ds_write_b128 v9, v[52:55] offset:13312
    s_branch L_wv_121
L_wn_122:
    s_cmp_lg_u32 s56, 1
    s_cbranch_scc1 L_wn_123
    ds_read_b64_tr_b16 v[40:41], v32 offset:16384
    ds_read_b64_tr_b16 v[42:43], v32 offset:16640
    ds_read_b64_tr_b16 v[44:45], v32 offset:24576
    ds_read_b64_tr_b16 v[46:47], v32 offset:24832
    ds_read_b64_tr_b16 v[48:49], v32 offset:16392
    ds_read_b64_tr_b16 v[50:51], v32 offset:16648
    ds_read_b64_tr_b16 v[52:53], v32 offset:24584
    ds_read_b64_tr_b16 v[54:55], v32 offset:24840
    s_waitcnt lgkmcnt(0)
    ds_write_b128 v9, v[40:43] offset:4096
    ds_write_b128 v9, v[44:47] offset:5120
    ds_write_b128 v9, v[48:51] offset:10240
    ds_write_b128 v9, v[52:55] offset:11264
    s_branch L_wv_121
L_wn_123:
    s_cmp_lg_u32 s56, 2
    s_cbranch_scc1 L_wn_124
    ds_read_b64_tr_b16 v[40:41], v32 offset:16384
    ds_read_b64_tr_b16 v[42:43], v32 offset:16640
    ds_read_b64_tr_b16 v[44:45], v32 offset:24576
    ds_read_b64_tr_b16 v[46:47], v32 offset:24832
    ds_read_b64_tr_b16 a[56:57], v32 offset:16392
    ds_read_b64_tr_b16 a[58:59], v32 offset:16648
    ds_read_b64_tr_b16 a[60:61], v32 offset:24584
    ds_read_b64_tr_b16 a[62:63], v32 offset:24840
    s_waitcnt lgkmcnt(0)
    ds_write_b128 v9, v[40:43] offset:2048
    ds_write_b128 v9, v[44:47] offset:3072
    s_branch L_wv_121
L_wn_124:
    ds_read_b64_tr_b16 v[40:41], v32 offset:16384
    ds_read_b64_tr_b16 v[42:43], v32 offset:16640
    ds_read_b64_tr_b16 v[44:45], v32 offset:24576
    ds_read_b64_tr_b16 v[46:47], v32 offset:24832
    ds_read_b64_tr_b16 v[48:49], v32 offset:16392
    ds_read_b64_tr_b16 v[50:51], v32 offset:16648
    ds_read_b64_tr_b16 v[52:53], v32 offset:24584
    ds_read_b64_tr_b16 v[54:55], v32 offset:24840
    s_waitcnt lgkmcnt(0)
    ds_write_b128 v9, v[40:43] offset:8192
    ds_write_b128 v9, v[44:47] offset:9216
    ds_write_b128 v9, v[48:51] offset:14336
    ds_write_b128 v9, v[52:55] offset:15360
L_wv_121:
    s_waitcnt lgkmcnt(0)
    s_barrier
    s_lshl_b32 s62, s56, 12
    s_add_u32 m0, s62, 147456
    s_mov_b32 s63, 3670016
    buffer_load_dwordx4 v24, s[28:31], s63 offen lds
    s_lshl_b32 s62, s56, 12
    s_add_u32 m0, s62, 148480
    s_mov_b32 s63, 3670016
    buffer_load_dwordx4 v25, s[28:31], s63 offen lds
    s_lshl_b32 s62, s56, 12
    s_add_u32 m0, s62, 149504
    s_mov_b32 s63, 3670016
    buffer_load_dwordx4 v26, s[28:31], s63 offen lds
    s_lshl_b32 s62, s56, 12
    s_add_u32 m0, s62, 150528
    s_mov_b32 s63, 3670016
    buffer_load_dwordx4 v27, s[28:31], s63 offen lds
    s_waitcnt vmcnt(4)
    s_barrier
    s_cmp_lg_u32 s56, 0
    s_cbranch_scc1 L_wn_127
    ds_read_b64_tr_b16 a[128:129], v32 offset:0
    ds_read_b64_tr_b16 a[130:131], v32 offset:256
    ds_read_b64_tr_b16 a[132:133], v32 offset:8192
    ds_read_b64_tr_b16 a[134:135], v32 offset:8448
    ds_read_b64_tr_b16 a[200:201], v32 offset:8
    ds_read_b64_tr_b16 a[202:203], v32 offset:264
    ds_read_b64_tr_b16 a[204:205], v32 offset:8200
    ds_read_b64_tr_b16 a[206:207], v32 offset:8456
    s_branch L_wv_126
L_wn_127:
    s_cmp_lg_u32 s56, 1
    s_cbranch_scc1 L_wn_128
    ds_read_b64_tr_b16 a[104:105], v32 offset:0
    ds_read_b64_tr_b16 a[106:107], v32 offset:256
    ds_read_b64_tr_b16 a[108:109], v32 offset:8192
    ds_read_b64_tr_b16 a[110:111], v32 offset:8448
    ds_read_b64_tr_b16 a[176:177], v32 offset:8
    ds_read_b64_tr_b16 a[178:179], v32 offset:264
    ds_read_b64_tr_b16 a[180:181], v32 offset:8200
    ds_read_b64_tr_b16 a[182:183], v32 offset:8456
    s_branch L_wv_126
L_wn_128:
    s_cmp_lg_u32 s56, 2
    s_cbranch_scc1 L_wn_129
    ds_read_b64_tr_b16 a[80:81], v32 offset:0
    ds_read_b64_tr_b16 a[82:83], v32 offset:256
    ds_read_b64_tr_b16 a[84:85], v32 offset:8192
    ds_read_b64_tr_b16 a[86:87], v32 offset:8448
    ds_read_b64_tr_b16 a[152:153], v32 offset:8
    ds_read_b64_tr_b16 a[154:155], v32 offset:264
    ds_read_b64_tr_b16 a[156:157], v32 offset:8200
    ds_read_b64_tr_b16 a[158:159], v32 offset:8456
    s_branch L_wv_126
L_wn_129:
    ds_read_b64_tr_b16 a[8:9], v32 offset:0
    ds_read_b64_tr_b16 a[10:11], v32 offset:256
    ds_read_b64_tr_b16 a[12:13], v32 offset:8192
    ds_read_b64_tr_b16 a[14:15], v32 offset:8448
    ds_read_b64_tr_b16 v[48:49], v32 offset:8
    ds_read_b64_tr_b16 v[50:51], v32 offset:264
    ds_read_b64_tr_b16 v[52:53], v32 offset:8200
    ds_read_b64_tr_b16 v[54:55], v32 offset:8456
    s_waitcnt lgkmcnt(0)
    ds_write_b128 v9, v[48:51] offset:0
    ds_write_b128 v9, v[52:55] offset:1024
L_wv_126:
    s_waitcnt lgkmcnt(0)
    s_barrier
    s_waitcnt vmcnt(0)
    s_barrier
    s_cmp_lg_u32 s56, 0
    s_cbranch_scc1 L_wn_132
    ds_read_b64_tr_b16 v[40:41], v32 offset:16384
    ds_read_b64_tr_b16 v[42:43], v32 offset:16640
    ds_read_b64_tr_b16 v[44:45], v32 offset:24576
    ds_read_b64_tr_b16 v[46:47], v32 offset:24832
    ds_read_b64_tr_b16 v[48:49], v32 offset:16392
    ds_read_b64_tr_b16 v[50:51], v32 offset:16648
    ds_read_b64_tr_b16 v[52:53], v32 offset:24584
    ds_read_b64_tr_b16 v[54:55], v32 offset:24840
    s_waitcnt lgkmcnt(0)
    ds_write_b128 v9, v[40:43] offset:8192
    ds_write_b128 v9, v[44:47] offset:9216
    ds_write_b128 v9, v[48:51] offset:14336
    ds_write_b128 v9, v[52:55] offset:15360
    s_branch L_wv_131
L_wn_132:
    s_cmp_lg_u32 s56, 1
    s_cbranch_scc1 L_wn_133
    ds_read_b64_tr_b16 v[40:41], v32 offset:16384
    ds_read_b64_tr_b16 v[42:43], v32 offset:16640
    ds_read_b64_tr_b16 v[44:45], v32 offset:24576
    ds_read_b64_tr_b16 v[46:47], v32 offset:24832
    ds_read_b64_tr_b16 v[48:49], v32 offset:16392
    ds_read_b64_tr_b16 v[50:51], v32 offset:16648
    ds_read_b64_tr_b16 v[52:53], v32 offset:24584
    ds_read_b64_tr_b16 v[54:55], v32 offset:24840
    s_waitcnt lgkmcnt(0)
    ds_write_b128 v9, v[40:43] offset:6144
    ds_write_b128 v9, v[44:47] offset:7168
    ds_write_b128 v9, v[48:51] offset:12288
    ds_write_b128 v9, v[52:55] offset:13312
    s_branch L_wv_131
L_wn_133:
    s_cmp_lg_u32 s56, 2
    s_cbranch_scc1 L_wn_134
    ds_read_b64_tr_b16 v[40:41], v32 offset:16384
    ds_read_b64_tr_b16 v[42:43], v32 offset:16640
    ds_read_b64_tr_b16 v[44:45], v32 offset:24576
    ds_read_b64_tr_b16 v[46:47], v32 offset:24832
    ds_read_b64_tr_b16 v[48:49], v32 offset:16392
    ds_read_b64_tr_b16 v[50:51], v32 offset:16648
    ds_read_b64_tr_b16 v[52:53], v32 offset:24584
    ds_read_b64_tr_b16 v[54:55], v32 offset:24840
    s_waitcnt lgkmcnt(0)
    ds_write_b128 v9, v[40:43] offset:4096
    ds_write_b128 v9, v[44:47] offset:5120
    ds_write_b128 v9, v[48:51] offset:10240
    ds_write_b128 v9, v[52:55] offset:11264
    s_branch L_wv_131
L_wn_134:
    ds_read_b64_tr_b16 v[40:41], v32 offset:16384
    ds_read_b64_tr_b16 v[42:43], v32 offset:16640
    ds_read_b64_tr_b16 v[44:45], v32 offset:24576
    ds_read_b64_tr_b16 v[46:47], v32 offset:24832
    ds_read_b64_tr_b16 a[56:57], v32 offset:16392
    ds_read_b64_tr_b16 a[58:59], v32 offset:16648
    ds_read_b64_tr_b16 a[60:61], v32 offset:24584
    ds_read_b64_tr_b16 a[62:63], v32 offset:24840
    s_waitcnt lgkmcnt(0)
    ds_write_b128 v9, v[40:43] offset:2048
    ds_write_b128 v9, v[44:47] offset:3072
L_wv_131:
    s_waitcnt lgkmcnt(0)
    s_barrier
    s_waitcnt lgkmcnt(0)
    v_mov_b32 v121, 12
L_winit_136:
    buffer_load_dword v120, v121, s[48:51], 0 offen sc1
    s_waitcnt vmcnt(0)
    v_cmp_gt_u32 vcc, 32, v120
    s_cbranch_vccnz L_winit_136
    v_and_b32 v120, 63, v0
    v_and_b32 v121, 15, v120
    v_lshrrev_b32 v122, 4, v120
    v_lshrrev_b32 v123, 2, v121
    v_and_b32 v124, 1, v121
    v_lshl_add_u32 v123, v123, 1, v124
    v_lshlrev_b32 v123, 10, v123
    v_and_b32 v124, 2, v121
    v_lshlrev_b32 v124, 3, v124
    v_lshlrev_b32 v125, 5, v122
    v_add3_u32 v123, v123, v124, v125
    s_lshl_b32 s62, s56, 8
    buffer_load_dwordx4 v[32:35], v123, s[24:27], s62 offen
    buffer_load_dwordx4 v[36:39], v123, s[24:27], s62 offen offset:128
    s_waitcnt vmcnt(0)
    s_mov_b32 s62, 0x05040100
    s_mov_b32 s63, 0x07060302
    v_perm_b32 v24, v34, v32, s62
    v_perm_b32 v25, v34, v32, s63
    v_perm_b32 v26, v35, v33, s62
    v_perm_b32 v27, v35, v33, s63
    v_perm_b32 v28, v38, v36, s62
    v_perm_b32 v29, v38, v36, s63
    v_perm_b32 v30, v39, v37, s62
    v_perm_b32 v31, v39, v37, s63
    v_and_b32 v121, 15, v0
    v_cmp_lt_u32 vcc, 7, v121
    v_mov_b32 v122, 0x3f803f80
    s_nop 0
    v_cndmask_b32 v4, v4, v122, vcc
    v_cndmask_b32 v5, v5, v122, vcc
    v_cndmask_b32 v6, v6, v122, vcc
    v_cndmask_b32 v7, v7, v122, vcc
    v_mov_b32 v0, v119
    s_cmp_lg_u32 s68, 0
    s_cbranch_scc1 L_rec_slow
    s_mov_b32 s58, 0
    s_mov_b32 s59, 0
    s_mov_b32 s60, 76546048
    s_mov_b32 s65, 16777216
    s_mov_b32 s67, 0
    s_mov_b32 s64, 1040356334
    s_mov_b32 s4, 1040356334
    s_mov_b32 s5, 1040356334
    s_mov_b32 s98, 0xf0f0f0f0
    s_mov_b32 s99, 0xf0f0f0f0
    s_mov_b32 s66, 75497472
    s_lshl_b32 s69, s56, 12
    s_add_u32 s69, s69, 147456
    s_lshl_b32 s71, s57, 7
    s_add_u32 s71, s71, 95289344
    s_cmp_eq_u32 s56, 0
    s_cselect_b32 s90, 1, 0
    s_mov_b32 s91, 0
    s_lshl_b32 s92, s56, 1
    s_add_u32 s92, s92, 2
    s_and_b32 s92, s92, 7
    s_lshl_b32 s92, s92, 10
    s_lshl_b32 s93, s56, 1
    s_add_u32 s93, s93, 3
    s_and_b32 s93, s93, 7
    s_lshl_b32 s93, s93, 10
    s_lshl_b32 s94, s56, 1
    s_add_u32 s94, s94, 4
    s_and_b32 s94, s94, 7
    s_lshl_b32 s94, s94, 10
    s_lshl_b32 s95, s56, 1
    s_add_u32 s95, s95, 5
    s_and_b32 s95, s95, 7
    s_lshl_b32 s95, s95, 10
    s_lshl_b32 s96, s56, 1
    s_add_u32 s96, s96, 6
    s_and_b32 s96, s96, 7
    s_lshl_b32 s96, s96, 10
    s_lshl_b32 s97, s56, 1
    s_add_u32 s97, s97, 7
    s_and_b32 s97, s97, 7
    s_lshl_b32 s97, s97, 10
    s_mov_b32 s70, 0
    v_mov_b32 v23, 28
L_kvw_137:
    buffer_load_dword v22, v23, s[48:51], 0 offen sc1
    s_waitcnt vmcnt(0)
    v_cmp_gt_u32 vcc, 32, v22
    s_cbranch_vccnz L_kvw_137
    s_mov_b32 m0, s69
    s_nop 0
    buffer_load_dwordx4 v14, s[52:55], s65 offen offset:0 sc1 lds
    buffer_load_dwordx4 v14, s[52:55], s65 offen offset:1024 sc1 lds
    buffer_load_dwordx4 v14, s[52:55], s65 offen offset:2048 sc1 lds
    buffer_load_dwordx4 v14, s[52:55], s65 offen offset:3072 sc1 lds
    ds_read_b128 v[80:83], v9 offset:0
    ds_read_b128 v[84:87], v9 offset:1024
    ds_read_b128 v[88:91], v9 offset:2048
    ds_read_b128 v[92:95], v9 offset:3072
    ds_read_b128 v[96:99], v9 offset:16384
    ds_read_b128 v[100:103], v9 offset:17408
    v_mov_b64 v[56:57], 0
    v_mov_b64 v[58:59], 0
    v_mov_b64 v[60:61], 0
    v_mov_b64 v[62:63], 0
    v_mov_b64 v[64:65], 0
    v_mov_b64 v[66:67], 0
    v_mov_b64 v[68:69], 0
    v_mov_b64 v[70:71], 0
    v_mov_b64 v[72:73], 0
    v_mov_b64 v[74:75], 0
    v_mov_b64 v[76:77], 0
    v_mov_b64 v[78:79], 0
    s_waitcnt vmcnt(0)
    ds_read_b128 v[104:107], v15 offset:0
    ds_read_b128 v[108:111], v15 offset:1024
    ds_read_b128 v[112:115], v15 offset:2048
    ds_read_b128 v[116:119], v15 offset:3072
    s_add_u32 s65, s65, 524288
    s_branch L_recf_have_mem
L_recf_step:
    s_sub_u32 s62, s60, 131072
L_recf_poll2:
    buffer_load_dwordx4 v[24:27], v10, s[52:55], s62 offen sc1
    buffer_load_dwordx4 v[28:31], v10, s[52:55], s62 offen offset:1024 sc1
    s_waitcnt vmcnt(0)
    v_max3_u32 v120, v24, v25, v26
    v_max3_u32 v121, v27, v28, v29
    v_max3_u32 v120, v120, v30, v31
    v_max_u32 v120, v120, v121
    v_cmp_eq_u32 vcc, -1, v120
    s_nop 0
    s_mov_b64 exec, vcc
    s_cbranch_execnz L_recf_poll2
    s_mov_b64 exec, -1
L_recf_have_mem:
    ds_write_b128 v10, v[24:27]
    ds_write_b128 v10, v[28:31] offset:1024
    v_smfmac_f32_16x16x64_bf16 v[56:59], v[24:27], a[0:7], v1
    v_smfmac_f32_16x16x64_bf16 v[60:63], v[24:27], a[8:15], v1
    v_smfmac_f32_16x16x64_bf16 v[64:67], v[24:27], a[16:23], v1
    s_add_u32 s63, s58, 1
    s_lshr_b32 s63, s63, 2
    s_cmp_lt_u32 s63, s70
    s_cbranch_scc1 L_kvd_140
    s_cmp_ge_u32 s63, 16
    s_cbranch_scc1 L_kvd_140
    s_cmp_eq_u32 s58, 0
    s_cbranch_scc1 L_kvd_140
    v_mbcnt_lo_u32_b32 v23, -1, 0
    v_lshlrev_b32 v23, 2, v23
    s_mov_b64 exec, 0xffff
L_kvw_139:
    buffer_load_dword v22, v23, s[48:51], 0 offen offset:32 sc1
    s_waitcnt vmcnt(0)
    v_and_b32 v22, 0xffff, v22
    v_cmp_gt_u32 vcc, 32, v22
    s_nop 0
    s_or_b32 s70, vcc_lo, 0x10000
    s_ff1_i32_b32 s70, s70
    s_cmp_lt_u32 s63, s70
    s_cbranch_scc0 L_kvw_139
    s_mov_b64 exec, -1
L_kvd_140:
    v_add_u32 v32, s92, v8
    v_add_u32 v36, s93, v8
    v_add_u32 v40, s94, v8
    v_add_u32 v44, s95, v8
    v_add_u32 v48, s96, v8
    v_add_u32 v52, s97, v8
    s_waitcnt lgkmcnt(0)
    s_barrier
    ds_read_b128 v[32:35], v32
    ds_read_b128 v[36:39], v36
    ds_read_b128 v[40:43], v40
    ds_read_b128 v[44:47], v44
    ds_read_b128 v[48:51], v48
    ds_read_b128 v[52:55], v52
    v_smfmac_f32_16x16x64_bf16 v[68:71], v[24:27], v[80:87], v1
    ds_read_b128 v[80:83], v9 offset:4096
    ds_read_b128 v[84:87], v9 offset:5120
    v_smfmac_f32_16x16x64_bf16 v[72:75], v[24:27], a[24:31], v1
    s_mov_b32 m0, s69
    s_nop 0
    buffer_load_dwordx4 v14, s[52:55], s65 offen offset:0 sc1 lds
    v_smfmac_f32_16x16x64_bf16 v[76:79], v[24:27], a[32:39], v1
    v_smfmac_f32_16x16x64_bf16 v[56:59], v[28:31], a[40:47], v1
    s_mov_b32 m0, s69
    s_nop 0
    buffer_load_dwordx4 v14, s[52:55], s65 offen offset:1024 sc1 lds
    v_smfmac_f32_16x16x64_bf16 v[60:63], v[28:31], v[88:95], v1
    ds_read_b128 v[88:91], v9 offset:6144
    ds_read_b128 v[92:95], v9 offset:7168
    v_smfmac_f32_16x16x64_bf16 v[64:67], v[28:31], a[48:55], v1
    s_mov_b32 m0, s69
    s_nop 0
    buffer_load_dwordx4 v14, s[52:55], s65 offen offset:2048 sc1 lds
    v_smfmac_f32_16x16x64_bf16 v[68:71], v[28:31], a[56:63], v1
    v_smfmac_f32_16x16x64_bf16 v[72:75], v[28:31], a[64:71], v1
    s_mov_b32 m0, s69
    s_nop 0
    buffer_load_dwordx4 v14, s[52:55], s65 offen offset:3072 sc1 lds
    v_smfmac_f32_16x16x64_bf16 v[76:79], v[28:31], v[96:103], v1
    ds_read_b128 v[96:99], v9 offset:8192
    ds_read_b128 v[100:103], v9 offset:9216
    s_add_u32 s65, s65, 524288
    s_cmp_lt_u32 s70, 16
    s_cbranch_scc1 L_recf_rdy1
L_recf_rdy1b:
    v_mov_b32 v22, s58
    s_mov_b64 exec, s[90:91]
    buffer_store_dword v22, v8, s[52:55], s71 offen sc1
    s_mov_b64 exec, -1
    s_waitcnt lgkmcnt(11)
    v_smfmac_f32_16x16x64_bf16 v[56:59], v[32:35], a[72:79], v1
    v_smfmac_f32_16x16x64_bf16 v[60:63], v[32:35], a[80:87], v1
    s_waitcnt lgkmcnt(10)
    v_smfmac_f32_16x16x64_bf16 v[56:59], v[36:39], a[88:95], v1
    s_waitcnt lgkmcnt(4)
    v_smfmac_f32_16x16x64_bf16 v[60:63], v[36:39], v[80:87], v1
    ds_read_b128 v[80:83], v9 offset:10240
    ds_read_b128 v[84:87], v9 offset:11264
    v_smfmac_f32_16x16x64_bf16 v[56:59], v[40:43], a[96:103], v1
    v_smfmac_f32_16x16x64_bf16 v[60:63], v[40:43], a[104:111], v1
    v_smfmac_f32_16x16x64_bf16 v[56:59], v[44:47], a[112:119], v1
    s_waitcnt lgkmcnt(4)
    v_smfmac_f32_16x16x64_bf16 v[60:63], v[44:47], v[88:95], v1
    ds_read_b128 v[88:91], v9 offset:12288
    ds_read_b128 v[92:95], v9 offset:13312
    v_smfmac_f32_16x16x64_bf16 v[56:59], v[48:51], a[120:127], v1
    v_smfmac_f32_16x16x64_bf16 v[60:63], v[48:51], a[128:135], v1
    v_smfmac_f32_16x16x64_bf16 v[56:59], v[52:55], a[136:143], v1
    s_waitcnt lgkmcnt(4)
    v_smfmac_f32_16x16x64_bf16 v[60:63], v[52:55], v[96:103], v1
    ds_read_b128 v[96:99], v9 offset:14336
    ds_read_b128 v[100:103], v9 offset:15360
    v_smfmac_f32_16x16x64_bf16 v[64:67], v[32:35], a[144:151], v1
    s_nop 2
    v_add_f32 v56, v56, v58
    v_smfmac_f32_16x16x64_bf16 v[68:71], v[32:35], a[152:159], v1
    v_add_f32 v57, v57, v59
    v_smfmac_f32_16x16x64_bf16 v[64:67], v[36:39], a[160:167], v1
    v_add_f32 v60, v60, v62
    s_waitcnt lgkmcnt(4)
    v_smfmac_f32_16x16x64_bf16 v[68:71], v[36:39], v[80:87], v1
    ds_read_b128 v[80:83], v9 offset:18432
    ds_read_b128 v[84:87], v9 offset:19456
    v_add_f32 v61, v61, v63
    v_smfmac_f32_16x16x64_bf16 v[64:67], v[40:43], a[168:175], v1
    v_cvt_pk_bf16_f32 v22, v56, v57
    v_smfmac_f32_16x16x64_bf16 v[68:71], v[40:43], a[176:183], v1
    v_cvt_pk_bf16_f32 v23, v60, v61
    v_smfmac_f32_16x16x64_bf16 v[64:67], v[44:47], a[184:191], v1
    s_nop 0
    v_mfma_f32_16x16x16_bf16 v[120:123], v[22:23], v[2:3], 0
    s_waitcnt lgkmcnt(4)
    v_smfmac_f32_16x16x64_bf16 v[68:71], v[44:47], v[88:95], v1
    ds_read_b128 v[88:91], v9 offset:20480
    ds_read_b128 v[92:95], v9 offset:21504
    v_smfmac_f32_16x16x64_bf16 v[64:67], v[48:51], a[192:199], v1
    v_smfmac_f32_16x16x64_bf16 v[68:71], v[48:51], a[200:207], v1
    v_smfmac_f32_16x16x64_bf16 v[64:67], v[52:55], a[208:215], v1
    s_nop 0
    v_cvt_pk_bf16_f32 v124, v120, v121
    s_waitcnt lgkmcnt(4)
    v_smfmac_f32_16x16x64_bf16 v[68:71], v[52:55], v[96:103], v1
    ds_read_b128 v[96:99], v9 offset:22528
    ds_read_b128 v[100:103], v9 offset:23552
    v_cvt_pk_bf16_f32 v125, v122, v123
    s_waitcnt lgkmcnt(4)
    v_smfmac_f32_16x16x64_bf16 v[72:75], v[32:35], v[80:87], v1
    v_add_f32 v64, v64, v66
    v_add_f32 v65, v65, v67
    s_nop 0
    v_add_f32 v68, v68, v70
    v_add_f32 v69, v69, v71
    v_cvt_pk_bf16_f32 v22, v64, v65
    v_cvt_pk_bf16_f32 v23, v68, v69
    s_nop 1
    v_mfma_f32_16x16x16_bf16 v[120:123], v[22:23], v[2:3], 0
    v_smfmac_f32_16x16x64_bf16 v[76:79], v[32:35], a[216:223], v1
    s_waitcnt lgkmcnt(2)
    v_smfmac_f32_16x16x64_bf16 v[72:75], v[36:39], v[88:95], v1
    s_nop 4
    v_cvt_pk_bf16_f32 v126, v120, v121
    v_cvt_pk_bf16_f32 v127, v122, v123
    s_nop 1
    v_mfma_f32_16x16x32_bf16 v[56:59], v[104:107], v[124:127], 0
    v_mfma_f32_16x16x32_bf16 v[60:63], v[108:111], v[124:127], 0
    v_mfma_f32_16x16x32_bf16 v[64:67], v[124:127], v[124:127], 0
    v_smfmac_f32_16x16x64_bf16 v[76:79], v[36:39], a[224:231], v1
    s_lshl_b32 s62, s67, 1
    s_add_u32 s62, s62, 67108864
    s_mov_b64 exec, s[6:7]
    s_nop 1
    ds_write_b128 v18, v[56:59] offset:32
    ds_write_b128 v18, v[60:63]
    ds_write2_b32 v0, v65, v64 offset0:0 offset1:8
    s_mov_b64 exec, -1
    buffer_store_dwordx4 v[124:127], v17, s[52:55], s62 offen sc1
    v_smfmac_f32_16x16x64_bf16 v[72:75], v[40:43], a[232:239], v1
    v_smfmac_f32_16x16x64_bf16 v[76:79], v[40:43], a[240:247], v1
    v_smfmac_f32_16x16x64_bf16 v[72:75], v[44:47], a[248:255], v1
    v_smfmac_f32_16x16x64_bf16 v[76:79], v[44:47], v[128:135], v1
    s_waitcnt lgkmcnt(0)
    s_barrier
    ds_read_b128 v[56:59], v19 offset:0
    ds_read_b128 v[60:63], v19 offset:1024
    ds_read_b128 v[64:67], v19 offset:2048
    ds_read_b128 v[104:107], v19 offset:3072
    ds_read_b128 v[68:71], v19 offset:4096
    v_smfmac_f32_16x16x64_bf16 v[72:75], v[48:51], v[136:143], v1
    v_smfmac_f32_16x16x64_bf16 v[76:79], v[48:51], v[144:151], v1
    v_smfmac_f32_16x16x64_bf16 v[72:75], v[52:55], v[152:159], v1
    v_smfmac_f32_16x16x64_bf16 v[76:79], v[52:55], v[160:167], v1
    s_waitcnt lgkmcnt(3)
    v_pk_add_f32 v[56:57], v[56:57], v[60:61]
    v_pk_add_f32 v[58:59], v[58:59], v[62:63]
    s_waitcnt lgkmcnt(1)
    v_pk_add_f32 v[64:65], v[64:65], v[104:105]
    v_pk_add_f32 v[66:67], v[66:67], v[106:107]
    s_waitcnt lgkmcnt(0)
    v_pk_add_f32 v[68:69], v[68:69], v[70:71]
    v_pk_add_f32 v[56:57], v[56:57], v[64:65]
    v_pk_add_f32 v[58:59], v[58:59], v[66:67]
    v_add_f32 v60, v68, v69
    v_max3_f32 v120, v56, v57, v58
    v_max3_f32 v120, v120, v59, v60
    ds_read_b128 v[80:83], v9 offset:24576
    ds_read_b128 v[84:87], v9 offset:25600
    v_max_f32_dpp v120, v120, v120 quad_perm:[2,3,0,1] row_mask:0xf bank_mask:0xf
    v_mov_b32 v121, v120
    ds_read_b128 v[88:91], v9 offset:26624
    ds_read_b128 v[92:95], v9 offset:27648
    v_permlane16_swap_b32 v120, v121
    v_max_f32 v120, v120, v121
    v_mov_b32 v121, v120
    s_nop 1
    v_permlane32_swap_b32 v120, v121
    v_max_f32 v120, v120, v121
    v_mul_f32 v120, s64, v120
    v_pk_fma_f32 v[56:57], v[56:57], s[4:5], v[120:121] op_sel_hi:[1,1,0] neg_lo:[0,0,1] neg_hi:[0,0,1]
    v_pk_fma_f32 v[58:59], v[58:59], s[4:5], v[120:121] op_sel_hi:[1,1,0] neg_lo:[0,0,1] neg_hi:[0,0,1]
    v_fma_f32 v60, v60, s64, -v120
    v_exp_f32 v56, v56
    v_exp_f32 v57, v57
    v_exp_f32 v58, v58
    v_exp_f32 v59, v59
    v_exp_f32 v60, v60
    v_cvt_pk_bf16_f32 v120, v56, v57
    v_cvt_pk_bf16_f32 v121, v58, v59
    v_mov_b32_dpp v61, v60 quad_perm:[2,3,0,1] row_mask:0xf bank_mask:0xf
    v_mov_b32_dpp v122, v120 quad_perm:[2,3,0,1] row_mask:0xf bank_mask:0xf
    v_mov_b32_dpp v123, v121 quad_perm:[2,3,0,1] row_mask:0xf bank_mask:0xf
    v_cvt_pk_bf16_f32 v68, v60, v61
    v_mov_b32 v69, 0
    v_mfma_f32_16x16x32_bf16 v[64:67], v[4:7], v[120:123], 0
    v_add_f32 v72, v72, v74
    v_add_f32 v73, v73, v75
    v_mfma_f32_16x16x32_bf16 v[56:59], v[112:115], v[120:123], 0
    v_add_f32 v76, v76, v78
    v_add_f32 v77, v77, v79
    v_mfma_f32_16x16x32_bf16 v[60:63], v[116:119], v[120:123], 0
    v_cvt_pk_bf16_f32 v124, v72, v73
    v_mov_b32 v125, 0
    v_cvt_pk_bf16_f32 v126, v76, v77
    v_mov_b32 v127, 0
    s_cmp_eq_u32 s58, 63
    s_cbranch_scc1 L_recf_done
    v_mfma_f32_16x16x16_bf16 v[64:67], v[4:5], v[68:69], v[64:67]
    v_mfma_f32_16x16x16_bf16 v[56:59], v[124:125], v[68:69], v[56:59]
    v_mfma_f32_16x16x16_bf16 v[60:63], v[126:127], v[68:69], v[60:63]
    s_lshl_b32 s62, s67, 1
    s_add_u32 s62, s62, 100663296
    buffer_store_dwordx4 v[124:127], v17, s[52:55], s62 offen sc1
    v_mov_b64 v[24:25], 0
    v_mov_b64 v[26:27], 0
    v_mov_b64 v[28:29], 0
    v_mov_b64 v[30:31], 0
    v_rcp_f32 v22, v64
    v_mov_b64 v[32:33], 0
    v_mov_b32 v23, v22
    v_mov_b64 v[34:35], 0
    v_mov_b64 v[36:37], 0
    v_permlane32_swap_b32 v22, v23
    v_pk_mul_f32 v[56:57], v[56:57], v[22:23] op_sel:[0,1] op_sel_hi:[1,1]
    v_pk_mul_f32 v[58:59], v[58:59], v[22:23] op_sel:[0,1] op_sel_hi:[1,1]
    v_pk_mul_f32 v[60:61], v[60:61], v[22:23] op_sel:[0,1] op_sel_hi:[1,1]
    v_pk_mul_f32 v[62:63], v[62:63], v[22:23] op_sel:[0,1] op_sel_hi:[1,1]
    v_cvt_pk_bf16_f32 v120, v56, v57
    v_cvt_pk_bf16_f32 v121, v58, v59
    v_cvt_pk_bf16_f32 v122, v60, v61
    v_cvt_pk_bf16_f32 v123, v62, v63
    s_mov_b64 exec, s[6:7]
    ds_write_b128 v20, v[120:123]
    s_mov_b64 exec, -1
    v_mov_b64 v[38:39], 0
    v_mov_b64 v[40:41], 0
    v_mov_b64 v[42:43], 0
    v_mov_b64 v[44:45], 0
    v_mov_b64 v[46:47], 0
    s_waitcnt lgkmcnt(0)
    s_barrier
    ds_read_b128 v[56:59], v8 offset:14336
    ds_read_b128 v[60:63], v8 offset:15360
    v_mov_b64 v[48:49], 0
    v_mov_b64 v[50:51], 0
    v_mov_b64 v[52:53], 0
    v_mov_b64 v[54:55], 0
    s_add_u32 s62, s66, 32768
    s_waitcnt lgkmcnt(1)
    v_smfmac_f32_16x16x64_bf16 v[24:27], v[56:59], v[168:175], v1
    s_waitcnt lgkmcnt(0)
    v_smfmac_f32_16x16x64_bf16 v[24:27], v[60:63], v[96:103], v1
    ds_read_b128 v[96:99], v9 offset:28672
    ds_read_b128 v[100:103], v9 offset:29696
    v_smfmac_f32_16x16x64_bf16 v[28:31], v[56:59], v[176:183], v1
    v_smfmac_f32_16x16x64_bf16 v[28:31], v[60:63], v[184:191], v1
    v_smfmac_f32_16x16x64_bf16 v[32:35], v[56:59], v[80:87], v1
    ds_read_b128 v[80:83], v9 offset:30720
    ds_read_b128 v[84:87], v9 offset:31744
    s_nop 0
    v_add_f32 v24, v24, v26
    v_add_f32 v25, v25, v27
    v_smfmac_f32_16x16x64_bf16 v[32:35], v[60:63], v[192:199], v1
    v_cvt_pk_bf16_f32 v72, v24, v25
    v_bfi_b32 v72, 1, s59, v72
    v_smfmac_f32_16x16x64_bf16 v[36:39], v[56:59], v[200:207], v1
    v_add_f32 v28, v28, v30
    v_add_f32 v29, v29, v31
    v_smfmac_f32_16x16x64_bf16 v[36:39], v[60:63], v[88:95], v1
    v_cvt_pk_bf16_f32 v73, v28, v29
    v_bfi_b32 v73, 1, s59, v73
    v_smfmac_f32_16x16x64_bf16 v[40:43], v[56:59], v[208:215], v1
    v_add_f32 v32, v32, v34
    v_add_f32 v33, v33, v35
    v_smfmac_f32_16x16x64_bf16 v[40:43], v[60:63], v[216:223], v1
    v_cvt_pk_bf16_f32 v74, v32, v33
    v_bfi_b32 v74, 1, s59, v74
    s_waitcnt lgkmcnt(2)
    v_smfmac_f32_16x16x64_bf16 v[44:47], v[56:59], v[96:103], v1
    v_add_f32 v36, v36, v38
    v_add_f32 v37, v37, v39
    v_smfmac_f32_16x16x64_bf16 v[44:47], v[60:63], v[224:231], v1
    v_cvt_pk_bf16_f32 v75, v36, v37
    v_bfi_b32 v75, 1, s59, v75
    buffer_store_dwordx4 v[72:75], v11, s[52:55], s66 offen
    v_smfmac_f32_16x16x64_bf16 v[48:51], v[56:59], v[232:239], v1
    v_add_f32 v40, v40, v42
    v_add_f32 v41, v41, v43
    s_waitcnt lgkmcnt(0)
    v_smfmac_f32_16x16x64_bf16 v[48:51], v[60:63], v[80:87], v1
    v_cvt_pk_bf16_f32 v76, v40, v41
    v_bfi_b32 v76, 1, s59, v76
    v_smfmac_f32_16x16x64_bf16 v[52:55], v[56:59], v[240:247], v1
    v_add_f32 v44, v44, v46
    v_add_f32 v45, v45, v47
    v_smfmac_f32_16x16x64_bf16 v[52:55], v[60:63], v[248:255], v1
    v_cvt_pk_bf16_f32 v77, v44, v45
    v_bfi_b32 v77, 1, s59, v77
    v_add_f32 v48, v48, v50
    v_add_f32 v49, v49, v51
    v_cvt_pk_bf16_f32 v78, v48, v49
    v_bfi_b32 v78, 1, s59, v78
    s_nop 1
    v_add_f32 v52, v52, v54
    v_add_f32 v53, v53, v55
    v_cvt_pk_bf16_f32 v79, v52, v53
    v_bfi_b32 v79, 1, s59, v79
    buffer_store_dwordx4 v[76:79], v11, s[52:55], s62 offen
    s_add_u32 s62, s66, 1024
    ds_read_b128 v[80:83], v9 offset:0
    ds_read_b128 v[84:87], v9 offset:1024
    ds_read_b128 v[88:91], v9 offset:2048
    ds_read_b128 v[92:95], v9 offset:3072
    ds_read_b128 v[96:99], v9 offset:16384
    ds_read_b128 v[100:103], v9 offset:17408
    v_mov_b64 v[56:57], 0
    v_mov_b64 v[58:59], 0
    v_mov_b64 v[60:61], 0
    v_mov_b64 v[62:63], 0
    v_mov_b64 v[64:65], 0
    v_mov_b64 v[66:67], 0
    v_mov_b64 v[68:69], 0
    v_mov_b64 v[70:71], 0
    s_add_u32 s61, s60, 8192
    s_and_b32 s61, s61, 32767
    s_add_u32 s61, s61, 76546048
    s_waitcnt vmcnt(0)
L_recf_poll1:
    buffer_load_dwordx4 v[24:27], v12, s[52:55], s66 offen sc1
    buffer_load_dwordx4 v[28:31], v12, s[52:55], s62 offen sc1
L_recf_poll1c:
    s_waitcnt vmcnt(0)
    v_bitop3_b32 v120, v24, v25, s59 bitop3:126
    v_bitop3_b32 v121, v26, v27, s59 bitop3:126
    v_bitop3_b32 v122, v28, v29, s59 bitop3:126
    v_bitop3_b32 v123, v30, v31, s59 bitop3:126
    v_or3_b32 v120, v120, v121, v122
    v_bitop3_b32 v120, v120, v123, 1 bitop3:0xa8
    v_cmp_ne_u32 vcc, 0, v120
    s_nop 0
    s_mov_b64 exec, vcc
    s_cbranch_execnz L_recf_poll1
    s_mov_b64 exec, -1
    v_mfma_f32_16x16x32_bf16 v[120:123], v[4:7], v[24:27], 0
    v_mfma_f32_16x16x32_bf16 v[120:123], v[4:7], v[28:31], v[120:123]
    ds_read_b128 v[104:107], v15 offset:0
    ds_read_b128 v[108:111], v15 offset:1024
    ds_read_b128 v[112:115], v15 offset:2048
    ds_read_b128 v[116:119], v15 offset:3072
    v_mov_b32 v126, -1
    s_nop 2
    v_add_f32_dpp v120, v120, v120 row_ror:4 row_mask:0xf bank_mask:0xf
    v_add_f32_dpp v121, v121, v121 row_ror:4 row_mask:0xf bank_mask:0xf
    v_add_f32_dpp v122, v122, v122 row_ror:4 row_mask:0xf bank_mask:0xf
    v_add_f32_dpp v123, v123, v123 row_ror:4 row_mask:0xf bank_mask:0xf
    v_add_f32_dpp v120, v120, v120 row_ror:8 row_mask:0xf bank_mask:0xf
    v_add_f32_dpp v121, v121, v121 row_ror:8 row_mask:0xf bank_mask:0xf
    v_add_f32_dpp v122, v122, v122 row_ror:8 row_mask:0xf bank_mask:0xf
    v_add_f32_dpp v123, v123, v123 row_ror:8 row_mask:0xf bank_mask:0xf
    v_cvt_pk_bf16_f32 v124, v120, v122
    v_cvt_pk_bf16_f32 v125, v121, v123
    v_cndmask_b32 v124, v124, v125, s[98:99]
    v_min_u32 v124, -2, v124
    s_mov_b64 exec, 0xff00ff
    buffer_store_dword v124, v13, s[52:55], s61 offen
    buffer_store_dword v126, v13, s[52:55], s60 offen
    s_mov_b64 exec, -1
    v_mov_b64 v[72:73], 0
    v_mov_b64 v[74:75], 0
    v_mov_b64 v[76:77], 0
    v_mov_b64 v[78:79], 0
    s_cmp_lt_u32 s70, 16
    s_cbranch_scc1 L_recf_rdy2
L_recf_rdy2b:
    s_mov_b32 s60, s61
    s_xor_b32 s59, s59, 1
    s_add_u32 s67, s67, 65536
    s_add_u32 s58, s58, 1
    s_branch L_recf_step
L_recf_rdy1:
    v_mbcnt_lo_u32_b32 v21, -1, 0
    v_lshlrev_b32 v21, 2, v21
    s_mov_b64 exec, 0xffff
    buffer_load_dword v21, v21, s[48:51], 0 offen offset:32 sc1
    s_mov_b64 exec, -1
    s_branch L_recf_rdy1b
L_recf_rdy2:
    s_mov_b64 exec, 0xffff
    v_and_b32 v21, 0xffff, v21
    v_cmp_gt_u32 vcc, 32, v21
    s_nop 0
    s_or_b32 s63, vcc_lo, 0x10000
    s_ff1_i32_b32 s63, s63
    s_max_u32 s70, s70, s63
    s_mov_b64 exec, -1
    s_branch L_recf_rdy2b
L_recf_done:
    s_lshl_b32 s62, s67, 1
    s_add_u32 s62, s62, 100663296
    buffer_store_dwordx4 v[124:127], v17, s[52:55], s62 offen sc1
    s_waitcnt vmcnt(0)
    s_barrier
    s_cmp_lg_u32 s56, 0
    s_cbranch_scc1 L_nofl_141
    v_mov_b32 v22, 64
    s_lshl_b32 s62, s57, 7
    s_add_u32 s62, s62, 95420416
    v_mov_b32 v23, s62
    s_mov_b64 exec, 1
    buffer_store_dword v22, v23, s[52:55], 0 offen sc1
    s_mov_b64 exec, -1
    s_waitcnt vmcnt(0)
L_nofl_141:
    v_mbcnt_lo_u32_b32 v0, -1, 0
    v_mbcnt_hi_u32_b32 v0, -1, v0
    s_lshl_b32 s62, s56, 6
    v_add_u32 v0, s62, v0
    s_branch L_worker2
L_rec_slow:
    s_mov_b32 s58, 0
    s_mov_b32 s59, 0
    s_mov_b32 s60, 76546048
    s_mov_b32 s65, 16777216
    s_mov_b32 s67, 0
    s_mov_b32 s64, 1040356334
    s_mov_b32 s4, 1040356334
    s_mov_b32 s5, 1040356334
    s_mov_b32 s98, 0xf0f0f0f0
    s_mov_b32 s99, 0xf0f0f0f0
    s_mov_b32 s66, 75497472
    s_lshl_b32 s69, s56, 12
    s_add_u32 s69, s69, 147456
    s_lshl_b32 s71, s57, 7
    s_add_u32 s71, s71, 95289344
    s_cmp_eq_u32 s56, 0
    s_cselect_b32 s90, 1, 0
    s_mov_b32 s91, 0
    s_lshl_b32 s92, s56, 1
    s_add_u32 s92, s92, 2
    s_and_b32 s92, s92, 7
    s_lshl_b32 s92, s92, 10
    s_lshl_b32 s93, s56, 1
    s_add_u32 s93, s93, 3
    s_and_b32 s93, s93, 7
    s_lshl_b32 s93, s93, 10
    s_lshl_b32 s94, s56, 1
    s_add_u32 s94, s94, 4
    s_and_b32 s94, s94, 7
    s_lshl_b32 s94, s94, 10
    s_lshl_b32 s95, s56, 1
    s_add_u32 s95, s95, 5
    s_and_b32 s95, s95, 7
    s_lshl_b32 s95, s95, 10
    s_lshl_b32 s96, s56, 1
    s_add_u32 s96, s96, 6
    s_and_b32 s96, s96, 7
    s_lshl_b32 s96, s96, 10
    s_lshl_b32 s97, s56, 1
    s_add_u32 s97, s97, 7
    s_and_b32 s97, s97, 7
    s_lshl_b32 s97, s97, 10
    s_mov_b32 s70, 0
    v_mov_b32 v23, 28
L_kvw_142:
    buffer_load_dword v22, v23, s[48:51], 0 offen sc1
    s_waitcnt vmcnt(0)
    v_cmp_gt_u32 vcc, 32, v22
    s_cbranch_vccnz L_kvw_142
    s_mov_b32 m0, s69
    s_nop 0
    buffer_load_dwordx4 v14, s[52:55], s65 offen offset:0 sc1 lds
    buffer_load_dwordx4 v14, s[52:55], s65 offen offset:1024 sc1 lds
    buffer_load_dwordx4 v14, s[52:55], s65 offen offset:2048 sc1 lds
    buffer_load_dwordx4 v14, s[52:55], s65 offen offset:3072 sc1 lds
    ds_read_b128 v[80:83], v9 offset:0
    ds_read_b128 v[84:87], v9 offset:1024
    ds_read_b128 v[88:91], v9 offset:2048
    ds_read_b128 v[92:95], v9 offset:3072
    ds_read_b128 v[96:99], v9 offset:16384
    ds_read_b128 v[100:103], v9 offset:17408
    v_mov_b64 v[56:57], 0
    v_mov_b64 v[58:59], 0
    v_mov_b64 v[60:61], 0
    v_mov_b64 v[62:63], 0
    v_mov_b64 v[64:65], 0
    v_mov_b64 v[66:67], 0
    v_mov_b64 v[68:69], 0
    v_mov_b64 v[70:71], 0
    v_mov_b64 v[72:73], 0
    v_mov_b64 v[74:75], 0
    v_mov_b64 v[76:77], 0
    v_mov_b64 v[78:79], 0
    s_waitcnt vmcnt(0)
    ds_read_b128 v[104:107], v15 offset:0
    ds_read_b128 v[108:111], v15 offset:1024
    ds_read_b128 v[112:115], v15 offset:2048
    ds_read_b128 v[116:119], v15 offset:3072
    s_add_u32 s65, s65, 524288
    s_branch L_recs_have_mem
L_recs_step:
    s_sub_u32 s62, s60, 131072
L_recs_poll2:
    buffer_load_dwordx4 v[24:27], v10, s[52:55], s62 offen sc1
    buffer_load_dwordx4 v[28:31], v10, s[52:55], s62 offen offset:1024 sc1
    s_waitcnt vmcnt(0)
    v_max3_u32 v120, v24, v25, v26
    v_max3_u32 v121, v27, v28, v29
    v_max3_u32 v120, v120, v30, v31
    v_max_u32 v120, v120, v121
    v_cmp_eq_u32 vcc, -1, v120
    s_nop 0
    s_mov_b64 exec, vcc
    s_cbranch_execnz L_recs_poll2
    s_mov_b64 exec, -1
L_recs_have_mem:
    ds_write_b128 v10, v[24:27]
    ds_write_b128 v10, v[28:31] offset:1024
    v_smfmac_f32_16x16x64_bf16 v[56:59], v[24:27], a[0:7], v1
    v_smfmac_f32_16x16x64_bf16 v[60:63], v[24:27], a[8:15], v1
    v_smfmac_f32_16x16x64_bf16 v[64:67], v[24:27], a[16:23], v1
    s_add_u32 s63, s58, 1
    s_lshr_b32 s63, s63, 2
    s_cmp_lt_u32 s63, s70
    s_cbranch_scc1 L_kvd_145
    s_cmp_ge_u32 s63, 16
    s_cbranch_scc1 L_kvd_145
    s_cmp_eq_u32 s58, 0
    s_cbranch_scc1 L_kvd_145
    v_mbcnt_lo_u32_b32 v23, -1, 0
    v_lshlrev_b32 v23, 2, v23
    s_mov_b64 exec, 0xffff
L_kvw_144:
    buffer_load_dword v22, v23, s[48:51], 0 offen offset:32 sc1
    s_waitcnt vmcnt(0)
    v_and_b32 v22, 0xffff, v22
    v_cmp_gt_u32 vcc, 32, v22
    s_nop 0
    s_or_b32 s70, vcc_lo, 0x10000
    s_ff1_i32_b32 s70, s70
    s_cmp_lt_u32 s63, s70
    s_cbranch_scc0 L_kvw_144
    s_mov_b64 exec, -1
L_kvd_145:
    v_add_u32 v32, s92, v8
    v_add_u32 v36, s93, v8
    v_add_u32 v40, s94, v8
    v_add_u32 v44, s95, v8
    v_add_u32 v48, s96, v8
    v_add_u32 v52, s97, v8
    s_waitcnt lgkmcnt(0)
    s_barrier
    ds_read_b128 v[32:35], v32
    ds_read_b128 v[36:39], v36
    ds_read_b128 v[40:43], v40
    ds_read_b128 v[44:47], v44
    ds_read_b128 v[48:51], v48
    ds_read_b128 v[52:55], v52
    v_smfmac_f32_16x16x64_bf16 v[68:71], v[24:27], v[80:87], v1
    ds_read_b128 v[80:83], v9 offset:4096
    ds_read_b128 v[84:87], v9 offset:5120
    v_smfmac_f32_16x16x64_bf16 v[72:75], v[24:27], a[24:31], v1
    s_mov_b32 m0, s69
    s_nop 0
    buffer_load_dwordx4 v14, s[52:55], s65 offen offset:0 sc1 lds
    v_smfmac_f32_16x16x64_bf16 v[76:79], v[24:27], a[32:39], v1
    v_smfmac_f32_16x16x64_bf16 v[56:59], v[28:31], a[40:47], v1
    s_mov_b32 m0, s69
    s_nop 0
    buffer_load_dwordx4 v14, s[52:55], s65 offen offset:1024 sc1 lds
    v_smfmac_f32_16x16x64_bf16 v[60:63], v[28:31], v[88:95], v1
    ds_read_b128 v[88:91], v9 offset:6144
    ds_read_b128 v[92:95], v9 offset:7168
    v_smfmac_f32_16x16x64_bf16 v[64:67], v[28:31], a[48:55], v1
    s_mov_b32 m0, s69
    s_nop 0
    buffer_load_dwordx4 v14, s[52:55], s65 offen offset:2048 sc1 lds
    v_smfmac_f32_16x16x64_bf16 v[68:71], v[28:31], a[56:63], v1
    v_smfmac_f32_16x16x64_bf16 v[72:75], v[28:31], a[64:71], v1
    s_mov_b32 m0, s69
    s_nop 0
    buffer_load_dwordx4 v14, s[52:55], s65 offen offset:3072 sc1 lds
    v_smfmac_f32_16x16x64_bf16 v[76:79], v[28:31], v[96:103], v1
    ds_read_b128 v[96:99], v9 offset:8192
    ds_read_b128 v[100:103], v9 offset:9216
    s_add_u32 s65, s65, 524288
    s_cmp_lt_u32 s70, 16
    s_cbranch_scc1 L_recs_rdy1
L_recs_rdy1b:
    v_mov_b32 v22, s58
    s_mov_b64 exec, s[90:91]
    buffer_store_dword v22, v8, s[52:55], s71 offen sc1
    s_mov_b64 exec, -1
    s_waitcnt lgkmcnt(11)
    v_smfmac_f32_16x16x64_bf16 v[56:59], v[32:35], a[72:79], v1
    v_smfmac_f32_16x16x64_bf16 v[60:63], v[32:35], a[80:87], v1
    s_waitcnt lgkmcnt(10)
    v_smfmac_f32_16x16x64_bf16 v[56:59], v[36:39], a[88:95], v1
    s_waitcnt lgkmcnt(4)
    v_smfmac_f32_16x16x64_bf16 v[60:63], v[36:39], v[80:87], v1
    ds_read_b128 v[80:83], v9 offset:10240
    ds_read_b128 v[84:87], v9 offset:11264
    v_smfmac_f32_16x16x64_bf16 v[56:59], v[40:43], a[96:103], v1
    v_smfmac_f32_16x16x64_bf16 v[60:63], v[40:43], a[104:111], v1
    v_smfmac_f32_16x16x64_bf16 v[56:59], v[44:47], a[112:119], v1
    s_waitcnt lgkmcnt(4)
    v_smfmac_f32_16x16x64_bf16 v[60:63], v[44:47], v[88:95], v1
    ds_read_b128 v[88:91], v9 offset:12288
    ds_read_b128 v[92:95], v9 offset:13312
    v_smfmac_f32_16x16x64_bf16 v[56:59], v[48:51], a[120:127], v1
    v_smfmac_f32_16x16x64_bf16 v[60:63], v[48:51], a[128:135], v1
    v_smfmac_f32_16x16x64_bf16 v[56:59], v[52:55], a[136:143], v1
    s_waitcnt lgkmcnt(4)
    v_smfmac_f32_16x16x64_bf16 v[60:63], v[52:55], v[96:103], v1
    ds_read_b128 v[96:99], v9 offset:14336
    ds_read_b128 v[100:103], v9 offset:15360
    v_smfmac_f32_16x16x64_bf16 v[64:67], v[32:35], a[144:151], v1
    s_nop 2
    v_add_f32 v56, v56, v58
    v_smfmac_f32_16x16x64_bf16 v[68:71], v[32:35], a[152:159], v1
    v_add_f32 v57, v57, v59
    v_smfmac_f32_16x16x64_bf16 v[64:67], v[36:39], a[160:167], v1
    v_add_f32 v60, v60, v62
    s_waitcnt lgkmcnt(4)
    v_smfmac_f32_16x16x64_bf16 v[68:71], v[36:39], v[80:87], v1
    ds_read_b128 v[80:83], v9 offset:18432
    ds_read_b128 v[84:87], v9 offset:19456
    v_add_f32 v61, v61, v63
    v_smfmac_f32_16x16x64_bf16 v[64:67], v[40:43], a[168:175], v1
    v_cvt_pk_bf16_f32 v22, v56, v57
    v_smfmac_f32_16x16x64_bf16 v[68:71], v[40:43], a[176:183], v1
    v_cvt_pk_bf16_f32 v23, v60, v61
    v_smfmac_f32_16x16x64_bf16 v[64:67], v[44:47], a[184:191], v1
    s_nop 0
    v_mfma_f32_16x16x16_bf16 v[120:123], v[22:23], v[2:3], 0
    s_waitcnt lgkmcnt(4)
    v_smfmac_f32_16x16x64_bf16 v[68:71], v[44:47], v[88:95], v1
    ds_read_b128 v[88:91], v9 offset:20480
    ds_read_b128 v[92:95], v9 offset:21504
    v_smfmac_f32_16x16x64_bf16 v[64:67], v[48:51], a[192:199], v1
    v_smfmac_f32_16x16x64_bf16 v[68:71], v[48:51], a[200:207], v1
    v_smfmac_f32_16x16x64_bf16 v[64:67], v[52:55], a[208:215], v1
    s_nop 0
    v_cvt_pk_bf16_f32 v124, v120, v121
    s_waitcnt lgkmcnt(4)
    v_smfmac_f32_16x16x64_bf16 v[68:71], v[52:55], v[96:103], v1
    ds_read_b128 v[96:99], v9 offset:22528
    ds_read_b128 v[100:103], v9 offset:23552
    v_cvt_pk_bf16_f32 v125, v122, v123
    s_waitcnt lgkmcnt(4)
    v_smfmac_f32_16x16x64_bf16 v[72:75], v[32:35], v[80:87], v1
    v_add_f32 v64, v64, v66
    v_add_f32 v65, v65, v67
    s_nop 0
    v_add_f32 v68, v68, v70
    v_add_f32 v69, v69, v71
    v_cvt_pk_bf16_f32 v22, v64, v65
    v_cvt_pk_bf16_f32 v23, v68, v69
    s_nop 1
    v_mfma_f32_16x16x16_bf16 v[120:123], v[22:23], v[2:3], 0
    v_smfmac_f32_16x16x64_bf16 v[76:79], v[32:35], a[216:223], v1
    s_waitcnt lgkmcnt(2)
    v_smfmac_f32_16x16x64_bf16 v[72:75], v[36:39], v[88:95], v1
    s_nop 4
    v_cvt_pk_bf16_f32 v126, v120, v121
    v_cvt_pk_bf16_f32 v127, v122, v123
    s_nop 1
    v_mfma_f32_16x16x32_bf16 v[56:59], v[104:107], v[124:127], 0
    v_mfma_f32_16x16x32_bf16 v[60:63], v[108:111], v[124:127], 0
    v_mfma_f32_16x16x32_bf16 v[64:67], v[124:127], v[124:127], 0
    v_smfmac_f32_16x16x64_bf16 v[76:79], v[36:39], a[224:231], v1
    s_lshl_b32 s62, s67, 1
    s_add_u32 s62, s62, 67108864
    s_mov_b64 exec, s[6:7]
    s_nop 1
    ds_write_b128 v18, v[56:59] offset:32
    ds_write_b128 v18, v[60:63]
    ds_write2_b32 v0, v65, v64 offset0:0 offset1:8
    s_mov_b64 exec, -1
    buffer_store_dwordx4 v[124:127], v17, s[52:55], s62 offen sc1
    v_smfmac_f32_16x16x64_bf16 v[72:75], v[40:43], a[232:239], v1
    v_smfmac_f32_16x16x64_bf16 v[76:79], v[40:43], a[240:247], v1
    v_smfmac_f32_16x16x64_bf16 v[72:75], v[44:47], a[248:255], v1
    v_smfmac_f32_16x16x64_bf16 v[76:79], v[44:47], v[128:135], v1
    s_waitcnt lgkmcnt(0)
    s_barrier
    ds_read_b128 v[56:59], v19 offset:0
    ds_read_b128 v[60:63], v19 offset:1024
    ds_read_b128 v[64:67], v19 offset:2048
    ds_read_b128 v[104:107], v19 offset:3072
    ds_read_b128 v[68:71], v19 offset:4096
    v_smfmac_f32_16x16x64_bf16 v[72:75], v[48:51], v[136:143], v1
    v_smfmac_f32_16x16x64_bf16 v[76:79], v[48:51], v[144:151], v1
    v_smfmac_f32_16x16x64_bf16 v[72:75], v[52:55], v[152:159], v1
    v_smfmac_f32_16x16x64_bf16 v[76:79], v[52:55], v[160:167], v1
    s_waitcnt lgkmcnt(3)
    v_pk_add_f32 v[56:57], v[56:57], v[60:61]
    v_pk_add_f32 v[58:59], v[58:59], v[62:63]
    s_waitcnt lgkmcnt(1)
    v_pk_add_f32 v[64:65], v[64:65], v[104:105]
    v_pk_add_f32 v[66:67], v[66:67], v[106:107]
    s_waitcnt lgkmcnt(0)
    v_pk_add_f32 v[68:69], v[68:69], v[70:71]
    v_pk_add_f32 v[56:57], v[56:57], v[64:65]
    v_pk_add_f32 v[58:59], v[58:59], v[66:67]
    v_add_f32 v60, v68, v69
    v_max3_f32 v120, v56, v57, v58
    v_max3_f32 v120, v120, v59, v60
    ds_read_b128 v[80:83], v9 offset:24576
    ds_read_b128 v[84:87], v9 offset:25600
    v_max_f32_dpp v120, v120, v120 quad_perm:[2,3,0,1] row_mask:0xf bank_mask:0xf
    v_mov_b32 v121, v120
    ds_read_b128 v[88:91], v9 offset:26624
    ds_read_b128 v[92:95], v9 offset:27648
    v_permlane16_swap_b32 v120, v121
    v_max_f32 v120, v120, v121
    v_mov_b32 v121, v120
    s_nop 1
    v_permlane32_swap_b32 v120, v121
    v_max_f32 v120, v120, v121
    v_mul_f32 v120, s64, v120
    v_pk_fma_f32 v[56:57], v[56:57], s[4:5], v[120:121] op_sel_hi:[1,1,0] neg_lo:[0,0,1] neg_hi:[0,0,1]
    v_pk_fma_f32 v[58:59], v[58:59], s[4:5], v[120:121] op_sel_hi:[1,1,0] neg_lo:[0,0,1] neg_hi:[0,0,1]
    v_fma_f32 v60, v60, s64, -v120
    v_exp_f32 v56, v56
    v_exp_f32 v57, v57
    v_exp_f32 v58, v58
    v_exp_f32 v59, v59
    v_exp_f32 v60, v60
    v_cvt_pk_bf16_f32 v120, v56, v57
    v_cvt_pk_bf16_f32 v121, v58, v59
    v_mov_b32_dpp v61, v60 quad_perm:[2,3,0,1] row_mask:0xf bank_mask:0xf
    v_mov_b32_dpp v122, v120 quad_perm:[2,3,0,1] row_mask:0xf bank_mask:0xf
    v_mov_b32_dpp v123, v121 quad_perm:[2,3,0,1] row_mask:0xf bank_mask:0xf
    v_cvt_pk_bf16_f32 v68, v60, v61
    v_mov_b32 v69, 0
    v_mfma_f32_16x16x32_bf16 v[64:67], v[4:7], v[120:123], 0
    v_add_f32 v72, v72, v74
    v_add_f32 v73, v73, v75
    v_mfma_f32_16x16x32_bf16 v[56:59], v[112:115], v[120:123], 0
    v_add_f32 v76, v76, v78
    v_add_f32 v77, v77, v79
    v_mfma_f32_16x16x32_bf16 v[60:63], v[116:119], v[120:123], 0
    v_cvt_pk_bf16_f32 v124, v72, v73
    v_mov_b32 v125, 0
    v_cvt_pk_bf16_f32 v126, v76, v77
    v_mov_b32 v127, 0
    s_cmp_eq_u32 s58, 63
    s_cbranch_scc1 L_recs_done
    v_mfma_f32_16x16x16_bf16 v[64:67], v[4:5], v[68:69], v[64:67]
    v_mfma_f32_16x16x16_bf16 v[56:59], v[124:125], v[68:69], v[56:59]
    v_mfma_f32_16x16x16_bf16 v[60:63], v[126:127], v[68:69], v[60:63]
    s_lshl_b32 s62, s67, 1
    s_add_u32 s62, s62, 100663296
    buffer_store_dwordx4 v[124:127], v17, s[52:55], s62 offen sc1
    v_mov_b64 v[24:25], 0
    v_mov_b64 v[26:27], 0
    v_mov_b64 v[28:29], 0
    v_mov_b64 v[30:31], 0
    v_rcp_f32 v22, v64
    v_mov_b64 v[32:33], 0
    v_mov_b32 v23, v22
    v_mov_b64 v[34:35], 0
    v_mov_b64 v[36:37], 0
    v_permlane32_swap_b32 v22, v23
    v_pk_mul_f32 v[56:57], v[56:57], v[22:23] op_sel:[0,1] op_sel_hi:[1,1]
    v_pk_mul_f32 v[58:59], v[58:59], v[22:23] op_sel:[0,1] op_sel_hi:[1,1]
    v_pk_mul_f32 v[60:61], v[60:61], v[22:23] op_sel:[0,1] op_sel_hi:[1,1]
    v_pk_mul_f32 v[62:63], v[62:63], v[22:23] op_sel:[0,1] op_sel_hi:[1,1]
    v_cvt_pk_bf16_f32 v120, v56, v57
    v_cvt_pk_bf16_f32 v121, v58, v59
    v_cvt_pk_bf16_f32 v122, v60, v61
    v_cvt_pk_bf16_f32 v123, v62, v63
    s_mov_b64 exec, s[6:7]
    ds_write_b128 v20, v[120:123]
    s_mov_b64 exec, -1
    v_mov_b64 v[38:39], 0
    v_mov_b64 v[40:41], 0
    v_mov_b64 v[42:43], 0
    v_mov_b64 v[44:45], 0
    v_mov_b64 v[46:47], 0
    s_waitcnt lgkmcnt(0)
    s_barrier
    ds_read_b128 v[56:59], v8 offset:14336
    ds_read_b128 v[60:63], v8 offset:15360
    v_mov_b64 v[48:49], 0
    v_mov_b64 v[50:51], 0
    v_mov_b64 v[52:53], 0
    v_mov_b64 v[54:55], 0
    s_add_u32 s62, s66, 32768
    s_waitcnt lgkmcnt(1)
    v_smfmac_f32_16x16x64_bf16 v[24:27], v[56:59], v[168:175], v1
    s_waitcnt lgkmcnt(0)
    v_smfmac_f32_16x16x64_bf16 v[24:27], v[60:63], v[96:103], v1
    ds_read_b128 v[96:99], v9 offset:28672
    ds_read_b128 v[100:103], v9 offset:29696
    v_smfmac_f32_16x16x64_bf16 v[28:31], v[56:59], v[176:183], v1
    v_smfmac_f32_16x16x64_bf16 v[28:31], v[60:63], v[184:191], v1
    v_smfmac_f32_16x16x64_bf16 v[32:35], v[56:59], v[80:87], v1
    ds_read_b128 v[80:83], v9 offset:30720
    ds_read_b128 v[84:87], v9 offset:31744
    s_nop 0
    v_add_f32 v24, v24, v26
    v_add_f32 v25, v25, v27
    v_smfmac_f32_16x16x64_bf16 v[32:35], v[60:63], v[192:199], v1
    v_cvt_pk_bf16_f32 v72, v24, v25
    v_bfi_b32 v72, 1, s59, v72
    v_smfmac_f32_16x16x64_bf16 v[36:39], v[56:59], v[200:207], v1
    v_add_f32 v28, v28, v30
    v_add_f32 v29, v29, v31
    v_smfmac_f32_16x16x64_bf16 v[36:39], v[60:63], v[88:95], v1
    v_cvt_pk_bf16_f32 v73, v28, v29
    v_bfi_b32 v73, 1, s59, v73
    v_smfmac_f32_16x16x64_bf16 v[40:43], v[56:59], v[208:215], v1
    v_add_f32 v32, v32, v34
    v_add_f32 v33, v33, v35
    v_smfmac_f32_16x16x64_bf16 v[40:43], v[60:63], v[216:223], v1
    v_cvt_pk_bf16_f32 v74, v32, v33
    v_bfi_b32 v74, 1, s59, v74
    s_waitcnt lgkmcnt(2)
    v_smfmac_f32_16x16x64_bf16 v[44:47], v[56:59], v[96:103], v1
    v_add_f32 v36, v36, v38
    v_add_f32 v37, v37, v39
    v_smfmac_f32_16x16x64_bf16 v[44:47], v[60:63], v[224:231], v1
    v_cvt_pk_bf16_f32 v75, v36, v37
    v_bfi_b32 v75, 1, s59, v75
    buffer_store_dwordx4 v[72:75], v11, s[52:55], s66 offen sc1
    v_smfmac_f32_16x16x64_bf16 v[48:51], v[56:59], v[232:239], v1
    v_add_f32 v40, v40, v42
    v_add_f32 v41, v41, v43
    s_waitcnt lgkmcnt(0)
    v_smfmac_f32_16x16x64_bf16 v[48:51], v[60:63], v[80:87], v1
    v_cvt_pk_bf16_f32 v76, v40, v41
    v_bfi_b32 v76, 1, s59, v76
    v_smfmac_f32_16x16x64_bf16 v[52:55], v[56:59], v[240:247], v1
    v_add_f32 v44, v44, v46
    v_add_f32 v45, v45, v47
    v_smfmac_f32_16x16x64_bf16 v[52:55], v[60:63], v[248:255], v1
    v_cvt_pk_bf16_f32 v77, v44, v45
    v_bfi_b32 v77, 1, s59, v77
    v_add_f32 v48, v48, v50
    v_add_f32 v49, v49, v51
    v_cvt_pk_bf16_f32 v78, v48, v49
    v_bfi_b32 v78, 1, s59, v78
    s_nop 1
    v_add_f32 v52, v52, v54
    v_add_f32 v53, v53, v55
    v_cvt_pk_bf16_f32 v79, v52, v53
    v_bfi_b32 v79, 1, s59, v79
    buffer_store_dwordx4 v[76:79], v11, s[52:55], s62 offen sc1
    s_add_u32 s62, s66, 1024
    ds_read_b128 v[80:83], v9 offset:0
    ds_read_b128 v[84:87], v9 offset:1024
    ds_read_b128 v[88:91], v9 offset:2048
    ds_read_b128 v[92:95], v9 offset:3072
    ds_read_b128 v[96:99], v9 offset:16384
    ds_read_b128 v[100:103], v9 offset:17408
    v_mov_b64 v[56:57], 0
    v_mov_b64 v[58:59], 0
    v_mov_b64 v[60:61], 0
    v_mov_b64 v[62:63], 0
    v_mov_b64 v[64:65], 0
    v_mov_b64 v[66:67], 0
    v_mov_b64 v[68:69], 0
    v_mov_b64 v[70:71], 0
    s_add_u32 s61, s60, 8192
    s_and_b32 s61, s61, 32767
    s_add_u32 s61, s61, 76546048
    s_waitcnt vmcnt(0)
L_recs_poll1:
    buffer_load_dwordx4 v[24:27], v12, s[52:55], s66 offen sc1
    buffer_load_dwordx4 v[28:31], v12, s[52:55], s62 offen sc1
L_recs_poll1c:
    s_waitcnt vmcnt(0)
    v_bitop3_b32 v120, v24, v25, s59 bitop3:126
    v_bitop3_b32 v121, v26, v27, s59 bitop3:126
    v_bitop3_b32 v122, v28, v29, s59 bitop3:126
    v_bitop3_b32 v123, v30, v31, s59 bitop3:126
    v_or3_b32 v120, v120, v121, v122
    v_bitop3_b32 v120, v120, v123, 1 bitop3:0xa8
    v_cmp_ne_u32 vcc, 0, v120
    s_nop 0
    s_mov_b64 exec, vcc
    s_cbranch_execnz L_recs_poll1
    s_mov_b64 exec, -1
    v_mfma_f32_16x16x32_bf16 v[120:123], v[4:7], v[24:27], 0
    v_mfma_f32_16x16x32_bf16 v[120:123], v[4:7], v[28:31], v[120:123]
    ds_read_b128 v[104:107], v15 offset:0
    ds_read_b128 v[108:111], v15 offset:1024
    ds_read_b128 v[112:115], v15 offset:2048
    ds_read_b128 v[116:119], v15 offset:3072
    v_mov_b32 v126, -1
    s_nop 2
    v_add_f32_dpp v120, v120, v120 row_ror:4 row_mask:0xf bank_mask:0xf
    v_add_f32_dpp v121, v121, v121 row_ror:4 row_mask:0xf bank_mask:0xf
    v_add_f32_dpp v122, v122, v122 row_ror:4 row_mask:0xf bank_mask:0xf
    v_add_f32_dpp v123, v123, v123 row_ror:4 row_mask:0xf bank_mask:0xf
    v_add_f32_dpp v120, v120, v120 row_ror:8 row_mask:0xf bank_mask:0xf
    v_add_f32_dpp v121, v121, v121 row_ror:8 row_mask:0xf bank_mask:0xf
    v_add_f32_dpp v122, v122, v122 row_ror:8 row_mask:0xf bank_mask:0xf
    v_add_f32_dpp v123, v123, v123 row_ror:8 row_mask:0xf bank_mask:0xf
    v_cvt_pk_bf16_f32 v124, v120, v122
    v_cvt_pk_bf16_f32 v125, v121, v123
    v_cndmask_b32 v124, v124, v125, s[98:99]
    v_min_u32 v124, -2, v124
    s_mov_b64 exec, 0xff00ff
    buffer_store_dword v124, v13, s[52:55], s61 offen sc1
    buffer_store_dword v126, v13, s[52:55], s60 offen sc1
    s_mov_b64 exec, -1
    v_mov_b64 v[72:73], 0
    v_mov_b64 v[74:75], 0
    v_mov_b64 v[76:77], 0
    v_mov_b64 v[78:79], 0
    s_cmp_lt_u32 s70, 16
    s_cbranch_scc1 L_recs_rdy2
L_recs_rdy2b:
    s_mov_b32 s60, s61
    s_xor_b32 s59, s59, 1
    s_add_u32 s67, s67, 65536
    s_add_u32 s58, s58, 1
    s_branch L_recs_step
L_recs_rdy1:
    v_mbcnt_lo_u32_b32 v21, -1, 0
    v_lshlrev_b32 v21, 2, v21
    s_mov_b64 exec, 0xffff
    buffer_load_dword v21, v21, s[48:51], 0 offen offset:32 sc1
    s_mov_b64 exec, -1
    s_branch L_recs_rdy1b
L_recs_rdy2:
    s_mov_b64 exec, 0xffff
    v_and_b32 v21, 0xffff, v21
    v_cmp_gt_u32 vcc, 32, v21
    s_nop 0
    s_or_b32 s63, vcc_lo, 0x10000
    s_ff1_i32_b32 s63, s63
    s_max_u32 s70, s70, s63
    s_mov_b64 exec, -1
    s_branch L_recs_rdy2b
L_recs_done:
    s_lshl_b32 s62, s67, 1
    s_add_u32 s62, s62, 100663296
    buffer_store_dwordx4 v[124:127], v17, s[52:55], s62 offen sc1
    s_waitcnt vmcnt(0)
    s_barrier
    s_cmp_lg_u32 s56, 0
    s_cbranch_scc1 L_nofl_146
    v_mov_b32 v22, 64
    s_lshl_b32 s62, s57, 7
    s_add_u32 s62, s62, 95420416
    v_mov_b32 v23, s62
    s_mov_b64 exec, 1
    buffer_store_dword v22, v23, s[52:55], 0 offen sc1
    s_mov_b64 exec, -1
    s_waitcnt vmcnt(0)
L_nofl_146:
    v_mbcnt_lo_u32_b32 v0, -1, 0
    v_mbcnt_hi_u32_b32 v0, -1, v0
    s_lshl_b32 s62, s56, 6
    v_add_u32 v0, s62, v0
    s_branch L_worker2
L_worker:
    s_mov_b32 s88, 4000
    s_mov_b32 s97, 0
    s_branch L_next
L_worker2:
    s_mov_b32 s88, 4000
    s_mov_b32 s97, 2
L_next:
    s_barrier
    s_cmp_lg_u32 s56, 0
    s_cbranch_scc1 L_ntk_147
    s_mov_b64 exec, 1
    v_mov_b32 v122, 163776
    s_cmp_lg_u32 s97, 1
    s_cbranch_scc1 L_take
    v_mov_b32 v123, 0
L_dec:
    buffer_load_dwordx2 v[120:121], v123, s[48:51], 0 offen sc1
    s_waitcnt vmcnt(0)
    v_readfirstlane_b32 s77, v120
    v_readfirstlane_b32 s78, v121
    s_cmp_ge_u32 s77, 32
    s_cbranch_scc1 L_take
    s_cmp_ge_u32 s78, 256
    s_cbranch_scc1 L_dec2
    s_sleep 2
    s_branch L_dec
L_dec2:
    buffer_load_dword v120, v123, s[48:51], 0 offen sc1
    s_waitcnt vmcnt(0)
    v_readfirstlane_b32 s77, v120
    s_nop 0
    s_cmp_ge_u32 s77, 32
    s_cbranch_scc1 L_take
    v_mov_b32 v120, 1
    v_mov_b32 v121, 8
    buffer_atomic_add v120, v121, s[48:51], 0 offen sc0
    s_waitcnt vmcnt(0)
    v_readfirstlane_b32 s78, v120
    s_nop 0
    s_add_u32 s77, s77, s78
    s_cmp_ge_u32 s77, 32
    s_cbranch_scc1 L_take
    s_add_u32 s77, s77, 0x10000
    v_mov_b32 v120, s77
    s_branch L_pub
L_take:
    v_mov_b32 v120, 1
    v_mov_b32 v121, 96
    buffer_atomic_add v120, v121, s[48:51], 0 offen sc0
    s_waitcnt vmcnt(0)
L_pub:
    ds_write_b32 v122, v120
    s_mov_b64 exec, -1
    s_waitcnt lgkmcnt(0)
L_ntk_147:
    s_barrier
    v_mov_b32 v122, 163776
    ds_read_b32 v120, v122
    s_waitcnt lgkmcnt(0)
    v_readfirstlane_b32 s88, v120
    s_mov_b32 s79, s97
    s_add_u32 s97, s97, 1
    s_min_u32 s97, s97, 2
    s_cmp_lt_u32 s88, 0x10000
    s_cbranch_scc1 L_disp
    s_and_b32 s57, s88, 31
    s_barrier
    s_branch L_head
L_disp:
    s_cmp_lt_u32 s88, 192
    s_cbranch_scc1 L_task_kv
    s_cmp_lt_u32 s88, 216
    s_cbranch_scc1 L_task_g2
    s_cmp_lt_u32 s88, 280
    s_cbranch_scc1 L_task_q
    s_cmp_lt_u32 s88, 408
    s_cbranch_scc1 L_task_sv
    s_cmp_lt_u32 s88, 664
    s_cbranch_scc1 L_task_at
    s_cmp_lt_u32 s88, 728
    s_cbranch_scc1 L_task_g3
    s_cmp_eq_u32 s79, 0
    s_cbranch_scc1 L_next
    s_branch L_end0
L_task_kv:
    s_lshr_b32 s77, s88, 5
    s_and_b32 s90, s88, 15
    s_bfe_u32 s91, s88, 0x10004
    s_sub_u32 s89, s77, 2
    s_lshl_b32 s89, s89, 2
    s_mov_b32 s72, 4
    s_cmp_lt_u32 s77, 3
    s_cselect_b32 s89, s77, s89
    s_cselect_b32 s72, 2, s72
    s_cmp_lt_u32 s77, 2
    s_cselect_b32 s72, 1, s72
    s_cmp_lg_u32 s88, 0
    s_cbranch_scc1 L_nz_148
    v_lshlrev_b32 v120, 7, v0
    v_mov_b32 v122, 0
    v_mov_b32 v123, 0
    s_mov_b32 s77, 94371840
    buffer_store_dwordx2 v[122:123], v120, s[52:55], s77 offen sc1
L_nz_148:
    s_cmp_eq_u32 s91, 0
    s_cbranch_scc1 L_g1_k
    s_mov_b32 s64, s36
    s_mov_b32 s65, s37
    s_mov_b32 s66, s38
    s_mov_b32 s67, s39
    s_branch L_g1_go
L_g1_k:
    s_mov_b32 s64, s32
    s_mov_b32 s65, s33
    s_mov_b32 s66, s34
    s_mov_b32 s67, s35
    s_branch L_g1_go
L_task_q:
    s_sub_u32 s77, s88, 216
    s_lshr_b32 s89, s77, 4
    s_lshl_b32 s89, s89, 2
    s_and_b32 s90, s77, 15
    s_mov_b32 s91, 2
    s_mov_b32 s72, 4
    s_mov_b32 s64, s28
    s_mov_b32 s65, s29
    s_mov_b32 s66, s30
    s_mov_b32 s67, s31
L_g1_go:
    s_mov_b32 s60, s20
    s_mov_b32 s61, s21
    s_mov_b32 s62, s22
    s_mov_b32 s63, s23
    s_mov_b32 s69, 8192
    s_lshl_b32 s71, s90, 9
L_urg_149:
    v_and_b32 v10, 63, v0
    v_lshrrev_b32 v11, 5, v10
    v_and_b32 v12, 31, v10
    s_lshl_b32 s77, s56, 4
    v_add_u32 v13, s77, v11
    v_mul_lo_u32 v13, v13, s69
    v_lshlrev_b32 v14, 2, v11
    v_xor_b32 v14, v14, v12
    v_lshl_add_u32 v2, v14, 4, v13
    v_xor_b32 v3, 128, v2
    s_lshl_b32 s84, s69, 1
    s_lshl_b32 s82, s56, 13
    v_and_b32 v11, 15, v10
    v_lshrrev_b32 v12, 4, v10
    v_lshrrev_b32 v13, 2, v11
    v_and_b32 v14, 3, v11
    v_lshl_add_u32 v15, v12, 3, v13
    s_lshl_b32 s77, s56, 1
    s_add_u32 s77, s77, 0
    v_xor_b32 v9, s77, v13
    v_lshl_add_u32 v9, v9, 2, v14
    v_lshlrev_b32 v9, 4, v9
    v_lshl_add_u32 v4, v15, 9, v9
    s_lshl_b32 s77, s56, 1
    s_add_u32 s77, s77, 1
    v_xor_b32 v9, s77, v13
    v_lshl_add_u32 v9, v9, 2, v14
    v_lshlrev_b32 v9, 4, v9
    v_lshl_add_u32 v5, v15, 9, v9
    v_add_u32 v128, 65536, v4
    v_add_u32 v129, 65536, v5
    s_barrier
    s_mov_b32 s79, s71
    s_add_u32 m0, s82, 0
    s_nop 0
    buffer_load_dwordx4 v2, s[64:67], s79 offen lds
    s_add_u32 s79, s79, s84
    s_add_u32 m0, s82, 1024
    s_nop 0
    buffer_load_dwordx4 v3, s[64:67], s79 offen lds
    s_add_u32 s79, s79, s84
    s_add_u32 m0, s82, 2048
    s_nop 0
    buffer_load_dwordx4 v2, s[64:67], s79 offen lds
    s_add_u32 s79, s79, s84
    s_add_u32 m0, s82, 3072
    s_nop 0
    buffer_load_dwordx4 v3, s[64:67], s79 offen lds
    s_add_u32 s79, s79, s84
    s_add_u32 m0, s82, 4096
    s_nop 0
    buffer_load_dwordx4 v2, s[64:67], s79 offen lds
    s_add_u32 s79, s79, s84
    s_add_u32 m0, s82, 5120
    s_nop 0
    buffer_load_dwordx4 v3, s[64:67], s79 offen lds
    s_add_u32 s79, s79, s84
    s_add_u32 m0, s82, 6144
    s_nop 0
    buffer_load_dwordx4 v2, s[64:67], s79 offen lds
    s_add_u32 s79, s79, s84
    s_add_u32 m0, s82, 7168
    s_nop 0
    buffer_load_dwordx4 v3, s[64:67], s79 offen lds
    s_lshl_b32 s79, s69, 6
    s_add_u32 s71, s71, s79
    s_mov_b32 s79, s71
    s_add_u32 m0, s82, 32768
    s_nop 0
    buffer_load_dwordx4 v2, s[64:67], s79 offen lds
    s_add_u32 s79, s79, s84
    s_add_u32 m0, s82, 33792
    s_nop 0
    buffer_load_dwordx4 v3, s[64:67], s79 offen lds
    s_add_u32 s79, s79, s84
    s_add_u32 m0, s82, 34816
    s_nop 0
    buffer_load_dwordx4 v2, s[64:67], s79 offen lds
    s_add_u32 s79, s79, s84
    s_add_u32 m0, s82, 35840
    s_nop 0
    buffer_load_dwordx4 v3, s[64:67], s79 offen lds
    s_add_u32 s79, s79, s84
    s_add_u32 m0, s82, 36864
    s_nop 0
    buffer_load_dwordx4 v2, s[64:67], s79 offen lds
    s_add_u32 s79, s79, s84
    s_add_u32 m0, s82, 37888
    s_nop 0
    buffer_load_dwordx4 v3, s[64:67], s79 offen lds
    s_add_u32 s79, s79, s84
    s_add_u32 m0, s82, 38912
    s_nop 0
    buffer_load_dwordx4 v2, s[64:67], s79 offen lds
    s_add_u32 s79, s79, s84
    s_add_u32 m0, s82, 39936
    s_nop 0
    buffer_load_dwordx4 v3, s[64:67], s79 offen lds
    s_lshl_b32 s79, s69, 6
    s_add_u32 s71, s71, s79
    s_mov_b32 s79, s71
    s_add_u32 m0, s82, 65536
    s_nop 0
    buffer_load_dwordx4 v2, s[64:67], s79 offen lds
    s_add_u32 s79, s79, s84
    s_add_u32 m0, s82, 66560
    s_nop 0
    buffer_load_dwordx4 v3, s[64:67], s79 offen lds
    s_add_u32 s79, s79, s84
    s_add_u32 m0, s82, 67584
    s_nop 0
    buffer_load_dwordx4 v2, s[64:67], s79 offen lds
    s_add_u32 s79, s79, s84
    s_add_u32 m0, s82, 68608
    s_nop 0
    buffer_load_dwordx4 v3, s[64:67], s79 offen lds
    s_add_u32 s79, s79, s84
    s_add_u32 m0, s82, 69632
    s_nop 0
    buffer_load_dwordx4 v2, s[64:67], s79 offen lds
    s_add_u32 s79, s79, s84
    s_add_u32 m0, s82, 70656
    s_nop 0
    buffer_load_dwordx4 v3, s[64:67], s79 offen lds
    s_add_u32 s79, s79, s84
    s_add_u32 m0, s82, 71680
    s_nop 0
    buffer_load_dwordx4 v2, s[64:67], s79 offen lds
    s_add_u32 s79, s79, s84
    s_add_u32 m0, s82, 72704
    s_nop 0
    buffer_load_dwordx4 v3, s[64:67], s79 offen lds
    s_lshl_b32 s79, s69, 6
    s_add_u32 s71, s71, s79
    s_waitcnt vmcnt(16)
    s_barrier
    s_mov_b32 s79, s71
    s_add_u32 m0, s82, 98304
    s_nop 0
    buffer_load_dwordx4 v2, s[64:67], s79 offen lds
    s_add_u32 s79, s79, s84
    s_add_u32 m0, s82, 99328
    s_nop 0
    buffer_load_dwordx4 v3, s[64:67], s79 offen lds
    s_add_u32 s79, s79, s84
    s_add_u32 m0, s82, 100352
    s_nop 0
    buffer_load_dwordx4 v2, s[64:67], s79 offen lds
    s_add_u32 s79, s79, s84
    s_add_u32 m0, s82, 101376
    s_nop 0
    buffer_load_dwordx4 v3, s[64:67], s79 offen lds
    s_add_u32 s79, s79, s84
    s_add_u32 m0, s82, 102400
    s_nop 0
    buffer_load_dwordx4 v2, s[64:67], s79 offen lds
    s_add_u32 s79, s79, s84
    s_add_u32 m0, s82, 103424
    s_nop 0
    buffer_load_dwordx4 v3, s[64:67], s79 offen lds
    s_add_u32 s79, s79, s84
    s_add_u32 m0, s82, 104448
    s_nop 0
    buffer_load_dwordx4 v2, s[64:67], s79 offen lds
    s_add_u32 s79, s79, s84
    s_add_u32 m0, s82, 105472
    s_nop 0
    buffer_load_dwordx4 v3, s[64:67], s79 offen lds
    s_lshl_b32 s79, s69, 6
    s_add_u32 s71, s71, s79
    ds_read_b64_tr_b16 a[0:1], v4 offset:0
    ds_read_b64_tr_b16 a[2:3], v4 offset:2048
    ds_read_b64_tr_b16 a[64:65], v4 offset:8
    ds_read_b64_tr_b16 a[66:67], v4 offset:2056
    ds_read_b64_tr_b16 a[128:129], v5 offset:0
    ds_read_b64_tr_b16 a[130:131], v5 offset:2048
    ds_read_b64_tr_b16 a[192:193], v5 offset:8
    ds_read_b64_tr_b16 a[194:195], v5 offset:2056
    ds_read_b64_tr_b16 a[4:5], v4 offset:16384
    ds_read_b64_tr_b16 a[6:7], v4 offset:18432
    ds_read_b64_tr_b16 a[68:69], v4 offset:16392
    ds_read_b64_tr_b16 a[70:71], v4 offset:18440
    ds_read_b64_tr_b16 a[132:133], v5 offset:16384
    ds_read_b64_tr_b16 a[134:135], v5 offset:18432
    ds_read_b64_tr_b16 a[196:197], v5 offset:16392
    ds_read_b64_tr_b16 a[198:199], v5 offset:18440
    s_waitcnt lgkmcnt(0)
    s_waitcnt vmcnt(16)
    s_barrier
    s_mov_b32 s79, s71
    s_add_u32 m0, s82, 0
    s_nop 0
    buffer_load_dwordx4 v2, s[64:67], s79 offen lds
    s_add_u32 s79, s79, s84
    s_add_u32 m0, s82, 1024
    s_nop 0
    buffer_load_dwordx4 v3, s[64:67], s79 offen lds
    s_add_u32 s79, s79, s84
    s_add_u32 m0, s82, 2048
    s_nop 0
    buffer_load_dwordx4 v2, s[64:67], s79 offen lds
    s_add_u32 s79, s79, s84
    s_add_u32 m0, s82, 3072
    s_nop 0
    buffer_load_dwordx4 v3, s[64:67], s79 offen lds
    s_add_u32 s79, s79, s84
    s_add_u32 m0, s82, 4096
    s_nop 0
    buffer_load_dwordx4 v2, s[64:67], s79 offen lds
    s_add_u32 s79, s79, s84
    s_add_u32 m0, s82, 5120
    s_nop 0
    buffer_load_dwordx4 v3, s[64:67], s79 offen lds
    s_add_u32 s79, s79, s84
    s_add_u32 m0, s82, 6144
    s_nop 0
    buffer_load_dwordx4 v2, s[64:67], s79 offen lds
    s_add_u32 s79, s79, s84
    s_add_u32 m0, s82, 7168
    s_nop 0
    buffer_load_dwordx4 v3, s[64:67], s79 offen lds
    s_lshl_b32 s79, s69, 6
    s_add_u32 s71, s71, s79
    ds_read_b64_tr_b16 a[8:9], v4 offset:32768
    ds_read_b64_tr_b16 a[10:11], v4 offset:34816
    ds_read_b64_tr_b16 a[72:73], v4 offset:32776
    ds_read_b64_tr_b16 a[74:75], v4 offset:34824
    ds_read_b64_tr_b16 a[136:137], v5 offset:32768
    ds_read_b64_tr_b16 a[138:139], v5 offset:34816
    ds_read_b64_tr_b16 a[200:201], v5 offset:32776
    ds_read_b64_tr_b16 a[202:203], v5 offset:34824
    ds_read_b64_tr_b16 a[12:13], v4 offset:49152
    ds_read_b64_tr_b16 a[14:15], v4 offset:51200
    ds_read_b64_tr_b16 a[76:77], v4 offset:49160
    ds_read_b64_tr_b16 a[78:79], v4 offset:51208
    ds_read_b64_tr_b16 a[140:141], v5 offset:49152
    ds_read_b64_tr_b16 a[142:143], v5 offset:51200
    ds_read_b64_tr_b16 a[204:205], v5 offset:49160
    ds_read_b64_tr_b16 a[206:207], v5 offset:51208
    s_waitcnt lgkmcnt(0)
    s_waitcnt vmcnt(16)
    s_barrier
    s_mov_b32 s79, s71
    s_add_u32 m0, s82, 32768
    s_nop 0
    buffer_load_dwordx4 v2, s[64:67], s79 offen lds
    s_add_u32 s79, s79, s84
    s_add_u32 m0, s82, 33792
    s_nop 0
    buffer_load_dwordx4 v3, s[64:67], s79 offen lds
    s_add_u32 s79, s79, s84
    s_add_u32 m0, s82, 34816
    s_nop 0
    buffer_load_dwordx4 v2, s[64:67], s79 offen lds
    s_add_u32 s79, s79, s84
    s_add_u32 m0, s82, 35840
    s_nop 0
    buffer_load_dwordx4 v3, s[64:67], s79 offen lds
    s_add_u32 s79, s79, s84
    s_add_u32 m0, s82, 36864
    s_nop 0
    buffer_load_dwordx4 v2, s[64:67], s79 offen lds
    s_add_u32 s79, s79, s84
    s_add_u32 m0, s82, 37888
    s_nop 0
    buffer_load_dwordx4 v3, s[64:67], s79 offen lds
    s_add_u32 s79, s79, s84
    s_add_u32 m0, s82, 38912
    s_nop 0
    buffer_load_dwordx4 v2, s[64:67], s79 offen lds
    s_add_u32 s79, s79, s84
    s_add_u32 m0, s82, 39936
    s_nop 0
    buffer_load_dwordx4 v3, s[64:67], s79 offen lds
    s_lshl_b32 s79, s69, 6
    s_add_u32 s71, s71, s79
    ds_read_b64_tr_b16 a[16:17], v128 offset:0
    ds_read_b64_tr_b16 a[18:19], v128 offset:2048
    ds_read_b64_tr_b16 a[80:81], v128 offset:8
    ds_read_b64_tr_b16 a[82:83], v128 offset:2056
    ds_read_b64_tr_b16 a[144:145], v129 offset:0
    ds_read_b64_tr_b16 a[146:147], v129 offset:2048
    ds_read_b64_tr_b16 a[208:209], v129 offset:8
    ds_read_b64_tr_b16 a[210:211], v129 offset:2056
    ds_read_b64_tr_b16 a[20:21], v128 offset:16384
    ds_read_b64_tr_b16 a[22:23], v128 offset:18432
    ds_read_b64_tr_b16 a[84:85], v128 offset:16392
    ds_read_b64_tr_b16 a[86:87], v128 offset:18440
    ds_read_b64_tr_b16 a[148:149], v129 offset:16384
    ds_read_b64_tr_b16 a[150:151], v129 offset:18432
    ds_read_b64_tr_b16 a[212:213], v129 offset:16392
    ds_read_b64_tr_b16 a[214:215], v129 offset:18440
    s_waitcnt lgkmcnt(0)
    s_waitcnt vmcnt(16)
    s_barrier
    s_mov_b32 s79, s71
    s_add_u32 m0, s82, 65536
    s_nop 0
    buffer_load_dwordx4 v2, s[64:67], s79 offen lds
    s_add_u32 s79, s79, s84
    s_add_u32 m0, s82, 66560
    s_nop 0
    buffer_load_dwordx4 v3, s[64:67], s79 offen lds
    s_add_u32 s79, s79, s84
    s_add_u32 m0, s82, 67584
    s_nop 0
    buffer_load_dwordx4 v2, s[64:67], s79 offen lds
    s_add_u32 s79, s79, s84
    s_add_u32 m0, s82, 68608
    s_nop 0
    buffer_load_dwordx4 v3, s[64:67], s79 offen lds
    s_add_u32 s79, s79, s84
    s_add_u32 m0, s82, 69632
    s_nop 0
    buffer_load_dwordx4 v2, s[64:67], s79 offen lds
    s_add_u32 s79, s79, s84
    s_add_u32 m0, s82, 70656
    s_nop 0
    buffer_load_dwordx4 v3, s[64:67], s79 offen lds
    s_add_u32 s79, s79, s84
    s_add_u32 m0, s82, 71680
    s_nop 0
    buffer_load_dwordx4 v2, s[64:67], s79 offen lds
    s_add_u32 s79, s79, s84
    s_add_u32 m0, s82, 72704
    s_nop 0
    buffer_load_dwordx4 v3, s[64:67], s79 offen lds
    s_lshl_b32 s79, s69, 6
    s_add_u32 s71, s71, s79
    ds_read_b64_tr_b16 a[24:25], v128 offset:32768
    ds_read_b64_tr_b16 a[26:27], v128 offset:34816
    ds_read_b64_tr_b16 a[88:89], v128 offset:32776
    ds_read_b64_tr_b16 a[90:91], v128 offset:34824
    ds_read_b64_tr_b16 a[152:153], v129 offset:32768
    ds_read_b64_tr_b16 a[154:155], v129 offset:34816
    ds_read_b64_tr_b16 a[216:217], v129 offset:32776
    ds_read_b64_tr_b16 a[218:219], v129 offset:34824
    ds_read_b64_tr_b16 a[28:29], v128 offset:49152
    ds_read_b64_tr_b16 a[30:31], v128 offset:51200
    ds_read_b64_tr_b16 a[92:93], v128 offset:49160
    ds_read_b64_tr_b16 a[94:95], v128 offset:51208
    ds_read_b64_tr_b16 a[156:157], v129 offset:49152
    ds_read_b64_tr_b16 a[158:159], v129 offset:51200
    ds_read_b64_tr_b16 a[220:221], v129 offset:49160
    ds_read_b64_tr_b16 a[222:223], v129 offset:51208
    s_waitcnt lgkmcnt(0)
    s_waitcnt vmcnt(16)
    s_barrier
    s_mov_b32 s79, s71
    s_add_u32 m0, s82, 98304
    s_nop 0
    buffer_load_dwordx4 v2, s[64:67], s79 offen lds
    s_add_u32 s79, s79, s84
    s_add_u32 m0, s82, 99328
    s_nop 0
    buffer_load_dwordx4 v3, s[64:67], s79 offen lds
    s_add_u32 s79, s79, s84
    s_add_u32 m0, s82, 100352
    s_nop 0
    buffer_load_dwordx4 v2, s[64:67], s79 offen lds
    s_add_u32 s79, s79, s84
    s_add_u32 m0, s82, 101376
    s_nop 0
    buffer_load_dwordx4 v3, s[64:67], s79 offen lds
    s_add_u32 s79, s79, s84
    s_add_u32 m0, s82, 102400
    s_nop 0
    buffer_load_dwordx4 v2, s[64:67], s79 offen lds
    s_add_u32 s79, s79, s84
    s_add_u32 m0, s82, 103424
    s_nop 0
    buffer_load_dwordx4 v3, s[64:67], s79 offen lds
    s_add_u32 s79, s79, s84
    s_add_u32 m0, s82, 104448
    s_nop 0
    buffer_load_dwordx4 v2, s[64:67], s79 offen lds
    s_add_u32 s79, s79, s84
    s_add_u32 m0, s82, 105472
    s_nop 0
    buffer_load_dwordx4 v3, s[64:67], s79 offen lds
    s_lshl_b32 s79, s69, 6
    s_add_u32 s71, s71, s79
    ds_read_b64_tr_b16 a[32:33], v4 offset:0
    ds_read_b64_tr_b16 a[34:35], v4 offset:2048
    ds_read_b64_tr_b16 a[96:97], v4 offset:8
    ds_read_b64_tr_b16 a[98:99], v4 offset:2056
    ds_read_b64_tr_b16 a[160:161], v5 offset:0
    ds_read_b64_tr_b16 a[162:163], v5 offset:2048
    ds_read_b64_tr_b16 a[224:225], v5 offset:8
    ds_read_b64_tr_b16 a[226:227], v5 offset:2056
    ds_read_b64_tr_b16 a[36:37], v4 offset:16384
    ds_read_b64_tr_b16 a[38:39], v4 offset:18432
    ds_read_b64_tr_b16 a[100:101], v4 offset:16392
    ds_read_b64_tr_b16 a[102:103], v4 offset:18440
    ds_read_b64_tr_b16 a[164:165], v5 offset:16384
    ds_read_b64_tr_b16 a[166:167], v5 offset:18432
    ds_read_b64_tr_b16 a[228:229], v5 offset:16392
    ds_read_b64_tr_b16 a[230:231], v5 offset:18440
    s_waitcnt lgkmcnt(0)
    s_waitcnt vmcnt(16)
    s_barrier
    ds_read_b64_tr_b16 a[40:41], v4 offset:32768
    ds_read_b64_tr_b16 a[42:43], v4 offset:34816
    ds_read_b64_tr_b16 a[104:105], v4 offset:32776
    ds_read_b64_tr_b16 a[106:107], v4 offset:34824
    ds_read_b64_tr_b16 a[168:169], v5 offset:32768
    ds_read_b64_tr_b16 a[170:171], v5 offset:34816
    ds_read_b64_tr_b16 a[232:233], v5 offset:32776
    ds_read_b64_tr_b16 a[234:235], v5 offset:34824
    ds_read_b64_tr_b16 a[44:45], v4 offset:49152
    ds_read_b64_tr_b16 a[46:47], v4 offset:51200
    ds_read_b64_tr_b16 a[108:109], v4 offset:49160
    ds_read_b64_tr_b16 a[110:111], v4 offset:51208
    ds_read_b64_tr_b16 a[172:173], v5 offset:49152
    ds_read_b64_tr_b16 a[174:175], v5 offset:51200
    ds_read_b64_tr_b16 a[236:237], v5 offset:49160
    ds_read_b64_tr_b16 a[238:239], v5 offset:51208
    s_waitcnt lgkmcnt(0)
    s_waitcnt vmcnt(8)
    s_barrier
    ds_read_b64_tr_b16 a[48:49], v128 offset:0
    ds_read_b64_tr_b16 a[50:51], v128 offset:2048
    ds_read_b64_tr_b16 a[112:113], v128 offset:8
    ds_read_b64_tr_b16 a[114:115], v128 offset:2056
    ds_read_b64_tr_b16 a[176:177], v129 offset:0
    ds_read_b64_tr_b16 a[178:179], v129 offset:2048
    ds_read_b64_tr_b16 a[240:241], v129 offset:8
    ds_read_b64_tr_b16 a[242:243], v129 offset:2056
    ds_read_b64_tr_b16 a[52:53], v128 offset:16384
    ds_read_b64_tr_b16 a[54:55], v128 offset:18432
    ds_read_b64_tr_b16 a[116:117], v128 offset:16392
    ds_read_b64_tr_b16 a[118:119], v128 offset:18440
    ds_read_b64_tr_b16 a[180:181], v129 offset:16384
    ds_read_b64_tr_b16 a[182:183], v129 offset:18432
    ds_read_b64_tr_b16 a[244:245], v129 offset:16392
    ds_read_b64_tr_b16 a[246:247], v129 offset:18440
    s_waitcnt lgkmcnt(0)
    s_waitcnt vmcnt(0)
    s_barrier
    ds_read_b64_tr_b16 a[56:57], v128 offset:32768
    ds_read_b64_tr_b16 a[58:59], v128 offset:34816
    ds_read_b64_tr_b16 a[120:121], v128 offset:32776
    ds_read_b64_tr_b16 a[122:123], v128 offset:34824
    ds_read_b64_tr_b16 a[184:185], v129 offset:32768
    ds_read_b64_tr_b16 a[186:187], v129 offset:34816
    ds_read_b64_tr_b16 a[248:249], v129 offset:32776
    ds_read_b64_tr_b16 a[250:251], v129 offset:34824
    ds_read_b64_tr_b16 a[60:61], v128 offset:49152
    ds_read_b64_tr_b16 a[62:63], v128 offset:51200
    ds_read_b64_tr_b16 a[124:125], v128 offset:49160
    ds_read_b64_tr_b16 a[126:127], v128 offset:51208
    ds_read_b64_tr_b16 a[188:189], v129 offset:49152
    ds_read_b64_tr_b16 a[190:191], v129 offset:51200
    ds_read_b64_tr_b16 a[252:253], v129 offset:49160
    ds_read_b64_tr_b16 a[254:255], v129 offset:51208
    s_waitcnt lgkmcnt(0)
    s_barrier
    v_and_b32 v10, 63, v0
    s_lshr_b32 s77, s56, 1
    s_lshl_b32 s77, s77, 15
    s_and_b32 s78, s56, 1
    s_lshl_b32 s78, s78, 12
    s_add_u32 s81, s77, s78
    v_lshlrev_b32 v6, 4, v10
    v_add_u32 v6, s81, v6
    v_and_b32 v11, 15, v10
    v_lshrrev_b32 v12, 4, v10
    v_lshrrev_b32 v13, 2, v11
    v_and_b32 v14, 3, v11
    v_lshl_add_u32 v15, v13, 3, v14
    v_lshlrev_b32 v15, 10, v15
    v_add_u32 v9, 0, v12
    v_xor_b32 v9, v9, v11
    v_lshl_add_u32 v128, v9, 4, v15
    v_add_u32 v132, 65536, v128
    v_add_u32 v9, 4, v12
    v_xor_b32 v9, v9, v11
    v_lshl_add_u32 v129, v9, 4, v15
    v_add_u32 v133, 65536, v129
    v_add_u32 v9, 8, v12
    v_xor_b32 v9, v9, v11
    v_lshl_add_u32 v130, v9, 4, v15
    v_add_u32 v134, 65536, v130
    v_add_u32 v9, 12, v12
    v_xor_b32 v9, v9, v11
    v_lshl_add_u32 v131, v9, 4, v15
    v_add_u32 v135, 65536, v131
    s_lshl_b32 s70, s89, 17
    v_lshlrev_b32 v1, 4, v10
    s_lshl_b32 s73, s89, 7
    s_lshl_b32 s77, s90, 1
    s_add_u32 s73, s73, s77
    s_lshr_b32 s77, s56, 1
    s_add_u32 s73, s73, s77
    s_lshl_b32 s73, s73, 2
    s_and_b32 s77, s56, 1
    s_lshl_b32 s77, s77, 1
    s_add_u32 s73, s73, s77
    s_cmp_eq_u32 s91, 2
    s_cselect_b32 s74, 11, 12
    s_cselect_b32 s75, 0, 16777216
    s_cselect_b32 s68, 65536, 1
    s_lshl_b32 s73, s73, s74
    s_add_u32 s73, s73, s75
    s_lshl_b32 s76, 1, s74
    s_cmp_eq_u32 s91, 1
    s_cbranch_scc1 L_g1_v
    v_xor_b32 v7, 0, v6
    s_add_u32 m0, s81, 0
    s_add_u32 s79, s70, 0
    buffer_load_dwordx4 v7, s[60:63], s79 offen sc1 lds
    v_xor_b32 v7, 16, v6
    s_add_u32 m0, s81, 1024
    s_add_u32 s79, s70, 1024
    buffer_load_dwordx4 v7, s[60:63], s79 offen sc1 lds
    v_xor_b32 v7, 32, v6
    s_add_u32 m0, s81, 2048
    s_add_u32 s79, s70, 2048
    buffer_load_dwordx4 v7, s[60:63], s79 offen sc1 lds
    v_xor_b32 v7, 48, v6
    s_add_u32 m0, s81, 3072
    s_add_u32 s79, s70, 3072
    buffer_load_dwordx4 v7, s[60:63], s79 offen sc1 lds
    v_xor_b32 v7, 64, v6
    s_add_u32 m0, s81, 8192
    s_add_u32 s79, s70, 8192
    buffer_load_dwordx4 v7, s[60:63], s79 offen sc1 lds
    v_xor_b32 v7, 80, v6
    s_add_u32 m0, s81, 9216
    s_add_u32 s79, s70, 9216
    buffer_load_dwordx4 v7, s[60:63], s79 offen sc1 lds
    v_xor_b32 v7, 96, v6
    s_add_u32 m0, s81, 10240
    s_add_u32 s79, s70, 10240
    buffer_load_dwordx4 v7, s[60:63], s79 offen sc1 lds
    v_xor_b32 v7, 112, v6
    s_add_u32 m0, s81, 11264
    s_add_u32 s79, s70, 11264
    buffer_load_dwordx4 v7, s[60:63], s79 offen sc1 lds
    v_xor_b32 v7, 128, v6
    s_add_u32 m0, s81, 16384
    s_add_u32 s79, s70, 16384
    buffer_load_dwordx4 v7, s[60:63], s79 offen sc1 lds
    v_xor_b32 v7, 144, v6
    s_add_u32 m0, s81, 17408
    s_add_u32 s79, s70, 17408
    buffer_load_dwordx4 v7, s[60:63], s79 offen sc1 lds
    v_xor_b32 v7, 160, v6
    s_add_u32 m0, s81, 18432
    s_add_u32 s79, s70, 18432
    buffer_load_dwordx4 v7, s[60:63], s79 offen sc1 lds
    v_xor_b32 v7, 176, v6
    s_add_u32 m0, s81, 19456
    s_add_u32 s79, s70, 19456
    buffer_load_dwordx4 v7, s[60:63], s79 offen sc1 lds
    v_xor_b32 v7, 192, v6
    s_add_u32 m0, s81, 24576
    s_add_u32 s79, s70, 24576
    buffer_load_dwordx4 v7, s[60:63], s79 offen sc1 lds
    v_xor_b32 v7, 208, v6
    s_add_u32 m0, s81, 25600
    s_add_u32 s79, s70, 25600
    buffer_load_dwordx4 v7, s[60:63], s79 offen sc1 lds
    v_xor_b32 v7, 224, v6
    s_add_u32 m0, s81, 26624
    s_add_u32 s79, s70, 26624
    buffer_load_dwordx4 v7, s[60:63], s79 offen sc1 lds
    v_xor_b32 v7, 240, v6
    s_add_u32 m0, s81, 27648
    s_add_u32 s79, s70, 27648
    buffer_load_dwordx4 v7, s[60:63], s79 offen sc1 lds
    s_add_u32 s70, s70, 65536
    s_mov_b32 s83, 0
    s_waitcnt vmcnt(0)
L_wsg1t_150:
    s_waitcnt vmcnt(8)
    s_barrier
    ds_read_b128 v[16:19], v128 offset:0
    ds_read_b128 v[20:23], v128 offset:4096
    ds_read_b128 v[24:27], v128 offset:32768
    ds_read_b128 v[28:31], v128 offset:36864
    ds_read_b128 v[32:35], v129 offset:0
    ds_read_b128 v[36:39], v129 offset:4096
    ds_read_b128 v[40:43], v129 offset:32768
    ds_read_b128 v[44:47], v129 offset:36864
    s_waitcnt lgkmcnt(4)
    v_mfma_f32_16x16x32_bf16 v[48:51], a[0:3], v[16:19], 0
    v_mfma_f32_16x16x32_bf16 v[52:55], a[64:67], v[16:19], 0
    v_mfma_f32_16x16x32_bf16 v[56:59], a[128:131], v[16:19], 0
    v_mfma_f32_16x16x32_bf16 v[60:63], a[192:195], v[16:19], 0
    v_xor_b32 v7, 0, v6
    s_add_u32 m0, s81, 65536
    s_add_u32 s79, s70, 0
    buffer_load_dwordx4 v7, s[60:63], s79 offen sc1 lds
    v_mfma_f32_16x16x32_bf16 v[64:67], a[0:3], v[20:23], 0
    v_mfma_f32_16x16x32_bf16 v[68:71], a[64:67], v[20:23], 0
    v_mfma_f32_16x16x32_bf16 v[72:75], a[128:131], v[20:23], 0
    v_mfma_f32_16x16x32_bf16 v[76:79], a[192:195], v[20:23], 0
    v_mfma_f32_16x16x32_bf16 v[80:83], a[0:3], v[24:27], 0
    v_mfma_f32_16x16x32_bf16 v[84:87], a[64:67], v[24:27], 0
    v_mfma_f32_16x16x32_bf16 v[88:91], a[128:131], v[24:27], 0
    v_mfma_f32_16x16x32_bf16 v[92:95], a[192:195], v[24:27], 0
    v_mfma_f32_16x16x32_bf16 v[96:99], a[0:3], v[28:31], 0
    v_mfma_f32_16x16x32_bf16 v[100:103], a[64:67], v[28:31], 0
    v_mfma_f32_16x16x32_bf16 v[104:107], a[128:131], v[28:31], 0
    v_mfma_f32_16x16x32_bf16 v[108:111], a[192:195], v[28:31], 0
    ds_read_b128 v[16:19], v130 offset:0
    ds_read_b128 v[20:23], v130 offset:4096
    ds_read_b128 v[24:27], v130 offset:32768
    ds_read_b128 v[28:31], v130 offset:36864
    s_waitcnt lgkmcnt(4)
    v_mfma_f32_16x16x32_bf16 v[48:51], a[4:7], v[32:35], v[48:51]
    v_mfma_f32_16x16x32_bf16 v[52:55], a[68:71], v[32:35], v[52:55]
    v_mfma_f32_16x16x32_bf16 v[56:59], a[132:135], v[32:35], v[56:59]
    v_mfma_f32_16x16x32_bf16 v[60:63], a[196:199], v[32:35], v[60:63]
    v_xor_b32 v7, 16, v6
    s_add_u32 m0, s81, 66560
    s_add_u32 s79, s70, 1024
    buffer_load_dwordx4 v7, s[60:63], s79 offen sc1 lds
    v_mfma_f32_16x16x32_bf16 v[64:67], a[4:7], v[36:39], v[64:67]
    v_mfma_f32_16x16x32_bf16 v[68:71], a[68:71], v[36:39], v[68:71]
    v_mfma_f32_16x16x32_bf16 v[72:75], a[132:135], v[36:39], v[72:75]
    v_mfma_f32_16x16x32_bf16 v[76:79], a[196:199], v[36:39], v[76:79]
    v_mfma_f32_16x16x32_bf16 v[80:83], a[4:7], v[40:43], v[80:83]
    v_mfma_f32_16x16x32_bf16 v[84:87], a[68:71], v[40:43], v[84:87]
    v_mfma_f32_16x16x32_bf16 v[88:91], a[132:135], v[40:43], v[88:91]
    v_mfma_f32_16x16x32_bf16 v[92:95], a[196:199], v[40:43], v[92:95]
    v_mfma_f32_16x16x32_bf16 v[96:99], a[4:7], v[44:47], v[96:99]
    v_mfma_f32_16x16x32_bf16 v[100:103], a[68:71], v[44:47], v[100:103]
    v_mfma_f32_16x16x32_bf16 v[104:107], a[132:135], v[44:47], v[104:107]
    v_mfma_f32_16x16x32_bf16 v[108:111], a[196:199], v[44:47], v[108:111]
    ds_read_b128 v[32:35], v131 offset:0
    ds_read_b128 v[36:39], v131 offset:4096
    ds_read_b128 v[40:43], v131 offset:32768
    ds_read_b128 v[44:47], v131 offset:36864
    s_waitcnt lgkmcnt(4)
    v_mfma_f32_16x16x32_bf16 v[48:51], a[8:11], v[16:19], v[48:51]
    v_mfma_f32_16x16x32_bf16 v[52:55], a[72:75], v[16:19], v[52:55]
    v_mfma_f32_16x16x32_bf16 v[56:59], a[136:139], v[16:19], v[56:59]
    v_mfma_f32_16x16x32_bf16 v[60:63], a[200:203], v[16:19], v[60:63]
    v_xor_b32 v7, 32, v6
    s_add_u32 m0, s81, 67584
    s_add_u32 s79, s70, 2048
    buffer_load_dwordx4 v7, s[60:63], s79 offen sc1 lds
    v_mfma_f32_16x16x32_bf16 v[64:67], a[8:11], v[20:23], v[64:67]
    v_mfma_f32_16x16x32_bf16 v[68:71], a[72:75], v[20:23], v[68:71]
    v_mfma_f32_16x16x32_bf16 v[72:75], a[136:139], v[20:23], v[72:75]
    v_mfma_f32_16x16x32_bf16 v[76:79], a[200:203], v[20:23], v[76:79]
    v_mfma_f32_16x16x32_bf16 v[80:83], a[8:11], v[24:27], v[80:83]
    v_mfma_f32_16x16x32_bf16 v[84:87], a[72:75], v[24:27], v[84:87]
    v_mfma_f32_16x16x32_bf16 v[88:91], a[136:139], v[24:27], v[88:91]
    v_mfma_f32_16x16x32_bf16 v[92:95], a[200:203], v[24:27], v[92:95]
    v_mfma_f32_16x16x32_bf16 v[96:99], a[8:11], v[28:31], v[96:99]
    v_mfma_f32_16x16x32_bf16 v[100:103], a[72:75], v[28:31], v[100:103]
    v_mfma_f32_16x16x32_bf16 v[104:107], a[136:139], v[28:31], v[104:107]
    v_mfma_f32_16x16x32_bf16 v[108:111], a[200:203], v[28:31], v[108:111]
    ds_read_b128 v[16:19], v128 offset:256
    ds_read_b128 v[20:23], v128 offset:4352
    ds_read_b128 v[24:27], v128 offset:33024
    ds_read_b128 v[28:31], v128 offset:37120
    s_waitcnt lgkmcnt(4)
    v_mfma_f32_16x16x32_bf16 v[48:51], a[12:15], v[32:35], v[48:51]
    v_mfma_f32_16x16x32_bf16 v[52:55], a[76:79], v[32:35], v[52:55]
    v_mfma_f32_16x16x32_bf16 v[56:59], a[140:143], v[32:35], v[56:59]
    v_mfma_f32_16x16x32_bf16 v[60:63], a[204:207], v[32:35], v[60:63]
    v_xor_b32 v7, 48, v6
    s_add_u32 m0, s81, 68608
    s_add_u32 s79, s70, 3072
    buffer_load_dwordx4 v7, s[60:63], s79 offen sc1 lds
    v_mfma_f32_16x16x32_bf16 v[64:67], a[12:15], v[36:39], v[64:67]
    v_mfma_f32_16x16x32_bf16 v[68:71], a[76:79], v[36:39], v[68:71]
    v_mfma_f32_16x16x32_bf16 v[72:75], a[140:143], v[36:39], v[72:75]
    v_mfma_f32_16x16x32_bf16 v[76:79], a[204:207], v[36:39], v[76:79]
    v_mfma_f32_16x16x32_bf16 v[80:83], a[12:15], v[40:43], v[80:83]
    v_mfma_f32_16x16x32_bf16 v[84:87], a[76:79], v[40:43], v[84:87]
    v_mfma_f32_16x16x32_bf16 v[88:91], a[140:143], v[40:43], v[88:91]
    v_mfma_f32_16x16x32_bf16 v[92:95], a[204:207], v[40:43], v[92:95]
    v_mfma_f32_16x16x32_bf16 v[96:99], a[12:15], v[44:47], v[96:99]
    v_mfma_f32_16x16x32_bf16 v[100:103], a[76:79], v[44:47], v[100:103]
    v_mfma_f32_16x16x32_bf16 v[104:107], a[140:143], v[44:47], v[104:107]
    v_mfma_f32_16x16x32_bf16 v[108:111], a[204:207], v[44:47], v[108:111]
    ds_read_b128 v[32:35], v129 offset:256
    ds_read_b128 v[36:39], v129 offset:4352
    ds_read_b128 v[40:43], v129 offset:33024
    ds_read_b128 v[44:47], v129 offset:37120
    s_waitcnt lgkmcnt(4)
    v_mfma_f32_16x16x32_bf16 v[48:51], a[16:19], v[16:19], v[48:51]
    v_mfma_f32_16x16x32_bf16 v[52:55], a[80:83], v[16:19], v[52:55]
    v_mfma_f32_16x16x32_bf16 v[56:59], a[144:147], v[16:19], v[56:59]
    v_mfma_f32_16x16x32_bf16 v[60:63], a[208:211], v[16:19], v[60:63]
    v_xor_b32 v7, 64, v6
    s_add_u32 m0, s81, 73728
    s_add_u32 s79, s70, 8192
    buffer_load_dwordx4 v7, s[60:63], s79 offen sc1 lds
    v_mfma_f32_16x16x32_bf16 v[64:67], a[16:19], v[20:23], v[64:67]
    v_mfma_f32_16x16x32_bf16 v[68:71], a[80:83], v[20:23], v[68:71]
    v_mfma_f32_16x16x32_bf16 v[72:75], a[144:147], v[20:23], v[72:75]
    v_mfma_f32_16x16x32_bf16 v[76:79], a[208:211], v[20:23], v[76:79]
    v_mfma_f32_16x16x32_bf16 v[80:83], a[16:19], v[24:27], v[80:83]
    v_mfma_f32_16x16x32_bf16 v[84:87], a[80:83], v[24:27], v[84:87]
    v_mfma_f32_16x16x32_bf16 v[88:91], a[144:147], v[24:27], v[88:91]
    v_mfma_f32_16x16x32_bf16 v[92:95], a[208:211], v[24:27], v[92:95]
    v_mfma_f32_16x16x32_bf16 v[96:99], a[16:19], v[28:31], v[96:99]
    v_mfma_f32_16x16x32_bf16 v[100:103], a[80:83], v[28:31], v[100:103]
    v_mfma_f32_16x16x32_bf16 v[104:107], a[144:147], v[28:31], v[104:107]
    v_mfma_f32_16x16x32_bf16 v[108:111], a[208:211], v[28:31], v[108:111]
    ds_read_b128 v[16:19], v130 offset:256
    ds_read_b128 v[20:23], v130 offset:4352
    ds_read_b128 v[24:27], v130 offset:33024
    ds_read_b128 v[28:31], v130 offset:37120
    s_waitcnt lgkmcnt(4)
    v_mfma_f32_16x16x32_bf16 v[48:51], a[20:23], v[32:35], v[48:51]
    v_mfma_f32_16x16x32_bf16 v[52:55], a[84:87], v[32:35], v[52:55]
    v_mfma_f32_16x16x32_bf16 v[56:59], a[148:151], v[32:35], v[56:59]
    v_mfma_f32_16x16x32_bf16 v[60:63], a[212:215], v[32:35], v[60:63]
    v_xor_b32 v7, 80, v6
    s_add_u32 m0, s81, 74752
    s_add_u32 s79, s70, 9216
    buffer_load_dwordx4 v7, s[60:63], s79 offen sc1 lds
    v_mfma_f32_16x16x32_bf16 v[64:67], a[20:23], v[36:39], v[64:67]
    v_mfma_f32_16x16x32_bf16 v[68:71], a[84:87], v[36:39], v[68:71]
    v_mfma_f32_16x16x32_bf16 v[72:75], a[148:151], v[36:39], v[72:75]
    v_mfma_f32_16x16x32_bf16 v[76:79], a[212:215], v[36:39], v[76:79]
    v_mfma_f32_16x16x32_bf16 v[80:83], a[20:23], v[40:43], v[80:83]
    v_mfma_f32_16x16x32_bf16 v[84:87], a[84:87], v[40:43], v[84:87]
    v_mfma_f32_16x16x32_bf16 v[88:91], a[148:151], v[40:43], v[88:91]
    v_mfma_f32_16x16x32_bf16 v[92:95], a[212:215], v[40:43], v[92:95]
    v_mfma_f32_16x16x32_bf16 v[96:99], a[20:23], v[44:47], v[96:99]
    v_mfma_f32_16x16x32_bf16 v[100:103], a[84:87], v[44:47], v[100:103]
    v_mfma_f32_16x16x32_bf16 v[104:107], a[148:151], v[44:47], v[104:107]
    v_mfma_f32_16x16x32_bf16 v[108:111], a[212:215], v[44:47], v[108:111]
    ds_read_b128 v[32:35], v131 offset:256
    ds_read_b128 v[36:39], v131 offset:4352
    ds_read_b128 v[40:43], v131 offset:33024
    ds_read_b128 v[44:47], v131 offset:37120
    s_waitcnt lgkmcnt(4)
    v_mfma_f32_16x16x32_bf16 v[48:51], a[24:27], v[16:19], v[48:51]
    v_mfma_f32_16x16x32_bf16 v[52:55], a[88:91], v[16:19], v[52:55]
    v_mfma_f32_16x16x32_bf16 v[56:59], a[152:155], v[16:19], v[56:59]
    v_mfma_f32_16x16x32_bf16 v[60:63], a[216:219], v[16:19], v[60:63]
    v_xor_b32 v7, 96, v6
    s_add_u32 m0, s81, 75776
    s_add_u32 s79, s70, 10240
    buffer_load_dwordx4 v7, s[60:63], s79 offen sc1 lds
    v_mfma_f32_16x16x32_bf16 v[64:67], a[24:27], v[20:23], v[64:67]
    v_mfma_f32_16x16x32_bf16 v[68:71], a[88:91], v[20:23], v[68:71]
    v_mfma_f32_16x16x32_bf16 v[72:75], a[152:155], v[20:23], v[72:75]
    v_mfma_f32_16x16x32_bf16 v[76:79], a[216:219], v[20:23], v[76:79]
    v_mfma_f32_16x16x32_bf16 v[80:83], a[24:27], v[24:27], v[80:83]
    v_mfma_f32_16x16x32_bf16 v[84:87], a[88:91], v[24:27], v[84:87]
    v_mfma_f32_16x16x32_bf16 v[88:91], a[152:155], v[24:27], v[88:91]
    v_mfma_f32_16x16x32_bf16 v[92:95], a[216:219], v[24:27], v[92:95]
    v_mfma_f32_16x16x32_bf16 v[96:99], a[24:27], v[28:31], v[96:99]
    v_mfma_f32_16x16x32_bf16 v[100:103], a[88:91], v[28:31], v[100:103]
    v_mfma_f32_16x16x32_bf16 v[104:107], a[152:155], v[28:31], v[104:107]
    v_mfma_f32_16x16x32_bf16 v[108:111], a[216:219], v[28:31], v[108:111]
    ds_read_b128 v[16:19], v128 offset:512
    ds_read_b128 v[20:23], v128 offset:4608
    ds_read_b128 v[24:27], v128 offset:33280
    ds_read_b128 v[28:31], v128 offset:37376
    s_waitcnt lgkmcnt(4)
    v_mfma_f32_16x16x32_bf16 v[48:51], a[28:31], v[32:35], v[48:51]
    v_mfma_f32_16x16x32_bf16 v[52:55], a[92:95], v[32:35], v[52:55]
    v_mfma_f32_16x16x32_bf16 v[56:59], a[156:159], v[32:35], v[56:59]
    v_mfma_f32_16x16x32_bf16 v[60:63], a[220:223], v[32:35], v[60:63]
    v_xor_b32 v7, 112, v6
    s_add_u32 m0, s81, 76800
    s_add_u32 s79, s70, 11264
    buffer_load_dwordx4 v7, s[60:63], s79 offen sc1 lds
    v_mfma_f32_16x16x32_bf16 v[64:67], a[28:31], v[36:39], v[64:67]
    v_mfma_f32_16x16x32_bf16 v[68:71], a[92:95], v[36:39], v[68:71]
    v_mfma_f32_16x16x32_bf16 v[72:75], a[156:159], v[36:39], v[72:75]
    v_mfma_f32_16x16x32_bf16 v[76:79], a[220:223], v[36:39], v[76:79]
    v_mfma_f32_16x16x32_bf16 v[80:83], a[28:31], v[40:43], v[80:83]
    v_mfma_f32_16x16x32_bf16 v[84:87], a[92:95], v[40:43], v[84:87]
    v_mfma_f32_16x16x32_bf16 v[88:91], a[156:159], v[40:43], v[88:91]
    v_mfma_f32_16x16x32_bf16 v[92:95], a[220:223], v[40:43], v[92:95]
    v_mfma_f32_16x16x32_bf16 v[96:99], a[28:31], v[44:47], v[96:99]
    v_mfma_f32_16x16x32_bf16 v[100:103], a[92:95], v[44:47], v[100:103]
    v_mfma_f32_16x16x32_bf16 v[104:107], a[156:159], v[44:47], v[104:107]
    v_mfma_f32_16x16x32_bf16 v[108:111], a[220:223], v[44:47], v[108:111]
    ds_read_b128 v[32:35], v129 offset:512
    ds_read_b128 v[36:39], v129 offset:4608
    ds_read_b128 v[40:43], v129 offset:33280
    ds_read_b128 v[44:47], v129 offset:37376
    s_waitcnt lgkmcnt(4)
    v_mfma_f32_16x16x32_bf16 v[48:51], a[32:35], v[16:19], v[48:51]
    v_mfma_f32_16x16x32_bf16 v[52:55], a[96:99], v[16:19], v[52:55]
    v_mfma_f32_16x16x32_bf16 v[56:59], a[160:163], v[16:19], v[56:59]
    v_mfma_f32_16x16x32_bf16 v[60:63], a[224:227], v[16:19], v[60:63]
    v_xor_b32 v7, 128, v6
    s_add_u32 m0, s81, 81920
    s_add_u32 s79, s70, 16384
    buffer_load_dwordx4 v7, s[60:63], s79 offen sc1 lds
    v_mfma_f32_16x16x32_bf16 v[64:67], a[32:35], v[20:23], v[64:67]
    v_mfma_f32_16x16x32_bf16 v[68:71], a[96:99], v[20:23], v[68:71]
    v_mfma_f32_16x16x32_bf16 v[72:75], a[160:163], v[20:23], v[72:75]
    v_mfma_f32_16x16x32_bf16 v[76:79], a[224:227], v[20:23], v[76:79]
    v_mfma_f32_16x16x32_bf16 v[80:83], a[32:35], v[24:27], v[80:83]
    v_mfma_f32_16x16x32_bf16 v[84:87], a[96:99], v[24:27], v[84:87]
    v_mfma_f32_16x16x32_bf16 v[88:91], a[160:163], v[24:27], v[88:91]
    v_mfma_f32_16x16x32_bf16 v[92:95], a[224:227], v[24:27], v[92:95]
    v_mfma_f32_16x16x32_bf16 v[96:99], a[32:35], v[28:31], v[96:99]
    v_mfma_f32_16x16x32_bf16 v[100:103], a[96:99], v[28:31], v[100:103]
    v_mfma_f32_16x16x32_bf16 v[104:107], a[160:163], v[28:31], v[104:107]
    v_mfma_f32_16x16x32_bf16 v[108:111], a[224:227], v[28:31], v[108:111]
    ds_read_b128 v[16:19], v130 offset:512
    ds_read_b128 v[20:23], v130 offset:4608
    ds_read_b128 v[24:27], v130 offset:33280
    ds_read_b128 v[28:31], v130 offset:37376
    s_waitcnt lgkmcnt(4)
    v_mfma_f32_16x16x32_bf16 v[48:51], a[36:39], v[32:35], v[48:51]
    v_mfma_f32_16x16x32_bf16 v[52:55], a[100:103], v[32:35], v[52:55]
    v_mfma_f32_16x16x32_bf16 v[56:59], a[164:167], v[32:35], v[56:59]
    v_mfma_f32_16x16x32_bf16 v[60:63], a[228:231], v[32:35], v[60:63]
    v_xor_b32 v7, 144, v6
    s_add_u32 m0, s81, 82944
    s_add_u32 s79, s70, 17408
    buffer_load_dwordx4 v7, s[60:63], s79 offen sc1 lds
    v_mfma_f32_16x16x32_bf16 v[64:67], a[36:39], v[36:39], v[64:67]
    v_mfma_f32_16x16x32_bf16 v[68:71], a[100:103], v[36:39], v[68:71]
    v_mfma_f32_16x16x32_bf16 v[72:75], a[164:167], v[36:39], v[72:75]
    v_mfma_f32_16x16x32_bf16 v[76:79], a[228:231], v[36:39], v[76:79]
    v_mfma_f32_16x16x32_bf16 v[80:83], a[36:39], v[40:43], v[80:83]
    v_mfma_f32_16x16x32_bf16 v[84:87], a[100:103], v[40:43], v[84:87]
    v_mfma_f32_16x16x32_bf16 v[88:91], a[164:167], v[40:43], v[88:91]
    v_mfma_f32_16x16x32_bf16 v[92:95], a[228:231], v[40:43], v[92:95]
    v_mfma_f32_16x16x32_bf16 v[96:99], a[36:39], v[44:47], v[96:99]
    v_mfma_f32_16x16x32_bf16 v[100:103], a[100:103], v[44:47], v[100:103]
    v_mfma_f32_16x16x32_bf16 v[104:107], a[164:167], v[44:47], v[104:107]
    v_mfma_f32_16x16x32_bf16 v[108:111], a[228:231], v[44:47], v[108:111]
    ds_read_b128 v[32:35], v131 offset:512
    ds_read_b128 v[36:39], v131 offset:4608
    ds_read_b128 v[40:43], v131 offset:33280
    ds_read_b128 v[44:47], v131 offset:37376
    s_waitcnt lgkmcnt(4)
    v_mfma_f32_16x16x32_bf16 v[48:51], a[40:43], v[16:19], v[48:51]
    v_mfma_f32_16x16x32_bf16 v[52:55], a[104:107], v[16:19], v[52:55]
    v_mfma_f32_16x16x32_bf16 v[56:59], a[168:171], v[16:19], v[56:59]
    v_mfma_f32_16x16x32_bf16 v[60:63], a[232:235], v[16:19], v[60:63]
    v_xor_b32 v7, 160, v6
    s_add_u32 m0, s81, 83968
    s_add_u32 s79, s70, 18432
    buffer_load_dwordx4 v7, s[60:63], s79 offen sc1 lds
    v_mfma_f32_16x16x32_bf16 v[64:67], a[40:43], v[20:23], v[64:67]
    v_mfma_f32_16x16x32_bf16 v[68:71], a[104:107], v[20:23], v[68:71]
    v_mfma_f32_16x16x32_bf16 v[72:75], a[168:171], v[20:23], v[72:75]
    v_mfma_f32_16x16x32_bf16 v[76:79], a[232:235], v[20:23], v[76:79]
    v_mfma_f32_16x16x32_bf16 v[80:83], a[40:43], v[24:27], v[80:83]
    v_mfma_f32_16x16x32_bf16 v[84:87], a[104:107], v[24:27], v[84:87]
    v_mfma_f32_16x16x32_bf16 v[88:91], a[168:171], v[24:27], v[88:91]
    v_mfma_f32_16x16x32_bf16 v[92:95], a[232:235], v[24:27], v[92:95]
    v_mfma_f32_16x16x32_bf16 v[96:99], a[40:43], v[28:31], v[96:99]
    v_mfma_f32_16x16x32_bf16 v[100:103], a[104:107], v[28:31], v[100:103]
    v_mfma_f32_16x16x32_bf16 v[104:107], a[168:171], v[28:31], v[104:107]
    v_mfma_f32_16x16x32_bf16 v[108:111], a[232:235], v[28:31], v[108:111]
    ds_read_b128 v[16:19], v128 offset:768
    ds_read_b128 v[20:23], v128 offset:4864
    ds_read_b128 v[24:27], v128 offset:33536
    ds_read_b128 v[28:31], v128 offset:37632
    s_waitcnt lgkmcnt(4)
    v_mfma_f32_16x16x32_bf16 v[48:51], a[44:47], v[32:35], v[48:51]
    v_mfma_f32_16x16x32_bf16 v[52:55], a[108:111], v[32:35], v[52:55]
    v_mfma_f32_16x16x32_bf16 v[56:59], a[172:175], v[32:35], v[56:59]
    v_mfma_f32_16x16x32_bf16 v[60:63], a[236:239], v[32:35], v[60:63]
    v_xor_b32 v7, 176, v6
    s_add_u32 m0, s81, 84992
    s_add_u32 s79, s70, 19456
    buffer_load_dwordx4 v7, s[60:63], s79 offen sc1 lds
    v_mfma_f32_16x16x32_bf16 v[64:67], a[44:47], v[36:39], v[64:67]
    v_mfma_f32_16x16x32_bf16 v[68:71], a[108:111], v[36:39], v[68:71]
    v_mfma_f32_16x16x32_bf16 v[72:75], a[172:175], v[36:39], v[72:75]
    v_mfma_f32_16x16x32_bf16 v[76:79], a[236:239], v[36:39], v[76:79]
    v_mfma_f32_16x16x32_bf16 v[80:83], a[44:47], v[40:43], v[80:83]
    v_mfma_f32_16x16x32_bf16 v[84:87], a[108:111], v[40:43], v[84:87]
    v_mfma_f32_16x16x32_bf16 v[88:91], a[172:175], v[40:43], v[88:91]
    v_mfma_f32_16x16x32_bf16 v[92:95], a[236:239], v[40:43], v[92:95]
    v_mfma_f32_16x16x32_bf16 v[96:99], a[44:47], v[44:47], v[96:99]
    v_mfma_f32_16x16x32_bf16 v[100:103], a[108:111], v[44:47], v[100:103]
    v_mfma_f32_16x16x32_bf16 v[104:107], a[172:175], v[44:47], v[104:107]
    v_mfma_f32_16x16x32_bf16 v[108:111], a[236:239], v[44:47], v[108:111]
    ds_read_b128 v[32:35], v129 offset:768
    ds_read_b128 v[36:39], v129 offset:4864
    ds_read_b128 v[40:43], v129 offset:33536
    ds_read_b128 v[44:47], v129 offset:37632
    s_waitcnt lgkmcnt(4)
    v_mfma_f32_16x16x32_bf16 v[48:51], a[48:51], v[16:19], v[48:51]
    v_mfma_f32_16x16x32_bf16 v[52:55], a[112:115], v[16:19], v[52:55]
    v_mfma_f32_16x16x32_bf16 v[56:59], a[176:179], v[16:19], v[56:59]
    v_mfma_f32_16x16x32_bf16 v[60:63], a[240:243], v[16:19], v[60:63]
    v_xor_b32 v7, 192, v6
    s_add_u32 m0, s81, 90112
    s_add_u32 s79, s70, 24576
    buffer_load_dwordx4 v7, s[60:63], s79 offen sc1 lds
    v_mfma_f32_16x16x32_bf16 v[64:67], a[48:51], v[20:23], v[64:67]
    v_mfma_f32_16x16x32_bf16 v[68:71], a[112:115], v[20:23], v[68:71]
    v_mfma_f32_16x16x32_bf16 v[72:75], a[176:179], v[20:23], v[72:75]
    v_mfma_f32_16x16x32_bf16 v[76:79], a[240:243], v[20:23], v[76:79]
    v_mfma_f32_16x16x32_bf16 v[80:83], a[48:51], v[24:27], v[80:83]
    v_mfma_f32_16x16x32_bf16 v[84:87], a[112:115], v[24:27], v[84:87]
    v_mfma_f32_16x16x32_bf16 v[88:91], a[176:179], v[24:27], v[88:91]
    v_mfma_f32_16x16x32_bf16 v[92:95], a[240:243], v[24:27], v[92:95]
    v_mfma_f32_16x16x32_bf16 v[96:99], a[48:51], v[28:31], v[96:99]
    v_mfma_f32_16x16x32_bf16 v[100:103], a[112:115], v[28:31], v[100:103]
    v_mfma_f32_16x16x32_bf16 v[104:107], a[176:179], v[28:31], v[104:107]
    v_mfma_f32_16x16x32_bf16 v[108:111], a[240:243], v[28:31], v[108:111]
    ds_read_b128 v[16:19], v130 offset:768
    ds_read_b128 v[20:23], v130 offset:4864
    ds_read_b128 v[24:27], v130 offset:33536
    ds_read_b128 v[28:31], v130 offset:37632
    s_waitcnt lgkmcnt(4)
    v_mfma_f32_16x16x32_bf16 v[48:51], a[52:55], v[32:35], v[48:51]
    v_mfma_f32_16x16x32_bf16 v[52:55], a[116:119], v[32:35], v[52:55]
    v_mfma_f32_16x16x32_bf16 v[56:59], a[180:183], v[32:35], v[56:59]
    v_mfma_f32_16x16x32_bf16 v[60:63], a[244:247], v[32:35], v[60:63]
    v_xor_b32 v7, 208, v6
    s_add_u32 m0, s81, 91136
    s_add_u32 s79, s70, 25600
    buffer_load_dwordx4 v7, s[60:63], s79 offen sc1 lds
    v_mfma_f32_16x16x32_bf16 v[64:67], a[52:55], v[36:39], v[64:67]
    v_mfma_f32_16x16x32_bf16 v[68:71], a[116:119], v[36:39], v[68:71]
    v_mfma_f32_16x16x32_bf16 v[72:75], a[180:183], v[36:39], v[72:75]
    v_mfma_f32_16x16x32_bf16 v[76:79], a[244:247], v[36:39], v[76:79]
    v_mfma_f32_16x16x32_bf16 v[80:83], a[52:55], v[40:43], v[80:83]
    v_mfma_f32_16x16x32_bf16 v[84:87], a[116:119], v[40:43], v[84:87]
    v_mfma_f32_16x16x32_bf16 v[88:91], a[180:183], v[40:43], v[88:91]
    v_mfma_f32_16x16x32_bf16 v[92:95], a[244:247], v[40:43], v[92:95]
    v_mfma_f32_16x16x32_bf16 v[96:99], a[52:55], v[44:47], v[96:99]
    v_mfma_f32_16x16x32_bf16 v[100:103], a[116:119], v[44:47], v[100:103]
    v_mfma_f32_16x16x32_bf16 v[104:107], a[180:183], v[44:47], v[104:107]
    v_mfma_f32_16x16x32_bf16 v[108:111], a[244:247], v[44:47], v[108:111]
    ds_read_b128 v[32:35], v131 offset:768
    ds_read_b128 v[36:39], v131 offset:4864
    ds_read_b128 v[40:43], v131 offset:33536
    ds_read_b128 v[44:47], v131 offset:37632
    s_waitcnt lgkmcnt(4)
    v_mfma_f32_16x16x32_bf16 v[48:51], a[56:59], v[16:19], v[48:51]
    v_mfma_f32_16x16x32_bf16 v[52:55], a[120:123], v[16:19], v[52:55]
    v_mfma_f32_16x16x32_bf16 v[56:59], a[184:187], v[16:19], v[56:59]
    v_mfma_f32_16x16x32_bf16 v[60:63], a[248:251], v[16:19], v[60:63]
    v_xor_b32 v7, 224, v6
    s_add_u32 m0, s81, 92160
    s_add_u32 s79, s70, 26624
    buffer_load_dwordx4 v7, s[60:63], s79 offen sc1 lds
    v_mfma_f32_16x16x32_bf16 v[64:67], a[56:59], v[20:23], v[64:67]
    v_mfma_f32_16x16x32_bf16 v[68:71], a[120:123], v[20:23], v[68:71]
    v_mfma_f32_16x16x32_bf16 v[72:75], a[184:187], v[20:23], v[72:75]
    v_mfma_f32_16x16x32_bf16 v[76:79], a[248:251], v[20:23], v[76:79]
    v_mfma_f32_16x16x32_bf16 v[80:83], a[56:59], v[24:27], v[80:83]
    v_mfma_f32_16x16x32_bf16 v[84:87], a[120:123], v[24:27], v[84:87]
    v_mfma_f32_16x16x32_bf16 v[88:91], a[184:187], v[24:27], v[88:91]
    v_mfma_f32_16x16x32_bf16 v[92:95], a[248:251], v[24:27], v[92:95]
    v_mfma_f32_16x16x32_bf16 v[96:99], a[56:59], v[28:31], v[96:99]
    v_mfma_f32_16x16x32_bf16 v[100:103], a[120:123], v[28:31], v[100:103]
    v_mfma_f32_16x16x32_bf16 v[104:107], a[184:187], v[28:31], v[104:107]
    v_mfma_f32_16x16x32_bf16 v[108:111], a[248:251], v[28:31], v[108:111]
    s_waitcnt lgkmcnt(0)
    v_mfma_f32_16x16x32_bf16 v[48:51], a[60:63], v[32:35], v[48:51]
    v_mfma_f32_16x16x32_bf16 v[52:55], a[124:127], v[32:35], v[52:55]
    v_mfma_f32_16x16x32_bf16 v[56:59], a[188:191], v[32:35], v[56:59]
    v_mfma_f32_16x16x32_bf16 v[60:63], a[252:255], v[32:35], v[60:63]
    v_xor_b32 v7, 240, v6
    s_add_u32 m0, s81, 93184
    s_add_u32 s79, s70, 27648
    buffer_load_dwordx4 v7, s[60:63], s79 offen sc1 lds
    v_mfma_f32_16x16x32_bf16 v[64:67], a[60:63], v[36:39], v[64:67]
    v_mfma_f32_16x16x32_bf16 v[68:71], a[124:127], v[36:39], v[68:71]
    v_mfma_f32_16x16x32_bf16 v[72:75], a[188:191], v[36:39], v[72:75]
    v_mfma_f32_16x16x32_bf16 v[76:79], a[252:255], v[36:39], v[76:79]
    v_mfma_f32_16x16x32_bf16 v[80:83], a[60:63], v[40:43], v[80:83]
    v_mfma_f32_16x16x32_bf16 v[84:87], a[124:127], v[40:43], v[84:87]
    v_mfma_f32_16x16x32_bf16 v[88:91], a[188:191], v[40:43], v[88:91]
    v_mfma_f32_16x16x32_bf16 v[92:95], a[252:255], v[40:43], v[92:95]
    v_mfma_f32_16x16x32_bf16 v[96:99], a[60:63], v[44:47], v[96:99]
    v_mfma_f32_16x16x32_bf16 v[100:103], a[124:127], v[44:47], v[100:103]
    v_mfma_f32_16x16x32_bf16 v[104:107], a[188:191], v[44:47], v[104:107]
    v_mfma_f32_16x16x32_bf16 v[108:111], a[252:255], v[44:47], v[108:111]
    s_add_u32 s70, s70, 65536
    s_mul_i32 s77, s76, 0
    s_add_u32 s77, s77, s73
    v_cvt_pk_bf16_f32 v112, v48, v49
    v_cvt_pk_bf16_f32 v113, v50, v51
    v_cvt_pk_bf16_f32 v114, v52, v53
    v_cvt_pk_bf16_f32 v115, v54, v55
    buffer_store_dwordx4 v[112:115], v1, s[52:55], s77 offen offset:0 sc1
    v_cvt_pk_bf16_f32 v116, v64, v65
    v_cvt_pk_bf16_f32 v117, v66, v67
    v_cvt_pk_bf16_f32 v118, v68, v69
    v_cvt_pk_bf16_f32 v119, v70, v71
    buffer_store_dwordx4 v[116:119], v1, s[52:55], s77 offen offset:1024 sc1
    s_mul_i32 s77, s76, 1
    s_add_u32 s77, s77, s73
    v_cvt_pk_bf16_f32 v112, v56, v57
    v_cvt_pk_bf16_f32 v113, v58, v59
    v_cvt_pk_bf16_f32 v114, v60, v61
    v_cvt_pk_bf16_f32 v115, v62, v63
    buffer_store_dwordx4 v[112:115], v1, s[52:55], s77 offen offset:0 sc1
    v_cvt_pk_bf16_f32 v116, v72, v73
    v_cvt_pk_bf16_f32 v117, v74, v75
    v_cvt_pk_bf16_f32 v118, v76, v77
    v_cvt_pk_bf16_f32 v119, v78, v79
    buffer_store_dwordx4 v[116:119], v1, s[52:55], s77 offen offset:1024 sc1
    s_mul_i32 s77, s76, 128
    s_add_u32 s77, s77, s73
    v_cvt_pk_bf16_f32 v112, v80, v81
    v_cvt_pk_bf16_f32 v113, v82, v83
    v_cvt_pk_bf16_f32 v114, v84, v85
    v_cvt_pk_bf16_f32 v115, v86, v87
    buffer_store_dwordx4 v[112:115], v1, s[52:55], s77 offen offset:0 sc1
    v_cvt_pk_bf16_f32 v116, v96, v97
    v_cvt_pk_bf16_f32 v117, v98, v99
    v_cvt_pk_bf16_f32 v118, v100, v101
    v_cvt_pk_bf16_f32 v119, v102, v103
    buffer_store_dwordx4 v[116:119], v1, s[52:55], s77 offen offset:1024 sc1
    s_mul_i32 s77, s76, 129
    s_add_u32 s77, s77, s73
    v_cvt_pk_bf16_f32 v112, v88, v89
    v_cvt_pk_bf16_f32 v113, v90, v91
    v_cvt_pk_bf16_f32 v114, v92, v93
    v_cvt_pk_bf16_f32 v115, v94, v95
    buffer_store_dwordx4 v[112:115], v1, s[52:55], s77 offen offset:0 sc1
    v_cvt_pk_bf16_f32 v116, v104, v105
    v_cvt_pk_bf16_f32 v117, v106, v107
    v_cvt_pk_bf16_f32 v118, v108, v109
    v_cvt_pk_bf16_f32 v119, v110, v111
    buffer_store_dwordx4 v[116:119], v1, s[52:55], s77 offen offset:1024 sc1
    s_lshl_b32 s77, s76, 8
    s_add_u32 s73, s73, s77
    s_cmp_lg_u32 s83, 0
    s_cbranch_scc1 L_wse_151
    s_cmp_ge_u32 s88, 32
    s_cbranch_scc1 L_wse_151
    s_waitcnt vmcnt(0)
    s_barrier
    s_cmp_lg_u32 s56, 0
    s_cbranch_scc1 L_wse_151
    s_mov_b32 s80, 28
    v_mov_b32 v120, 1
    v_mov_b32 v121, s80
    s_mov_b64 exec, 1
    buffer_atomic_add v120, v121, s[48:51], 0 offen
    s_mov_b64 exec, -1
L_wse_151:
    s_waitcnt vmcnt(8)
    s_barrier
    s_cmp_eq_u32 s83, 0
    s_cbranch_scc1 L_wsg_152
    s_cmp_lg_u32 s56, 0
    s_cbranch_scc1 L_wsg_152
    s_add_u32 s80, s89, s83
    s_lshl_b32 s80, s80, 2
    s_add_u32 s80, s80, 28
    v_mov_b32 v120, s68
    v_mov_b32 v121, s80
    s_mov_b64 exec, 1
    buffer_atomic_add v120, v121, s[48:51], 0 offen
    s_mov_b64 exec, -1
    s_nop 0
L_wsg_152:
    ds_read_b128 v[16:19], v132 offset:0
    ds_read_b128 v[20:23], v132 offset:4096
    ds_read_b128 v[24:27], v132 offset:32768
    ds_read_b128 v[28:31], v132 offset:36864
    ds_read_b128 v[32:35], v133 offset:0
    ds_read_b128 v[36:39], v133 offset:4096
    ds_read_b128 v[40:43], v133 offset:32768
    ds_read_b128 v[44:47], v133 offset:36864
    s_waitcnt lgkmcnt(4)
    v_mfma_f32_16x16x32_bf16 v[48:51], a[0:3], v[16:19], 0
    v_mfma_f32_16x16x32_bf16 v[52:55], a[64:67], v[16:19], 0
    v_mfma_f32_16x16x32_bf16 v[56:59], a[128:131], v[16:19], 0
    v_mfma_f32_16x16x32_bf16 v[60:63], a[192:195], v[16:19], 0
    v_xor_b32 v7, 0, v6
    s_add_u32 m0, s81, 0
    s_add_u32 s79, s70, 0
    buffer_load_dwordx4 v7, s[60:63], s79 offen sc1 lds
    v_mfma_f32_16x16x32_bf16 v[64:67], a[0:3], v[20:23], 0
    v_mfma_f32_16x16x32_bf16 v[68:71], a[64:67], v[20:23], 0
    v_mfma_f32_16x16x32_bf16 v[72:75], a[128:131], v[20:23], 0
    v_mfma_f32_16x16x32_bf16 v[76:79], a[192:195], v[20:23], 0
    v_mfma_f32_16x16x32_bf16 v[80:83], a[0:3], v[24:27], 0
    v_mfma_f32_16x16x32_bf16 v[84:87], a[64:67], v[24:27], 0
    v_mfma_f32_16x16x32_bf16 v[88:91], a[128:131], v[24:27], 0
    v_mfma_f32_16x16x32_bf16 v[92:95], a[192:195], v[24:27], 0
    v_mfma_f32_16x16x32_bf16 v[96:99], a[0:3], v[28:31], 0
    v_mfma_f32_16x16x32_bf16 v[100:103], a[64:67], v[28:31], 0
    v_mfma_f32_16x16x32_bf16 v[104:107], a[128:131], v[28:31], 0
    v_mfma_f32_16x16x32_bf16 v[108:111], a[192:195], v[28:31], 0
    ds_read_b128 v[16:19], v134 offset:0
    ds_read_b128 v[20:23], v134 offset:4096
    ds_read_b128 v[24:27], v134 offset:32768
    ds_read_b128 v[28:31], v134 offset:36864
    s_waitcnt lgkmcnt(4)
    v_mfma_f32_16x16x32_bf16 v[48:51], a[4:7], v[32:35], v[48:51]
    v_mfma_f32_16x16x32_bf16 v[52:55], a[68:71], v[32:35], v[52:55]
    v_mfma_f32_16x16x32_bf16 v[56:59], a[132:135], v[32:35], v[56:59]
    v_mfma_f32_16x16x32_bf16 v[60:63], a[196:199], v[32:35], v[60:63]
    v_xor_b32 v7, 16, v6
    s_add_u32 m0, s81, 1024
    s_add_u32 s79, s70, 1024
    buffer_load_dwordx4 v7, s[60:63], s79 offen sc1 lds
    v_mfma_f32_16x16x32_bf16 v[64:67], a[4:7], v[36:39], v[64:67]
    v_mfma_f32_16x16x32_bf16 v[68:71], a[68:71], v[36:39], v[68:71]
    v_mfma_f32_16x16x32_bf16 v[72:75], a[132:135], v[36:39], v[72:75]
    v_mfma_f32_16x16x32_bf16 v[76:79], a[196:199], v[36:39], v[76:79]
    v_mfma_f32_16x16x32_bf16 v[80:83], a[4:7], v[40:43], v[80:83]
    v_mfma_f32_16x16x32_bf16 v[84:87], a[68:71], v[40:43], v[84:87]
    v_mfma_f32_16x16x32_bf16 v[88:91], a[132:135], v[40:43], v[88:91]
    v_mfma_f32_16x16x32_bf16 v[92:95], a[196:199], v[40:43], v[92:95]
    v_mfma_f32_16x16x32_bf16 v[96:99], a[4:7], v[44:47], v[96:99]
    v_mfma_f32_16x16x32_bf16 v[100:103], a[68:71], v[44:47], v[100:103]
    v_mfma_f32_16x16x32_bf16 v[104:107], a[132:135], v[44:47], v[104:107]
    v_mfma_f32_16x16x32_bf16 v[108:111], a[196:199], v[44:47], v[108:111]
    ds_read_b128 v[32:35], v135 offset:0
    ds_read_b128 v[36:39], v135 offset:4096
    ds_read_b128 v[40:43], v135 offset:32768
    ds_read_b128 v[44:47], v135 offset:36864
    s_waitcnt lgkmcnt(4)
    v_mfma_f32_16x16x32_bf16 v[48:51], a[8:11], v[16:19], v[48:51]
    v_mfma_f32_16x16x32_bf16 v[52:55], a[72:75], v[16:19], v[52:55]
    v_mfma_f32_16x16x32_bf16 v[56:59], a[136:139], v[16:19], v[56:59]
    v_mfma_f32_16x16x32_bf16 v[60:63], a[200:203], v[16:19], v[60:63]
    v_xor_b32 v7, 32, v6
    s_add_u32 m0, s81, 2048
    s_add_u32 s79, s70, 2048
    buffer_load_dwordx4 v7, s[60:63], s79 offen sc1 lds
    v_mfma_f32_16x16x32_bf16 v[64:67], a[8:11], v[20:23], v[64:67]
    v_mfma_f32_16x16x32_bf16 v[68:71], a[72:75], v[20:23], v[68:71]
    v_mfma_f32_16x16x32_bf16 v[72:75], a[136:139], v[20:23], v[72:75]
    v_mfma_f32_16x16x32_bf16 v[76:79], a[200:203], v[20:23], v[76:79]
    v_mfma_f32_16x16x32_bf16 v[80:83], a[8:11], v[24:27], v[80:83]
    v_mfma_f32_16x16x32_bf16 v[84:87], a[72:75], v[24:27], v[84:87]
    v_mfma_f32_16x16x32_bf16 v[88:91], a[136:139], v[24:27], v[88:91]
    v_mfma_f32_16x16x32_bf16 v[92:95], a[200:203], v[24:27], v[92:95]
    v_mfma_f32_16x16x32_bf16 v[96:99], a[8:11], v[28:31], v[96:99]
    v_mfma_f32_16x16x32_bf16 v[100:103], a[72:75], v[28:31], v[100:103]
    v_mfma_f32_16x16x32_bf16 v[104:107], a[136:139], v[28:31], v[104:107]
    v_mfma_f32_16x16x32_bf16 v[108:111], a[200:203], v[28:31], v[108:111]
    ds_read_b128 v[16:19], v132 offset:256
    ds_read_b128 v[20:23], v132 offset:4352
    ds_read_b128 v[24:27], v132 offset:33024
    ds_read_b128 v[28:31], v132 offset:37120
    s_waitcnt lgkmcnt(4)
    v_mfma_f32_16x16x32_bf16 v[48:51], a[12:15], v[32:35], v[48:51]
    v_mfma_f32_16x16x32_bf16 v[52:55], a[76:79], v[32:35], v[52:55]
    v_mfma_f32_16x16x32_bf16 v[56:59], a[140:143], v[32:35], v[56:59]
    v_mfma_f32_16x16x32_bf16 v[60:63], a[204:207], v[32:35], v[60:63]
    v_xor_b32 v7, 48, v6
    s_add_u32 m0, s81, 3072
    s_add_u32 s79, s70, 3072
    buffer_load_dwordx4 v7, s[60:63], s79 offen sc1 lds
    v_mfma_f32_16x16x32_bf16 v[64:67], a[12:15], v[36:39], v[64:67]
    v_mfma_f32_16x16x32_bf16 v[68:71], a[76:79], v[36:39], v[68:71]
    v_mfma_f32_16x16x32_bf16 v[72:75], a[140:143], v[36:39], v[72:75]
    v_mfma_f32_16x16x32_bf16 v[76:79], a[204:207], v[36:39], v[76:79]
    v_mfma_f32_16x16x32_bf16 v[80:83], a[12:15], v[40:43], v[80:83]
    v_mfma_f32_16x16x32_bf16 v[84:87], a[76:79], v[40:43], v[84:87]
    v_mfma_f32_16x16x32_bf16 v[88:91], a[140:143], v[40:43], v[88:91]
    v_mfma_f32_16x16x32_bf16 v[92:95], a[204:207], v[40:43], v[92:95]
    v_mfma_f32_16x16x32_bf16 v[96:99], a[12:15], v[44:47], v[96:99]
    v_mfma_f32_16x16x32_bf16 v[100:103], a[76:79], v[44:47], v[100:103]
    v_mfma_f32_16x16x32_bf16 v[104:107], a[140:143], v[44:47], v[104:107]
    v_mfma_f32_16x16x32_bf16 v[108:111], a[204:207], v[44:47], v[108:111]
    ds_read_b128 v[32:35], v133 offset:256
    ds_read_b128 v[36:39], v133 offset:4352
    ds_read_b128 v[40:43], v133 offset:33024
    ds_read_b128 v[44:47], v133 offset:37120
    s_waitcnt lgkmcnt(4)
    v_mfma_f32_16x16x32_bf16 v[48:51], a[16:19], v[16:19], v[48:51]
    v_mfma_f32_16x16x32_bf16 v[52:55], a[80:83], v[16:19], v[52:55]
    v_mfma_f32_16x16x32_bf16 v[56:59], a[144:147], v[16:19], v[56:59]
    v_mfma_f32_16x16x32_bf16 v[60:63], a[208:211], v[16:19], v[60:63]
    v_xor_b32 v7, 64, v6
    s_add_u32 m0, s81, 8192
    s_add_u32 s79, s70, 8192
    buffer_load_dwordx4 v7, s[60:63], s79 offen sc1 lds
    v_mfma_f32_16x16x32_bf16 v[64:67], a[16:19], v[20:23], v[64:67]
    v_mfma_f32_16x16x32_bf16 v[68:71], a[80:83], v[20:23], v[68:71]
    v_mfma_f32_16x16x32_bf16 v[72:75], a[144:147], v[20:23], v[72:75]
    v_mfma_f32_16x16x32_bf16 v[76:79], a[208:211], v[20:23], v[76:79]
    v_mfma_f32_16x16x32_bf16 v[80:83], a[16:19], v[24:27], v[80:83]
    v_mfma_f32_16x16x32_bf16 v[84:87], a[80:83], v[24:27], v[84:87]
    v_mfma_f32_16x16x32_bf16 v[88:91], a[144:147], v[24:27], v[88:91]
    v_mfma_f32_16x16x32_bf16 v[92:95], a[208:211], v[24:27], v[92:95]
    v_mfma_f32_16x16x32_bf16 v[96:99], a[16:19], v[28:31], v[96:99]
    v_mfma_f32_16x16x32_bf16 v[100:103], a[80:83], v[28:31], v[100:103]
    v_mfma_f32_16x16x32_bf16 v[104:107], a[144:147], v[28:31], v[104:107]
    v_mfma_f32_16x16x32_bf16 v[108:111], a[208:211], v[28:31], v[108:111]
    ds_read_b128 v[16:19], v134 offset:256
    ds_read_b128 v[20:23], v134 offset:4352
    ds_read_b128 v[24:27], v134 offset:33024
    ds_read_b128 v[28:31], v134 offset:37120
    s_waitcnt lgkmcnt(4)
    v_mfma_f32_16x16x32_bf16 v[48:51], a[20:23], v[32:35], v[48:51]
    v_mfma_f32_16x16x32_bf16 v[52:55], a[84:87], v[32:35], v[52:55]
    v_mfma_f32_16x16x32_bf16 v[56:59], a[148:151], v[32:35], v[56:59]
    v_mfma_f32_16x16x32_bf16 v[60:63], a[212:215], v[32:35], v[60:63]
    v_xor_b32 v7, 80, v6
    s_add_u32 m0, s81, 9216
    s_add_u32 s79, s70, 9216
    buffer_load_dwordx4 v7, s[60:63], s79 offen sc1 lds
    v_mfma_f32_16x16x32_bf16 v[64:67], a[20:23], v[36:39], v[64:67]
    v_mfma_f32_16x16x32_bf16 v[68:71], a[84:87], v[36:39], v[68:71]
    v_mfma_f32_16x16x32_bf16 v[72:75], a[148:151], v[36:39], v[72:75]
    v_mfma_f32_16x16x32_bf16 v[76:79], a[212:215], v[36:39], v[76:79]
    v_mfma_f32_16x16x32_bf16 v[80:83], a[20:23], v[40:43], v[80:83]
    v_mfma_f32_16x16x32_bf16 v[84:87], a[84:87], v[40:43], v[84:87]
    v_mfma_f32_16x16x32_bf16 v[88:91], a[148:151], v[40:43], v[88:91]
    v_mfma_f32_16x16x32_bf16 v[92:95], a[212:215], v[40:43], v[92:95]
    v_mfma_f32_16x16x32_bf16 v[96:99], a[20:23], v[44:47], v[96:99]
    v_mfma_f32_16x16x32_bf16 v[100:103], a[84:87], v[44:47], v[100:103]
    v_mfma_f32_16x16x32_bf16 v[104:107], a[148:151], v[44:47], v[104:107]
    v_mfma_f32_16x16x32_bf16 v[108:111], a[212:215], v[44:47], v[108:111]
    ds_read_b128 v[32:35], v135 offset:256
    ds_read_b128 v[36:39], v135 offset:4352
    ds_read_b128 v[40:43], v135 offset:33024
    ds_read_b128 v[44:47], v135 offset:37120
    s_waitcnt lgkmcnt(4)
    v_mfma_f32_16x16x32_bf16 v[48:51], a[24:27], v[16:19], v[48:51]
    v_mfma_f32_16x16x32_bf16 v[52:55], a[88:91], v[16:19], v[52:55]
    v_mfma_f32_16x16x32_bf16 v[56:59], a[152:155], v[16:19], v[56:59]
    v_mfma_f32_16x16x32_bf16 v[60:63], a[216:219], v[16:19], v[60:63]
    v_xor_b32 v7, 96, v6
    s_add_u32 m0, s81, 10240
    s_add_u32 s79, s70, 10240
    buffer_load_dwordx4 v7, s[60:63], s79 offen sc1 lds
    v_mfma_f32_16x16x32_bf16 v[64:67], a[24:27], v[20:23], v[64:67]
    v_mfma_f32_16x16x32_bf16 v[68:71], a[88:91], v[20:23], v[68:71]
    v_mfma_f32_16x16x32_bf16 v[72:75], a[152:155], v[20:23], v[72:75]
    v_mfma_f32_16x16x32_bf16 v[76:79], a[216:219], v[20:23], v[76:79]
    v_mfma_f32_16x16x32_bf16 v[80:83], a[24:27], v[24:27], v[80:83]
    v_mfma_f32_16x16x32_bf16 v[84:87], a[88:91], v[24:27], v[84:87]
    v_mfma_f32_16x16x32_bf16 v[88:91], a[152:155], v[24:27], v[88:91]
    v_mfma_f32_16x16x32_bf16 v[92:95], a[216:219], v[24:27], v[92:95]
    v_mfma_f32_16x16x32_bf16 v[96:99], a[24:27], v[28:31], v[96:99]
    v_mfma_f32_16x16x32_bf16 v[100:103], a[88:91], v[28:31], v[100:103]
    v_mfma_f32_16x16x32_bf16 v[104:107], a[152:155], v[28:31], v[104:107]
    v_mfma_f32_16x16x32_bf16 v[108:111], a[216:219], v[28:31], v[108:111]
    ds_read_b128 v[16:19], v132 offset:512
    ds_read_b128 v[20:23], v132 offset:4608
    ds_read_b128 v[24:27], v132 offset:33280
    ds_read_b128 v[28:31], v132 offset:37376
    s_waitcnt lgkmcnt(4)
    v_mfma_f32_16x16x32_bf16 v[48:51], a[28:31], v[32:35], v[48:51]
    v_mfma_f32_16x16x32_bf16 v[52:55], a[92:95], v[32:35], v[52:55]
    v_mfma_f32_16x16x32_bf16 v[56:59], a[156:159], v[32:35], v[56:59]
    v_mfma_f32_16x16x32_bf16 v[60:63], a[220:223], v[32:35], v[60:63]
    v_xor_b32 v7, 112, v6
    s_add_u32 m0, s81, 11264
    s_add_u32 s79, s70, 11264
    buffer_load_dwordx4 v7, s[60:63], s79 offen sc1 lds
    v_mfma_f32_16x16x32_bf16 v[64:67], a[28:31], v[36:39], v[64:67]
    v_mfma_f32_16x16x32_bf16 v[68:71], a[92:95], v[36:39], v[68:71]
    v_mfma_f32_16x16x32_bf16 v[72:75], a[156:159], v[36:39], v[72:75]
    v_mfma_f32_16x16x32_bf16 v[76:79], a[220:223], v[36:39], v[76:79]
    v_mfma_f32_16x16x32_bf16 v[80:83], a[28:31], v[40:43], v[80:83]
    v_mfma_f32_16x16x32_bf16 v[84:87], a[92:95], v[40:43], v[84:87]
    v_mfma_f32_16x16x32_bf16 v[88:91], a[156:159], v[40:43], v[88:91]
    v_mfma_f32_16x16x32_bf16 v[92:95], a[220:223], v[40:43], v[92:95]
    v_mfma_f32_16x16x32_bf16 v[96:99], a[28:31], v[44:47], v[96:99]
    v_mfma_f32_16x16x32_bf16 v[100:103], a[92:95], v[44:47], v[100:103]
    v_mfma_f32_16x16x32_bf16 v[104:107], a[156:159], v[44:47], v[104:107]
    v_mfma_f32_16x16x32_bf16 v[108:111], a[220:223], v[44:47], v[108:111]
    ds_read_b128 v[32:35], v133 offset:512
    ds_read_b128 v[36:39], v133 offset:4608
    ds_read_b128 v[40:43], v133 offset:33280
    ds_read_b128 v[44:47], v133 offset:37376
    s_waitcnt lgkmcnt(4)
    v_mfma_f32_16x16x32_bf16 v[48:51], a[32:35], v[16:19], v[48:51]
    v_mfma_f32_16x16x32_bf16 v[52:55], a[96:99], v[16:19], v[52:55]
    v_mfma_f32_16x16x32_bf16 v[56:59], a[160:163], v[16:19], v[56:59]
    v_mfma_f32_16x16x32_bf16 v[60:63], a[224:227], v[16:19], v[60:63]
    v_xor_b32 v7, 128, v6
    s_add_u32 m0, s81, 16384
    s_add_u32 s79, s70, 16384
    buffer_load_dwordx4 v7, s[60:63], s79 offen sc1 lds
    v_mfma_f32_16x16x32_bf16 v[64:67], a[32:35], v[20:23], v[64:67]
    v_mfma_f32_16x16x32_bf16 v[68:71], a[96:99], v[20:23], v[68:71]
    v_mfma_f32_16x16x32_bf16 v[72:75], a[160:163], v[20:23], v[72:75]
    v_mfma_f32_16x16x32_bf16 v[76:79], a[224:227], v[20:23], v[76:79]
    v_mfma_f32_16x16x32_bf16 v[80:83], a[32:35], v[24:27], v[80:83]
    v_mfma_f32_16x16x32_bf16 v[84:87], a[96:99], v[24:27], v[84:87]
    v_mfma_f32_16x16x32_bf16 v[88:91], a[160:163], v[24:27], v[88:91]
    v_mfma_f32_16x16x32_bf16 v[92:95], a[224:227], v[24:27], v[92:95]
    v_mfma_f32_16x16x32_bf16 v[96:99], a[32:35], v[28:31], v[96:99]
    v_mfma_f32_16x16x32_bf16 v[100:103], a[96:99], v[28:31], v[100:103]
    v_mfma_f32_16x16x32_bf16 v[104:107], a[160:163], v[28:31], v[104:107]
    v_mfma_f32_16x16x32_bf16 v[108:111], a[224:227], v[28:31], v[108:111]
    ds_read_b128 v[16:19], v134 offset:512
    ds_read_b128 v[20:23], v134 offset:4608
    ds_read_b128 v[24:27], v134 offset:33280
    ds_read_b128 v[28:31], v134 offset:37376
    s_waitcnt lgkmcnt(4)
    v_mfma_f32_16x16x32_bf16 v[48:51], a[36:39], v[32:35], v[48:51]
    v_mfma_f32_16x16x32_bf16 v[52:55], a[100:103], v[32:35], v[52:55]
    v_mfma_f32_16x16x32_bf16 v[56:59], a[164:167], v[32:35], v[56:59]
    v_mfma_f32_16x16x32_bf16 v[60:63], a[228:231], v[32:35], v[60:63]
    v_xor_b32 v7, 144, v6
    s_add_u32 m0, s81, 17408
    s_add_u32 s79, s70, 17408
    buffer_load_dwordx4 v7, s[60:63], s79 offen sc1 lds
    v_mfma_f32_16x16x32_bf16 v[64:67], a[36:39], v[36:39], v[64:67]
    v_mfma_f32_16x16x32_bf16 v[68:71], a[100:103], v[36:39], v[68:71]
    v_mfma_f32_16x16x32_bf16 v[72:75], a[164:167], v[36:39], v[72:75]
    v_mfma_f32_16x16x32_bf16 v[76:79], a[228:231], v[36:39], v[76:79]
    v_mfma_f32_16x16x32_bf16 v[80:83], a[36:39], v[40:43], v[80:83]
    v_mfma_f32_16x16x32_bf16 v[84:87], a[100:103], v[40:43], v[84:87]
    v_mfma_f32_16x16x32_bf16 v[88:91], a[164:167], v[40:43], v[88:91]
    v_mfma_f32_16x16x32_bf16 v[92:95], a[228:231], v[40:43], v[92:95]
    v_mfma_f32_16x16x32_bf16 v[96:99], a[36:39], v[44:47], v[96:99]
    v_mfma_f32_16x16x32_bf16 v[100:103], a[100:103], v[44:47], v[100:103]
    v_mfma_f32_16x16x32_bf16 v[104:107], a[164:167], v[44:47], v[104:107]
    v_mfma_f32_16x16x32_bf16 v[108:111], a[228:231], v[44:47], v[108:111]
    ds_read_b128 v[32:35], v135 offset:512
    ds_read_b128 v[36:39], v135 offset:4608
    ds_read_b128 v[40:43], v135 offset:33280
    ds_read_b128 v[44:47], v135 offset:37376
    s_waitcnt lgkmcnt(4)
    v_mfma_f32_16x16x32_bf16 v[48:51], a[40:43], v[16:19], v[48:51]
    v_mfma_f32_16x16x32_bf16 v[52:55], a[104:107], v[16:19], v[52:55]
    v_mfma_f32_16x16x32_bf16 v[56:59], a[168:171], v[16:19], v[56:59]
    v_mfma_f32_16x16x32_bf16 v[60:63], a[232:235], v[16:19], v[60:63]
    v_xor_b32 v7, 160, v6
    s_add_u32 m0, s81, 18432
    s_add_u32 s79, s70, 18432
    buffer_load_dwordx4 v7, s[60:63], s79 offen sc1 lds
    v_mfma_f32_16x16x32_bf16 v[64:67], a[40:43], v[20:23], v[64:67]
    v_mfma_f32_16x16x32_bf16 v[68:71], a[104:107], v[20:23], v[68:71]
    v_mfma_f32_16x16x32_bf16 v[72:75], a[168:171], v[20:23], v[72:75]
    v_mfma_f32_16x16x32_bf16 v[76:79], a[232:235], v[20:23], v[76:79]
    v_mfma_f32_16x16x32_bf16 v[80:83], a[40:43], v[24:27], v[80:83]
    v_mfma_f32_16x16x32_bf16 v[84:87], a[104:107], v[24:27], v[84:87]
    v_mfma_f32_16x16x32_bf16 v[88:91], a[168:171], v[24:27], v[88:91]
    v_mfma_f32_16x16x32_bf16 v[92:95], a[232:235], v[24:27], v[92:95]
    v_mfma_f32_16x16x32_bf16 v[96:99], a[40:43], v[28:31], v[96:99]
    v_mfma_f32_16x16x32_bf16 v[100:103], a[104:107], v[28:31], v[100:103]
    v_mfma_f32_16x16x32_bf16 v[104:107], a[168:171], v[28:31], v[104:107]
    v_mfma_f32_16x16x32_bf16 v[108:111], a[232:235], v[28:31], v[108:111]
    ds_read_b128 v[16:19], v132 offset:768
    ds_read_b128 v[20:23], v132 offset:4864
    ds_read_b128 v[24:27], v132 offset:33536
    ds_read_b128 v[28:31], v132 offset:37632
    s_waitcnt lgkmcnt(4)
    v_mfma_f32_16x16x32_bf16 v[48:51], a[44:47], v[32:35], v[48:51]
    v_mfma_f32_16x16x32_bf16 v[52:55], a[108:111], v[32:35], v[52:55]
    v_mfma_f32_16x16x32_bf16 v[56:59], a[172:175], v[32:35], v[56:59]
    v_mfma_f32_16x16x32_bf16 v[60:63], a[236:239], v[32:35], v[60:63]
    v_xor_b32 v7, 176, v6
    s_add_u32 m0, s81, 19456
    s_add_u32 s79, s70, 19456
    buffer_load_dwordx4 v7, s[60:63], s79 offen sc1 lds
    v_mfma_f32_16x16x32_bf16 v[64:67], a[44:47], v[36:39], v[64:67]
    v_mfma_f32_16x16x32_bf16 v[68:71], a[108:111], v[36:39], v[68:71]
    v_mfma_f32_16x16x32_bf16 v[72:75], a[172:175], v[36:39], v[72:75]
    v_mfma_f32_16x16x32_bf16 v[76:79], a[236:239], v[36:39], v[76:79]
    v_mfma_f32_16x16x32_bf16 v[80:83], a[44:47], v[40:43], v[80:83]
    v_mfma_f32_16x16x32_bf16 v[84:87], a[108:111], v[40:43], v[84:87]
    v_mfma_f32_16x16x32_bf16 v[88:91], a[172:175], v[40:43], v[88:91]
    v_mfma_f32_16x16x32_bf16 v[92:95], a[236:239], v[40:43], v[92:95]
    v_mfma_f32_16x16x32_bf16 v[96:99], a[44:47], v[44:47], v[96:99]
    v_mfma_f32_16x16x32_bf16 v[100:103], a[108:111], v[44:47], v[100:103]
    v_mfma_f32_16x16x32_bf16 v[104:107], a[172:175], v[44:47], v[104:107]
    v_mfma_f32_16x16x32_bf16 v[108:111], a[236:239], v[44:47], v[108:111]
    ds_read_b128 v[32:35], v133 offset:768
    ds_read_b128 v[36:39], v133 offset:4864
    ds_read_b128 v[40:43], v133 offset:33536
    ds_read_b128 v[44:47], v133 offset:37632
    s_waitcnt lgkmcnt(4)
    v_mfma_f32_16x16x32_bf16 v[48:51], a[48:51], v[16:19], v[48:51]
    v_mfma_f32_16x16x32_bf16 v[52:55], a[112:115], v[16:19], v[52:55]
    v_mfma_f32_16x16x32_bf16 v[56:59], a[176:179], v[16:19], v[56:59]
    v_mfma_f32_16x16x32_bf16 v[60:63], a[240:243], v[16:19], v[60:63]
    v_xor_b32 v7, 192, v6
    s_add_u32 m0, s81, 24576
    s_add_u32 s79, s70, 24576
    buffer_load_dwordx4 v7, s[60:63], s79 offen sc1 lds
    v_mfma_f32_16x16x32_bf16 v[64:67], a[48:51], v[20:23], v[64:67]
    v_mfma_f32_16x16x32_bf16 v[68:71], a[112:115], v[20:23], v[68:71]
    v_mfma_f32_16x16x32_bf16 v[72:75], a[176:179], v[20:23], v[72:75]
    v_mfma_f32_16x16x32_bf16 v[76:79], a[240:243], v[20:23], v[76:79]
    v_mfma_f32_16x16x32_bf16 v[80:83], a[48:51], v[24:27], v[80:83]
    v_mfma_f32_16x16x32_bf16 v[84:87], a[112:115], v[24:27], v[84:87]
    v_mfma_f32_16x16x32_bf16 v[88:91], a[176:179], v[24:27], v[88:91]
    v_mfma_f32_16x16x32_bf16 v[92:95], a[240:243], v[24:27], v[92:95]
    v_mfma_f32_16x16x32_bf16 v[96:99], a[48:51], v[28:31], v[96:99]
    v_mfma_f32_16x16x32_bf16 v[100:103], a[112:115], v[28:31], v[100:103]
    v_mfma_f32_16x16x32_bf16 v[104:107], a[176:179], v[28:31], v[104:107]
    v_mfma_f32_16x16x32_bf16 v[108:111], a[240:243], v[28:31], v[108:111]
    ds_read_b128 v[16:19], v134 offset:768
    ds_read_b128 v[20:23], v134 offset:4864
    ds_read_b128 v[24:27], v134 offset:33536
    ds_read_b128 v[28:31], v134 offset:37632
    s_waitcnt lgkmcnt(4)
    v_mfma_f32_16x16x32_bf16 v[48:51], a[52:55], v[32:35], v[48:51]
    v_mfma_f32_16x16x32_bf16 v[52:55], a[116:119], v[32:35], v[52:55]
    v_mfma_f32_16x16x32_bf16 v[56:59], a[180:183], v[32:35], v[56:59]
    v_mfma_f32_16x16x32_bf16 v[60:63], a[244:247], v[32:35], v[60:63]
    v_xor_b32 v7, 208, v6
    s_add_u32 m0, s81, 25600
    s_add_u32 s79, s70, 25600
    buffer_load_dwordx4 v7, s[60:63], s79 offen sc1 lds
    v_mfma_f32_16x16x32_bf16 v[64:67], a[52:55], v[36:39], v[64:67]
    v_mfma_f32_16x16x32_bf16 v[68:71], a[116:119], v[36:39], v[68:71]
    v_mfma_f32_16x16x32_bf16 v[72:75], a[180:183], v[36:39], v[72:75]
    v_mfma_f32_16x16x32_bf16 v[76:79], a[244:247], v[36:39], v[76:79]
    v_mfma_f32_16x16x32_bf16 v[80:83], a[52:55], v[40:43], v[80:83]
    v_mfma_f32_16x16x32_bf16 v[84:87], a[116:119], v[40:43], v[84:87]
    v_mfma_f32_16x16x32_bf16 v[88:91], a[180:183], v[40:43], v[88:91]
    v_mfma_f32_16x16x32_bf16 v[92:95], a[244:247], v[40:43], v[92:95]
    v_mfma_f32_16x16x32_bf16 v[96:99], a[52:55], v[44:47], v[96:99]
    v_mfma_f32_16x16x32_bf16 v[100:103], a[116:119], v[44:47], v[100:103]
    v_mfma_f32_16x16x32_bf16 v[104:107], a[180:183], v[44:47], v[104:107]
    v_mfma_f32_16x16x32_bf16 v[108:111], a[244:247], v[44:47], v[108:111]
    ds_read_b128 v[32:35], v135 offset:768
    ds_read_b128 v[36:39], v135 offset:4864
    ds_read_b128 v[40:43], v135 offset:33536
    ds_read_b128 v[44:47], v135 offset:37632
    s_waitcnt lgkmcnt(4)
    v_mfma_f32_16x16x32_bf16 v[48:51], a[56:59], v[16:19], v[48:51]
    v_mfma_f32_16x16x32_bf16 v[52:55], a[120:123], v[16:19], v[52:55]
    v_mfma_f32_16x16x32_bf16 v[56:59], a[184:187], v[16:19], v[56:59]
    v_mfma_f32_16x16x32_bf16 v[60:63], a[248:251], v[16:19], v[60:63]
    v_xor_b32 v7, 224, v6
    s_add_u32 m0, s81, 26624
    s_add_u32 s79, s70, 26624
    buffer_load_dwordx4 v7, s[60:63], s79 offen sc1 lds
    v_mfma_f32_16x16x32_bf16 v[64:67], a[56:59], v[20:23], v[64:67]
    v_mfma_f32_16x16x32_bf16 v[68:71], a[120:123], v[20:23], v[68:71]
    v_mfma_f32_16x16x32_bf16 v[72:75], a[184:187], v[20:23], v[72:75]
    v_mfma_f32_16x16x32_bf16 v[76:79], a[248:251], v[20:23], v[76:79]
    v_mfma_f32_16x16x32_bf16 v[80:83], a[56:59], v[24:27], v[80:83]
    v_mfma_f32_16x16x32_bf16 v[84:87], a[120:123], v[24:27], v[84:87]
    v_mfma_f32_16x16x32_bf16 v[88:91], a[184:187], v[24:27], v[88:91]
    v_mfma_f32_16x16x32_bf16 v[92:95], a[248:251], v[24:27], v[92:95]
    v_mfma_f32_16x16x32_bf16 v[96:99], a[56:59], v[28:31], v[96:99]
    v_mfma_f32_16x16x32_bf16 v[100:103], a[120:123], v[28:31], v[100:103]
    v_mfma_f32_16x16x32_bf16 v[104:107], a[184:187], v[28:31], v[104:107]
    v_mfma_f32_16x16x32_bf16 v[108:111], a[248:251], v[28:31], v[108:111]
    s_waitcnt lgkmcnt(0)
    v_mfma_f32_16x16x32_bf16 v[48:51], a[60:63], v[32:35], v[48:51]
    v_mfma_f32_16x16x32_bf16 v[52:55], a[124:127], v[32:35], v[52:55]
    v_mfma_f32_16x16x32_bf16 v[56:59], a[188:191], v[32:35], v[56:59]
    v_mfma_f32_16x16x32_bf16 v[60:63], a[252:255], v[32:35], v[60:63]
    v_xor_b32 v7, 240, v6
    s_add_u32 m0, s81, 27648
    s_add_u32 s79, s70, 27648
    buffer_load_dwordx4 v7, s[60:63], s79 offen sc1 lds
    v_mfma_f32_16x16x32_bf16 v[64:67], a[60:63], v[36:39], v[64:67]
    v_mfma_f32_16x16x32_bf16 v[68:71], a[124:127], v[36:39], v[68:71]
    v_mfma_f32_16x16x32_bf16 v[72:75], a[188:191], v[36:39], v[72:75]
    v_mfma_f32_16x16x32_bf16 v[76:79], a[252:255], v[36:39], v[76:79]
    v_mfma_f32_16x16x32_bf16 v[80:83], a[60:63], v[40:43], v[80:83]
    v_mfma_f32_16x16x32_bf16 v[84:87], a[124:127], v[40:43], v[84:87]
    v_mfma_f32_16x16x32_bf16 v[88:91], a[188:191], v[40:43], v[88:91]
    v_mfma_f32_16x16x32_bf16 v[92:95], a[252:255], v[40:43], v[92:95]
    v_mfma_f32_16x16x32_bf16 v[96:99], a[60:63], v[44:47], v[96:99]
    v_mfma_f32_16x16x32_bf16 v[100:103], a[124:127], v[44:47], v[100:103]
    v_mfma_f32_16x16x32_bf16 v[104:107], a[188:191], v[44:47], v[104:107]
    v_mfma_f32_16x16x32_bf16 v[108:111], a[252:255], v[44:47], v[108:111]
    s_add_u32 s70, s70, 65536
    s_mul_i32 s77, s76, 0
    s_add_u32 s77, s77, s73
    v_cvt_pk_bf16_f32 v112, v48, v49
    v_cvt_pk_bf16_f32 v113, v50, v51
    v_cvt_pk_bf16_f32 v114, v52, v53
    v_cvt_pk_bf16_f32 v115, v54, v55
    buffer_store_dwordx4 v[112:115], v1, s[52:55], s77 offen offset:0 sc1
    v_cvt_pk_bf16_f32 v116, v64, v65
    v_cvt_pk_bf16_f32 v117, v66, v67
    v_cvt_pk_bf16_f32 v118, v68, v69
    v_cvt_pk_bf16_f32 v119, v70, v71
    buffer_store_dwordx4 v[116:119], v1, s[52:55], s77 offen offset:1024 sc1
    s_mul_i32 s77, s76, 1
    s_add_u32 s77, s77, s73
    v_cvt_pk_bf16_f32 v112, v56, v57
    v_cvt_pk_bf16_f32 v113, v58, v59
    v_cvt_pk_bf16_f32 v114, v60, v61
    v_cvt_pk_bf16_f32 v115, v62, v63
    buffer_store_dwordx4 v[112:115], v1, s[52:55], s77 offen offset:0 sc1
    v_cvt_pk_bf16_f32 v116, v72, v73
    v_cvt_pk_bf16_f32 v117, v74, v75
    v_cvt_pk_bf16_f32 v118, v76, v77
    v_cvt_pk_bf16_f32 v119, v78, v79
    buffer_store_dwordx4 v[116:119], v1, s[52:55], s77 offen offset:1024 sc1
    s_mul_i32 s77, s76, 128
    s_add_u32 s77, s77, s73
    v_cvt_pk_bf16_f32 v112, v80, v81
    v_cvt_pk_bf16_f32 v113, v82, v83
    v_cvt_pk_bf16_f32 v114, v84, v85
    v_cvt_pk_bf16_f32 v115, v86, v87
    buffer_store_dwordx4 v[112:115], v1, s[52:55], s77 offen offset:0 sc1
    v_cvt_pk_bf16_f32 v116, v96, v97
    v_cvt_pk_bf16_f32 v117, v98, v99
    v_cvt_pk_bf16_f32 v118, v100, v101
    v_cvt_pk_bf16_f32 v119, v102, v103
    buffer_store_dwordx4 v[116:119], v1, s[52:55], s77 offen offset:1024 sc1
    s_mul_i32 s77, s76, 129
    s_add_u32 s77, s77, s73
    v_cvt_pk_bf16_f32 v112, v88, v89
    v_cvt_pk_bf16_f32 v113, v90, v91
    v_cvt_pk_bf16_f32 v114, v92, v93
    v_cvt_pk_bf16_f32 v115, v94, v95
    buffer_store_dwordx4 v[112:115], v1, s[52:55], s77 offen offset:0 sc1
    v_cvt_pk_bf16_f32 v116, v104, v105
    v_cvt_pk_bf16_f32 v117, v106, v107
    v_cvt_pk_bf16_f32 v118, v108, v109
    v_cvt_pk_bf16_f32 v119, v110, v111
    buffer_store_dwordx4 v[116:119], v1, s[52:55], s77 offen offset:1024 sc1
    s_lshl_b32 s77, s76, 8
    s_add_u32 s73, s73, s77
    s_add_u32 s83, s83, 1
    s_cmp_lt_u32 s83, s72
    s_cbranch_scc1 L_wsg1t_150
    s_waitcnt vmcnt(0)
    s_barrier
    s_cmp_lg_u32 s56, 0
    s_cbranch_scc1 L_wsg_153
    s_add_u32 s80, s89, s83
    s_lshl_b32 s80, s80, 2
    s_add_u32 s80, s80, 28
    v_mov_b32 v120, s68
    v_mov_b32 v121, s80
    s_mov_b64 exec, 1
    buffer_atomic_add v120, v121, s[48:51], 0 offen
    s_mov_b64 exec, -1
L_wsg_153:
    s_branch L_next
L_g1_v:
    v_xor_b32 v7, 0, v6
    s_add_u32 m0, s81, 0
    s_add_u32 s79, s70, 0
    buffer_load_dwordx4 v7, s[60:63], s79 offen sc1 lds
    v_xor_b32 v7, 16, v6
    s_add_u32 m0, s81, 1024
    s_add_u32 s79, s70, 1024
    buffer_load_dwordx4 v7, s[60:63], s79 offen sc1 lds
    v_xor_b32 v7, 32, v6
    s_add_u32 m0, s81, 2048
    s_add_u32 s79, s70, 2048
    buffer_load_dwordx4 v7, s[60:63], s79 offen sc1 lds
    v_xor_b32 v7, 48, v6
    s_add_u32 m0, s81, 3072
    s_add_u32 s79, s70, 3072
    buffer_load_dwordx4 v7, s[60:63], s79 offen sc1 lds
    v_xor_b32 v7, 64, v6
    s_add_u32 m0, s81, 8192
    s_add_u32 s79, s70, 8192
    buffer_load_dwordx4 v7, s[60:63], s79 offen sc1 lds
    v_xor_b32 v7, 80, v6
    s_add_u32 m0, s81, 9216
    s_add_u32 s79, s70, 9216
    buffer_load_dwordx4 v7, s[60:63], s79 offen sc1 lds
    v_xor_b32 v7, 96, v6
    s_add_u32 m0, s81, 10240
    s_add_u32 s79, s70, 10240
    buffer_load_dwordx4 v7, s[60:63], s79 offen sc1 lds
    v_xor_b32 v7, 112, v6
    s_add_u32 m0, s81, 11264
    s_add_u32 s79, s70, 11264
    buffer_load_dwordx4 v7, s[60:63], s79 offen sc1 lds
    v_xor_b32 v7, 128, v6
    s_add_u32 m0, s81, 16384
    s_add_u32 s79, s70, 16384
    buffer_load_dwordx4 v7, s[60:63], s79 offen sc1 lds
    v_xor_b32 v7, 144, v6
    s_add_u32 m0, s81, 17408
    s_add_u32 s79, s70, 17408
    buffer_load_dwordx4 v7, s[60:63], s79 offen sc1 lds
    v_xor_b32 v7, 160, v6
    s_add_u32 m0, s81, 18432
    s_add_u32 s79, s70, 18432
    buffer_load_dwordx4 v7, s[60:63], s79 offen sc1 lds
    v_xor_b32 v7, 176, v6
    s_add_u32 m0, s81, 19456
    s_add_u32 s79, s70, 19456
    buffer_load_dwordx4 v7, s[60:63], s79 offen sc1 lds
    v_xor_b32 v7, 192, v6
    s_add_u32 m0, s81, 24576
    s_add_u32 s79, s70, 24576
    buffer_load_dwordx4 v7, s[60:63], s79 offen sc1 lds
    v_xor_b32 v7, 208, v6
    s_add_u32 m0, s81, 25600
    s_add_u32 s79, s70, 25600
    buffer_load_dwordx4 v7, s[60:63], s79 offen sc1 lds
    v_xor_b32 v7, 224, v6
    s_add_u32 m0, s81, 26624
    s_add_u32 s79, s70, 26624
    buffer_load_dwordx4 v7, s[60:63], s79 offen sc1 lds
    v_xor_b32 v7, 240, v6
    s_add_u32 m0, s81, 27648
    s_add_u32 s79, s70, 27648
    buffer_load_dwordx4 v7, s[60:63], s79 offen sc1 lds
    s_add_u32 s70, s70, 65536
    s_mov_b32 s83, 0
    s_waitcnt vmcnt(0)
L_wsg1n_154:
    s_waitcnt vmcnt(8)
    s_barrier
    ds_read_b128 v[16:19], v128 offset:0
    ds_read_b128 v[20:23], v128 offset:4096
    ds_read_b128 v[24:27], v128 offset:32768
    ds_read_b128 v[28:31], v128 offset:36864
    ds_read_b128 v[32:35], v129 offset:0
    ds_read_b128 v[36:39], v129 offset:4096
    ds_read_b128 v[40:43], v129 offset:32768
    ds_read_b128 v[44:47], v129 offset:36864
    s_waitcnt lgkmcnt(4)
    v_mfma_f32_16x16x32_bf16 v[48:51], v[16:19], a[0:3], 0
    v_mfma_f32_16x16x32_bf16 v[52:55], v[16:19], a[64:67], 0
    v_mfma_f32_16x16x32_bf16 v[56:59], v[16:19], a[128:131], 0
    v_mfma_f32_16x16x32_bf16 v[60:63], v[16:19], a[192:195], 0
    v_xor_b32 v7, 0, v6
    s_add_u32 m0, s81, 65536
    s_add_u32 s79, s70, 0
    buffer_load_dwordx4 v7, s[60:63], s79 offen sc1 lds
    v_mfma_f32_16x16x32_bf16 v[64:67], v[20:23], a[0:3], 0
    v_mfma_f32_16x16x32_bf16 v[68:71], v[20:23], a[64:67], 0
    v_mfma_f32_16x16x32_bf16 v[72:75], v[20:23], a[128:131], 0
    v_mfma_f32_16x16x32_bf16 v[76:79], v[20:23], a[192:195], 0
    v_mfma_f32_16x16x32_bf16 v[80:83], v[24:27], a[0:3], 0
    v_mfma_f32_16x16x32_bf16 v[84:87], v[24:27], a[64:67], 0
    v_mfma_f32_16x16x32_bf16 v[88:91], v[24:27], a[128:131], 0
    v_mfma_f32_16x16x32_bf16 v[92:95], v[24:27], a[192:195], 0
    v_mfma_f32_16x16x32_bf16 v[96:99], v[28:31], a[0:3], 0
    v_mfma_f32_16x16x32_bf16 v[100:103], v[28:31], a[64:67], 0
    v_mfma_f32_16x16x32_bf16 v[104:107], v[28:31], a[128:131], 0
    v_mfma_f32_16x16x32_bf16 v[108:111], v[28:31], a[192:195], 0
    ds_read_b128 v[16:19], v130 offset:0
    ds_read_b128 v[20:23], v130 offset:4096
    ds_read_b128 v[24:27], v130 offset:32768
    ds_read_b128 v[28:31], v130 offset:36864
    s_waitcnt lgkmcnt(4)
    v_mfma_f32_16x16x32_bf16 v[48:51], v[32:35], a[4:7], v[48:51]
    v_mfma_f32_16x16x32_bf16 v[52:55], v[32:35], a[68:71], v[52:55]
    v_mfma_f32_16x16x32_bf16 v[56:59], v[32:35], a[132:135], v[56:59]
    v_mfma_f32_16x16x32_bf16 v[60:63], v[32:35], a[196:199], v[60:63]
    v_xor_b32 v7, 16, v6
    s_add_u32 m0, s81, 66560
    s_add_u32 s79, s70, 1024
    buffer_load_dwordx4 v7, s[60:63], s79 offen sc1 lds
    v_mfma_f32_16x16x32_bf16 v[64:67], v[36:39], a[4:7], v[64:67]
    v_mfma_f32_16x16x32_bf16 v[68:71], v[36:39], a[68:71], v[68:71]
    v_mfma_f32_16x16x32_bf16 v[72:75], v[36:39], a[132:135], v[72:75]
    v_mfma_f32_16x16x32_bf16 v[76:79], v[36:39], a[196:199], v[76:79]
    v_mfma_f32_16x16x32_bf16 v[80:83], v[40:43], a[4:7], v[80:83]
    v_mfma_f32_16x16x32_bf16 v[84:87], v[40:43], a[68:71], v[84:87]
    v_mfma_f32_16x16x32_bf16 v[88:91], v[40:43], a[132:135], v[88:91]
    v_mfma_f32_16x16x32_bf16 v[92:95], v[40:43], a[196:199], v[92:95]
    v_mfma_f32_16x16x32_bf16 v[96:99], v[44:47], a[4:7], v[96:99]
    v_mfma_f32_16x16x32_bf16 v[100:103], v[44:47], a[68:71], v[100:103]
    v_mfma_f32_16x16x32_bf16 v[104:107], v[44:47], a[132:135], v[104:107]
    v_mfma_f32_16x16x32_bf16 v[108:111], v[44:47], a[196:199], v[108:111]
    ds_read_b128 v[32:35], v131 offset:0
    ds_read_b128 v[36:39], v131 offset:4096
    ds_read_b128 v[40:43], v131 offset:32768
    ds_read_b128 v[44:47], v131 offset:36864
    s_waitcnt lgkmcnt(4)
    v_mfma_f32_16x16x32_bf16 v[48:51], v[16:19], a[8:11], v[48:51]
    v_mfma_f32_16x16x32_bf16 v[52:55], v[16:19], a[72:75], v[52:55]
    v_mfma_f32_16x16x32_bf16 v[56:59], v[16:19], a[136:139], v[56:59]
    v_mfma_f32_16x16x32_bf16 v[60:63], v[16:19], a[200:203], v[60:63]
    v_xor_b32 v7, 32, v6
    s_add_u32 m0, s81, 67584
    s_add_u32 s79, s70, 2048
    buffer_load_dwordx4 v7, s[60:63], s79 offen sc1 lds
    v_mfma_f32_16x16x32_bf16 v[64:67], v[20:23], a[8:11], v[64:67]
    v_mfma_f32_16x16x32_bf16 v[68:71], v[20:23], a[72:75], v[68:71]
    v_mfma_f32_16x16x32_bf16 v[72:75], v[20:23], a[136:139], v[72:75]
    v_mfma_f32_16x16x32_bf16 v[76:79], v[20:23], a[200:203], v[76:79]
    v_mfma_f32_16x16x32_bf16 v[80:83], v[24:27], a[8:11], v[80:83]
    v_mfma_f32_16x16x32_bf16 v[84:87], v[24:27], a[72:75], v[84:87]
    v_mfma_f32_16x16x32_bf16 v[88:91], v[24:27], a[136:139], v[88:91]
    v_mfma_f32_16x16x32_bf16 v[92:95], v[24:27], a[200:203], v[92:95]
    v_mfma_f32_16x16x32_bf16 v[96:99], v[28:31], a[8:11], v[96:99]
    v_mfma_f32_16x16x32_bf16 v[100:103], v[28:31], a[72:75], v[100:103]
    v_mfma_f32_16x16x32_bf16 v[104:107], v[28:31], a[136:139], v[104:107]
    v_mfma_f32_16x16x32_bf16 v[108:111], v[28:31], a[200:203], v[108:111]
    ds_read_b128 v[16:19], v128 offset:256
    ds_read_b128 v[20:23], v128 offset:4352
    ds_read_b128 v[24:27], v128 offset:33024
    ds_read_b128 v[28:31], v128 offset:37120
    s_waitcnt lgkmcnt(4)
    v_mfma_f32_16x16x32_bf16 v[48:51], v[32:35], a[12:15], v[48:51]
    v_mfma_f32_16x16x32_bf16 v[52:55], v[32:35], a[76:79], v[52:55]
    v_mfma_f32_16x16x32_bf16 v[56:59], v[32:35], a[140:143], v[56:59]
    v_mfma_f32_16x16x32_bf16 v[60:63], v[32:35], a[204:207], v[60:63]
    v_xor_b32 v7, 48, v6
    s_add_u32 m0, s81, 68608
    s_add_u32 s79, s70, 3072
    buffer_load_dwordx4 v7, s[60:63], s79 offen sc1 lds
    v_mfma_f32_16x16x32_bf16 v[64:67], v[36:39], a[12:15], v[64:67]
    v_mfma_f32_16x16x32_bf16 v[68:71], v[36:39], a[76:79], v[68:71]
    v_mfma_f32_16x16x32_bf16 v[72:75], v[36:39], a[140:143], v[72:75]
    v_mfma_f32_16x16x32_bf16 v[76:79], v[36:39], a[204:207], v[76:79]
    v_mfma_f32_16x16x32_bf16 v[80:83], v[40:43], a[12:15], v[80:83]
    v_mfma_f32_16x16x32_bf16 v[84:87], v[40:43], a[76:79], v[84:87]
    v_mfma_f32_16x16x32_bf16 v[88:91], v[40:43], a[140:143], v[88:91]
    v_mfma_f32_16x16x32_bf16 v[92:95], v[40:43], a[204:207], v[92:95]
    v_mfma_f32_16x16x32_bf16 v[96:99], v[44:47], a[12:15], v[96:99]
    v_mfma_f32_16x16x32_bf16 v[100:103], v[44:47], a[76:79], v[100:103]
    v_mfma_f32_16x16x32_bf16 v[104:107], v[44:47], a[140:143], v[104:107]
    v_mfma_f32_16x16x32_bf16 v[108:111], v[44:47], a[204:207], v[108:111]
    ds_read_b128 v[32:35], v129 offset:256
    ds_read_b128 v[36:39], v129 offset:4352
    ds_read_b128 v[40:43], v129 offset:33024
    ds_read_b128 v[44:47], v129 offset:37120
    s_waitcnt lgkmcnt(4)
    v_mfma_f32_16x16x32_bf16 v[48:51], v[16:19], a[16:19], v[48:51]
    v_mfma_f32_16x16x32_bf16 v[52:55], v[16:19], a[80:83], v[52:55]
    v_mfma_f32_16x16x32_bf16 v[56:59], v[16:19], a[144:147], v[56:59]
    v_mfma_f32_16x16x32_bf16 v[60:63], v[16:19], a[208:211], v[60:63]
    v_xor_b32 v7, 64, v6
    s_add_u32 m0, s81, 73728
    s_add_u32 s79, s70, 8192
    buffer_load_dwordx4 v7, s[60:63], s79 offen sc1 lds
    v_mfma_f32_16x16x32_bf16 v[64:67], v[20:23], a[16:19], v[64:67]
    v_mfma_f32_16x16x32_bf16 v[68:71], v[20:23], a[80:83], v[68:71]
    v_mfma_f32_16x16x32_bf16 v[72:75], v[20:23], a[144:147], v[72:75]
    v_mfma_f32_16x16x32_bf16 v[76:79], v[20:23], a[208:211], v[76:79]
    v_mfma_f32_16x16x32_bf16 v[80:83], v[24:27], a[16:19], v[80:83]
    v_mfma_f32_16x16x32_bf16 v[84:87], v[24:27], a[80:83], v[84:87]
    v_mfma_f32_16x16x32_bf16 v[88:91], v[24:27], a[144:147], v[88:91]
    v_mfma_f32_16x16x32_bf16 v[92:95], v[24:27], a[208:211], v[92:95]
    v_mfma_f32_16x16x32_bf16 v[96:99], v[28:31], a[16:19], v[96:99]
    v_mfma_f32_16x16x32_bf16 v[100:103], v[28:31], a[80:83], v[100:103]
    v_mfma_f32_16x16x32_bf16 v[104:107], v[28:31], a[144:147], v[104:107]
    v_mfma_f32_16x16x32_bf16 v[108:111], v[28:31], a[208:211], v[108:111]
    ds_read_b128 v[16:19], v130 offset:256
    ds_read_b128 v[20:23], v130 offset:4352
    ds_read_b128 v[24:27], v130 offset:33024
    ds_read_b128 v[28:31], v130 offset:37120
    s_waitcnt lgkmcnt(4)
    v_mfma_f32_16x16x32_bf16 v[48:51], v[32:35], a[20:23], v[48:51]
    v_mfma_f32_16x16x32_bf16 v[52:55], v[32:35], a[84:87], v[52:55]
    v_mfma_f32_16x16x32_bf16 v[56:59], v[32:35], a[148:151], v[56:59]
    v_mfma_f32_16x16x32_bf16 v[60:63], v[32:35], a[212:215], v[60:63]
    v_xor_b32 v7, 80, v6
    s_add_u32 m0, s81, 74752
    s_add_u32 s79, s70, 9216
    buffer_load_dwordx4 v7, s[60:63], s79 offen sc1 lds
    v_mfma_f32_16x16x32_bf16 v[64:67], v[36:39], a[20:23], v[64:67]
    v_mfma_f32_16x16x32_bf16 v[68:71], v[36:39], a[84:87], v[68:71]
    v_mfma_f32_16x16x32_bf16 v[72:75], v[36:39], a[148:151], v[72:75]
    v_mfma_f32_16x16x32_bf16 v[76:79], v[36:39], a[212:215], v[76:79]
    v_mfma_f32_16x16x32_bf16 v[80:83], v[40:43], a[20:23], v[80:83]
    v_mfma_f32_16x16x32_bf16 v[84:87], v[40:43], a[84:87], v[84:87]
    v_mfma_f32_16x16x32_bf16 v[88:91], v[40:43], a[148:151], v[88:91]
    v_mfma_f32_16x16x32_bf16 v[92:95], v[40:43], a[212:215], v[92:95]
    v_mfma_f32_16x16x32_bf16 v[96:99], v[44:47], a[20:23], v[96:99]
    v_mfma_f32_16x16x32_bf16 v[100:103], v[44:47], a[84:87], v[100:103]
    v_mfma_f32_16x16x32_bf16 v[104:107], v[44:47], a[148:151], v[104:107]
    v_mfma_f32_16x16x32_bf16 v[108:111], v[44:47], a[212:215], v[108:111]
    ds_read_b128 v[32:35], v131 offset:256
    ds_read_b128 v[36:39], v131 offset:4352
    ds_read_b128 v[40:43], v131 offset:33024
    ds_read_b128 v[44:47], v131 offset:37120
    s_waitcnt lgkmcnt(4)
    v_mfma_f32_16x16x32_bf16 v[48:51], v[16:19], a[24:27], v[48:51]
    v_mfma_f32_16x16x32_bf16 v[52:55], v[16:19], a[88:91], v[52:55]
    v_mfma_f32_16x16x32_bf16 v[56:59], v[16:19], a[152:155], v[56:59]
    v_mfma_f32_16x16x32_bf16 v[60:63], v[16:19], a[216:219], v[60:63]
    v_xor_b32 v7, 96, v6
    s_add_u32 m0, s81, 75776
    s_add_u32 s79, s70, 10240
    buffer_load_dwordx4 v7, s[60:63], s79 offen sc1 lds
    v_mfma_f32_16x16x32_bf16 v[64:67], v[20:23], a[24:27], v[64:67]
    v_mfma_f32_16x16x32_bf16 v[68:71], v[20:23], a[88:91], v[68:71]
    v_mfma_f32_16x16x32_bf16 v[72:75], v[20:23], a[152:155], v[72:75]
    v_mfma_f32_16x16x32_bf16 v[76:79], v[20:23], a[216:219], v[76:79]
    v_mfma_f32_16x16x32_bf16 v[80:83], v[24:27], a[24:27], v[80:83]
    v_mfma_f32_16x16x32_bf16 v[84:87], v[24:27], a[88:91], v[84:87]
    v_mfma_f32_16x16x32_bf16 v[88:91], v[24:27], a[152:155], v[88:91]
    v_mfma_f32_16x16x32_bf16 v[92:95], v[24:27], a[216:219], v[92:95]
    v_mfma_f32_16x16x32_bf16 v[96:99], v[28:31], a[24:27], v[96:99]
    v_mfma_f32_16x16x32_bf16 v[100:103], v[28:31], a[88:91], v[100:103]
    v_mfma_f32_16x16x32_bf16 v[104:107], v[28:31], a[152:155], v[104:107]
    v_mfma_f32_16x16x32_bf16 v[108:111], v[28:31], a[216:219], v[108:111]
    ds_read_b128 v[16:19], v128 offset:512
    ds_read_b128 v[20:23], v128 offset:4608
    ds_read_b128 v[24:27], v128 offset:33280
    ds_read_b128 v[28:31], v128 offset:37376
    s_waitcnt lgkmcnt(4)
    v_mfma_f32_16x16x32_bf16 v[48:51], v[32:35], a[28:31], v[48:51]
    v_mfma_f32_16x16x32_bf16 v[52:55], v[32:35], a[92:95], v[52:55]
    v_mfma_f32_16x16x32_bf16 v[56:59], v[32:35], a[156:159], v[56:59]
    v_mfma_f32_16x16x32_bf16 v[60:63], v[32:35], a[220:223], v[60:63]
    v_xor_b32 v7, 112, v6
    s_add_u32 m0, s81, 76800
    s_add_u32 s79, s70, 11264
    buffer_load_dwordx4 v7, s[60:63], s79 offen sc1 lds
    v_mfma_f32_16x16x32_bf16 v[64:67], v[36:39], a[28:31], v[64:67]
    v_mfma_f32_16x16x32_bf16 v[68:71], v[36:39], a[92:95], v[68:71]
    v_mfma_f32_16x16x32_bf16 v[72:75], v[36:39], a[156:159], v[72:75]
    v_mfma_f32_16x16x32_bf16 v[76:79], v[36:39], a[220:223], v[76:79]
    v_mfma_f32_16x16x32_bf16 v[80:83], v[40:43], a[28:31], v[80:83]
    v_mfma_f32_16x16x32_bf16 v[84:87], v[40:43], a[92:95], v[84:87]
    v_mfma_f32_16x16x32_bf16 v[88:91], v[40:43], a[156:159], v[88:91]
    v_mfma_f32_16x16x32_bf16 v[92:95], v[40:43], a[220:223], v[92:95]
    v_mfma_f32_16x16x32_bf16 v[96:99], v[44:47], a[28:31], v[96:99]
    v_mfma_f32_16x16x32_bf16 v[100:103], v[44:47], a[92:95], v[100:103]
    v_mfma_f32_16x16x32_bf16 v[104:107], v[44:47], a[156:159], v[104:107]
    v_mfma_f32_16x16x32_bf16 v[108:111], v[44:47], a[220:223], v[108:111]
    ds_read_b128 v[32:35], v129 offset:512
    ds_read_b128 v[36:39], v129 offset:4608
    ds_read_b128 v[40:43], v129 offset:33280
    ds_read_b128 v[44:47], v129 offset:37376
    s_waitcnt lgkmcnt(4)
    v_mfma_f32_16x16x32_bf16 v[48:51], v[16:19], a[32:35], v[48:51]
    v_mfma_f32_16x16x32_bf16 v[52:55], v[16:19], a[96:99], v[52:55]
    v_mfma_f32_16x16x32_bf16 v[56:59], v[16:19], a[160:163], v[56:59]
    v_mfma_f32_16x16x32_bf16 v[60:63], v[16:19], a[224:227], v[60:63]
    v_xor_b32 v7, 128, v6
    s_add_u32 m0, s81, 81920
    s_add_u32 s79, s70, 16384
    buffer_load_dwordx4 v7, s[60:63], s79 offen sc1 lds
    v_mfma_f32_16x16x32_bf16 v[64:67], v[20:23], a[32:35], v[64:67]
    v_mfma_f32_16x16x32_bf16 v[68:71], v[20:23], a[96:99], v[68:71]
    v_mfma_f32_16x16x32_bf16 v[72:75], v[20:23], a[160:163], v[72:75]
    v_mfma_f32_16x16x32_bf16 v[76:79], v[20:23], a[224:227], v[76:79]
    v_mfma_f32_16x16x32_bf16 v[80:83], v[24:27], a[32:35], v[80:83]
    v_mfma_f32_16x16x32_bf16 v[84:87], v[24:27], a[96:99], v[84:87]
    v_mfma_f32_16x16x32_bf16 v[88:91], v[24:27], a[160:163], v[88:91]
    v_mfma_f32_16x16x32_bf16 v[92:95], v[24:27], a[224:227], v[92:95]
    v_mfma_f32_16x16x32_bf16 v[96:99], v[28:31], a[32:35], v[96:99]
    v_mfma_f32_16x16x32_bf16 v[100:103], v[28:31], a[96:99], v[100:103]
    v_mfma_f32_16x16x32_bf16 v[104:107], v[28:31], a[160:163], v[104:107]
    v_mfma_f32_16x16x32_bf16 v[108:111], v[28:31], a[224:227], v[108:111]
    ds_read_b128 v[16:19], v130 offset:512
    ds_read_b128 v[20:23], v130 offset:4608
    ds_read_b128 v[24:27], v130 offset:33280
    ds_read_b128 v[28:31], v130 offset:37376
    s_waitcnt lgkmcnt(4)
    v_mfma_f32_16x16x32_bf16 v[48:51], v[32:35], a[36:39], v[48:51]
    v_mfma_f32_16x16x32_bf16 v[52:55], v[32:35], a[100:103], v[52:55]
    v_mfma_f32_16x16x32_bf16 v[56:59], v[32:35], a[164:167], v[56:59]
    v_mfma_f32_16x16x32_bf16 v[60:63], v[32:35], a[228:231], v[60:63]
    v_xor_b32 v7, 144, v6
    s_add_u32 m0, s81, 82944
    s_add_u32 s79, s70, 17408
    buffer_load_dwordx4 v7, s[60:63], s79 offen sc1 lds
    v_mfma_f32_16x16x32_bf16 v[64:67], v[36:39], a[36:39], v[64:67]
    v_mfma_f32_16x16x32_bf16 v[68:71], v[36:39], a[100:103], v[68:71]
    v_mfma_f32_16x16x32_bf16 v[72:75], v[36:39], a[164:167], v[72:75]
    v_mfma_f32_16x16x32_bf16 v[76:79], v[36:39], a[228:231], v[76:79]
    v_mfma_f32_16x16x32_bf16 v[80:83], v[40:43], a[36:39], v[80:83]
    v_mfma_f32_16x16x32_bf16 v[84:87], v[40:43], a[100:103], v[84:87]
    v_mfma_f32_16x16x32_bf16 v[88:91], v[40:43], a[164:167], v[88:91]
    v_mfma_f32_16x16x32_bf16 v[92:95], v[40:43], a[228:231], v[92:95]
    v_mfma_f32_16x16x32_bf16 v[96:99], v[44:47], a[36:39], v[96:99]
    v_mfma_f32_16x16x32_bf16 v[100:103], v[44:47], a[100:103], v[100:103]
    v_mfma_f32_16x16x32_bf16 v[104:107], v[44:47], a[164:167], v[104:107]
    v_mfma_f32_16x16x32_bf16 v[108:111], v[44:47], a[228:231], v[108:111]
    ds_read_b128 v[32:35], v131 offset:512
    ds_read_b128 v[36:39], v131 offset:4608
    ds_read_b128 v[40:43], v131 offset:33280
    ds_read_b128 v[44:47], v131 offset:37376
    s_waitcnt lgkmcnt(4)
    v_mfma_f32_16x16x32_bf16 v[48:51], v[16:19], a[40:43], v[48:51]
    v_mfma_f32_16x16x32_bf16 v[52:55], v[16:19], a[104:107], v[52:55]
    v_mfma_f32_16x16x32_bf16 v[56:59], v[16:19], a[168:171], v[56:59]
    v_mfma_f32_16x16x32_bf16 v[60:63], v[16:19], a[232:235], v[60:63]
    v_xor_b32 v7, 160, v6
    s_add_u32 m0, s81, 83968
    s_add_u32 s79, s70, 18432
    buffer_load_dwordx4 v7, s[60:63], s79 offen sc1 lds
    v_mfma_f32_16x16x32_bf16 v[64:67], v[20:23], a[40:43], v[64:67]
    v_mfma_f32_16x16x32_bf16 v[68:71], v[20:23], a[104:107], v[68:71]
    v_mfma_f32_16x16x32_bf16 v[72:75], v[20:23], a[168:171], v[72:75]
    v_mfma_f32_16x16x32_bf16 v[76:79], v[20:23], a[232:235], v[76:79]
    v_mfma_f32_16x16x32_bf16 v[80:83], v[24:27], a[40:43], v[80:83]
    v_mfma_f32_16x16x32_bf16 v[84:87], v[24:27], a[104:107], v[84:87]
    v_mfma_f32_16x16x32_bf16 v[88:91], v[24:27], a[168:171], v[88:91]
    v_mfma_f32_16x16x32_bf16 v[92:95], v[24:27], a[232:235], v[92:95]
    v_mfma_f32_16x16x32_bf16 v[96:99], v[28:31], a[40:43], v[96:99]
    v_mfma_f32_16x16x32_bf16 v[100:103], v[28:31], a[104:107], v[100:103]
    v_mfma_f32_16x16x32_bf16 v[104:107], v[28:31], a[168:171], v[104:107]
    v_mfma_f32_16x16x32_bf16 v[108:111], v[28:31], a[232:235], v[108:111]
    ds_read_b128 v[16:19], v128 offset:768
    ds_read_b128 v[20:23], v128 offset:4864
    ds_read_b128 v[24:27], v128 offset:33536
    ds_read_b128 v[28:31], v128 offset:37632
    s_waitcnt lgkmcnt(4)
    v_mfma_f32_16x16x32_bf16 v[48:51], v[32:35], a[44:47], v[48:51]
    v_mfma_f32_16x16x32_bf16 v[52:55], v[32:35], a[108:111], v[52:55]
    v_mfma_f32_16x16x32_bf16 v[56:59], v[32:35], a[172:175], v[56:59]
    v_mfma_f32_16x16x32_bf16 v[60:63], v[32:35], a[236:239], v[60:63]
    v_xor_b32 v7, 176, v6
    s_add_u32 m0, s81, 84992
    s_add_u32 s79, s70, 19456
    buffer_load_dwordx4 v7, s[60:63], s79 offen sc1 lds
    v_mfma_f32_16x16x32_bf16 v[64:67], v[36:39], a[44:47], v[64:67]
    v_mfma_f32_16x16x32_bf16 v[68:71], v[36:39], a[108:111], v[68:71]
    v_mfma_f32_16x16x32_bf16 v[72:75], v[36:39], a[172:175], v[72:75]
    v_mfma_f32_16x16x32_bf16 v[76:79], v[36:39], a[236:239], v[76:79]
    v_mfma_f32_16x16x32_bf16 v[80:83], v[40:43], a[44:47], v[80:83]
    v_mfma_f32_16x16x32_bf16 v[84:87], v[40:43], a[108:111], v[84:87]
    v_mfma_f32_16x16x32_bf16 v[88:91], v[40:43], a[172:175], v[88:91]
    v_mfma_f32_16x16x32_bf16 v[92:95], v[40:43], a[236:239], v[92:95]
    v_mfma_f32_16x16x32_bf16 v[96:99], v[44:47], a[44:47], v[96:99]
    v_mfma_f32_16x16x32_bf16 v[100:103], v[44:47], a[108:111], v[100:103]
    v_mfma_f32_16x16x32_bf16 v[104:107], v[44:47], a[172:175], v[104:107]
    v_mfma_f32_16x16x32_bf16 v[108:111], v[44:47], a[236:239], v[108:111]
    ds_read_b128 v[32:35], v129 offset:768
    ds_read_b128 v[36:39], v129 offset:4864
    ds_read_b128 v[40:43], v129 offset:33536
    ds_read_b128 v[44:47], v129 offset:37632
    s_waitcnt lgkmcnt(4)
    v_mfma_f32_16x16x32_bf16 v[48:51], v[16:19], a[48:51], v[48:51]
    v_mfma_f32_16x16x32_bf16 v[52:55], v[16:19], a[112:115], v[52:55]
    v_mfma_f32_16x16x32_bf16 v[56:59], v[16:19], a[176:179], v[56:59]
    v_mfma_f32_16x16x32_bf16 v[60:63], v[16:19], a[240:243], v[60:63]
    v_xor_b32 v7, 192, v6
    s_add_u32 m0, s81, 90112
    s_add_u32 s79, s70, 24576
    buffer_load_dwordx4 v7, s[60:63], s79 offen sc1 lds
    v_mfma_f32_16x16x32_bf16 v[64:67], v[20:23], a[48:51], v[64:67]
    v_mfma_f32_16x16x32_bf16 v[68:71], v[20:23], a[112:115], v[68:71]
    v_mfma_f32_16x16x32_bf16 v[72:75], v[20:23], a[176:179], v[72:75]
    v_mfma_f32_16x16x32_bf16 v[76:79], v[20:23], a[240:243], v[76:79]
    v_mfma_f32_16x16x32_bf16 v[80:83], v[24:27], a[48:51], v[80:83]
    v_mfma_f32_16x16x32_bf16 v[84:87], v[24:27], a[112:115], v[84:87]
    v_mfma_f32_16x16x32_bf16 v[88:91], v[24:27], a[176:179], v[88:91]
    v_mfma_f32_16x16x32_bf16 v[92:95], v[24:27], a[240:243], v[92:95]
    v_mfma_f32_16x16x32_bf16 v[96:99], v[28:31], a[48:51], v[96:99]
    v_mfma_f32_16x16x32_bf16 v[100:103], v[28:31], a[112:115], v[100:103]
    v_mfma_f32_16x16x32_bf16 v[104:107], v[28:31], a[176:179], v[104:107]
    v_mfma_f32_16x16x32_bf16 v[108:111], v[28:31], a[240:243], v[108:111]
    ds_read_b128 v[16:19], v130 offset:768
    ds_read_b128 v[20:23], v130 offset:4864
    ds_read_b128 v[24:27], v130 offset:33536
    ds_read_b128 v[28:31], v130 offset:37632
    s_waitcnt lgkmcnt(4)
    v_mfma_f32_16x16x32_bf16 v[48:51], v[32:35], a[52:55], v[48:51]
    v_mfma_f32_16x16x32_bf16 v[52:55], v[32:35], a[116:119], v[52:55]
    v_mfma_f32_16x16x32_bf16 v[56:59], v[32:35], a[180:183], v[56:59]
    v_mfma_f32_16x16x32_bf16 v[60:63], v[32:35], a[244:247], v[60:63]
    v_xor_b32 v7, 208, v6
    s_add_u32 m0, s81, 91136
    s_add_u32 s79, s70, 25600
    buffer_load_dwordx4 v7, s[60:63], s79 offen sc1 lds
    v_mfma_f32_16x16x32_bf16 v[64:67], v[36:39], a[52:55], v[64:67]
    v_mfma_f32_16x16x32_bf16 v[68:71], v[36:39], a[116:119], v[68:71]
    v_mfma_f32_16x16x32_bf16 v[72:75], v[36:39], a[180:183], v[72:75]
    v_mfma_f32_16x16x32_bf16 v[76:79], v[36:39], a[244:247], v[76:79]
    v_mfma_f32_16x16x32_bf16 v[80:83], v[40:43], a[52:55], v[80:83]
    v_mfma_f32_16x16x32_bf16 v[84:87], v[40:43], a[116:119], v[84:87]
    v_mfma_f32_16x16x32_bf16 v[88:91], v[40:43], a[180:183], v[88:91]
    v_mfma_f32_16x16x32_bf16 v[92:95], v[40:43], a[244:247], v[92:95]
    v_mfma_f32_16x16x32_bf16 v[96:99], v[44:47], a[52:55], v[96:99]
    v_mfma_f32_16x16x32_bf16 v[100:103], v[44:47], a[116:119], v[100:103]
    v_mfma_f32_16x16x32_bf16 v[104:107], v[44:47], a[180:183], v[104:107]
    v_mfma_f32_16x16x32_bf16 v[108:111], v[44:47], a[244:247], v[108:111]
    ds_read_b128 v[32:35], v131 offset:768
    ds_read_b128 v[36:39], v131 offset:4864
    ds_read_b128 v[40:43], v131 offset:33536
    ds_read_b128 v[44:47], v131 offset:37632
    s_waitcnt lgkmcnt(4)
    v_mfma_f32_16x16x32_bf16 v[48:51], v[16:19], a[56:59], v[48:51]
    v_mfma_f32_16x16x32_bf16 v[52:55], v[16:19], a[120:123], v[52:55]
    v_mfma_f32_16x16x32_bf16 v[56:59], v[16:19], a[184:187], v[56:59]
    v_mfma_f32_16x16x32_bf16 v[60:63], v[16:19], a[248:251], v[60:63]
    v_xor_b32 v7, 224, v6
    s_add_u32 m0, s81, 92160
    s_add_u32 s79, s70, 26624
    buffer_load_dwordx4 v7, s[60:63], s79 offen sc1 lds
    v_mfma_f32_16x16x32_bf16 v[64:67], v[20:23], a[56:59], v[64:67]
    v_mfma_f32_16x16x32_bf16 v[68:71], v[20:23], a[120:123], v[68:71]
    v_mfma_f32_16x16x32_bf16 v[72:75], v[20:23], a[184:187], v[72:75]
    v_mfma_f32_16x16x32_bf16 v[76:79], v[20:23], a[248:251], v[76:79]
    v_mfma_f32_16x16x32_bf16 v[80:83], v[24:27], a[56:59], v[80:83]
    v_mfma_f32_16x16x32_bf16 v[84:87], v[24:27], a[120:123], v[84:87]
    v_mfma_f32_16x16x32_bf16 v[88:91], v[24:27], a[184:187], v[88:91]
    v_mfma_f32_16x16x32_bf16 v[92:95], v[24:27], a[248:251], v[92:95]
    v_mfma_f32_16x16x32_bf16 v[96:99], v[28:31], a[56:59], v[96:99]
    v_mfma_f32_16x16x32_bf16 v[100:103], v[28:31], a[120:123], v[100:103]
    v_mfma_f32_16x16x32_bf16 v[104:107], v[28:31], a[184:187], v[104:107]
    v_mfma_f32_16x16x32_bf16 v[108:111], v[28:31], a[248:251], v[108:111]
    s_waitcnt lgkmcnt(0)
    v_mfma_f32_16x16x32_bf16 v[48:51], v[32:35], a[60:63], v[48:51]
    v_mfma_f32_16x16x32_bf16 v[52:55], v[32:35], a[124:127], v[52:55]
    v_mfma_f32_16x16x32_bf16 v[56:59], v[32:35], a[188:191], v[56:59]
    v_mfma_f32_16x16x32_bf16 v[60:63], v[32:35], a[252:255], v[60:63]
    v_xor_b32 v7, 240, v6
    s_add_u32 m0, s81, 93184
    s_add_u32 s79, s70, 27648
    buffer_load_dwordx4 v7, s[60:63], s79 offen sc1 lds
    v_mfma_f32_16x16x32_bf16 v[64:67], v[36:39], a[60:63], v[64:67]
    v_mfma_f32_16x16x32_bf16 v[68:71], v[36:39], a[124:127], v[68:71]
    v_mfma_f32_16x16x32_bf16 v[72:75], v[36:39], a[188:191], v[72:75]
    v_mfma_f32_16x16x32_bf16 v[76:79], v[36:39], a[252:255], v[76:79]
    v_mfma_f32_16x16x32_bf16 v[80:83], v[40:43], a[60:63], v[80:83]
    v_mfma_f32_16x16x32_bf16 v[84:87], v[40:43], a[124:127], v[84:87]
    v_mfma_f32_16x16x32_bf16 v[88:91], v[40:43], a[188:191], v[88:91]
    v_mfma_f32_16x16x32_bf16 v[92:95], v[40:43], a[252:255], v[92:95]
    v_mfma_f32_16x16x32_bf16 v[96:99], v[44:47], a[60:63], v[96:99]
    v_mfma_f32_16x16x32_bf16 v[100:103], v[44:47], a[124:127], v[100:103]
    v_mfma_f32_16x16x32_bf16 v[104:107], v[44:47], a[188:191], v[104:107]
    v_mfma_f32_16x16x32_bf16 v[108:111], v[44:47], a[252:255], v[108:111]
    s_add_u32 s70, s70, 65536
    s_add_u32 s77, s73, 0
    v_cvt_pk_bf16_f32 v112, v48, v49
    v_cvt_pk_bf16_f32 v113, v50, v51
    v_cvt_pk_bf16_f32 v114, v64, v65
    v_cvt_pk_bf16_f32 v115, v66, v67
    buffer_store_dwordx4 v[112:115], v1, s[52:55], s77 offen offset:2048 sc1
    v_cvt_pk_bf16_f32 v116, v52, v53
    v_cvt_pk_bf16_f32 v117, v54, v55
    v_cvt_pk_bf16_f32 v118, v68, v69
    v_cvt_pk_bf16_f32 v119, v70, v71
    buffer_store_dwordx4 v[116:119], v1, s[52:55], s77 offen offset:3072 sc1
    s_add_u32 s77, s73, 4096
    v_cvt_pk_bf16_f32 v112, v56, v57
    v_cvt_pk_bf16_f32 v113, v58, v59
    v_cvt_pk_bf16_f32 v114, v72, v73
    v_cvt_pk_bf16_f32 v115, v74, v75
    buffer_store_dwordx4 v[112:115], v1, s[52:55], s77 offen offset:2048 sc1
    v_cvt_pk_bf16_f32 v116, v60, v61
    v_cvt_pk_bf16_f32 v117, v62, v63
    v_cvt_pk_bf16_f32 v118, v76, v77
    v_cvt_pk_bf16_f32 v119, v78, v79
    buffer_store_dwordx4 v[116:119], v1, s[52:55], s77 offen offset:3072 sc1
    s_add_u32 s77, s73, 524288
    v_cvt_pk_bf16_f32 v112, v80, v81
    v_cvt_pk_bf16_f32 v113, v82, v83
    v_cvt_pk_bf16_f32 v114, v96, v97
    v_cvt_pk_bf16_f32 v115, v98, v99
    buffer_store_dwordx4 v[112:115], v1, s[52:55], s77 offen offset:2048 sc1
    v_cvt_pk_bf16_f32 v116, v84, v85
    v_cvt_pk_bf16_f32 v117, v86, v87
    v_cvt_pk_bf16_f32 v118, v100, v101
    v_cvt_pk_bf16_f32 v119, v102, v103
    buffer_store_dwordx4 v[116:119], v1, s[52:55], s77 offen offset:3072 sc1
    s_add_u32 s77, s73, 528384
    v_cvt_pk_bf16_f32 v112, v88, v89
    v_cvt_pk_bf16_f32 v113, v90, v91
    v_cvt_pk_bf16_f32 v114, v104, v105
    v_cvt_pk_bf16_f32 v115, v106, v107
    buffer_store_dwordx4 v[112:115], v1, s[52:55], s77 offen offset:2048 sc1
    v_cvt_pk_bf16_f32 v116, v92, v93
    v_cvt_pk_bf16_f32 v117, v94, v95
    v_cvt_pk_bf16_f32 v118, v108, v109
    v_cvt_pk_bf16_f32 v119, v110, v111
    buffer_store_dwordx4 v[116:119], v1, s[52:55], s77 offen offset:3072 sc1
    s_add_u32 s73, s73, 1048576
    s_cmp_lg_u32 s83, 0
    s_cbranch_scc1 L_wse_155
    s_cmp_ge_u32 s88, 32
    s_cbranch_scc1 L_wse_155
    s_waitcnt vmcnt(0)
    s_barrier
    s_cmp_lg_u32 s56, 0
    s_cbranch_scc1 L_wse_155
    s_mov_b32 s80, 28
    v_mov_b32 v120, 1
    v_mov_b32 v121, s80
    s_mov_b64 exec, 1
    buffer_atomic_add v120, v121, s[48:51], 0 offen
    s_mov_b64 exec, -1
L_wse_155:
    s_waitcnt vmcnt(8)
    s_barrier
    s_cmp_eq_u32 s83, 0
    s_cbranch_scc1 L_wsg_156
    s_cmp_lg_u32 s56, 0
    s_cbranch_scc1 L_wsg_156
    s_add_u32 s80, s89, s83
    s_lshl_b32 s80, s80, 2
    s_add_u32 s80, s80, 28
    v_mov_b32 v120, s68
    v_mov_b32 v121, s80
    s_mov_b64 exec, 1
    buffer_atomic_add v120, v121, s[48:51], 0 offen
    s_mov_b64 exec, -1
    s_nop 0
L_wsg_156:
    ds_read_b128 v[16:19], v132 offset:0
    ds_read_b128 v[20:23], v132 offset:4096
    ds_read_b128 v[24:27], v132 offset:32768
    ds_read_b128 v[28:31], v132 offset:36864
    ds_read_b128 v[32:35], v133 offset:0
    ds_read_b128 v[36:39], v133 offset:4096
    ds_read_b128 v[40:43], v133 offset:32768
    ds_read_b128 v[44:47], v133 offset:36864
    s_waitcnt lgkmcnt(4)
    v_mfma_f32_16x16x32_bf16 v[48:51], v[16:19], a[0:3], 0
    v_mfma_f32_16x16x32_bf16 v[52:55], v[16:19], a[64:67], 0
    v_mfma_f32_16x16x32_bf16 v[56:59], v[16:19], a[128:131], 0
    v_mfma_f32_16x16x32_bf16 v[60:63], v[16:19], a[192:195], 0
    v_xor_b32 v7, 0, v6
    s_add_u32 m0, s81, 0
    s_add_u32 s79, s70, 0
    buffer_load_dwordx4 v7, s[60:63], s79 offen sc1 lds
    v_mfma_f32_16x16x32_bf16 v[64:67], v[20:23], a[0:3], 0
    v_mfma_f32_16x16x32_bf16 v[68:71], v[20:23], a[64:67], 0
    v_mfma_f32_16x16x32_bf16 v[72:75], v[20:23], a[128:131], 0
    v_mfma_f32_16x16x32_bf16 v[76:79], v[20:23], a[192:195], 0
    v_mfma_f32_16x16x32_bf16 v[80:83], v[24:27], a[0:3], 0
    v_mfma_f32_16x16x32_bf16 v[84:87], v[24:27], a[64:67], 0
    v_mfma_f32_16x16x32_bf16 v[88:91], v[24:27], a[128:131], 0
    v_mfma_f32_16x16x32_bf16 v[92:95], v[24:27], a[192:195], 0
    v_mfma_f32_16x16x32_bf16 v[96:99], v[28:31], a[0:3], 0
    v_mfma_f32_16x16x32_bf16 v[100:103], v[28:31], a[64:67], 0
    v_mfma_f32_16x16x32_bf16 v[104:107], v[28:31], a[128:131], 0
    v_mfma_f32_16x16x32_bf16 v[108:111], v[28:31], a[192:195], 0
    ds_read_b128 v[16:19], v134 offset:0
    ds_read_b128 v[20:23], v134 offset:4096
    ds_read_b128 v[24:27], v134 offset:32768
    ds_read_b128 v[28:31], v134 offset:36864
    s_waitcnt lgkmcnt(4)
    v_mfma_f32_16x16x32_bf16 v[48:51], v[32:35], a[4:7], v[48:51]
    v_mfma_f32_16x16x32_bf16 v[52:55], v[32:35], a[68:71], v[52:55]
    v_mfma_f32_16x16x32_bf16 v[56:59], v[32:35], a[132:135], v[56:59]
    v_mfma_f32_16x16x32_bf16 v[60:63], v[32:35], a[196:199], v[60:63]
    v_xor_b32 v7, 16, v6
    s_add_u32 m0, s81, 1024
    s_add_u32 s79, s70, 1024
    buffer_load_dwordx4 v7, s[60:63], s79 offen sc1 lds
    v_mfma_f32_16x16x32_bf16 v[64:67], v[36:39], a[4:7], v[64:67]
    v_mfma_f32_16x16x32_bf16 v[68:71], v[36:39], a[68:71], v[68:71]
    v_mfma_f32_16x16x32_bf16 v[72:75], v[36:39], a[132:135], v[72:75]
    v_mfma_f32_16x16x32_bf16 v[76:79], v[36:39], a[196:199], v[76:79]
    v_mfma_f32_16x16x32_bf16 v[80:83], v[40:43], a[4:7], v[80:83]
    v_mfma_f32_16x16x32_bf16 v[84:87], v[40:43], a[68:71], v[84:87]
    v_mfma_f32_16x16x32_bf16 v[88:91], v[40:43], a[132:135], v[88:91]
    v_mfma_f32_16x16x32_bf16 v[92:95], v[40:43], a[196:199], v[92:95]
    v_mfma_f32_16x16x32_bf16 v[96:99], v[44:47], a[4:7], v[96:99]
    v_mfma_f32_16x16x32_bf16 v[100:103], v[44:47], a[68:71], v[100:103]
    v_mfma_f32_16x16x32_bf16 v[104:107], v[44:47], a[132:135], v[104:107]
    v_mfma_f32_16x16x32_bf16 v[108:111], v[44:47], a[196:199], v[108:111]
    ds_read_b128 v[32:35], v135 offset:0
    ds_read_b128 v[36:39], v135 offset:4096
    ds_read_b128 v[40:43], v135 offset:32768
    ds_read_b128 v[44:47], v135 offset:36864
    s_waitcnt lgkmcnt(4)
    v_mfma_f32_16x16x32_bf16 v[48:51], v[16:19], a[8:11], v[48:51]
    v_mfma_f32_16x16x32_bf16 v[52:55], v[16:19], a[72:75], v[52:55]
    v_mfma_f32_16x16x32_bf16 v[56:59], v[16:19], a[136:139], v[56:59]
    v_mfma_f32_16x16x32_bf16 v[60:63], v[16:19], a[200:203], v[60:63]
    v_xor_b32 v7, 32, v6
    s_add_u32 m0, s81, 2048
    s_add_u32 s79, s70, 2048
    buffer_load_dwordx4 v7, s[60:63], s79 offen sc1 lds
    v_mfma_f32_16x16x32_bf16 v[64:67], v[20:23], a[8:11], v[64:67]
    v_mfma_f32_16x16x32_bf16 v[68:71], v[20:23], a[72:75], v[68:71]
    v_mfma_f32_16x16x32_bf16 v[72:75], v[20:23], a[136:139], v[72:75]
    v_mfma_f32_16x16x32_bf16 v[76:79], v[20:23], a[200:203], v[76:79]
    v_mfma_f32_16x16x32_bf16 v[80:83], v[24:27], a[8:11], v[80:83]
    v_mfma_f32_16x16x32_bf16 v[84:87], v[24:27], a[72:75], v[84:87]
    v_mfma_f32_16x16x32_bf16 v[88:91], v[24:27], a[136:139], v[88:91]
    v_mfma_f32_16x16x32_bf16 v[92:95], v[24:27], a[200:203], v[92:95]
    v_mfma_f32_16x16x32_bf16 v[96:99], v[28:31], a[8:11], v[96:99]
    v_mfma_f32_16x16x32_bf16 v[100:103], v[28:31], a[72:75], v[100:103]
    v_mfma_f32_16x16x32_bf16 v[104:107], v[28:31], a[136:139], v[104:107]
    v_mfma_f32_16x16x32_bf16 v[108:111], v[28:31], a[200:203], v[108:111]
    ds_read_b128 v[16:19], v132 offset:256
    ds_read_b128 v[20:23], v132 offset:4352
    ds_read_b128 v[24:27], v132 offset:33024
    ds_read_b128 v[28:31], v132 offset:37120
    s_waitcnt lgkmcnt(4)
    v_mfma_f32_16x16x32_bf16 v[48:51], v[32:35], a[12:15], v[48:51]
    v_mfma_f32_16x16x32_bf16 v[52:55], v[32:35], a[76:79], v[52:55]
    v_mfma_f32_16x16x32_bf16 v[56:59], v[32:35], a[140:143], v[56:59]
    v_mfma_f32_16x16x32_bf16 v[60:63], v[32:35], a[204:207], v[60:63]
    v_xor_b32 v7, 48, v6
    s_add_u32 m0, s81, 3072
    s_add_u32 s79, s70, 3072
    buffer_load_dwordx4 v7, s[60:63], s79 offen sc1 lds
    v_mfma_f32_16x16x32_bf16 v[64:67], v[36:39], a[12:15], v[64:67]
    v_mfma_f32_16x16x32_bf16 v[68:71], v[36:39], a[76:79], v[68:71]
    v_mfma_f32_16x16x32_bf16 v[72:75], v[36:39], a[140:143], v[72:75]
    v_mfma_f32_16x16x32_bf16 v[76:79], v[36:39], a[204:207], v[76:79]
    v_mfma_f32_16x16x32_bf16 v[80:83], v[40:43], a[12:15], v[80:83]
    v_mfma_f32_16x16x32_bf16 v[84:87], v[40:43], a[76:79], v[84:87]
    v_mfma_f32_16x16x32_bf16 v[88:91], v[40:43], a[140:143], v[88:91]
    v_mfma_f32_16x16x32_bf16 v[92:95], v[40:43], a[204:207], v[92:95]
    v_mfma_f32_16x16x32_bf16 v[96:99], v[44:47], a[12:15], v[96:99]
    v_mfma_f32_16x16x32_bf16 v[100:103], v[44:47], a[76:79], v[100:103]
    v_mfma_f32_16x16x32_bf16 v[104:107], v[44:47], a[140:143], v[104:107]
    v_mfma_f32_16x16x32_bf16 v[108:111], v[44:47], a[204:207], v[108:111]
    ds_read_b128 v[32:35], v133 offset:256
    ds_read_b128 v[36:39], v133 offset:4352
    ds_read_b128 v[40:43], v133 offset:33024
    ds_read_b128 v[44:47], v133 offset:37120
    s_waitcnt lgkmcnt(4)
    v_mfma_f32_16x16x32_bf16 v[48:51], v[16:19], a[16:19], v[48:51]
    v_mfma_f32_16x16x32_bf16 v[52:55], v[16:19], a[80:83], v[52:55]
    v_mfma_f32_16x16x32_bf16 v[56:59], v[16:19], a[144:147], v[56:59]
    v_mfma_f32_16x16x32_bf16 v[60:63], v[16:19], a[208:211], v[60:63]
    v_xor_b32 v7, 64, v6
    s_add_u32 m0, s81, 8192
    s_add_u32 s79, s70, 8192
    buffer_load_dwordx4 v7, s[60:63], s79 offen sc1 lds
    v_mfma_f32_16x16x32_bf16 v[64:67], v[20:23], a[16:19], v[64:67]
    v_mfma_f32_16x16x32_bf16 v[68:71], v[20:23], a[80:83], v[68:71]
    v_mfma_f32_16x16x32_bf16 v[72:75], v[20:23], a[144:147], v[72:75]
    v_mfma_f32_16x16x32_bf16 v[76:79], v[20:23], a[208:211], v[76:79]
    v_mfma_f32_16x16x32_bf16 v[80:83], v[24:27], a[16:19], v[80:83]
    v_mfma_f32_16x16x32_bf16 v[84:87], v[24:27], a[80:83], v[84:87]
    v_mfma_f32_16x16x32_bf16 v[88:91], v[24:27], a[144:147], v[88:91]
    v_mfma_f32_16x16x32_bf16 v[92:95], v[24:27], a[208:211], v[92:95]
    v_mfma_f32_16x16x32_bf16 v[96:99], v[28:31], a[16:19], v[96:99]
    v_mfma_f32_16x16x32_bf16 v[100:103], v[28:31], a[80:83], v[100:103]
    v_mfma_f32_16x16x32_bf16 v[104:107], v[28:31], a[144:147], v[104:107]
    v_mfma_f32_16x16x32_bf16 v[108:111], v[28:31], a[208:211], v[108:111]
    ds_read_b128 v[16:19], v134 offset:256
    ds_read_b128 v[20:23], v134 offset:4352
    ds_read_b128 v[24:27], v134 offset:33024
    ds_read_b128 v[28:31], v134 offset:37120
    s_waitcnt lgkmcnt(4)
    v_mfma_f32_16x16x32_bf16 v[48:51], v[32:35], a[20:23], v[48:51]
    v_mfma_f32_16x16x32_bf16 v[52:55], v[32:35], a[84:87], v[52:55]
    v_mfma_f32_16x16x32_bf16 v[56:59], v[32:35], a[148:151], v[56:59]
    v_mfma_f32_16x16x32_bf16 v[60:63], v[32:35], a[212:215], v[60:63]
    v_xor_b32 v7, 80, v6
    s_add_u32 m0, s81, 9216
    s_add_u32 s79, s70, 9216
    buffer_load_dwordx4 v7, s[60:63], s79 offen sc1 lds
    v_mfma_f32_16x16x32_bf16 v[64:67], v[36:39], a[20:23], v[64:67]
    v_mfma_f32_16x16x32_bf16 v[68:71], v[36:39], a[84:87], v[68:71]
    v_mfma_f32_16x16x32_bf16 v[72:75], v[36:39], a[148:151], v[72:75]
    v_mfma_f32_16x16x32_bf16 v[76:79], v[36:39], a[212:215], v[76:79]
    v_mfma_f32_16x16x32_bf16 v[80:83], v[40:43], a[20:23], v[80:83]
    v_mfma_f32_16x16x32_bf16 v[84:87], v[40:43], a[84:87], v[84:87]
    v_mfma_f32_16x16x32_bf16 v[88:91], v[40:43], a[148:151], v[88:91]
    v_mfma_f32_16x16x32_bf16 v[92:95], v[40:43], a[212:215], v[92:95]
    v_mfma_f32_16x16x32_bf16 v[96:99], v[44:47], a[20:23], v[96:99]
    v_mfma_f32_16x16x32_bf16 v[100:103], v[44:47], a[84:87], v[100:103]
    v_mfma_f32_16x16x32_bf16 v[104:107], v[44:47], a[148:151], v[104:107]
    v_mfma_f32_16x16x32_bf16 v[108:111], v[44:47], a[212:215], v[108:111]
    ds_read_b128 v[32:35], v135 offset:256
    ds_read_b128 v[36:39], v135 offset:4352
    ds_read_b128 v[40:43], v135 offset:33024
    ds_read_b128 v[44:47], v135 offset:37120
    s_waitcnt lgkmcnt(4)
    v_mfma_f32_16x16x32_bf16 v[48:51], v[16:19], a[24:27], v[48:51]
    v_mfma_f32_16x16x32_bf16 v[52:55], v[16:19], a[88:91], v[52:55]
    v_mfma_f32_16x16x32_bf16 v[56:59], v[16:19], a[152:155], v[56:59]
    v_mfma_f32_16x16x32_bf16 v[60:63], v[16:19], a[216:219], v[60:63]
    v_xor_b32 v7, 96, v6
    s_add_u32 m0, s81, 10240
    s_add_u32 s79, s70, 10240
    buffer_load_dwordx4 v7, s[60:63], s79 offen sc1 lds
    v_mfma_f32_16x16x32_bf16 v[64:67], v[20:23], a[24:27], v[64:67]
    v_mfma_f32_16x16x32_bf16 v[68:71], v[20:23], a[88:91], v[68:71]
    v_mfma_f32_16x16x32_bf16 v[72:75], v[20:23], a[152:155], v[72:75]
    v_mfma_f32_16x16x32_bf16 v[76:79], v[20:23], a[216:219], v[76:79]
    v_mfma_f32_16x16x32_bf16 v[80:83], v[24:27], a[24:27], v[80:83]
    v_mfma_f32_16x16x32_bf16 v[84:87], v[24:27], a[88:91], v[84:87]
    v_mfma_f32_16x16x32_bf16 v[88:91], v[24:27], a[152:155], v[88:91]
    v_mfma_f32_16x16x32_bf16 v[92:95], v[24:27], a[216:219], v[92:95]
    v_mfma_f32_16x16x32_bf16 v[96:99], v[28:31], a[24:27], v[96:99]
    v_mfma_f32_16x16x32_bf16 v[100:103], v[28:31], a[88:91], v[100:103]
    v_mfma_f32_16x16x32_bf16 v[104:107], v[28:31], a[152:155], v[104:107]
    v_mfma_f32_16x16x32_bf16 v[108:111], v[28:31], a[216:219], v[108:111]
    ds_read_b128 v[16:19], v132 offset:512
    ds_read_b128 v[20:23], v132 offset:4608
    ds_read_b128 v[24:27], v132 offset:33280
    ds_read_b128 v[28:31], v132 offset:37376
    s_waitcnt lgkmcnt(4)
    v_mfma_f32_16x16x32_bf16 v[48:51], v[32:35], a[28:31], v[48:51]
    v_mfma_f32_16x16x32_bf16 v[52:55], v[32:35], a[92:95], v[52:55]
    v_mfma_f32_16x16x32_bf16 v[56:59], v[32:35], a[156:159], v[56:59]
    v_mfma_f32_16x16x32_bf16 v[60:63], v[32:35], a[220:223], v[60:63]
    v_xor_b32 v7, 112, v6
    s_add_u32 m0, s81, 11264
    s_add_u32 s79, s70, 11264
    buffer_load_dwordx4 v7, s[60:63], s79 offen sc1 lds
    v_mfma_f32_16x16x32_bf16 v[64:67], v[36:39], a[28:31], v[64:67]
    v_mfma_f32_16x16x32_bf16 v[68:71], v[36:39], a[92:95], v[68:71]
    v_mfma_f32_16x16x32_bf16 v[72:75], v[36:39], a[156:159], v[72:75]
    v_mfma_f32_16x16x32_bf16 v[76:79], v[36:39], a[220:223], v[76:79]
    v_mfma_f32_16x16x32_bf16 v[80:83], v[40:43], a[28:31], v[80:83]
    v_mfma_f32_16x16x32_bf16 v[84:87], v[40:43], a[92:95], v[84:87]
    v_mfma_f32_16x16x32_bf16 v[88:91], v[40:43], a[156:159], v[88:91]
    v_mfma_f32_16x16x32_bf16 v[92:95], v[40:43], a[220:223], v[92:95]
    v_mfma_f32_16x16x32_bf16 v[96:99], v[44:47], a[28:31], v[96:99]
    v_mfma_f32_16x16x32_bf16 v[100:103], v[44:47], a[92:95], v[100:103]
    v_mfma_f32_16x16x32_bf16 v[104:107], v[44:47], a[156:159], v[104:107]
    v_mfma_f32_16x16x32_bf16 v[108:111], v[44:47], a[220:223], v[108:111]
    ds_read_b128 v[32:35], v133 offset:512
    ds_read_b128 v[36:39], v133 offset:4608
    ds_read_b128 v[40:43], v133 offset:33280
    ds_read_b128 v[44:47], v133 offset:37376
    s_waitcnt lgkmcnt(4)
    v_mfma_f32_16x16x32_bf16 v[48:51], v[16:19], a[32:35], v[48:51]
    v_mfma_f32_16x16x32_bf16 v[52:55], v[16:19], a[96:99], v[52:55]
    v_mfma_f32_16x16x32_bf16 v[56:59], v[16:19], a[160:163], v[56:59]
    v_mfma_f32_16x16x32_bf16 v[60:63], v[16:19], a[224:227], v[60:63]
    v_xor_b32 v7, 128, v6
    s_add_u32 m0, s81, 16384
    s_add_u32 s79, s70, 16384
    buffer_load_dwordx4 v7, s[60:63], s79 offen sc1 lds
    v_mfma_f32_16x16x32_bf16 v[64:67], v[20:23], a[32:35], v[64:67]
    v_mfma_f32_16x16x32_bf16 v[68:71], v[20:23], a[96:99], v[68:71]
    v_mfma_f32_16x16x32_bf16 v[72:75], v[20:23], a[160:163], v[72:75]
    v_mfma_f32_16x16x32_bf16 v[76:79], v[20:23], a[224:227], v[76:79]
    v_mfma_f32_16x16x32_bf16 v[80:83], v[24:27], a[32:35], v[80:83]
    v_mfma_f32_16x16x32_bf16 v[84:87], v[24:27], a[96:99], v[84:87]
    v_mfma_f32_16x16x32_bf16 v[88:91], v[24:27], a[160:163], v[88:91]
    v_mfma_f32_16x16x32_bf16 v[92:95], v[24:27], a[224:227], v[92:95]
    v_mfma_f32_16x16x32_bf16 v[96:99], v[28:31], a[32:35], v[96:99]
    v_mfma_f32_16x16x32_bf16 v[100:103], v[28:31], a[96:99], v[100:103]
    v_mfma_f32_16x16x32_bf16 v[104:107], v[28:31], a[160:163], v[104:107]
    v_mfma_f32_16x16x32_bf16 v[108:111], v[28:31], a[224:227], v[108:111]
    ds_read_b128 v[16:19], v134 offset:512
    ds_read_b128 v[20:23], v134 offset:4608
    ds_read_b128 v[24:27], v134 offset:33280
    ds_read_b128 v[28:31], v134 offset:37376
    s_waitcnt lgkmcnt(4)
    v_mfma_f32_16x16x32_bf16 v[48:51], v[32:35], a[36:39], v[48:51]
    v_mfma_f32_16x16x32_bf16 v[52:55], v[32:35], a[100:103], v[52:55]
    v_mfma_f32_16x16x32_bf16 v[56:59], v[32:35], a[164:167], v[56:59]
    v_mfma_f32_16x16x32_bf16 v[60:63], v[32:35], a[228:231], v[60:63]
    v_xor_b32 v7, 144, v6
    s_add_u32 m0, s81, 17408
    s_add_u32 s79, s70, 17408
    buffer_load_dwordx4 v7, s[60:63], s79 offen sc1 lds
    v_mfma_f32_16x16x32_bf16 v[64:67], v[36:39], a[36:39], v[64:67]
    v_mfma_f32_16x16x32_bf16 v[68:71], v[36:39], a[100:103], v[68:71]
    v_mfma_f32_16x16x32_bf16 v[72:75], v[36:39], a[164:167], v[72:75]
    v_mfma_f32_16x16x32_bf16 v[76:79], v[36:39], a[228:231], v[76:79]
    v_mfma_f32_16x16x32_bf16 v[80:83], v[40:43], a[36:39], v[80:83]
    v_mfma_f32_16x16x32_bf16 v[84:87], v[40:43], a[100:103], v[84:87]
    v_mfma_f32_16x16x32_bf16 v[88:91], v[40:43], a[164:167], v[88:91]
    v_mfma_f32_16x16x32_bf16 v[92:95], v[40:43], a[228:231], v[92:95]
    v_mfma_f32_16x16x32_bf16 v[96:99], v[44:47], a[36:39], v[96:99]
    v_mfma_f32_16x16x32_bf16 v[100:103], v[44:47], a[100:103], v[100:103]
    v_mfma_f32_16x16x32_bf16 v[104:107], v[44:47], a[164:167], v[104:107]
    v_mfma_f32_16x16x32_bf16 v[108:111], v[44:47], a[228:231], v[108:111]
    ds_read_b128 v[32:35], v135 offset:512
    ds_read_b128 v[36:39], v135 offset:4608
    ds_read_b128 v[40:43], v135 offset:33280
    ds_read_b128 v[44:47], v135 offset:37376
    s_waitcnt lgkmcnt(4)
    v_mfma_f32_16x16x32_bf16 v[48:51], v[16:19], a[40:43], v[48:51]
    v_mfma_f32_16x16x32_bf16 v[52:55], v[16:19], a[104:107], v[52:55]
    v_mfma_f32_16x16x32_bf16 v[56:59], v[16:19], a[168:171], v[56:59]
    v_mfma_f32_16x16x32_bf16 v[60:63], v[16:19], a[232:235], v[60:63]
    v_xor_b32 v7, 160, v6
    s_add_u32 m0, s81, 18432
    s_add_u32 s79, s70, 18432
    buffer_load_dwordx4 v7, s[60:63], s79 offen sc1 lds
    v_mfma_f32_16x16x32_bf16 v[64:67], v[20:23], a[40:43], v[64:67]
    v_mfma_f32_16x16x32_bf16 v[68:71], v[20:23], a[104:107], v[68:71]
    v_mfma_f32_16x16x32_bf16 v[72:75], v[20:23], a[168:171], v[72:75]
    v_mfma_f32_16x16x32_bf16 v[76:79], v[20:23], a[232:235], v[76:79]
    v_mfma_f32_16x16x32_bf16 v[80:83], v[24:27], a[40:43], v[80:83]
    v_mfma_f32_16x16x32_bf16 v[84:87], v[24:27], a[104:107], v[84:87]
    v_mfma_f32_16x16x32_bf16 v[88:91], v[24:27], a[168:171], v[88:91]
    v_mfma_f32_16x16x32_bf16 v[92:95], v[24:27], a[232:235], v[92:95]
    v_mfma_f32_16x16x32_bf16 v[96:99], v[28:31], a[40:43], v[96:99]
    v_mfma_f32_16x16x32_bf16 v[100:103], v[28:31], a[104:107], v[100:103]
    v_mfma_f32_16x16x32_bf16 v[104:107], v[28:31], a[168:171], v[104:107]
    v_mfma_f32_16x16x32_bf16 v[108:111], v[28:31], a[232:235], v[108:111]
    ds_read_b128 v[16:19], v132 offset:768
    ds_read_b128 v[20:23], v132 offset:4864
    ds_read_b128 v[24:27], v132 offset:33536
    ds_read_b128 v[28:31], v132 offset:37632
    s_waitcnt lgkmcnt(4)
    v_mfma_f32_16x16x32_bf16 v[48:51], v[32:35], a[44:47], v[48:51]
    v_mfma_f32_16x16x32_bf16 v[52:55], v[32:35], a[108:111], v[52:55]
    v_mfma_f32_16x16x32_bf16 v[56:59], v[32:35], a[172:175], v[56:59]
    v_mfma_f32_16x16x32_bf16 v[60:63], v[32:35], a[236:239], v[60:63]
    v_xor_b32 v7, 176, v6
    s_add_u32 m0, s81, 19456
    s_add_u32 s79, s70, 19456
    buffer_load_dwordx4 v7, s[60:63], s79 offen sc1 lds
    v_mfma_f32_16x16x32_bf16 v[64:67], v[36:39], a[44:47], v[64:67]
    v_mfma_f32_16x16x32_bf16 v[68:71], v[36:39], a[108:111], v[68:71]
    v_mfma_f32_16x16x32_bf16 v[72:75], v[36:39], a[172:175], v[72:75]
    v_mfma_f32_16x16x32_bf16 v[76:79], v[36:39], a[236:239], v[76:79]
    v_mfma_f32_16x16x32_bf16 v[80:83], v[40:43], a[44:47], v[80:83]
    v_mfma_f32_16x16x32_bf16 v[84:87], v[40:43], a[108:111], v[84:87]
    v_mfma_f32_16x16x32_bf16 v[88:91], v[40:43], a[172:175], v[88:91]
    v_mfma_f32_16x16x32_bf16 v[92:95], v[40:43], a[236:239], v[92:95]
    v_mfma_f32_16x16x32_bf16 v[96:99], v[44:47], a[44:47], v[96:99]
    v_mfma_f32_16x16x32_bf16 v[100:103], v[44:47], a[108:111], v[100:103]
    v_mfma_f32_16x16x32_bf16 v[104:107], v[44:47], a[172:175], v[104:107]
    v_mfma_f32_16x16x32_bf16 v[108:111], v[44:47], a[236:239], v[108:111]
    ds_read_b128 v[32:35], v133 offset:768
    ds_read_b128 v[36:39], v133 offset:4864
    ds_read_b128 v[40:43], v133 offset:33536
    ds_read_b128 v[44:47], v133 offset:37632
    s_waitcnt lgkmcnt(4)
    v_mfma_f32_16x16x32_bf16 v[48:51], v[16:19], a[48:51], v[48:51]
    v_mfma_f32_16x16x32_bf16 v[52:55], v[16:19], a[112:115], v[52:55]
    v_mfma_f32_16x16x32_bf16 v[56:59], v[16:19], a[176:179], v[56:59]
    v_mfma_f32_16x16x32_bf16 v[60:63], v[16:19], a[240:243], v[60:63]
    v_xor_b32 v7, 192, v6
    s_add_u32 m0, s81, 24576
    s_add_u32 s79, s70, 24576
    buffer_load_dwordx4 v7, s[60:63], s79 offen sc1 lds
    v_mfma_f32_16x16x32_bf16 v[64:67], v[20:23], a[48:51], v[64:67]
    v_mfma_f32_16x16x32_bf16 v[68:71], v[20:23], a[112:115], v[68:71]
    v_mfma_f32_16x16x32_bf16 v[72:75], v[20:23], a[176:179], v[72:75]
    v_mfma_f32_16x16x32_bf16 v[76:79], v[20:23], a[240:243], v[76:79]
    v_mfma_f32_16x16x32_bf16 v[80:83], v[24:27], a[48:51], v[80:83]
    v_mfma_f32_16x16x32_bf16 v[84:87], v[24:27], a[112:115], v[84:87]
    v_mfma_f32_16x16x32_bf16 v[88:91], v[24:27], a[176:179], v[88:91]
    v_mfma_f32_16x16x32_bf16 v[92:95], v[24:27], a[240:243], v[92:95]
    v_mfma_f32_16x16x32_bf16 v[96:99], v[28:31], a[48:51], v[96:99]
    v_mfma_f32_16x16x32_bf16 v[100:103], v[28:31], a[112:115], v[100:103]
    v_mfma_f32_16x16x32_bf16 v[104:107], v[28:31], a[176:179], v[104:107]
    v_mfma_f32_16x16x32_bf16 v[108:111], v[28:31], a[240:243], v[108:111]
    ds_read_b128 v[16:19], v134 offset:768
    ds_read_b128 v[20:23], v134 offset:4864
    ds_read_b128 v[24:27], v134 offset:33536
    ds_read_b128 v[28:31], v134 offset:37632
    s_waitcnt lgkmcnt(4)
    v_mfma_f32_16x16x32_bf16 v[48:51], v[32:35], a[52:55], v[48:51]
    v_mfma_f32_16x16x32_bf16 v[52:55], v[32:35], a[116:119], v[52:55]
    v_mfma_f32_16x16x32_bf16 v[56:59], v[32:35], a[180:183], v[56:59]
    v_mfma_f32_16x16x32_bf16 v[60:63], v[32:35], a[244:247], v[60:63]
    v_xor_b32 v7, 208, v6
    s_add_u32 m0, s81, 25600
    s_add_u32 s79, s70, 25600
    buffer_load_dwordx4 v7, s[60:63], s79 offen sc1 lds
    v_mfma_f32_16x16x32_bf16 v[64:67], v[36:39], a[52:55], v[64:67]
    v_mfma_f32_16x16x32_bf16 v[68:71], v[36:39], a[116:119], v[68:71]
    v_mfma_f32_16x16x32_bf16 v[72:75], v[36:39], a[180:183], v[72:75]
    v_mfma_f32_16x16x32_bf16 v[76:79], v[36:39], a[244:247], v[76:79]
    v_mfma_f32_16x16x32_bf16 v[80:83], v[40:43], a[52:55], v[80:83]
    v_mfma_f32_16x16x32_bf16 v[84:87], v[40:43], a[116:119], v[84:87]
    v_mfma_f32_16x16x32_bf16 v[88:91], v[40:43], a[180:183], v[88:91]
    v_mfma_f32_16x16x32_bf16 v[92:95], v[40:43], a[244:247], v[92:95]
    v_mfma_f32_16x16x32_bf16 v[96:99], v[44:47], a[52:55], v[96:99]
    v_mfma_f32_16x16x32_bf16 v[100:103], v[44:47], a[116:119], v[100:103]
    v_mfma_f32_16x16x32_bf16 v[104:107], v[44:47], a[180:183], v[104:107]
    v_mfma_f32_16x16x32_bf16 v[108:111], v[44:47], a[244:247], v[108:111]
    ds_read_b128 v[32:35], v135 offset:768
    ds_read_b128 v[36:39], v135 offset:4864
    ds_read_b128 v[40:43], v135 offset:33536
    ds_read_b128 v[44:47], v135 offset:37632
    s_waitcnt lgkmcnt(4)
    v_mfma_f32_16x16x32_bf16 v[48:51], v[16:19], a[56:59], v[48:51]
    v_mfma_f32_16x16x32_bf16 v[52:55], v[16:19], a[120:123], v[52:55]
    v_mfma_f32_16x16x32_bf16 v[56:59], v[16:19], a[184:187], v[56:59]
    v_mfma_f32_16x16x32_bf16 v[60:63], v[16:19], a[248:251], v[60:63]
    v_xor_b32 v7, 224, v6
    s_add_u32 m0, s81, 26624
    s_add_u32 s79, s70, 26624
    buffer_load_dwordx4 v7, s[60:63], s79 offen sc1 lds
    v_mfma_f32_16x16x32_bf16 v[64:67], v[20:23], a[56:59], v[64:67]
    v_mfma_f32_16x16x32_bf16 v[68:71], v[20:23], a[120:123], v[68:71]
    v_mfma_f32_16x16x32_bf16 v[72:75], v[20:23], a[184:187], v[72:75]
    v_mfma_f32_16x16x32_bf16 v[76:79], v[20:23], a[248:251], v[76:79]
    v_mfma_f32_16x16x32_bf16 v[80:83], v[24:27], a[56:59], v[80:83]
    v_mfma_f32_16x16x32_bf16 v[84:87], v[24:27], a[120:123], v[84:87]
    v_mfma_f32_16x16x32_bf16 v[88:91], v[24:27], a[184:187], v[88:91]
    v_mfma_f32_16x16x32_bf16 v[92:95], v[24:27], a[248:251], v[92:95]
    v_mfma_f32_16x16x32_bf16 v[96:99], v[28:31], a[56:59], v[96:99]
    v_mfma_f32_16x16x32_bf16 v[100:103], v[28:31], a[120:123], v[100:103]
    v_mfma_f32_16x16x32_bf16 v[104:107], v[28:31], a[184:187], v[104:107]
    v_mfma_f32_16x16x32_bf16 v[108:111], v[28:31], a[248:251], v[108:111]
    s_waitcnt lgkmcnt(0)
    v_mfma_f32_16x16x32_bf16 v[48:51], v[32:35], a[60:63], v[48:51]
    v_mfma_f32_16x16x32_bf16 v[52:55], v[32:35], a[124:127], v[52:55]
    v_mfma_f32_16x16x32_bf16 v[56:59], v[32:35], a[188:191], v[56:59]
    v_mfma_f32_16x16x32_bf16 v[60:63], v[32:35], a[252:255], v[60:63]
    v_xor_b32 v7, 240, v6
    s_add_u32 m0, s81, 27648
    s_add_u32 s79, s70, 27648
    buffer_load_dwordx4 v7, s[60:63], s79 offen sc1 lds
    v_mfma_f32_16x16x32_bf16 v[64:67], v[36:39], a[60:63], v[64:67]
    v_mfma_f32_16x16x32_bf16 v[68:71], v[36:39], a[124:127], v[68:71]
    v_mfma_f32_16x16x32_bf16 v[72:75], v[36:39], a[188:191], v[72:75]
    v_mfma_f32_16x16x32_bf16 v[76:79], v[36:39], a[252:255], v[76:79]
    v_mfma_f32_16x16x32_bf16 v[80:83], v[40:43], a[60:63], v[80:83]
    v_mfma_f32_16x16x32_bf16 v[84:87], v[40:43], a[124:127], v[84:87]
    v_mfma_f32_16x16x32_bf16 v[88:91], v[40:43], a[188:191], v[88:91]
    v_mfma_f32_16x16x32_bf16 v[92:95], v[40:43], a[252:255], v[92:95]
    v_mfma_f32_16x16x32_bf16 v[96:99], v[44:47], a[60:63], v[96:99]
    v_mfma_f32_16x16x32_bf16 v[100:103], v[44:47], a[124:127], v[100:103]
    v_mfma_f32_16x16x32_bf16 v[104:107], v[44:47], a[188:191], v[104:107]
    v_mfma_f32_16x16x32_bf16 v[108:111], v[44:47], a[252:255], v[108:111]
    s_add_u32 s70, s70, 65536
    s_add_u32 s77, s73, 0
    v_cvt_pk_bf16_f32 v112, v48, v49
    v_cvt_pk_bf16_f32 v113, v50, v51
    v_cvt_pk_bf16_f32 v114, v64, v65
    v_cvt_pk_bf16_f32 v115, v66, v67
    buffer_store_dwordx4 v[112:115], v1, s[52:55], s77 offen offset:2048 sc1
    v_cvt_pk_bf16_f32 v116, v52, v53
    v_cvt_pk_bf16_f32 v117, v54, v55
    v_cvt_pk_bf16_f32 v118, v68, v69
    v_cvt_pk_bf16_f32 v119, v70, v71
    buffer_store_dwordx4 v[116:119], v1, s[52:55], s77 offen offset:3072 sc1
    s_add_u32 s77, s73, 4096
    v_cvt_pk_bf16_f32 v112, v56, v57
    v_cvt_pk_bf16_f32 v113, v58, v59
    v_cvt_pk_bf16_f32 v114, v72, v73
    v_cvt_pk_bf16_f32 v115, v74, v75
    buffer_store_dwordx4 v[112:115], v1, s[52:55], s77 offen offset:2048 sc1
    v_cvt_pk_bf16_f32 v116, v60, v61
    v_cvt_pk_bf16_f32 v117, v62, v63
    v_cvt_pk_bf16_f32 v118, v76, v77
    v_cvt_pk_bf16_f32 v119, v78, v79
    buffer_store_dwordx4 v[116:119], v1, s[52:55], s77 offen offset:3072 sc1
    s_add_u32 s77, s73, 524288
    v_cvt_pk_bf16_f32 v112, v80, v81
    v_cvt_pk_bf16_f32 v113, v82, v83
    v_cvt_pk_bf16_f32 v114, v96, v97
    v_cvt_pk_bf16_f32 v115, v98, v99
    buffer_store_dwordx4 v[112:115], v1, s[52:55], s77 offen offset:2048 sc1
    v_cvt_pk_bf16_f32 v116, v84, v85
    v_cvt_pk_bf16_f32 v117, v86, v87
    v_cvt_pk_bf16_f32 v118, v100, v101
    v_cvt_pk_bf16_f32 v119, v102, v103
    buffer_store_dwordx4 v[116:119], v1, s[52:55], s77 offen offset:3072 sc1
    s_add_u32 s77, s73, 528384
    v_cvt_pk_bf16_f32 v112, v88, v89
    v_cvt_pk_bf16_f32 v113, v90, v91
    v_cvt_pk_bf16_f32 v114, v104, v105
    v_cvt_pk_bf16_f32 v115, v106, v107
    buffer_store_dwordx4 v[112:115], v1, s[52:55], s77 offen offset:2048 sc1
    v_cvt_pk_bf16_f32 v116, v92, v93
    v_cvt_pk_bf16_f32 v117, v94, v95
    v_cvt_pk_bf16_f32 v118, v108, v109
    v_cvt_pk_bf16_f32 v119, v110, v111
    buffer_store_dwordx4 v[116:119], v1, s[52:55], s77 offen offset:3072 sc1
    s_add_u32 s73, s73, 1048576
    s_add_u32 s83, s83, 1
    s_cmp_lt_u32 s83, s72
    s_cbranch_scc1 L_wsg1n_154
    s_waitcnt vmcnt(0)
    s_barrier
    s_cmp_lg_u32 s56, 0
    s_cbranch_scc1 L_wsg_157
    s_add_u32 s80, s89, s83
    s_lshl_b32 s80, s80, 2
    s_add_u32 s80, s80, 28
    v_mov_b32 v120, s68
    v_mov_b32 v121, s80
    s_mov_b64 exec, 1
    buffer_atomic_add v120, v121, s[48:51], 0 offen
    s_mov_b64 exec, -1
L_wsg_157:
    s_branch L_next
L_task_g2:
    s_sub_u32 s77, s88, 192
    s_mul_hi_u32 s89, s77, 715827883
    s_mul_i32 s90, s89, 6
    s_sub_u32 s90, s77, s90
    s_mov_b32 s60, s8
    s_mov_b32 s61, s9
    s_mov_b32 s62, s10
    s_mov_b32 s63, s11
    s_mov_b32 s64, s12
    s_mov_b32 s65, s13
    s_mov_b32 s66, s14
    s_mov_b32 s67, s15
    s_mov_b32 s69, 3072
    s_mov_b32 s72, 4
    s_lshl_b32 s71, s90, 9
    v_and_b32 v10, 63, v0
    v_lshrrev_b32 v11, 5, v10
    v_and_b32 v12, 31, v10
    s_lshl_b32 s77, s56, 4
    v_add_u32 v13, s77, v11
    v_mul_lo_u32 v13, v13, s69
    v_lshlrev_b32 v14, 2, v11
    v_xor_b32 v14, v14, v12
    v_lshl_add_u32 v2, v14, 4, v13
    v_xor_b32 v3, 128, v2
    s_lshl_b32 s84, s69, 1
    s_lshl_b32 s82, s56, 13
    v_and_b32 v11, 15, v10
    v_lshrrev_b32 v12, 4, v10
    v_lshrrev_b32 v13, 2, v11
    v_and_b32 v14, 3, v11
    v_lshl_add_u32 v15, v12, 3, v13
    s_lshl_b32 s77, s56, 1
    s_add_u32 s77, s77, 0
    v_xor_b32 v9, s77, v13
    v_lshl_add_u32 v9, v9, 2, v14
    v_lshlrev_b32 v9, 4, v9
    v_lshl_add_u32 v4, v15, 9, v9
    s_lshl_b32 s77, s56, 1
    s_add_u32 s77, s77, 1
    v_xor_b32 v9, s77, v13
    v_lshl_add_u32 v9, v9, 2, v14
    v_lshlrev_b32 v9, 4, v9
    v_lshl_add_u32 v5, v15, 9, v9
    v_add_u32 v128, 65536, v4
    v_add_u32 v129, 65536, v5
    s_barrier
    s_mov_b32 s79, s71
    s_add_u32 m0, s82, 0
    s_nop 0
    buffer_load_dwordx4 v2, s[64:67], s79 offen lds
    s_add_u32 s79, s79, s84
    s_add_u32 m0, s82, 1024
    s_nop 0
    buffer_load_dwordx4 v3, s[64:67], s79 offen lds
    s_add_u32 s79, s79, s84
    s_add_u32 m0, s82, 2048
    s_nop 0
    buffer_load_dwordx4 v2, s[64:67], s79 offen lds
    s_add_u32 s79, s79, s84
    s_add_u32 m0, s82, 3072
    s_nop 0
    buffer_load_dwordx4 v3, s[64:67], s79 offen lds
    s_add_u32 s79, s79, s84
    s_add_u32 m0, s82, 4096
    s_nop 0
    buffer_load_dwordx4 v2, s[64:67], s79 offen lds
    s_add_u32 s79, s79, s84
    s_add_u32 m0, s82, 5120
    s_nop 0
    buffer_load_dwordx4 v3, s[64:67], s79 offen lds
    s_add_u32 s79, s79, s84
    s_add_u32 m0, s82, 6144
    s_nop 0
    buffer_load_dwordx4 v2, s[64:67], s79 offen lds
    s_add_u32 s79, s79, s84
    s_add_u32 m0, s82, 7168
    s_nop 0
    buffer_load_dwordx4 v3, s[64:67], s79 offen lds
    s_lshl_b32 s79, s69, 6
    s_add_u32 s71, s71, s79
    s_mov_b32 s79, s71
    s_add_u32 m0, s82, 32768
    s_nop 0
    buffer_load_dwordx4 v2, s[64:67], s79 offen lds
    s_add_u32 s79, s79, s84
    s_add_u32 m0, s82, 33792
    s_nop 0
    buffer_load_dwordx4 v3, s[64:67], s79 offen lds
    s_add_u32 s79, s79, s84
    s_add_u32 m0, s82, 34816
    s_nop 0
    buffer_load_dwordx4 v2, s[64:67], s79 offen lds
    s_add_u32 s79, s79, s84
    s_add_u32 m0, s82, 35840
    s_nop 0
    buffer_load_dwordx4 v3, s[64:67], s79 offen lds
    s_add_u32 s79, s79, s84
    s_add_u32 m0, s82, 36864
    s_nop 0
    buffer_load_dwordx4 v2, s[64:67], s79 offen lds
    s_add_u32 s79, s79, s84
    s_add_u32 m0, s82, 37888
    s_nop 0
    buffer_load_dwordx4 v3, s[64:67], s79 offen lds
    s_add_u32 s79, s79, s84
    s_add_u32 m0, s82, 38912
    s_nop 0
    buffer_load_dwordx4 v2, s[64:67], s79 offen lds
    s_add_u32 s79, s79, s84
    s_add_u32 m0, s82, 39936
    s_nop 0
    buffer_load_dwordx4 v3, s[64:67], s79 offen lds
    s_lshl_b32 s79, s69, 6
    s_add_u32 s71, s71, s79
    s_mov_b32 s79, s71
    s_add_u32 m0, s82, 65536
    s_nop 0
    buffer_load_dwordx4 v2, s[64:67], s79 offen lds
    s_add_u32 s79, s79, s84
    s_add_u32 m0, s82, 66560
    s_nop 0
    buffer_load_dwordx4 v3, s[64:67], s79 offen lds
    s_add_u32 s79, s79, s84
    s_add_u32 m0, s82, 67584
    s_nop 0
    buffer_load_dwordx4 v2, s[64:67], s79 offen lds
    s_add_u32 s79, s79, s84
    s_add_u32 m0, s82, 68608
    s_nop 0
    buffer_load_dwordx4 v3, s[64:67], s79 offen lds
    s_add_u32 s79, s79, s84
    s_add_u32 m0, s82, 69632
    s_nop 0
    buffer_load_dwordx4 v2, s[64:67], s79 offen lds
    s_add_u32 s79, s79, s84
    s_add_u32 m0, s82, 70656
    s_nop 0
    buffer_load_dwordx4 v3, s[64:67], s79 offen lds
    s_add_u32 s79, s79, s84
    s_add_u32 m0, s82, 71680
    s_nop 0
    buffer_load_dwordx4 v2, s[64:67], s79 offen lds
    s_add_u32 s79, s79, s84
    s_add_u32 m0, s82, 72704
    s_nop 0
    buffer_load_dwordx4 v3, s[64:67], s79 offen lds
    s_lshl_b32 s79, s69, 6
    s_add_u32 s71, s71, s79
    s_waitcnt vmcnt(16)
    s_barrier
    s_mov_b32 s79, s71
    s_add_u32 m0, s82, 98304
    s_nop 0
    buffer_load_dwordx4 v2, s[64:67], s79 offen lds
    s_add_u32 s79, s79, s84
    s_add_u32 m0, s82, 99328
    s_nop 0
    buffer_load_dwordx4 v3, s[64:67], s79 offen lds
    s_add_u32 s79, s79, s84
    s_add_u32 m0, s82, 100352
    s_nop 0
    buffer_load_dwordx4 v2, s[64:67], s79 offen lds
    s_add_u32 s79, s79, s84
    s_add_u32 m0, s82, 101376
    s_nop 0
    buffer_load_dwordx4 v3, s[64:67], s79 offen lds
    s_add_u32 s79, s79, s84
    s_add_u32 m0, s82, 102400
    s_nop 0
    buffer_load_dwordx4 v2, s[64:67], s79 offen lds
    s_add_u32 s79, s79, s84
    s_add_u32 m0, s82, 103424
    s_nop 0
    buffer_load_dwordx4 v3, s[64:67], s79 offen lds
    s_add_u32 s79, s79, s84
    s_add_u32 m0, s82, 104448
    s_nop 0
    buffer_load_dwordx4 v2, s[64:67], s79 offen lds
    s_add_u32 s79, s79, s84
    s_add_u32 m0, s82, 105472
    s_nop 0
    buffer_load_dwordx4 v3, s[64:67], s79 offen lds
    s_lshl_b32 s79, s69, 6
    s_add_u32 s71, s71, s79
    ds_read_b64_tr_b16 a[0:1], v4 offset:0
    ds_read_b64_tr_b16 a[2:3], v4 offset:2048
    ds_read_b64_tr_b16 a[64:65], v4 offset:8
    ds_read_b64_tr_b16 a[66:67], v4 offset:2056
    ds_read_b64_tr_b16 a[128:129], v5 offset:0
    ds_read_b64_tr_b16 a[130:131], v5 offset:2048
    ds_read_b64_tr_b16 a[192:193], v5 offset:8
    ds_read_b64_tr_b16 a[194:195], v5 offset:2056
    ds_read_b64_tr_b16 a[4:5], v4 offset:16384
    ds_read_b64_tr_b16 a[6:7], v4 offset:18432
    ds_read_b64_tr_b16 a[68:69], v4 offset:16392
    ds_read_b64_tr_b16 a[70:71], v4 offset:18440
    ds_read_b64_tr_b16 a[132:133], v5 offset:16384
    ds_read_b64_tr_b16 a[134:135], v5 offset:18432
    ds_read_b64_tr_b16 a[196:197], v5 offset:16392
    ds_read_b64_tr_b16 a[198:199], v5 offset:18440
    s_waitcnt lgkmcnt(0)
    s_waitcnt vmcnt(16)
    s_barrier
    s_mov_b32 s79, s71
    s_add_u32 m0, s82, 0
    s_nop 0
    buffer_load_dwordx4 v2, s[64:67], s79 offen lds
    s_add_u32 s79, s79, s84
    s_add_u32 m0, s82, 1024
    s_nop 0
    buffer_load_dwordx4 v3, s[64:67], s79 offen lds
    s_add_u32 s79, s79, s84
    s_add_u32 m0, s82, 2048
    s_nop 0
    buffer_load_dwordx4 v2, s[64:67], s79 offen lds
    s_add_u32 s79, s79, s84
    s_add_u32 m0, s82, 3072
    s_nop 0
    buffer_load_dwordx4 v3, s[64:67], s79 offen lds
    s_add_u32 s79, s79, s84
    s_add_u32 m0, s82, 4096
    s_nop 0
    buffer_load_dwordx4 v2, s[64:67], s79 offen lds
    s_add_u32 s79, s79, s84
    s_add_u32 m0, s82, 5120
    s_nop 0
    buffer_load_dwordx4 v3, s[64:67], s79 offen lds
    s_add_u32 s79, s79, s84
    s_add_u32 m0, s82, 6144
    s_nop 0
    buffer_load_dwordx4 v2, s[64:67], s79 offen lds
    s_add_u32 s79, s79, s84
    s_add_u32 m0, s82, 7168
    s_nop 0
    buffer_load_dwordx4 v3, s[64:67], s79 offen lds
    s_lshl_b32 s79, s69, 6
    s_add_u32 s71, s71, s79
    ds_read_b64_tr_b16 a[8:9], v4 offset:32768
    ds_read_b64_tr_b16 a[10:11], v4 offset:34816
    ds_read_b64_tr_b16 a[72:73], v4 offset:32776
    ds_read_b64_tr_b16 a[74:75], v4 offset:34824
    ds_read_b64_tr_b16 a[136:137], v5 offset:32768
    ds_read_b64_tr_b16 a[138:139], v5 offset:34816
    ds_read_b64_tr_b16 a[200:201], v5 offset:32776
    ds_read_b64_tr_b16 a[202:203], v5 offset:34824
    ds_read_b64_tr_b16 a[12:13], v4 offset:49152
    ds_read_b64_tr_b16 a[14:15], v4 offset:51200
    ds_read_b64_tr_b16 a[76:77], v4 offset:49160
    ds_read_b64_tr_b16 a[78:79], v4 offset:51208
    ds_read_b64_tr_b16 a[140:141], v5 offset:49152
    ds_read_b64_tr_b16 a[142:143], v5 offset:51200
    ds_read_b64_tr_b16 a[204:205], v5 offset:49160
    ds_read_b64_tr_b16 a[206:207], v5 offset:51208
    s_waitcnt lgkmcnt(0)
    s_waitcnt vmcnt(16)
    s_barrier
    s_mov_b32 s79, s71
    s_add_u32 m0, s82, 32768
    s_nop 0
    buffer_load_dwordx4 v2, s[64:67], s79 offen lds
    s_add_u32 s79, s79, s84
    s_add_u32 m0, s82, 33792
    s_nop 0
    buffer_load_dwordx4 v3, s[64:67], s79 offen lds
    s_add_u32 s79, s79, s84
    s_add_u32 m0, s82, 34816
    s_nop 0
    buffer_load_dwordx4 v2, s[64:67], s79 offen lds
    s_add_u32 s79, s79, s84
    s_add_u32 m0, s82, 35840
    s_nop 0
    buffer_load_dwordx4 v3, s[64:67], s79 offen lds
    s_add_u32 s79, s79, s84
    s_add_u32 m0, s82, 36864
    s_nop 0
    buffer_load_dwordx4 v2, s[64:67], s79 offen lds
    s_add_u32 s79, s79, s84
    s_add_u32 m0, s82, 37888
    s_nop 0
    buffer_load_dwordx4 v3, s[64:67], s79 offen lds
    s_add_u32 s79, s79, s84
    s_add_u32 m0, s82, 38912
    s_nop 0
    buffer_load_dwordx4 v2, s[64:67], s79 offen lds
    s_add_u32 s79, s79, s84
    s_add_u32 m0, s82, 39936
    s_nop 0
    buffer_load_dwordx4 v3, s[64:67], s79 offen lds
    s_lshl_b32 s79, s69, 6
    s_add_u32 s71, s71, s79
    ds_read_b64_tr_b16 a[16:17], v128 offset:0
    ds_read_b64_tr_b16 a[18:19], v128 offset:2048
    ds_read_b64_tr_b16 a[80:81], v128 offset:8
    ds_read_b64_tr_b16 a[82:83], v128 offset:2056
    ds_read_b64_tr_b16 a[144:145], v129 offset:0
    ds_read_b64_tr_b16 a[146:147], v129 offset:2048
    ds_read_b64_tr_b16 a[208:209], v129 offset:8
    ds_read_b64_tr_b16 a[210:211], v129 offset:2056
    ds_read_b64_tr_b16 a[20:21], v128 offset:16384
    ds_read_b64_tr_b16 a[22:23], v128 offset:18432
    ds_read_b64_tr_b16 a[84:85], v128 offset:16392
    ds_read_b64_tr_b16 a[86:87], v128 offset:18440
    ds_read_b64_tr_b16 a[148:149], v129 offset:16384
    ds_read_b64_tr_b16 a[150:151], v129 offset:18432
    ds_read_b64_tr_b16 a[212:213], v129 offset:16392
    ds_read_b64_tr_b16 a[214:215], v129 offset:18440
    s_waitcnt lgkmcnt(0)
    s_waitcnt vmcnt(16)
    s_barrier
    s_mov_b32 s79, s71
    s_add_u32 m0, s82, 65536
    s_nop 0
    buffer_load_dwordx4 v2, s[64:67], s79 offen lds
    s_add_u32 s79, s79, s84
    s_add_u32 m0, s82, 66560
    s_nop 0
    buffer_load_dwordx4 v3, s[64:67], s79 offen lds
    s_add_u32 s79, s79, s84
    s_add_u32 m0, s82, 67584
    s_nop 0
    buffer_load_dwordx4 v2, s[64:67], s79 offen lds
    s_add_u32 s79, s79, s84
    s_add_u32 m0, s82, 68608
    s_nop 0
    buffer_load_dwordx4 v3, s[64:67], s79 offen lds
    s_add_u32 s79, s79, s84
    s_add_u32 m0, s82, 69632
    s_nop 0
    buffer_load_dwordx4 v2, s[64:67], s79 offen lds
    s_add_u32 s79, s79, s84
    s_add_u32 m0, s82, 70656
    s_nop 0
    buffer_load_dwordx4 v3, s[64:67], s79 offen lds
    s_add_u32 s79, s79, s84
    s_add_u32 m0, s82, 71680
    s_nop 0
    buffer_load_dwordx4 v2, s[64:67], s79 offen lds
    s_add_u32 s79, s79, s84
    s_add_u32 m0, s82, 72704
    s_nop 0
    buffer_load_dwordx4 v3, s[64:67], s79 offen lds
    s_lshl_b32 s79, s69, 6
    s_add_u32 s71, s71, s79
    ds_read_b64_tr_b16 a[24:25], v128 offset:32768
    ds_read_b64_tr_b16 a[26:27], v128 offset:34816
    ds_read_b64_tr_b16 a[88:89], v128 offset:32776
    ds_read_b64_tr_b16 a[90:91], v128 offset:34824
    ds_read_b64_tr_b16 a[152:153], v129 offset:32768
    ds_read_b64_tr_b16 a[154:155], v129 offset:34816
    ds_read_b64_tr_b16 a[216:217], v129 offset:32776
    ds_read_b64_tr_b16 a[218:219], v129 offset:34824
    ds_read_b64_tr_b16 a[28:29], v128 offset:49152
    ds_read_b64_tr_b16 a[30:31], v128 offset:51200
    ds_read_b64_tr_b16 a[92:93], v128 offset:49160
    ds_read_b64_tr_b16 a[94:95], v128 offset:51208
    ds_read_b64_tr_b16 a[156:157], v129 offset:49152
    ds_read_b64_tr_b16 a[158:159], v129 offset:51200
    ds_read_b64_tr_b16 a[220:221], v129 offset:49160
    ds_read_b64_tr_b16 a[222:223], v129 offset:51208
    s_waitcnt lgkmcnt(0)
    s_waitcnt vmcnt(16)
    s_barrier
    s_mov_b32 s79, s71
    s_add_u32 m0, s82, 98304
    s_nop 0
    buffer_load_dwordx4 v2, s[64:67], s79 offen lds
    s_add_u32 s79, s79, s84
    s_add_u32 m0, s82, 99328
    s_nop 0
    buffer_load_dwordx4 v3, s[64:67], s79 offen lds
    s_add_u32 s79, s79, s84
    s_add_u32 m0, s82, 100352
    s_nop 0
    buffer_load_dwordx4 v2, s[64:67], s79 offen lds
    s_add_u32 s79, s79, s84
    s_add_u32 m0, s82, 101376
    s_nop 0
    buffer_load_dwordx4 v3, s[64:67], s79 offen lds
    s_add_u32 s79, s79, s84
    s_add_u32 m0, s82, 102400
    s_nop 0
    buffer_load_dwordx4 v2, s[64:67], s79 offen lds
    s_add_u32 s79, s79, s84
    s_add_u32 m0, s82, 103424
    s_nop 0
    buffer_load_dwordx4 v3, s[64:67], s79 offen lds
    s_add_u32 s79, s79, s84
    s_add_u32 m0, s82, 104448
    s_nop 0
    buffer_load_dwordx4 v2, s[64:67], s79 offen lds
    s_add_u32 s79, s79, s84
    s_add_u32 m0, s82, 105472
    s_nop 0
    buffer_load_dwordx4 v3, s[64:67], s79 offen lds
    s_lshl_b32 s79, s69, 6
    s_add_u32 s71, s71, s79
    ds_read_b64_tr_b16 a[32:33], v4 offset:0
    ds_read_b64_tr_b16 a[34:35], v4 offset:2048
    ds_read_b64_tr_b16 a[96:97], v4 offset:8
    ds_read_b64_tr_b16 a[98:99], v4 offset:2056
    ds_read_b64_tr_b16 a[160:161], v5 offset:0
    ds_read_b64_tr_b16 a[162:163], v5 offset:2048
    ds_read_b64_tr_b16 a[224:225], v5 offset:8
    ds_read_b64_tr_b16 a[226:227], v5 offset:2056
    ds_read_b64_tr_b16 a[36:37], v4 offset:16384
    ds_read_b64_tr_b16 a[38:39], v4 offset:18432
    ds_read_b64_tr_b16 a[100:101], v4 offset:16392
    ds_read_b64_tr_b16 a[102:103], v4 offset:18440
    ds_read_b64_tr_b16 a[164:165], v5 offset:16384
    ds_read_b64_tr_b16 a[166:167], v5 offset:18432
    ds_read_b64_tr_b16 a[228:229], v5 offset:16392
    ds_read_b64_tr_b16 a[230:231], v5 offset:18440
    s_waitcnt lgkmcnt(0)
    s_waitcnt vmcnt(16)
    s_barrier
    ds_read_b64_tr_b16 a[40:41], v4 offset:32768
    ds_read_b64_tr_b16 a[42:43], v4 offset:34816
    ds_read_b64_tr_b16 a[104:105], v4 offset:32776
    ds_read_b64_tr_b16 a[106:107], v4 offset:34824
    ds_read_b64_tr_b16 a[168:169], v5 offset:32768
    ds_read_b64_tr_b16 a[170:171], v5 offset:34816
    ds_read_b64_tr_b16 a[232:233], v5 offset:32776
    ds_read_b64_tr_b16 a[234:235], v5 offset:34824
    ds_read_b64_tr_b16 a[44:45], v4 offset:49152
    ds_read_b64_tr_b16 a[46:47], v4 offset:51200
    ds_read_b64_tr_b16 a[108:109], v4 offset:49160
    ds_read_b64_tr_b16 a[110:111], v4 offset:51208
    ds_read_b64_tr_b16 a[172:173], v5 offset:49152
    ds_read_b64_tr_b16 a[174:175], v5 offset:51200
    ds_read_b64_tr_b16 a[236:237], v5 offset:49160
    ds_read_b64_tr_b16 a[238:239], v5 offset:51208
    s_waitcnt lgkmcnt(0)
    s_waitcnt vmcnt(8)
    s_barrier
    ds_read_b64_tr_b16 a[48:49], v128 offset:0
    ds_read_b64_tr_b16 a[50:51], v128 offset:2048
    ds_read_b64_tr_b16 a[112:113], v128 offset:8
    ds_read_b64_tr_b16 a[114:115], v128 offset:2056
    ds_read_b64_tr_b16 a[176:177], v129 offset:0
    ds_read_b64_tr_b16 a[178:179], v129 offset:2048
    ds_read_b64_tr_b16 a[240:241], v129 offset:8
    ds_read_b64_tr_b16 a[242:243], v129 offset:2056
    ds_read_b64_tr_b16 a[52:53], v128 offset:16384
    ds_read_b64_tr_b16 a[54:55], v128 offset:18432
    ds_read_b64_tr_b16 a[116:117], v128 offset:16392
    ds_read_b64_tr_b16 a[118:119], v128 offset:18440
    ds_read_b64_tr_b16 a[180:181], v129 offset:16384
    ds_read_b64_tr_b16 a[182:183], v129 offset:18432
    ds_read_b64_tr_b16 a[244:245], v129 offset:16392
    ds_read_b64_tr_b16 a[246:247], v129 offset:18440
    s_waitcnt lgkmcnt(0)
    s_waitcnt vmcnt(0)
    s_barrier
    ds_read_b64_tr_b16 a[56:57], v128 offset:32768
    ds_read_b64_tr_b16 a[58:59], v128 offset:34816
    ds_read_b64_tr_b16 a[120:121], v128 offset:32776
    ds_read_b64_tr_b16 a[122:123], v128 offset:34824
    ds_read_b64_tr_b16 a[184:185], v129 offset:32768
    ds_read_b64_tr_b16 a[186:187], v129 offset:34816
    ds_read_b64_tr_b16 a[248:249], v129 offset:32776
    ds_read_b64_tr_b16 a[250:251], v129 offset:34824
    ds_read_b64_tr_b16 a[60:61], v128 offset:49152
    ds_read_b64_tr_b16 a[62:63], v128 offset:51200
    ds_read_b64_tr_b16 a[124:125], v128 offset:49160
    ds_read_b64_tr_b16 a[126:127], v128 offset:51208
    ds_read_b64_tr_b16 a[188:189], v129 offset:49152
    ds_read_b64_tr_b16 a[190:191], v129 offset:51200
    ds_read_b64_tr_b16 a[252:253], v129 offset:49160
    ds_read_b64_tr_b16 a[254:255], v129 offset:51208
    s_waitcnt lgkmcnt(0)
    s_barrier
    v_and_b32 v10, 63, v0
    s_lshr_b32 s77, s56, 1
    s_lshl_b32 s77, s77, 15
    s_and_b32 s78, s56, 1
    s_lshl_b32 s78, s78, 12
    s_add_u32 s81, s77, s78
    v_lshlrev_b32 v6, 4, v10
    v_add_u32 v6, s81, v6
    v_and_b32 v11, 15, v10
    v_lshrrev_b32 v12, 4, v10
    v_lshrrev_b32 v13, 2, v11
    v_and_b32 v14, 3, v11
    v_lshl_add_u32 v15, v13, 3, v14
    v_lshlrev_b32 v15, 10, v15
    v_add_u32 v9, 0, v12
    v_xor_b32 v9, v9, v11
    v_lshl_add_u32 v128, v9, 4, v15
    v_add_u32 v132, 65536, v128
    v_add_u32 v9, 4, v12
    v_xor_b32 v9, v9, v11
    v_lshl_add_u32 v129, v9, 4, v15
    v_add_u32 v133, 65536, v129
    v_add_u32 v9, 8, v12
    v_xor_b32 v9, v9, v11
    v_lshl_add_u32 v130, v9, 4, v15
    v_add_u32 v134, 65536, v130
    v_add_u32 v9, 12, v12
    v_xor_b32 v9, v9, v11
    v_lshl_add_u32 v131, v9, 4, v15
    v_add_u32 v135, 65536, v131
    s_lshl_b32 s70, s89, 19
    v_and_b32 v10, 63, v0
    v_and_b32 v11, 15, v10
    v_lshrrev_b32 v12, 4, v10
    s_and_b32 s77, s90, 1
    s_lshl_b32 s77, s77, 4
    s_lshl_b32 s78, s56, 2
    s_add_u32 s77, s77, s78
    s_lshl_b32 s73, s77, 16
    s_lshl_b32 s77, s89, 14
    s_add_u32 s73, s73, s77
    s_cmp_ge_u32 s90, 4
    s_cbranch_scc1 L_g2_v
    v_lshrrev_b32 v13, 3, v11
    v_lshlrev_b32 v13, 4, v13
    v_and_b32 v14, 3, v11
    v_add_u32 v13, v13, v14
    v_bfe_u32 v14, v11, 2, 1
    s_cmp_ge_u32 s90, 2
    s_cselect_b32 s74, 2, 3
    s_cselect_b32 s75, 128, 64
    s_cselect_b32 s76, 2097152, 0
    s_add_u32 s76, s76, 83886080
    v_lshlrev_b32 v14, s74, v14
    v_add_u32 v13, v13, v14
    v_and_b32 v14, 1, v12
    v_lshl_add_u32 v13, v14, 5, v13
    v_lshlrev_b32 v13, 4, v13
    v_lshrrev_b32 v14, 1, v12
    v_lshl_add_u32 v1, v14, 16, v13
    s_add_u32 s73, s73, s76
    v_and_b32 v10, 63, v0
    s_lshr_b32 s77, s56, 1
    s_lshl_b32 s77, s77, 15
    s_and_b32 s78, s56, 1
    s_lshl_b32 s78, s78, 12
    s_add_u32 s81, s77, s78
    v_lshlrev_b32 v6, 4, v10
    v_add_u32 v6, s81, v6
    v_and_b32 v11, 15, v10
    v_lshrrev_b32 v12, 4, v10
    v_lshrrev_b32 v13, 2, v11
    v_and_b32 v14, 3, v11
    v_lshl_add_u32 v15, v13, 3, v14
    v_lshlrev_b32 v15, 10, v15
    v_add_u32 v9, 0, v12
    v_xor_b32 v9, v9, v11
    v_lshl_add_u32 v128, v9, 4, v15
    v_add_u32 v132, 65536, v128
    v_add_u32 v9, 4, v12
    v_xor_b32 v9, v9, v11
    v_lshl_add_u32 v129, v9, 4, v15
    v_add_u32 v133, 65536, v129
    v_add_u32 v9, 8, v12
    v_xor_b32 v9, v9, v11
    v_lshl_add_u32 v130, v9, 4, v15
    v_add_u32 v134, 65536, v130
    v_add_u32 v9, 12, v12
    v_xor_b32 v9, v9, v11
    v_lshl_add_u32 v131, v9, 4, v15
    v_add_u32 v135, 65536, v131
    v_xor_b32 v7, 0, v6
    s_add_u32 m0, s81, 0
    s_add_u32 s79, s70, 0
    buffer_load_dwordx4 v7, s[60:63], s79 offen sc1 lds
    v_xor_b32 v7, 16, v6
    s_add_u32 m0, s81, 1024
    s_add_u32 s79, s70, 1024
    buffer_load_dwordx4 v7, s[60:63], s79 offen sc1 lds
    v_xor_b32 v7, 32, v6
    s_add_u32 m0, s81, 2048
    s_add_u32 s79, s70, 2048
    buffer_load_dwordx4 v7, s[60:63], s79 offen sc1 lds
    v_xor_b32 v7, 48, v6
    s_add_u32 m0, s81, 3072
    s_add_u32 s79, s70, 3072
    buffer_load_dwordx4 v7, s[60:63], s79 offen sc1 lds
    v_xor_b32 v7, 64, v6
    s_add_u32 m0, s81, 8192
    s_add_u32 s79, s70, 8192
    buffer_load_dwordx4 v7, s[60:63], s79 offen sc1 lds
    v_xor_b32 v7, 80, v6
    s_add_u32 m0, s81, 9216
    s_add_u32 s79, s70, 9216
    buffer_load_dwordx4 v7, s[60:63], s79 offen sc1 lds
    v_xor_b32 v7, 96, v6
    s_add_u32 m0, s81, 10240
    s_add_u32 s79, s70, 10240
    buffer_load_dwordx4 v7, s[60:63], s79 offen sc1 lds
    v_xor_b32 v7, 112, v6
    s_add_u32 m0, s81, 11264
    s_add_u32 s79, s70, 11264
    buffer_load_dwordx4 v7, s[60:63], s79 offen sc1 lds
    v_xor_b32 v7, 128, v6
    s_add_u32 m0, s81, 16384
    s_add_u32 s79, s70, 16384
    buffer_load_dwordx4 v7, s[60:63], s79 offen sc1 lds
    v_xor_b32 v7, 144, v6
    s_add_u32 m0, s81, 17408
    s_add_u32 s79, s70, 17408
    buffer_load_dwordx4 v7, s[60:63], s79 offen sc1 lds
    v_xor_b32 v7, 160, v6
    s_add_u32 m0, s81, 18432
    s_add_u32 s79, s70, 18432
    buffer_load_dwordx4 v7, s[60:63], s79 offen sc1 lds
    v_xor_b32 v7, 176, v6
    s_add_u32 m0, s81, 19456
    s_add_u32 s79, s70, 19456
    buffer_load_dwordx4 v7, s[60:63], s79 offen sc1 lds
    v_xor_b32 v7, 192, v6
    s_add_u32 m0, s81, 24576
    s_add_u32 s79, s70, 24576
    buffer_load_dwordx4 v7, s[60:63], s79 offen sc1 lds
    v_xor_b32 v7, 208, v6
    s_add_u32 m0, s81, 25600
    s_add_u32 s79, s70, 25600
    buffer_load_dwordx4 v7, s[60:63], s79 offen sc1 lds
    v_xor_b32 v7, 224, v6
    s_add_u32 m0, s81, 26624
    s_add_u32 s79, s70, 26624
    buffer_load_dwordx4 v7, s[60:63], s79 offen sc1 lds
    v_xor_b32 v7, 240, v6
    s_add_u32 m0, s81, 27648
    s_add_u32 s79, s70, 27648
    buffer_load_dwordx4 v7, s[60:63], s79 offen sc1 lds
    s_add_u32 s70, s70, 65536
    s_mov_b32 s83, 0
    s_waitcnt vmcnt(0)
L_wsg2t_158:
    s_waitcnt vmcnt(8)
    s_barrier
    ds_read_b128 v[16:19], v128 offset:0
    ds_read_b128 v[20:23], v128 offset:4096
    ds_read_b128 v[24:27], v128 offset:32768
    ds_read_b128 v[28:31], v128 offset:36864
    ds_read_b128 v[32:35], v129 offset:0
    ds_read_b128 v[36:39], v129 offset:4096
    ds_read_b128 v[40:43], v129 offset:32768
    ds_read_b128 v[44:47], v129 offset:36864
    s_waitcnt lgkmcnt(4)
    v_mfma_f32_16x16x32_bf16 v[48:51], a[0:3], v[16:19], 0
    v_mfma_f32_16x16x32_bf16 v[52:55], a[64:67], v[16:19], 0
    v_mfma_f32_16x16x32_bf16 v[56:59], a[128:131], v[16:19], 0
    v_mfma_f32_16x16x32_bf16 v[60:63], a[192:195], v[16:19], 0
    v_xor_b32 v7, 0, v6
    s_add_u32 m0, s81, 65536
    s_add_u32 s79, s70, 0
    buffer_load_dwordx4 v7, s[60:63], s79 offen sc1 lds
    v_mfma_f32_16x16x32_bf16 v[64:67], a[0:3], v[20:23], 0
    v_mfma_f32_16x16x32_bf16 v[68:71], a[64:67], v[20:23], 0
    v_mfma_f32_16x16x32_bf16 v[72:75], a[128:131], v[20:23], 0
    v_mfma_f32_16x16x32_bf16 v[76:79], a[192:195], v[20:23], 0
    v_mfma_f32_16x16x32_bf16 v[80:83], a[0:3], v[24:27], 0
    v_mfma_f32_16x16x32_bf16 v[84:87], a[64:67], v[24:27], 0
    v_mfma_f32_16x16x32_bf16 v[88:91], a[128:131], v[24:27], 0
    v_mfma_f32_16x16x32_bf16 v[92:95], a[192:195], v[24:27], 0
    v_mfma_f32_16x16x32_bf16 v[96:99], a[0:3], v[28:31], 0
    v_mfma_f32_16x16x32_bf16 v[100:103], a[64:67], v[28:31], 0
    v_mfma_f32_16x16x32_bf16 v[104:107], a[128:131], v[28:31], 0
    v_mfma_f32_16x16x32_bf16 v[108:111], a[192:195], v[28:31], 0
    ds_read_b128 v[16:19], v130 offset:0
    ds_read_b128 v[20:23], v130 offset:4096
    ds_read_b128 v[24:27], v130 offset:32768
    ds_read_b128 v[28:31], v130 offset:36864
    s_waitcnt lgkmcnt(4)
    v_mfma_f32_16x16x32_bf16 v[48:51], a[4:7], v[32:35], v[48:51]
    v_mfma_f32_16x16x32_bf16 v[52:55], a[68:71], v[32:35], v[52:55]
    v_mfma_f32_16x16x32_bf16 v[56:59], a[132:135], v[32:35], v[56:59]
    v_mfma_f32_16x16x32_bf16 v[60:63], a[196:199], v[32:35], v[60:63]
    v_xor_b32 v7, 16, v6
    s_add_u32 m0, s81, 66560
    s_add_u32 s79, s70, 1024
    buffer_load_dwordx4 v7, s[60:63], s79 offen sc1 lds
    v_mfma_f32_16x16x32_bf16 v[64:67], a[4:7], v[36:39], v[64:67]
    v_mfma_f32_16x16x32_bf16 v[68:71], a[68:71], v[36:39], v[68:71]
    v_mfma_f32_16x16x32_bf16 v[72:75], a[132:135], v[36:39], v[72:75]
    v_mfma_f32_16x16x32_bf16 v[76:79], a[196:199], v[36:39], v[76:79]
    v_mfma_f32_16x16x32_bf16 v[80:83], a[4:7], v[40:43], v[80:83]
    v_mfma_f32_16x16x32_bf16 v[84:87], a[68:71], v[40:43], v[84:87]
    v_mfma_f32_16x16x32_bf16 v[88:91], a[132:135], v[40:43], v[88:91]
    v_mfma_f32_16x16x32_bf16 v[92:95], a[196:199], v[40:43], v[92:95]
    v_mfma_f32_16x16x32_bf16 v[96:99], a[4:7], v[44:47], v[96:99]
    v_mfma_f32_16x16x32_bf16 v[100:103], a[68:71], v[44:47], v[100:103]
    v_mfma_f32_16x16x32_bf16 v[104:107], a[132:135], v[44:47], v[104:107]
    v_mfma_f32_16x16x32_bf16 v[108:111], a[196:199], v[44:47], v[108:111]
    ds_read_b128 v[32:35], v131 offset:0
    ds_read_b128 v[36:39], v131 offset:4096
    ds_read_b128 v[40:43], v131 offset:32768
    ds_read_b128 v[44:47], v131 offset:36864
    s_waitcnt lgkmcnt(4)
    v_mfma_f32_16x16x32_bf16 v[48:51], a[8:11], v[16:19], v[48:51]
    v_mfma_f32_16x16x32_bf16 v[52:55], a[72:75], v[16:19], v[52:55]
    v_mfma_f32_16x16x32_bf16 v[56:59], a[136:139], v[16:19], v[56:59]
    v_mfma_f32_16x16x32_bf16 v[60:63], a[200:203], v[16:19], v[60:63]
    v_xor_b32 v7, 32, v6
    s_add_u32 m0, s81, 67584
    s_add_u32 s79, s70, 2048
    buffer_load_dwordx4 v7, s[60:63], s79 offen sc1 lds
    v_mfma_f32_16x16x32_bf16 v[64:67], a[8:11], v[20:23], v[64:67]
    v_mfma_f32_16x16x32_bf16 v[68:71], a[72:75], v[20:23], v[68:71]
    v_mfma_f32_16x16x32_bf16 v[72:75], a[136:139], v[20:23], v[72:75]
    v_mfma_f32_16x16x32_bf16 v[76:79], a[200:203], v[20:23], v[76:79]
    v_mfma_f32_16x16x32_bf16 v[80:83], a[8:11], v[24:27], v[80:83]
    v_mfma_f32_16x16x32_bf16 v[84:87], a[72:75], v[24:27], v[84:87]
    v_mfma_f32_16x16x32_bf16 v[88:91], a[136:139], v[24:27], v[88:91]
    v_mfma_f32_16x16x32_bf16 v[92:95], a[200:203], v[24:27], v[92:95]
    v_mfma_f32_16x16x32_bf16 v[96:99], a[8:11], v[28:31], v[96:99]
    v_mfma_f32_16x16x32_bf16 v[100:103], a[72:75], v[28:31], v[100:103]
    v_mfma_f32_16x16x32_bf16 v[104:107], a[136:139], v[28:31], v[104:107]
    v_mfma_f32_16x16x32_bf16 v[108:111], a[200:203], v[28:31], v[108:111]
    ds_read_b128 v[16:19], v128 offset:256
    ds_read_b128 v[20:23], v128 offset:4352
    ds_read_b128 v[24:27], v128 offset:33024
    ds_read_b128 v[28:31], v128 offset:37120
    s_waitcnt lgkmcnt(4)
    v_mfma_f32_16x16x32_bf16 v[48:51], a[12:15], v[32:35], v[48:51]
    v_mfma_f32_16x16x32_bf16 v[52:55], a[76:79], v[32:35], v[52:55]
    v_mfma_f32_16x16x32_bf16 v[56:59], a[140:143], v[32:35], v[56:59]
    v_mfma_f32_16x16x32_bf16 v[60:63], a[204:207], v[32:35], v[60:63]
    v_xor_b32 v7, 48, v6
    s_add_u32 m0, s81, 68608
    s_add_u32 s79, s70, 3072
    buffer_load_dwordx4 v7, s[60:63], s79 offen sc1 lds
    v_mfma_f32_16x16x32_bf16 v[64:67], a[12:15], v[36:39], v[64:67]
    v_mfma_f32_16x16x32_bf16 v[68:71], a[76:79], v[36:39], v[68:71]
    v_mfma_f32_16x16x32_bf16 v[72:75], a[140:143], v[36:39], v[72:75]
    v_mfma_f32_16x16x32_bf16 v[76:79], a[204:207], v[36:39], v[76:79]
    v_mfma_f32_16x16x32_bf16 v[80:83], a[12:15], v[40:43], v[80:83]
    v_mfma_f32_16x16x32_bf16 v[84:87], a[76:79], v[40:43], v[84:87]
    v_mfma_f32_16x16x32_bf16 v[88:91], a[140:143], v[40:43], v[88:91]
    v_mfma_f32_16x16x32_bf16 v[92:95], a[204:207], v[40:43], v[92:95]
    v_mfma_f32_16x16x32_bf16 v[96:99], a[12:15], v[44:47], v[96:99]
    v_mfma_f32_16x16x32_bf16 v[100:103], a[76:79], v[44:47], v[100:103]
    v_mfma_f32_16x16x32_bf16 v[104:107], a[140:143], v[44:47], v[104:107]
    v_mfma_f32_16x16x32_bf16 v[108:111], a[204:207], v[44:47], v[108:111]
    ds_read_b128 v[32:35], v129 offset:256
    ds_read_b128 v[36:39], v129 offset:4352
    ds_read_b128 v[40:43], v129 offset:33024
    ds_read_b128 v[44:47], v129 offset:37120
    s_waitcnt lgkmcnt(4)
    v_mfma_f32_16x16x32_bf16 v[48:51], a[16:19], v[16:19], v[48:51]
    v_mfma_f32_16x16x32_bf16 v[52:55], a[80:83], v[16:19], v[52:55]
    v_mfma_f32_16x16x32_bf16 v[56:59], a[144:147], v[16:19], v[56:59]
    v_mfma_f32_16x16x32_bf16 v[60:63], a[208:211], v[16:19], v[60:63]
    v_xor_b32 v7, 64, v6
    s_add_u32 m0, s81, 73728
    s_add_u32 s79, s70, 8192
    buffer_load_dwordx4 v7, s[60:63], s79 offen sc1 lds
    v_mfma_f32_16x16x32_bf16 v[64:67], a[16:19], v[20:23], v[64:67]
    v_mfma_f32_16x16x32_bf16 v[68:71], a[80:83], v[20:23], v[68:71]
    v_mfma_f32_16x16x32_bf16 v[72:75], a[144:147], v[20:23], v[72:75]
    v_mfma_f32_16x16x32_bf16 v[76:79], a[208:211], v[20:23], v[76:79]
    v_mfma_f32_16x16x32_bf16 v[80:83], a[16:19], v[24:27], v[80:83]
    v_mfma_f32_16x16x32_bf16 v[84:87], a[80:83], v[24:27], v[84:87]
    v_mfma_f32_16x16x32_bf16 v[88:91], a[144:147], v[24:27], v[88:91]
    v_mfma_f32_16x16x32_bf16 v[92:95], a[208:211], v[24:27], v[92:95]
    v_mfma_f32_16x16x32_bf16 v[96:99], a[16:19], v[28:31], v[96:99]
    v_mfma_f32_16x16x32_bf16 v[100:103], a[80:83], v[28:31], v[100:103]
    v_mfma_f32_16x16x32_bf16 v[104:107], a[144:147], v[28:31], v[104:107]
    v_mfma_f32_16x16x32_bf16 v[108:111], a[208:211], v[28:31], v[108:111]
    ds_read_b128 v[16:19], v130 offset:256
    ds_read_b128 v[20:23], v130 offset:4352
    ds_read_b128 v[24:27], v130 offset:33024
    ds_read_b128 v[28:31], v130 offset:37120
    s_waitcnt lgkmcnt(4)
    v_mfma_f32_16x16x32_bf16 v[48:51], a[20:23], v[32:35], v[48:51]
    v_mfma_f32_16x16x32_bf16 v[52:55], a[84:87], v[32:35], v[52:55]
    v_mfma_f32_16x16x32_bf16 v[56:59], a[148:151], v[32:35], v[56:59]
    v_mfma_f32_16x16x32_bf16 v[60:63], a[212:215], v[32:35], v[60:63]
    v_xor_b32 v7, 80, v6
    s_add_u32 m0, s81, 74752
    s_add_u32 s79, s70, 9216
    buffer_load_dwordx4 v7, s[60:63], s79 offen sc1 lds
    v_mfma_f32_16x16x32_bf16 v[64:67], a[20:23], v[36:39], v[64:67]
    v_mfma_f32_16x16x32_bf16 v[68:71], a[84:87], v[36:39], v[68:71]
    v_mfma_f32_16x16x32_bf16 v[72:75], a[148:151], v[36:39], v[72:75]
    v_mfma_f32_16x16x32_bf16 v[76:79], a[212:215], v[36:39], v[76:79]
    v_mfma_f32_16x16x32_bf16 v[80:83], a[20:23], v[40:43], v[80:83]
    v_mfma_f32_16x16x32_bf16 v[84:87], a[84:87], v[40:43], v[84:87]
    v_mfma_f32_16x16x32_bf16 v[88:91], a[148:151], v[40:43], v[88:91]
    v_mfma_f32_16x16x32_bf16 v[92:95], a[212:215], v[40:43], v[92:95]
    v_mfma_f32_16x16x32_bf16 v[96:99], a[20:23], v[44:47], v[96:99]
    v_mfma_f32_16x16x32_bf16 v[100:103], a[84:87], v[44:47], v[100:103]
    v_mfma_f32_16x16x32_bf16 v[104:107], a[148:151], v[44:47], v[104:107]
    v_mfma_f32_16x16x32_bf16 v[108:111], a[212:215], v[44:47], v[108:111]
    ds_read_b128 v[32:35], v131 offset:256
    ds_read_b128 v[36:39], v131 offset:4352
    ds_read_b128 v[40:43], v131 offset:33024
    ds_read_b128 v[44:47], v131 offset:37120
    s_waitcnt lgkmcnt(4)
    v_mfma_f32_16x16x32_bf16 v[48:51], a[24:27], v[16:19], v[48:51]
    v_mfma_f32_16x16x32_bf16 v[52:55], a[88:91], v[16:19], v[52:55]
    v_mfma_f32_16x16x32_bf16 v[56:59], a[152:155], v[16:19], v[56:59]
    v_mfma_f32_16x16x32_bf16 v[60:63], a[216:219], v[16:19], v[60:63]
    v_xor_b32 v7, 96, v6
    s_add_u32 m0, s81, 75776
    s_add_u32 s79, s70, 10240
    buffer_load_dwordx4 v7, s[60:63], s79 offen sc1 lds
    v_mfma_f32_16x16x32_bf16 v[64:67], a[24:27], v[20:23], v[64:67]
    v_mfma_f32_16x16x32_bf16 v[68:71], a[88:91], v[20:23], v[68:71]
    v_mfma_f32_16x16x32_bf16 v[72:75], a[152:155], v[20:23], v[72:75]
    v_mfma_f32_16x16x32_bf16 v[76:79], a[216:219], v[20:23], v[76:79]
    v_mfma_f32_16x16x32_bf16 v[80:83], a[24:27], v[24:27], v[80:83]
    v_mfma_f32_16x16x32_bf16 v[84:87], a[88:91], v[24:27], v[84:87]
    v_mfma_f32_16x16x32_bf16 v[88:91], a[152:155], v[24:27], v[88:91]
    v_mfma_f32_16x16x32_bf16 v[92:95], a[216:219], v[24:27], v[92:95]
    v_mfma_f32_16x16x32_bf16 v[96:99], a[24:27], v[28:31], v[96:99]
    v_mfma_f32_16x16x32_bf16 v[100:103], a[88:91], v[28:31], v[100:103]
    v_mfma_f32_16x16x32_bf16 v[104:107], a[152:155], v[28:31], v[104:107]
    v_mfma_f32_16x16x32_bf16 v[108:111], a[216:219], v[28:31], v[108:111]
    ds_read_b128 v[16:19], v128 offset:512
    ds_read_b128 v[20:23], v128 offset:4608
    ds_read_b128 v[24:27], v128 offset:33280
    ds_read_b128 v[28:31], v128 offset:37376
    s_waitcnt lgkmcnt(4)
    v_mfma_f32_16x16x32_bf16 v[48:51], a[28:31], v[32:35], v[48:51]
    v_mfma_f32_16x16x32_bf16 v[52:55], a[92:95], v[32:35], v[52:55]
    v_mfma_f32_16x16x32_bf16 v[56:59], a[156:159], v[32:35], v[56:59]
    v_mfma_f32_16x16x32_bf16 v[60:63], a[220:223], v[32:35], v[60:63]
    v_xor_b32 v7, 112, v6
    s_add_u32 m0, s81, 76800
    s_add_u32 s79, s70, 11264
    buffer_load_dwordx4 v7, s[60:63], s79 offen sc1 lds
    v_mfma_f32_16x16x32_bf16 v[64:67], a[28:31], v[36:39], v[64:67]
    v_mfma_f32_16x16x32_bf16 v[68:71], a[92:95], v[36:39], v[68:71]
    v_mfma_f32_16x16x32_bf16 v[72:75], a[156:159], v[36:39], v[72:75]
    v_mfma_f32_16x16x32_bf16 v[76:79], a[220:223], v[36:39], v[76:79]
    v_mfma_f32_16x16x32_bf16 v[80:83], a[28:31], v[40:43], v[80:83]
    v_mfma_f32_16x16x32_bf16 v[84:87], a[92:95], v[40:43], v[84:87]
    v_mfma_f32_16x16x32_bf16 v[88:91], a[156:159], v[40:43], v[88:91]
    v_mfma_f32_16x16x32_bf16 v[92:95], a[220:223], v[40:43], v[92:95]
    v_mfma_f32_16x16x32_bf16 v[96:99], a[28:31], v[44:47], v[96:99]
    v_mfma_f32_16x16x32_bf16 v[100:103], a[92:95], v[44:47], v[100:103]
    v_mfma_f32_16x16x32_bf16 v[104:107], a[156:159], v[44:47], v[104:107]
    v_mfma_f32_16x16x32_bf16 v[108:111], a[220:223], v[44:47], v[108:111]
    ds_read_b128 v[32:35], v129 offset:512
    ds_read_b128 v[36:39], v129 offset:4608
    ds_read_b128 v[40:43], v129 offset:33280
    ds_read_b128 v[44:47], v129 offset:37376
    s_waitcnt lgkmcnt(4)
    v_mfma_f32_16x16x32_bf16 v[48:51], a[32:35], v[16:19], v[48:51]
    v_mfma_f32_16x16x32_bf16 v[52:55], a[96:99], v[16:19], v[52:55]
    v_mfma_f32_16x16x32_bf16 v[56:59], a[160:163], v[16:19], v[56:59]
    v_mfma_f32_16x16x32_bf16 v[60:63], a[224:227], v[16:19], v[60:63]
    v_xor_b32 v7, 128, v6
    s_add_u32 m0, s81, 81920
    s_add_u32 s79, s70, 16384
    buffer_load_dwordx4 v7, s[60:63], s79 offen sc1 lds
    v_mfma_f32_16x16x32_bf16 v[64:67], a[32:35], v[20:23], v[64:67]
    v_mfma_f32_16x16x32_bf16 v[68:71], a[96:99], v[20:23], v[68:71]
    v_mfma_f32_16x16x32_bf16 v[72:75], a[160:163], v[20:23], v[72:75]
    v_mfma_f32_16x16x32_bf16 v[76:79], a[224:227], v[20:23], v[76:79]
    v_mfma_f32_16x16x32_bf16 v[80:83], a[32:35], v[24:27], v[80:83]
    v_mfma_f32_16x16x32_bf16 v[84:87], a[96:99], v[24:27], v[84:87]
    v_mfma_f32_16x16x32_bf16 v[88:91], a[160:163], v[24:27], v[88:91]
    v_mfma_f32_16x16x32_bf16 v[92:95], a[224:227], v[24:27], v[92:95]
    v_mfma_f32_16x16x32_bf16 v[96:99], a[32:35], v[28:31], v[96:99]
    v_mfma_f32_16x16x32_bf16 v[100:103], a[96:99], v[28:31], v[100:103]
    v_mfma_f32_16x16x32_bf16 v[104:107], a[160:163], v[28:31], v[104:107]
    v_mfma_f32_16x16x32_bf16 v[108:111], a[224:227], v[28:31], v[108:111]
    ds_read_b128 v[16:19], v130 offset:512
    ds_read_b128 v[20:23], v130 offset:4608
    ds_read_b128 v[24:27], v130 offset:33280
    ds_read_b128 v[28:31], v130 offset:37376
    s_waitcnt lgkmcnt(4)
    v_mfma_f32_16x16x32_bf16 v[48:51], a[36:39], v[32:35], v[48:51]
    v_mfma_f32_16x16x32_bf16 v[52:55], a[100:103], v[32:35], v[52:55]
    v_mfma_f32_16x16x32_bf16 v[56:59], a[164:167], v[32:35], v[56:59]
    v_mfma_f32_16x16x32_bf16 v[60:63], a[228:231], v[32:35], v[60:63]
    v_xor_b32 v7, 144, v6
    s_add_u32 m0, s81, 82944
    s_add_u32 s79, s70, 17408
    buffer_load_dwordx4 v7, s[60:63], s79 offen sc1 lds
    v_mfma_f32_16x16x32_bf16 v[64:67], a[36:39], v[36:39], v[64:67]
    v_mfma_f32_16x16x32_bf16 v[68:71], a[100:103], v[36:39], v[68:71]
    v_mfma_f32_16x16x32_bf16 v[72:75], a[164:167], v[36:39], v[72:75]
    v_mfma_f32_16x16x32_bf16 v[76:79], a[228:231], v[36:39], v[76:79]
    v_mfma_f32_16x16x32_bf16 v[80:83], a[36:39], v[40:43], v[80:83]
    v_mfma_f32_16x16x32_bf16 v[84:87], a[100:103], v[40:43], v[84:87]
    v_mfma_f32_16x16x32_bf16 v[88:91], a[164:167], v[40:43], v[88:91]
    v_mfma_f32_16x16x32_bf16 v[92:95], a[228:231], v[40:43], v[92:95]
    v_mfma_f32_16x16x32_bf16 v[96:99], a[36:39], v[44:47], v[96:99]
    v_mfma_f32_16x16x32_bf16 v[100:103], a[100:103], v[44:47], v[100:103]
    v_mfma_f32_16x16x32_bf16 v[104:107], a[164:167], v[44:47], v[104:107]
    v_mfma_f32_16x16x32_bf16 v[108:111], a[228:231], v[44:47], v[108:111]
    ds_read_b128 v[32:35], v131 offset:512
    ds_read_b128 v[36:39], v131 offset:4608
    ds_read_b128 v[40:43], v131 offset:33280
    ds_read_b128 v[44:47], v131 offset:37376
    s_waitcnt lgkmcnt(4)
    v_mfma_f32_16x16x32_bf16 v[48:51], a[40:43], v[16:19], v[48:51]
    v_mfma_f32_16x16x32_bf16 v[52:55], a[104:107], v[16:19], v[52:55]
    v_mfma_f32_16x16x32_bf16 v[56:59], a[168:171], v[16:19], v[56:59]
    v_mfma_f32_16x16x32_bf16 v[60:63], a[232:235], v[16:19], v[60:63]
    v_xor_b32 v7, 160, v6
    s_add_u32 m0, s81, 83968
    s_add_u32 s79, s70, 18432
    buffer_load_dwordx4 v7, s[60:63], s79 offen sc1 lds
    v_mfma_f32_16x16x32_bf16 v[64:67], a[40:43], v[20:23], v[64:67]
    v_mfma_f32_16x16x32_bf16 v[68:71], a[104:107], v[20:23], v[68:71]
    v_mfma_f32_16x16x32_bf16 v[72:75], a[168:171], v[20:23], v[72:75]
    v_mfma_f32_16x16x32_bf16 v[76:79], a[232:235], v[20:23], v[76:79]
    v_mfma_f32_16x16x32_bf16 v[80:83], a[40:43], v[24:27], v[80:83]
    v_mfma_f32_16x16x32_bf16 v[84:87], a[104:107], v[24:27], v[84:87]
    v_mfma_f32_16x16x32_bf16 v[88:91], a[168:171], v[24:27], v[88:91]
    v_mfma_f32_16x16x32_bf16 v[92:95], a[232:235], v[24:27], v[92:95]
    v_mfma_f32_16x16x32_bf16 v[96:99], a[40:43], v[28:31], v[96:99]
    v_mfma_f32_16x16x32_bf16 v[100:103], a[104:107], v[28:31], v[100:103]
    v_mfma_f32_16x16x32_bf16 v[104:107], a[168:171], v[28:31], v[104:107]
    v_mfma_f32_16x16x32_bf16 v[108:111], a[232:235], v[28:31], v[108:111]
    ds_read_b128 v[16:19], v128 offset:768
    ds_read_b128 v[20:23], v128 offset:4864
    ds_read_b128 v[24:27], v128 offset:33536
    ds_read_b128 v[28:31], v128 offset:37632
    s_waitcnt lgkmcnt(4)
    v_mfma_f32_16x16x32_bf16 v[48:51], a[44:47], v[32:35], v[48:51]
    v_mfma_f32_16x16x32_bf16 v[52:55], a[108:111], v[32:35], v[52:55]
    v_mfma_f32_16x16x32_bf16 v[56:59], a[172:175], v[32:35], v[56:59]
    v_mfma_f32_16x16x32_bf16 v[60:63], a[236:239], v[32:35], v[60:63]
    v_xor_b32 v7, 176, v6
    s_add_u32 m0, s81, 84992
    s_add_u32 s79, s70, 19456
    buffer_load_dwordx4 v7, s[60:63], s79 offen sc1 lds
    v_mfma_f32_16x16x32_bf16 v[64:67], a[44:47], v[36:39], v[64:67]
    v_mfma_f32_16x16x32_bf16 v[68:71], a[108:111], v[36:39], v[68:71]
    v_mfma_f32_16x16x32_bf16 v[72:75], a[172:175], v[36:39], v[72:75]
    v_mfma_f32_16x16x32_bf16 v[76:79], a[236:239], v[36:39], v[76:79]
    v_mfma_f32_16x16x32_bf16 v[80:83], a[44:47], v[40:43], v[80:83]
    v_mfma_f32_16x16x32_bf16 v[84:87], a[108:111], v[40:43], v[84:87]
    v_mfma_f32_16x16x32_bf16 v[88:91], a[172:175], v[40:43], v[88:91]
    v_mfma_f32_16x16x32_bf16 v[92:95], a[236:239], v[40:43], v[92:95]
    v_mfma_f32_16x16x32_bf16 v[96:99], a[44:47], v[44:47], v[96:99]
    v_mfma_f32_16x16x32_bf16 v[100:103], a[108:111], v[44:47], v[100:103]
    v_mfma_f32_16x16x32_bf16 v[104:107], a[172:175], v[44:47], v[104:107]
    v_mfma_f32_16x16x32_bf16 v[108:111], a[236:239], v[44:47], v[108:111]
    ds_read_b128 v[32:35], v129 offset:768
    ds_read_b128 v[36:39], v129 offset:4864
    ds_read_b128 v[40:43], v129 offset:33536
    ds_read_b128 v[44:47], v129 offset:37632
    s_waitcnt lgkmcnt(4)
    v_mfma_f32_16x16x32_bf16 v[48:51], a[48:51], v[16:19], v[48:51]
    v_mfma_f32_16x16x32_bf16 v[52:55], a[112:115], v[16:19], v[52:55]
    v_mfma_f32_16x16x32_bf16 v[56:59], a[176:179], v[16:19], v[56:59]
    v_mfma_f32_16x16x32_bf16 v[60:63], a[240:243], v[16:19], v[60:63]
    v_xor_b32 v7, 192, v6
    s_add_u32 m0, s81, 90112
    s_add_u32 s79, s70, 24576
    buffer_load_dwordx4 v7, s[60:63], s79 offen sc1 lds
    v_mfma_f32_16x16x32_bf16 v[64:67], a[48:51], v[20:23], v[64:67]
    v_mfma_f32_16x16x32_bf16 v[68:71], a[112:115], v[20:23], v[68:71]
    v_mfma_f32_16x16x32_bf16 v[72:75], a[176:179], v[20:23], v[72:75]
    v_mfma_f32_16x16x32_bf16 v[76:79], a[240:243], v[20:23], v[76:79]
    v_mfma_f32_16x16x32_bf16 v[80:83], a[48:51], v[24:27], v[80:83]
    v_mfma_f32_16x16x32_bf16 v[84:87], a[112:115], v[24:27], v[84:87]
    v_mfma_f32_16x16x32_bf16 v[88:91], a[176:179], v[24:27], v[88:91]
    v_mfma_f32_16x16x32_bf16 v[92:95], a[240:243], v[24:27], v[92:95]
    v_mfma_f32_16x16x32_bf16 v[96:99], a[48:51], v[28:31], v[96:99]
    v_mfma_f32_16x16x32_bf16 v[100:103], a[112:115], v[28:31], v[100:103]
    v_mfma_f32_16x16x32_bf16 v[104:107], a[176:179], v[28:31], v[104:107]
    v_mfma_f32_16x16x32_bf16 v[108:111], a[240:243], v[28:31], v[108:111]
    ds_read_b128 v[16:19], v130 offset:768
    ds_read_b128 v[20:23], v130 offset:4864
    ds_read_b128 v[24:27], v130 offset:33536
    ds_read_b128 v[28:31], v130 offset:37632
    s_waitcnt lgkmcnt(4)
    v_mfma_f32_16x16x32_bf16 v[48:51], a[52:55], v[32:35], v[48:51]
    v_mfma_f32_16x16x32_bf16 v[52:55], a[116:119], v[32:35], v[52:55]
    v_mfma_f32_16x16x32_bf16 v[56:59], a[180:183], v[32:35], v[56:59]
    v_mfma_f32_16x16x32_bf16 v[60:63], a[244:247], v[32:35], v[60:63]
    v_xor_b32 v7, 208, v6
    s_add_u32 m0, s81, 91136
    s_add_u32 s79, s70, 25600
    buffer_load_dwordx4 v7, s[60:63], s79 offen sc1 lds
    v_mfma_f32_16x16x32_bf16 v[64:67], a[52:55], v[36:39], v[64:67]
    v_mfma_f32_16x16x32_bf16 v[68:71], a[116:119], v[36:39], v[68:71]
    v_mfma_f32_16x16x32_bf16 v[72:75], a[180:183], v[36:39], v[72:75]
    v_mfma_f32_16x16x32_bf16 v[76:79], a[244:247], v[36:39], v[76:79]
    v_mfma_f32_16x16x32_bf16 v[80:83], a[52:55], v[40:43], v[80:83]
    v_mfma_f32_16x16x32_bf16 v[84:87], a[116:119], v[40:43], v[84:87]
    v_mfma_f32_16x16x32_bf16 v[88:91], a[180:183], v[40:43], v[88:91]
    v_mfma_f32_16x16x32_bf16 v[92:95], a[244:247], v[40:43], v[92:95]
    v_mfma_f32_16x16x32_bf16 v[96:99], a[52:55], v[44:47], v[96:99]
    v_mfma_f32_16x16x32_bf16 v[100:103], a[116:119], v[44:47], v[100:103]
    v_mfma_f32_16x16x32_bf16 v[104:107], a[180:183], v[44:47], v[104:107]
    v_mfma_f32_16x16x32_bf16 v[108:111], a[244:247], v[44:47], v[108:111]
    ds_read_b128 v[32:35], v131 offset:768
    ds_read_b128 v[36:39], v131 offset:4864
    ds_read_b128 v[40:43], v131 offset:33536
    ds_read_b128 v[44:47], v131 offset:37632
    s_waitcnt lgkmcnt(4)
    v_mfma_f32_16x16x32_bf16 v[48:51], a[56:59], v[16:19], v[48:51]
    v_mfma_f32_16x16x32_bf16 v[52:55], a[120:123], v[16:19], v[52:55]
    v_mfma_f32_16x16x32_bf16 v[56:59], a[184:187], v[16:19], v[56:59]
    v_mfma_f32_16x16x32_bf16 v[60:63], a[248:251], v[16:19], v[60:63]
    v_xor_b32 v7, 224, v6
    s_add_u32 m0, s81, 92160
    s_add_u32 s79, s70, 26624
    buffer_load_dwordx4 v7, s[60:63], s79 offen sc1 lds
    v_mfma_f32_16x16x32_bf16 v[64:67], a[56:59], v[20:23], v[64:67]
    v_mfma_f32_16x16x32_bf16 v[68:71], a[120:123], v[20:23], v[68:71]
    v_mfma_f32_16x16x32_bf16 v[72:75], a[184:187], v[20:23], v[72:75]
    v_mfma_f32_16x16x32_bf16 v[76:79], a[248:251], v[20:23], v[76:79]
    v_mfma_f32_16x16x32_bf16 v[80:83], a[56:59], v[24:27], v[80:83]
    v_mfma_f32_16x16x32_bf16 v[84:87], a[120:123], v[24:27], v[84:87]
    v_mfma_f32_16x16x32_bf16 v[88:91], a[184:187], v[24:27], v[88:91]
    v_mfma_f32_16x16x32_bf16 v[92:95], a[248:251], v[24:27], v[92:95]
    v_mfma_f32_16x16x32_bf16 v[96:99], a[56:59], v[28:31], v[96:99]
    v_mfma_f32_16x16x32_bf16 v[100:103], a[120:123], v[28:31], v[100:103]
    v_mfma_f32_16x16x32_bf16 v[104:107], a[184:187], v[28:31], v[104:107]
    v_mfma_f32_16x16x32_bf16 v[108:111], a[248:251], v[28:31], v[108:111]
    s_waitcnt lgkmcnt(0)
    v_mfma_f32_16x16x32_bf16 v[48:51], a[60:63], v[32:35], v[48:51]
    v_mfma_f32_16x16x32_bf16 v[52:55], a[124:127], v[32:35], v[52:55]
    v_mfma_f32_16x16x32_bf16 v[56:59], a[188:191], v[32:35], v[56:59]
    v_mfma_f32_16x16x32_bf16 v[60:63], a[252:255], v[32:35], v[60:63]
    v_xor_b32 v7, 240, v6
    s_add_u32 m0, s81, 93184
    s_add_u32 s79, s70, 27648
    buffer_load_dwordx4 v7, s[60:63], s79 offen sc1 lds
    v_mfma_f32_16x16x32_bf16 v[64:67], a[60:63], v[36:39], v[64:67]
    v_mfma_f32_16x16x32_bf16 v[68:71], a[124:127], v[36:39], v[68:71]
    v_mfma_f32_16x16x32_bf16 v[72:75], a[188:191], v[36:39], v[72:75]
    v_mfma_f32_16x16x32_bf16 v[76:79], a[252:255], v[36:39], v[76:79]
    v_mfma_f32_16x16x32_bf16 v[80:83], a[60:63], v[40:43], v[80:83]
    v_mfma_f32_16x16x32_bf16 v[84:87], a[124:127], v[40:43], v[84:87]
    v_mfma_f32_16x16x32_bf16 v[88:91], a[188:191], v[40:43], v[88:91]
    v_mfma_f32_16x16x32_bf16 v[92:95], a[252:255], v[40:43], v[92:95]
    v_mfma_f32_16x16x32_bf16 v[96:99], a[60:63], v[44:47], v[96:99]
    v_mfma_f32_16x16x32_bf16 v[100:103], a[124:127], v[44:47], v[100:103]
    v_mfma_f32_16x16x32_bf16 v[104:107], a[188:191], v[44:47], v[104:107]
    v_mfma_f32_16x16x32_bf16 v[108:111], a[252:255], v[44:47], v[108:111]
    s_add_u32 s70, s70, 65536
    s_add_u32 s77, s73, 0
    v_cvt_pk_bf16_f32 v112, v48, v49
    v_cvt_pk_bf16_f32 v113, v50, v51
    v_cvt_pk_bf16_f32 v114, v52, v53
    v_cvt_pk_bf16_f32 v115, v54, v55
    buffer_store_dwordx4 v[112:115], v1, s[52:55], s77 offen sc1
    s_add_u32 s77, s73, 0
    s_add_u32 s77, s77, s75
    v_cvt_pk_bf16_f32 v116, v64, v65
    v_cvt_pk_bf16_f32 v117, v66, v67
    v_cvt_pk_bf16_f32 v118, v68, v69
    v_cvt_pk_bf16_f32 v119, v70, v71
    buffer_store_dwordx4 v[116:119], v1, s[52:55], s77 offen sc1
    s_add_u32 s77, s73, 131072
    v_cvt_pk_bf16_f32 v112, v56, v57
    v_cvt_pk_bf16_f32 v113, v58, v59
    v_cvt_pk_bf16_f32 v114, v60, v61
    v_cvt_pk_bf16_f32 v115, v62, v63
    buffer_store_dwordx4 v[112:115], v1, s[52:55], s77 offen sc1
    s_add_u32 s77, s73, 131072
    s_add_u32 s77, s77, s75
    v_cvt_pk_bf16_f32 v116, v72, v73
    v_cvt_pk_bf16_f32 v117, v74, v75
    v_cvt_pk_bf16_f32 v118, v76, v77
    v_cvt_pk_bf16_f32 v119, v78, v79
    buffer_store_dwordx4 v[116:119], v1, s[52:55], s77 offen sc1
    s_add_u32 s77, s73, 1024
    v_cvt_pk_bf16_f32 v112, v80, v81
    v_cvt_pk_bf16_f32 v113, v82, v83
    v_cvt_pk_bf16_f32 v114, v84, v85
    v_cvt_pk_bf16_f32 v115, v86, v87
    buffer_store_dwordx4 v[112:115], v1, s[52:55], s77 offen sc1
    s_add_u32 s77, s73, 1024
    s_add_u32 s77, s77, s75
    v_cvt_pk_bf16_f32 v116, v96, v97
    v_cvt_pk_bf16_f32 v117, v98, v99
    v_cvt_pk_bf16_f32 v118, v100, v101
    v_cvt_pk_bf16_f32 v119, v102, v103
    buffer_store_dwordx4 v[116:119], v1, s[52:55], s77 offen sc1
    s_add_u32 s77, s73, 132096
    v_cvt_pk_bf16_f32 v112, v88, v89
    v_cvt_pk_bf16_f32 v113, v90, v91
    v_cvt_pk_bf16_f32 v114, v92, v93
    v_cvt_pk_bf16_f32 v115, v94, v95
    buffer_store_dwordx4 v[112:115], v1, s[52:55], s77 offen sc1
    s_add_u32 s77, s73, 132096
    s_add_u32 s77, s77, s75
    v_cvt_pk_bf16_f32 v116, v104, v105
    v_cvt_pk_bf16_f32 v117, v106, v107
    v_cvt_pk_bf16_f32 v118, v108, v109
    v_cvt_pk_bf16_f32 v119, v110, v111
    buffer_store_dwordx4 v[116:119], v1, s[52:55], s77 offen sc1
    s_add_u32 s73, s73, 2048
    s_waitcnt vmcnt(8)
    s_barrier
    s_cmp_eq_u32 s83, 0
    s_cbranch_scc1 L_wsg_159
    s_cmp_lg_u32 s56, 0
    s_cbranch_scc1 L_wsg_159
    s_mov_b32 s80, 20
    v_mov_b32 v120, 1
    v_mov_b32 v121, s80
    s_mov_b64 exec, 1
    buffer_atomic_add v120, v121, s[48:51], 0 offen
    s_mov_b64 exec, -1
    s_nop 0
L_wsg_159:
    ds_read_b128 v[16:19], v132 offset:0
    ds_read_b128 v[20:23], v132 offset:4096
    ds_read_b128 v[24:27], v132 offset:32768
    ds_read_b128 v[28:31], v132 offset:36864
    ds_read_b128 v[32:35], v133 offset:0
    ds_read_b128 v[36:39], v133 offset:4096
    ds_read_b128 v[40:43], v133 offset:32768
    ds_read_b128 v[44:47], v133 offset:36864
    s_waitcnt lgkmcnt(4)
    v_mfma_f32_16x16x32_bf16 v[48:51], a[0:3], v[16:19], 0
    v_mfma_f32_16x16x32_bf16 v[52:55], a[64:67], v[16:19], 0
    v_mfma_f32_16x16x32_bf16 v[56:59], a[128:131], v[16:19], 0
    v_mfma_f32_16x16x32_bf16 v[60:63], a[192:195], v[16:19], 0
    v_xor_b32 v7, 0, v6
    s_add_u32 m0, s81, 0
    s_add_u32 s79, s70, 0
    buffer_load_dwordx4 v7, s[60:63], s79 offen sc1 lds
    v_mfma_f32_16x16x32_bf16 v[64:67], a[0:3], v[20:23], 0
    v_mfma_f32_16x16x32_bf16 v[68:71], a[64:67], v[20:23], 0
    v_mfma_f32_16x16x32_bf16 v[72:75], a[128:131], v[20:23], 0
    v_mfma_f32_16x16x32_bf16 v[76:79], a[192:195], v[20:23], 0
    v_mfma_f32_16x16x32_bf16 v[80:83], a[0:3], v[24:27], 0
    v_mfma_f32_16x16x32_bf16 v[84:87], a[64:67], v[24:27], 0
    v_mfma_f32_16x16x32_bf16 v[88:91], a[128:131], v[24:27], 0
    v_mfma_f32_16x16x32_bf16 v[92:95], a[192:195], v[24:27], 0
    v_mfma_f32_16x16x32_bf16 v[96:99], a[0:3], v[28:31], 0
    v_mfma_f32_16x16x32_bf16 v[100:103], a[64:67], v[28:31], 0
    v_mfma_f32_16x16x32_bf16 v[104:107], a[128:131], v[28:31], 0
    v_mfma_f32_16x16x32_bf16 v[108:111], a[192:195], v[28:31], 0
    ds_read_b128 v[16:19], v134 offset:0
    ds_read_b128 v[20:23], v134 offset:4096
    ds_read_b128 v[24:27], v134 offset:32768
    ds_read_b128 v[28:31], v134 offset:36864
    s_waitcnt lgkmcnt(4)
    v_mfma_f32_16x16x32_bf16 v[48:51], a[4:7], v[32:35], v[48:51]
    v_mfma_f32_16x16x32_bf16 v[52:55], a[68:71], v[32:35], v[52:55]
    v_mfma_f32_16x16x32_bf16 v[56:59], a[132:135], v[32:35], v[56:59]
    v_mfma_f32_16x16x32_bf16 v[60:63], a[196:199], v[32:35], v[60:63]
    v_xor_b32 v7, 16, v6
    s_add_u32 m0, s81, 1024
    s_add_u32 s79, s70, 1024
    buffer_load_dwordx4 v7, s[60:63], s79 offen sc1 lds
    v_mfma_f32_16x16x32_bf16 v[64:67], a[4:7], v[36:39], v[64:67]
    v_mfma_f32_16x16x32_bf16 v[68:71], a[68:71], v[36:39], v[68:71]
    v_mfma_f32_16x16x32_bf16 v[72:75], a[132:135], v[36:39], v[72:75]
    v_mfma_f32_16x16x32_bf16 v[76:79], a[196:199], v[36:39], v[76:79]
    v_mfma_f32_16x16x32_bf16 v[80:83], a[4:7], v[40:43], v[80:83]
    v_mfma_f32_16x16x32_bf16 v[84:87], a[68:71], v[40:43], v[84:87]
    v_mfma_f32_16x16x32_bf16 v[88:91], a[132:135], v[40:43], v[88:91]
    v_mfma_f32_16x16x32_bf16 v[92:95], a[196:199], v[40:43], v[92:95]
    v_mfma_f32_16x16x32_bf16 v[96:99], a[4:7], v[44:47], v[96:99]
    v_mfma_f32_16x16x32_bf16 v[100:103], a[68:71], v[44:47], v[100:103]
    v_mfma_f32_16x16x32_bf16 v[104:107], a[132:135], v[44:47], v[104:107]
    v_mfma_f32_16x16x32_bf16 v[108:111], a[196:199], v[44:47], v[108:111]
    ds_read_b128 v[32:35], v135 offset:0
    ds_read_b128 v[36:39], v135 offset:4096
    ds_read_b128 v[40:43], v135 offset:32768
    ds_read_b128 v[44:47], v135 offset:36864
    s_waitcnt lgkmcnt(4)
    v_mfma_f32_16x16x32_bf16 v[48:51], a[8:11], v[16:19], v[48:51]
    v_mfma_f32_16x16x32_bf16 v[52:55], a[72:75], v[16:19], v[52:55]
    v_mfma_f32_16x16x32_bf16 v[56:59], a[136:139], v[16:19], v[56:59]
    v_mfma_f32_16x16x32_bf16 v[60:63], a[200:203], v[16:19], v[60:63]
    v_xor_b32 v7, 32, v6
    s_add_u32 m0, s81, 2048
    s_add_u32 s79, s70, 2048
    buffer_load_dwordx4 v7, s[60:63], s79 offen sc1 lds
    v_mfma_f32_16x16x32_bf16 v[64:67], a[8:11], v[20:23], v[64:67]
    v_mfma_f32_16x16x32_bf16 v[68:71], a[72:75], v[20:23], v[68:71]
    v_mfma_f32_16x16x32_bf16 v[72:75], a[136:139], v[20:23], v[72:75]
    v_mfma_f32_16x16x32_bf16 v[76:79], a[200:203], v[20:23], v[76:79]
    v_mfma_f32_16x16x32_bf16 v[80:83], a[8:11], v[24:27], v[80:83]
    v_mfma_f32_16x16x32_bf16 v[84:87], a[72:75], v[24:27], v[84:87]
    v_mfma_f32_16x16x32_bf16 v[88:91], a[136:139], v[24:27], v[88:91]
    v_mfma_f32_16x16x32_bf16 v[92:95], a[200:203], v[24:27], v[92:95]
    v_mfma_f32_16x16x32_bf16 v[96:99], a[8:11], v[28:31], v[96:99]
    v_mfma_f32_16x16x32_bf16 v[100:103], a[72:75], v[28:31], v[100:103]
    v_mfma_f32_16x16x32_bf16 v[104:107], a[136:139], v[28:31], v[104:107]
    v_mfma_f32_16x16x32_bf16 v[108:111], a[200:203], v[28:31], v[108:111]
    ds_read_b128 v[16:19], v132 offset:256
    ds_read_b128 v[20:23], v132 offset:4352
    ds_read_b128 v[24:27], v132 offset:33024
    ds_read_b128 v[28:31], v132 offset:37120
    s_waitcnt lgkmcnt(4)
    v_mfma_f32_16x16x32_bf16 v[48:51], a[12:15], v[32:35], v[48:51]
    v_mfma_f32_16x16x32_bf16 v[52:55], a[76:79], v[32:35], v[52:55]
    v_mfma_f32_16x16x32_bf16 v[56:59], a[140:143], v[32:35], v[56:59]
    v_mfma_f32_16x16x32_bf16 v[60:63], a[204:207], v[32:35], v[60:63]
    v_xor_b32 v7, 48, v6
    s_add_u32 m0, s81, 3072
    s_add_u32 s79, s70, 3072
    buffer_load_dwordx4 v7, s[60:63], s79 offen sc1 lds
    v_mfma_f32_16x16x32_bf16 v[64:67], a[12:15], v[36:39], v[64:67]
    v_mfma_f32_16x16x32_bf16 v[68:71], a[76:79], v[36:39], v[68:71]
    v_mfma_f32_16x16x32_bf16 v[72:75], a[140:143], v[36:39], v[72:75]
    v_mfma_f32_16x16x32_bf16 v[76:79], a[204:207], v[36:39], v[76:79]
    v_mfma_f32_16x16x32_bf16 v[80:83], a[12:15], v[40:43], v[80:83]
    v_mfma_f32_16x16x32_bf16 v[84:87], a[76:79], v[40:43], v[84:87]
    v_mfma_f32_16x16x32_bf16 v[88:91], a[140:143], v[40:43], v[88:91]
    v_mfma_f32_16x16x32_bf16 v[92:95], a[204:207], v[40:43], v[92:95]
    v_mfma_f32_16x16x32_bf16 v[96:99], a[12:15], v[44:47], v[96:99]
    v_mfma_f32_16x16x32_bf16 v[100:103], a[76:79], v[44:47], v[100:103]
    v_mfma_f32_16x16x32_bf16 v[104:107], a[140:143], v[44:47], v[104:107]
    v_mfma_f32_16x16x32_bf16 v[108:111], a[204:207], v[44:47], v[108:111]
    ds_read_b128 v[32:35], v133 offset:256
    ds_read_b128 v[36:39], v133 offset:4352
    ds_read_b128 v[40:43], v133 offset:33024
    ds_read_b128 v[44:47], v133 offset:37120
    s_waitcnt lgkmcnt(4)
    v_mfma_f32_16x16x32_bf16 v[48:51], a[16:19], v[16:19], v[48:51]
    v_mfma_f32_16x16x32_bf16 v[52:55], a[80:83], v[16:19], v[52:55]
    v_mfma_f32_16x16x32_bf16 v[56:59], a[144:147], v[16:19], v[56:59]
    v_mfma_f32_16x16x32_bf16 v[60:63], a[208:211], v[16:19], v[60:63]
    v_xor_b32 v7, 64, v6
    s_add_u32 m0, s81, 8192
    s_add_u32 s79, s70, 8192
    buffer_load_dwordx4 v7, s[60:63], s79 offen sc1 lds
    v_mfma_f32_16x16x32_bf16 v[64:67], a[16:19], v[20:23], v[64:67]
    v_mfma_f32_16x16x32_bf16 v[68:71], a[80:83], v[20:23], v[68:71]
    v_mfma_f32_16x16x32_bf16 v[72:75], a[144:147], v[20:23], v[72:75]
    v_mfma_f32_16x16x32_bf16 v[76:79], a[208:211], v[20:23], v[76:79]
    v_mfma_f32_16x16x32_bf16 v[80:83], a[16:19], v[24:27], v[80:83]
    v_mfma_f32_16x16x32_bf16 v[84:87], a[80:83], v[24:27], v[84:87]
    v_mfma_f32_16x16x32_bf16 v[88:91], a[144:147], v[24:27], v[88:91]
    v_mfma_f32_16x16x32_bf16 v[92:95], a[208:211], v[24:27], v[92:95]
    v_mfma_f32_16x16x32_bf16 v[96:99], a[16:19], v[28:31], v[96:99]
    v_mfma_f32_16x16x32_bf16 v[100:103], a[80:83], v[28:31], v[100:103]
    v_mfma_f32_16x16x32_bf16 v[104:107], a[144:147], v[28:31], v[104:107]
    v_mfma_f32_16x16x32_bf16 v[108:111], a[208:211], v[28:31], v[108:111]
    ds_read_b128 v[16:19], v134 offset:256
    ds_read_b128 v[20:23], v134 offset:4352
    ds_read_b128 v[24:27], v134 offset:33024
    ds_read_b128 v[28:31], v134 offset:37120
    s_waitcnt lgkmcnt(4)
    v_mfma_f32_16x16x32_bf16 v[48:51], a[20:23], v[32:35], v[48:51]
    v_mfma_f32_16x16x32_bf16 v[52:55], a[84:87], v[32:35], v[52:55]
    v_mfma_f32_16x16x32_bf16 v[56:59], a[148:151], v[32:35], v[56:59]
    v_mfma_f32_16x16x32_bf16 v[60:63], a[212:215], v[32:35], v[60:63]
    v_xor_b32 v7, 80, v6
    s_add_u32 m0, s81, 9216
    s_add_u32 s79, s70, 9216
    buffer_load_dwordx4 v7, s[60:63], s79 offen sc1 lds
    v_mfma_f32_16x16x32_bf16 v[64:67], a[20:23], v[36:39], v[64:67]
    v_mfma_f32_16x16x32_bf16 v[68:71], a[84:87], v[36:39], v[68:71]
    v_mfma_f32_16x16x32_bf16 v[72:75], a[148:151], v[36:39], v[72:75]
    v_mfma_f32_16x16x32_bf16 v[76:79], a[212:215], v[36:39], v[76:79]
    v_mfma_f32_16x16x32_bf16 v[80:83], a[20:23], v[40:43], v[80:83]
    v_mfma_f32_16x16x32_bf16 v[84:87], a[84:87], v[40:43], v[84:87]
    v_mfma_f32_16x16x32_bf16 v[88:91], a[148:151], v[40:43], v[88:91]
    v_mfma_f32_16x16x32_bf16 v[92:95], a[212:215], v[40:43], v[92:95]
    v_mfma_f32_16x16x32_bf16 v[96:99], a[20:23], v[44:47], v[96:99]
    v_mfma_f32_16x16x32_bf16 v[100:103], a[84:87], v[44:47], v[100:103]
    v_mfma_f32_16x16x32_bf16 v[104:107], a[148:151], v[44:47], v[104:107]
    v_mfma_f32_16x16x32_bf16 v[108:111], a[212:215], v[44:47], v[108:111]
    ds_read_b128 v[32:35], v135 offset:256
    ds_read_b128 v[36:39], v135 offset:4352
    ds_read_b128 v[40:43], v135 offset:33024
    ds_read_b128 v[44:47], v135 offset:37120
    s_waitcnt lgkmcnt(4)
    v_mfma_f32_16x16x32_bf16 v[48:51], a[24:27], v[16:19], v[48:51]
    v_mfma_f32_16x16x32_bf16 v[52:55], a[88:91], v[16:19], v[52:55]
    v_mfma_f32_16x16x32_bf16 v[56:59], a[152:155], v[16:19], v[56:59]
    v_mfma_f32_16x16x32_bf16 v[60:63], a[216:219], v[16:19], v[60:63]
    v_xor_b32 v7, 96, v6
    s_add_u32 m0, s81, 10240
    s_add_u32 s79, s70, 10240
    buffer_load_dwordx4 v7, s[60:63], s79 offen sc1 lds
    v_mfma_f32_16x16x32_bf16 v[64:67], a[24:27], v[20:23], v[64:67]
    v_mfma_f32_16x16x32_bf16 v[68:71], a[88:91], v[20:23], v[68:71]
    v_mfma_f32_16x16x32_bf16 v[72:75], a[152:155], v[20:23], v[72:75]
    v_mfma_f32_16x16x32_bf16 v[76:79], a[216:219], v[20:23], v[76:79]
    v_mfma_f32_16x16x32_bf16 v[80:83], a[24:27], v[24:27], v[80:83]
    v_mfma_f32_16x16x32_bf16 v[84:87], a[88:91], v[24:27], v[84:87]
    v_mfma_f32_16x16x32_bf16 v[88:91], a[152:155], v[24:27], v[88:91]
    v_mfma_f32_16x16x32_bf16 v[92:95], a[216:219], v[24:27], v[92:95]
    v_mfma_f32_16x16x32_bf16 v[96:99], a[24:27], v[28:31], v[96:99]
    v_mfma_f32_16x16x32_bf16 v[100:103], a[88:91], v[28:31], v[100:103]
    v_mfma_f32_16x16x32_bf16 v[104:107], a[152:155], v[28:31], v[104:107]
    v_mfma_f32_16x16x32_bf16 v[108:111], a[216:219], v[28:31], v[108:111]
    ds_read_b128 v[16:19], v132 offset:512
    ds_read_b128 v[20:23], v132 offset:4608
    ds_read_b128 v[24:27], v132 offset:33280
    ds_read_b128 v[28:31], v132 offset:37376
    s_waitcnt lgkmcnt(4)
    v_mfma_f32_16x16x32_bf16 v[48:51], a[28:31], v[32:35], v[48:51]
    v_mfma_f32_16x16x32_bf16 v[52:55], a[92:95], v[32:35], v[52:55]
    v_mfma_f32_16x16x32_bf16 v[56:59], a[156:159], v[32:35], v[56:59]
    v_mfma_f32_16x16x32_bf16 v[60:63], a[220:223], v[32:35], v[60:63]
    v_xor_b32 v7, 112, v6
    s_add_u32 m0, s81, 11264
    s_add_u32 s79, s70, 11264
    buffer_load_dwordx4 v7, s[60:63], s79 offen sc1 lds
    v_mfma_f32_16x16x32_bf16 v[64:67], a[28:31], v[36:39], v[64:67]
    v_mfma_f32_16x16x32_bf16 v[68:71], a[92:95], v[36:39], v[68:71]
    v_mfma_f32_16x16x32_bf16 v[72:75], a[156:159], v[36:39], v[72:75]
    v_mfma_f32_16x16x32_bf16 v[76:79], a[220:223], v[36:39], v[76:79]
    v_mfma_f32_16x16x32_bf16 v[80:83], a[28:31], v[40:43], v[80:83]
    v_mfma_f32_16x16x32_bf16 v[84:87], a[92:95], v[40:43], v[84:87]
    v_mfma_f32_16x16x32_bf16 v[88:91], a[156:159], v[40:43], v[88:91]
    v_mfma_f32_16x16x32_bf16 v[92:95], a[220:223], v[40:43], v[92:95]
    v_mfma_f32_16x16x32_bf16 v[96:99], a[28:31], v[44:47], v[96:99]
    v_mfma_f32_16x16x32_bf16 v[100:103], a[92:95], v[44:47], v[100:103]
    v_mfma_f32_16x16x32_bf16 v[104:107], a[156:159], v[44:47], v[104:107]
    v_mfma_f32_16x16x32_bf16 v[108:111], a[220:223], v[44:47], v[108:111]
    ds_read_b128 v[32:35], v133 offset:512
    ds_read_b128 v[36:39], v133 offset:4608
    ds_read_b128 v[40:43], v133 offset:33280
    ds_read_b128 v[44:47], v133 offset:37376
    s_waitcnt lgkmcnt(4)
    v_mfma_f32_16x16x32_bf16 v[48:51], a[32:35], v[16:19], v[48:51]
    v_mfma_f32_16x16x32_bf16 v[52:55], a[96:99], v[16:19], v[52:55]
    v_mfma_f32_16x16x32_bf16 v[56:59], a[160:163], v[16:19], v[56:59]
    v_mfma_f32_16x16x32_bf16 v[60:63], a[224:227], v[16:19], v[60:63]
    v_xor_b32 v7, 128, v6
    s_add_u32 m0, s81, 16384
    s_add_u32 s79, s70, 16384
    buffer_load_dwordx4 v7, s[60:63], s79 offen sc1 lds
    v_mfma_f32_16x16x32_bf16 v[64:67], a[32:35], v[20:23], v[64:67]
    v_mfma_f32_16x16x32_bf16 v[68:71], a[96:99], v[20:23], v[68:71]
    v_mfma_f32_16x16x32_bf16 v[72:75], a[160:163], v[20:23], v[72:75]
    v_mfma_f32_16x16x32_bf16 v[76:79], a[224:227], v[20:23], v[76:79]
    v_mfma_f32_16x16x32_bf16 v[80:83], a[32:35], v[24:27], v[80:83]
    v_mfma_f32_16x16x32_bf16 v[84:87], a[96:99], v[24:27], v[84:87]
    v_mfma_f32_16x16x32_bf16 v[88:91], a[160:163], v[24:27], v[88:91]
    v_mfma_f32_16x16x32_bf16 v[92:95], a[224:227], v[24:27], v[92:95]
    v_mfma_f32_16x16x32_bf16 v[96:99], a[32:35], v[28:31], v[96:99]
    v_mfma_f32_16x16x32_bf16 v[100:103], a[96:99], v[28:31], v[100:103]
    v_mfma_f32_16x16x32_bf16 v[104:107], a[160:163], v[28:31], v[104:107]
    v_mfma_f32_16x16x32_bf16 v[108:111], a[224:227], v[28:31], v[108:111]
    ds_read_b128 v[16:19], v134 offset:512
    ds_read_b128 v[20:23], v134 offset:4608
    ds_read_b128 v[24:27], v134 offset:33280
    ds_read_b128 v[28:31], v134 offset:37376
    s_waitcnt lgkmcnt(4)
    v_mfma_f32_16x16x32_bf16 v[48:51], a[36:39], v[32:35], v[48:51]
    v_mfma_f32_16x16x32_bf16 v[52:55], a[100:103], v[32:35], v[52:55]
    v_mfma_f32_16x16x32_bf16 v[56:59], a[164:167], v[32:35], v[56:59]
    v_mfma_f32_16x16x32_bf16 v[60:63], a[228:231], v[32:35], v[60:63]
    v_xor_b32 v7, 144, v6
    s_add_u32 m0, s81, 17408
    s_add_u32 s79, s70, 17408
    buffer_load_dwordx4 v7, s[60:63], s79 offen sc1 lds
    v_mfma_f32_16x16x32_bf16 v[64:67], a[36:39], v[36:39], v[64:67]
    v_mfma_f32_16x16x32_bf16 v[68:71], a[100:103], v[36:39], v[68:71]
    v_mfma_f32_16x16x32_bf16 v[72:75], a[164:167], v[36:39], v[72:75]
    v_mfma_f32_16x16x32_bf16 v[76:79], a[228:231], v[36:39], v[76:79]
    v_mfma_f32_16x16x32_bf16 v[80:83], a[36:39], v[40:43], v[80:83]
    v_mfma_f32_16x16x32_bf16 v[84:87], a[100:103], v[40:43], v[84:87]
    v_mfma_f32_16x16x32_bf16 v[88:91], a[164:167], v[40:43], v[88:91]
    v_mfma_f32_16x16x32_bf16 v[92:95], a[228:231], v[40:43], v[92:95]
    v_mfma_f32_16x16x32_bf16 v[96:99], a[36:39], v[44:47], v[96:99]
    v_mfma_f32_16x16x32_bf16 v[100:103], a[100:103], v[44:47], v[100:103]
    v_mfma_f32_16x16x32_bf16 v[104:107], a[164:167], v[44:47], v[104:107]
    v_mfma_f32_16x16x32_bf16 v[108:111], a[228:231], v[44:47], v[108:111]
    ds_read_b128 v[32:35], v135 offset:512
    ds_read_b128 v[36:39], v135 offset:4608
    ds_read_b128 v[40:43], v135 offset:33280
    ds_read_b128 v[44:47], v135 offset:37376
    s_waitcnt lgkmcnt(4)
    v_mfma_f32_16x16x32_bf16 v[48:51], a[40:43], v[16:19], v[48:51]
    v_mfma_f32_16x16x32_bf16 v[52:55], a[104:107], v[16:19], v[52:55]
    v_mfma_f32_16x16x32_bf16 v[56:59], a[168:171], v[16:19], v[56:59]
    v_mfma_f32_16x16x32_bf16 v[60:63], a[232:235], v[16:19], v[60:63]
    v_xor_b32 v7, 160, v6
    s_add_u32 m0, s81, 18432
    s_add_u32 s79, s70, 18432
    buffer_load_dwordx4 v7, s[60:63], s79 offen sc1 lds
    v_mfma_f32_16x16x32_bf16 v[64:67], a[40:43], v[20:23], v[64:67]
    v_mfma_f32_16x16x32_bf16 v[68:71], a[104:107], v[20:23], v[68:71]
    v_mfma_f32_16x16x32_bf16 v[72:75], a[168:171], v[20:23], v[72:75]
    v_mfma_f32_16x16x32_bf16 v[76:79], a[232:235], v[20:23], v[76:79]
    v_mfma_f32_16x16x32_bf16 v[80:83], a[40:43], v[24:27], v[80:83]
    v_mfma_f32_16x16x32_bf16 v[84:87], a[104:107], v[24:27], v[84:87]
    v_mfma_f32_16x16x32_bf16 v[88:91], a[168:171], v[24:27], v[88:91]
    v_mfma_f32_16x16x32_bf16 v[92:95], a[232:235], v[24:27], v[92:95]
    v_mfma_f32_16x16x32_bf16 v[96:99], a[40:43], v[28:31], v[96:99]
    v_mfma_f32_16x16x32_bf16 v[100:103], a[104:107], v[28:31], v[100:103]
    v_mfma_f32_16x16x32_bf16 v[104:107], a[168:171], v[28:31], v[104:107]
    v_mfma_f32_16x16x32_bf16 v[108:111], a[232:235], v[28:31], v[108:111]
    ds_read_b128 v[16:19], v132 offset:768
    ds_read_b128 v[20:23], v132 offset:4864
    ds_read_b128 v[24:27], v132 offset:33536
    ds_read_b128 v[28:31], v132 offset:37632
    s_waitcnt lgkmcnt(4)
    v_mfma_f32_16x16x32_bf16 v[48:51], a[44:47], v[32:35], v[48:51]
    v_mfma_f32_16x16x32_bf16 v[52:55], a[108:111], v[32:35], v[52:55]
    v_mfma_f32_16x16x32_bf16 v[56:59], a[172:175], v[32:35], v[56:59]
    v_mfma_f32_16x16x32_bf16 v[60:63], a[236:239], v[32:35], v[60:63]
    v_xor_b32 v7, 176, v6
    s_add_u32 m0, s81, 19456
    s_add_u32 s79, s70, 19456
    buffer_load_dwordx4 v7, s[60:63], s79 offen sc1 lds
    v_mfma_f32_16x16x32_bf16 v[64:67], a[44:47], v[36:39], v[64:67]
    v_mfma_f32_16x16x32_bf16 v[68:71], a[108:111], v[36:39], v[68:71]
    v_mfma_f32_16x16x32_bf16 v[72:75], a[172:175], v[36:39], v[72:75]
    v_mfma_f32_16x16x32_bf16 v[76:79], a[236:239], v[36:39], v[76:79]
    v_mfma_f32_16x16x32_bf16 v[80:83], a[44:47], v[40:43], v[80:83]
    v_mfma_f32_16x16x32_bf16 v[84:87], a[108:111], v[40:43], v[84:87]
    v_mfma_f32_16x16x32_bf16 v[88:91], a[172:175], v[40:43], v[88:91]
    v_mfma_f32_16x16x32_bf16 v[92:95], a[236:239], v[40:43], v[92:95]
    v_mfma_f32_16x16x32_bf16 v[96:99], a[44:47], v[44:47], v[96:99]
    v_mfma_f32_16x16x32_bf16 v[100:103], a[108:111], v[44:47], v[100:103]
    v_mfma_f32_16x16x32_bf16 v[104:107], a[172:175], v[44:47], v[104:107]
    v_mfma_f32_16x16x32_bf16 v[108:111], a[236:239], v[44:47], v[108:111]
    ds_read_b128 v[32:35], v133 offset:768
    ds_read_b128 v[36:39], v133 offset:4864
    ds_read_b128 v[40:43], v133 offset:33536
    ds_read_b128 v[44:47], v133 offset:37632
    s_waitcnt lgkmcnt(4)
    v_mfma_f32_16x16x32_bf16 v[48:51], a[48:51], v[16:19], v[48:51]
    v_mfma_f32_16x16x32_bf16 v[52:55], a[112:115], v[16:19], v[52:55]
    v_mfma_f32_16x16x32_bf16 v[56:59], a[176:179], v[16:19], v[56:59]
    v_mfma_f32_16x16x32_bf16 v[60:63], a[240:243], v[16:19], v[60:63]
    v_xor_b32 v7, 192, v6
    s_add_u32 m0, s81, 24576
    s_add_u32 s79, s70, 24576
    buffer_load_dwordx4 v7, s[60:63], s79 offen sc1 lds
    v_mfma_f32_16x16x32_bf16 v[64:67], a[48:51], v[20:23], v[64:67]
    v_mfma_f32_16x16x32_bf16 v[68:71], a[112:115], v[20:23], v[68:71]
    v_mfma_f32_16x16x32_bf16 v[72:75], a[176:179], v[20:23], v[72:75]
    v_mfma_f32_16x16x32_bf16 v[76:79], a[240:243], v[20:23], v[76:79]
    v_mfma_f32_16x16x32_bf16 v[80:83], a[48:51], v[24:27], v[80:83]
    v_mfma_f32_16x16x32_bf16 v[84:87], a[112:115], v[24:27], v[84:87]
    v_mfma_f32_16x16x32_bf16 v[88:91], a[176:179], v[24:27], v[88:91]
    v_mfma_f32_16x16x32_bf16 v[92:95], a[240:243], v[24:27], v[92:95]
    v_mfma_f32_16x16x32_bf16 v[96:99], a[48:51], v[28:31], v[96:99]
    v_mfma_f32_16x16x32_bf16 v[100:103], a[112:115], v[28:31], v[100:103]
    v_mfma_f32_16x16x32_bf16 v[104:107], a[176:179], v[28:31], v[104:107]
    v_mfma_f32_16x16x32_bf16 v[108:111], a[240:243], v[28:31], v[108:111]
    ds_read_b128 v[16:19], v134 offset:768
    ds_read_b128 v[20:23], v134 offset:4864
    ds_read_b128 v[24:27], v134 offset:33536
    ds_read_b128 v[28:31], v134 offset:37632
    s_waitcnt lgkmcnt(4)
    v_mfma_f32_16x16x32_bf16 v[48:51], a[52:55], v[32:35], v[48:51]
    v_mfma_f32_16x16x32_bf16 v[52:55], a[116:119], v[32:35], v[52:55]
    v_mfma_f32_16x16x32_bf16 v[56:59], a[180:183], v[32:35], v[56:59]
    v_mfma_f32_16x16x32_bf16 v[60:63], a[244:247], v[32:35], v[60:63]
    v_xor_b32 v7, 208, v6
    s_add_u32 m0, s81, 25600
    s_add_u32 s79, s70, 25600
    buffer_load_dwordx4 v7, s[60:63], s79 offen sc1 lds
    v_mfma_f32_16x16x32_bf16 v[64:67], a[52:55], v[36:39], v[64:67]
    v_mfma_f32_16x16x32_bf16 v[68:71], a[116:119], v[36:39], v[68:71]
    v_mfma_f32_16x16x32_bf16 v[72:75], a[180:183], v[36:39], v[72:75]
    v_mfma_f32_16x16x32_bf16 v[76:79], a[244:247], v[36:39], v[76:79]
    v_mfma_f32_16x16x32_bf16 v[80:83], a[52:55], v[40:43], v[80:83]
    v_mfma_f32_16x16x32_bf16 v[84:87], a[116:119], v[40:43], v[84:87]
    v_mfma_f32_16x16x32_bf16 v[88:91], a[180:183], v[40:43], v[88:91]
    v_mfma_f32_16x16x32_bf16 v[92:95], a[244:247], v[40:43], v[92:95]
    v_mfma_f32_16x16x32_bf16 v[96:99], a[52:55], v[44:47], v[96:99]
    v_mfma_f32_16x16x32_bf16 v[100:103], a[116:119], v[44:47], v[100:103]
    v_mfma_f32_16x16x32_bf16 v[104:107], a[180:183], v[44:47], v[104:107]
    v_mfma_f32_16x16x32_bf16 v[108:111], a[244:247], v[44:47], v[108:111]
    ds_read_b128 v[32:35], v135 offset:768
    ds_read_b128 v[36:39], v135 offset:4864
    ds_read_b128 v[40:43], v135 offset:33536
    ds_read_b128 v[44:47], v135 offset:37632
    s_waitcnt lgkmcnt(4)
    v_mfma_f32_16x16x32_bf16 v[48:51], a[56:59], v[16:19], v[48:51]
    v_mfma_f32_16x16x32_bf16 v[52:55], a[120:123], v[16:19], v[52:55]
    v_mfma_f32_16x16x32_bf16 v[56:59], a[184:187], v[16:19], v[56:59]
    v_mfma_f32_16x16x32_bf16 v[60:63], a[248:251], v[16:19], v[60:63]
    v_xor_b32 v7, 224, v6
    s_add_u32 m0, s81, 26624
    s_add_u32 s79, s70, 26624
    buffer_load_dwordx4 v7, s[60:63], s79 offen sc1 lds
    v_mfma_f32_16x16x32_bf16 v[64:67], a[56:59], v[20:23], v[64:67]
    v_mfma_f32_16x16x32_bf16 v[68:71], a[120:123], v[20:23], v[68:71]
    v_mfma_f32_16x16x32_bf16 v[72:75], a[184:187], v[20:23], v[72:75]
    v_mfma_f32_16x16x32_bf16 v[76:79], a[248:251], v[20:23], v[76:79]
    v_mfma_f32_16x16x32_bf16 v[80:83], a[56:59], v[24:27], v[80:83]
    v_mfma_f32_16x16x32_bf16 v[84:87], a[120:123], v[24:27], v[84:87]
    v_mfma_f32_16x16x32_bf16 v[88:91], a[184:187], v[24:27], v[88:91]
    v_mfma_f32_16x16x32_bf16 v[92:95], a[248:251], v[24:27], v[92:95]
    v_mfma_f32_16x16x32_bf16 v[96:99], a[56:59], v[28:31], v[96:99]
    v_mfma_f32_16x16x32_bf16 v[100:103], a[120:123], v[28:31], v[100:103]
    v_mfma_f32_16x16x32_bf16 v[104:107], a[184:187], v[28:31], v[104:107]
    v_mfma_f32_16x16x32_bf16 v[108:111], a[248:251], v[28:31], v[108:111]
    s_waitcnt lgkmcnt(0)
    v_mfma_f32_16x16x32_bf16 v[48:51], a[60:63], v[32:35], v[48:51]
    v_mfma_f32_16x16x32_bf16 v[52:55], a[124:127], v[32:35], v[52:55]
    v_mfma_f32_16x16x32_bf16 v[56:59], a[188:191], v[32:35], v[56:59]
    v_mfma_f32_16x16x32_bf16 v[60:63], a[252:255], v[32:35], v[60:63]
    v_xor_b32 v7, 240, v6
    s_add_u32 m0, s81, 27648
    s_add_u32 s79, s70, 27648
    buffer_load_dwordx4 v7, s[60:63], s79 offen sc1 lds
    v_mfma_f32_16x16x32_bf16 v[64:67], a[60:63], v[36:39], v[64:67]
    v_mfma_f32_16x16x32_bf16 v[68:71], a[124:127], v[36:39], v[68:71]
    v_mfma_f32_16x16x32_bf16 v[72:75], a[188:191], v[36:39], v[72:75]
    v_mfma_f32_16x16x32_bf16 v[76:79], a[252:255], v[36:39], v[76:79]
    v_mfma_f32_16x16x32_bf16 v[80:83], a[60:63], v[40:43], v[80:83]
    v_mfma_f32_16x16x32_bf16 v[84:87], a[124:127], v[40:43], v[84:87]
    v_mfma_f32_16x16x32_bf16 v[88:91], a[188:191], v[40:43], v[88:91]
    v_mfma_f32_16x16x32_bf16 v[92:95], a[252:255], v[40:43], v[92:95]
    v_mfma_f32_16x16x32_bf16 v[96:99], a[60:63], v[44:47], v[96:99]
    v_mfma_f32_16x16x32_bf16 v[100:103], a[124:127], v[44:47], v[100:103]
    v_mfma_f32_16x16x32_bf16 v[104:107], a[188:191], v[44:47], v[104:107]
    v_mfma_f32_16x16x32_bf16 v[108:111], a[252:255], v[44:47], v[108:111]
    s_add_u32 s70, s70, 65536
    s_add_u32 s77, s73, 0
    v_cvt_pk_bf16_f32 v112, v48, v49
    v_cvt_pk_bf16_f32 v113, v50, v51
    v_cvt_pk_bf16_f32 v114, v52, v53
    v_cvt_pk_bf16_f32 v115, v54, v55
    buffer_store_dwordx4 v[112:115], v1, s[52:55], s77 offen sc1
    s_add_u32 s77, s73, 0
    s_add_u32 s77, s77, s75
    v_cvt_pk_bf16_f32 v116, v64, v65
    v_cvt_pk_bf16_f32 v117, v66, v67
    v_cvt_pk_bf16_f32 v118, v68, v69
    v_cvt_pk_bf16_f32 v119, v70, v71
    buffer_store_dwordx4 v[116:119], v1, s[52:55], s77 offen sc1
    s_add_u32 s77, s73, 131072
    v_cvt_pk_bf16_f32 v112, v56, v57
    v_cvt_pk_bf16_f32 v113, v58, v59
    v_cvt_pk_bf16_f32 v114, v60, v61
    v_cvt_pk_bf16_f32 v115, v62, v63
    buffer_store_dwordx4 v[112:115], v1, s[52:55], s77 offen sc1
    s_add_u32 s77, s73, 131072
    s_add_u32 s77, s77, s75
    v_cvt_pk_bf16_f32 v116, v72, v73
    v_cvt_pk_bf16_f32 v117, v74, v75
    v_cvt_pk_bf16_f32 v118, v76, v77
    v_cvt_pk_bf16_f32 v119, v78, v79
    buffer_store_dwordx4 v[116:119], v1, s[52:55], s77 offen sc1
    s_add_u32 s77, s73, 1024
    v_cvt_pk_bf16_f32 v112, v80, v81
    v_cvt_pk_bf16_f32 v113, v82, v83
    v_cvt_pk_bf16_f32 v114, v84, v85
    v_cvt_pk_bf16_f32 v115, v86, v87
    buffer_store_dwordx4 v[112:115], v1, s[52:55], s77 offen sc1
    s_add_u32 s77, s73, 1024
    s_add_u32 s77, s77, s75
    v_cvt_pk_bf16_f32 v116, v96, v97
    v_cvt_pk_bf16_f32 v117, v98, v99
    v_cvt_pk_bf16_f32 v118, v100, v101
    v_cvt_pk_bf16_f32 v119, v102, v103
    buffer_store_dwordx4 v[116:119], v1, s[52:55], s77 offen sc1
    s_add_u32 s77, s73, 132096
    v_cvt_pk_bf16_f32 v112, v88, v89
    v_cvt_pk_bf16_f32 v113, v90, v91
    v_cvt_pk_bf16_f32 v114, v92, v93
    v_cvt_pk_bf16_f32 v115, v94, v95
    buffer_store_dwordx4 v[112:115], v1, s[52:55], s77 offen sc1
    s_add_u32 s77, s73, 132096
    s_add_u32 s77, s77, s75
    v_cvt_pk_bf16_f32 v116, v104, v105
    v_cvt_pk_bf16_f32 v117, v106, v107
    v_cvt_pk_bf16_f32 v118, v108, v109
    v_cvt_pk_bf16_f32 v119, v110, v111
    buffer_store_dwordx4 v[116:119], v1, s[52:55], s77 offen sc1
    s_add_u32 s73, s73, 2048
    s_add_u32 s83, s83, 1
    s_cmp_lt_u32 s83, s72
    s_cbranch_scc1 L_wsg2t_158
    s_waitcnt vmcnt(0)
    s_barrier
    s_cmp_lg_u32 s56, 0
    s_cbranch_scc1 L_wsg_160
    s_mov_b32 s80, 20
    v_mov_b32 v120, 1
    v_mov_b32 v121, s80
    s_mov_b64 exec, 1
    buffer_atomic_add v120, v121, s[48:51], 0 offen
    s_mov_b64 exec, -1
L_wsg_160:
    s_branch L_next
L_g2_v:
    v_and_b32 v13, 7, v11
    v_and_b32 v14, 1, v12
    v_lshl_add_u32 v13, v14, 4, v13
    v_lshrrev_b32 v14, 1, v12
    v_lshl_add_u32 v13, v14, 5, v13
    v_lshlrev_b32 v13, 4, v13
    v_lshrrev_b32 v14, 3, v11
    v_lshl_add_u32 v1, v14, 16, v13
    s_add_u32 s73, s73, 88080384
    v_and_b32 v10, 63, v0
    s_lshr_b32 s77, s56, 1
    s_lshl_b32 s77, s77, 15
    s_and_b32 s78, s56, 1
    s_lshl_b32 s78, s78, 12
    s_add_u32 s81, s77, s78
    v_lshlrev_b32 v6, 4, v10
    v_add_u32 v6, s81, v6
    v_and_b32 v11, 15, v10
    v_lshrrev_b32 v12, 4, v10
    v_lshrrev_b32 v13, 2, v11
    v_and_b32 v14, 3, v11
    v_lshl_add_u32 v15, v13, 3, v14
    v_lshlrev_b32 v15, 10, v15
    v_add_u32 v9, 0, v12
    v_xor_b32 v9, v9, v11
    v_lshl_add_u32 v128, v9, 4, v15
    v_add_u32 v132, 65536, v128
    v_add_u32 v9, 4, v12
    v_xor_b32 v9, v9, v11
    v_lshl_add_u32 v129, v9, 4, v15
    v_add_u32 v133, 65536, v129
    v_add_u32 v9, 8, v12
    v_xor_b32 v9, v9, v11
    v_lshl_add_u32 v130, v9, 4, v15
    v_add_u32 v134, 65536, v130
    v_add_u32 v9, 12, v12
    v_xor_b32 v9, v9, v11
    v_lshl_add_u32 v131, v9, 4, v15
    v_add_u32 v135, 65536, v131
    v_xor_b32 v7, 0, v6
    s_add_u32 m0, s81, 0
    s_add_u32 s79, s70, 0
    buffer_load_dwordx4 v7, s[60:63], s79 offen sc1 lds
    v_xor_b32 v7, 16, v6
    s_add_u32 m0, s81, 1024
    s_add_u32 s79, s70, 1024
    buffer_load_dwordx4 v7, s[60:63], s79 offen sc1 lds
    v_xor_b32 v7, 32, v6
    s_add_u32 m0, s81, 2048
    s_add_u32 s79, s70, 2048
    buffer_load_dwordx4 v7, s[60:63], s79 offen sc1 lds
    v_xor_b32 v7, 48, v6
    s_add_u32 m0, s81, 3072
    s_add_u32 s79, s70, 3072
    buffer_load_dwordx4 v7, s[60:63], s79 offen sc1 lds
    v_xor_b32 v7, 64, v6
    s_add_u32 m0, s81, 8192
    s_add_u32 s79, s70, 8192
    buffer_load_dwordx4 v7, s[60:63], s79 offen sc1 lds
    v_xor_b32 v7, 80, v6
    s_add_u32 m0, s81, 9216
    s_add_u32 s79, s70, 9216
    buffer_load_dwordx4 v7, s[60:63], s79 offen sc1 lds
    v_xor_b32 v7, 96, v6
    s_add_u32 m0, s81, 10240
    s_add_u32 s79, s70, 10240
    buffer_load_dwordx4 v7, s[60:63], s79 offen sc1 lds
    v_xor_b32 v7, 112, v6
    s_add_u32 m0, s81, 11264
    s_add_u32 s79, s70, 11264
    buffer_load_dwordx4 v7, s[60:63], s79 offen sc1 lds
    v_xor_b32 v7, 128, v6
    s_add_u32 m0, s81, 16384
    s_add_u32 s79, s70, 16384
    buffer_load_dwordx4 v7, s[60:63], s79 offen sc1 lds
    v_xor_b32 v7, 144, v6
    s_add_u32 m0, s81, 17408
    s_add_u32 s79, s70, 17408
    buffer_load_dwordx4 v7, s[60:63], s79 offen sc1 lds
    v_xor_b32 v7, 160, v6
    s_add_u32 m0, s81, 18432
    s_add_u32 s79, s70, 18432
    buffer_load_dwordx4 v7, s[60:63], s79 offen sc1 lds
    v_xor_b32 v7, 176, v6
    s_add_u32 m0, s81, 19456
    s_add_u32 s79, s70, 19456
    buffer_load_dwordx4 v7, s[60:63], s79 offen sc1 lds
    v_xor_b32 v7, 192, v6
    s_add_u32 m0, s81, 24576
    s_add_u32 s79, s70, 24576
    buffer_load_dwordx4 v7, s[60:63], s79 offen sc1 lds
    v_xor_b32 v7, 208, v6
    s_add_u32 m0, s81, 25600
    s_add_u32 s79, s70, 25600
    buffer_load_dwordx4 v7, s[60:63], s79 offen sc1 lds
    v_xor_b32 v7, 224, v6
    s_add_u32 m0, s81, 26624
    s_add_u32 s79, s70, 26624
    buffer_load_dwordx4 v7, s[60:63], s79 offen sc1 lds
    v_xor_b32 v7, 240, v6
    s_add_u32 m0, s81, 27648
    s_add_u32 s79, s70, 27648
    buffer_load_dwordx4 v7, s[60:63], s79 offen sc1 lds
    s_add_u32 s70, s70, 65536
    s_mov_b32 s83, 0
    s_waitcnt vmcnt(0)
L_wsg2n_161:
    s_waitcnt vmcnt(8)
    s_barrier
    ds_read_b128 v[16:19], v128 offset:0
    ds_read_b128 v[20:23], v128 offset:4096
    ds_read_b128 v[24:27], v128 offset:32768
    ds_read_b128 v[28:31], v128 offset:36864
    ds_read_b128 v[32:35], v129 offset:0
    ds_read_b128 v[36:39], v129 offset:4096
    ds_read_b128 v[40:43], v129 offset:32768
    ds_read_b128 v[44:47], v129 offset:36864
    s_waitcnt lgkmcnt(4)
    v_mfma_f32_16x16x32_bf16 v[48:51], v[16:19], a[0:3], 0
    v_mfma_f32_16x16x32_bf16 v[52:55], v[16:19], a[64:67], 0
    v_mfma_f32_16x16x32_bf16 v[56:59], v[16:19], a[128:131], 0
    v_mfma_f32_16x16x32_bf16 v[60:63], v[16:19], a[192:195], 0
    v_xor_b32 v7, 0, v6
    s_add_u32 m0, s81, 65536
    s_add_u32 s79, s70, 0
    buffer_load_dwordx4 v7, s[60:63], s79 offen sc1 lds
    v_mfma_f32_16x16x32_bf16 v[64:67], v[20:23], a[0:3], 0
    v_mfma_f32_16x16x32_bf16 v[68:71], v[20:23], a[64:67], 0
    v_mfma_f32_16x16x32_bf16 v[72:75], v[20:23], a[128:131], 0
    v_mfma_f32_16x16x32_bf16 v[76:79], v[20:23], a[192:195], 0
    v_mfma_f32_16x16x32_bf16 v[80:83], v[24:27], a[0:3], 0
    v_mfma_f32_16x16x32_bf16 v[84:87], v[24:27], a[64:67], 0
    v_mfma_f32_16x16x32_bf16 v[88:91], v[24:27], a[128:131], 0
    v_mfma_f32_16x16x32_bf16 v[92:95], v[24:27], a[192:195], 0
    v_mfma_f32_16x16x32_bf16 v[96:99], v[28:31], a[0:3], 0
    v_mfma_f32_16x16x32_bf16 v[100:103], v[28:31], a[64:67], 0
    v_mfma_f32_16x16x32_bf16 v[104:107], v[28:31], a[128:131], 0
    v_mfma_f32_16x16x32_bf16 v[108:111], v[28:31], a[192:195], 0
    ds_read_b128 v[16:19], v130 offset:0
    ds_read_b128 v[20:23], v130 offset:4096
    ds_read_b128 v[24:27], v130 offset:32768
    ds_read_b128 v[28:31], v130 offset:36864
    s_waitcnt lgkmcnt(4)
    v_mfma_f32_16x16x32_bf16 v[48:51], v[32:35], a[4:7], v[48:51]
    v_mfma_f32_16x16x32_bf16 v[52:55], v[32:35], a[68:71], v[52:55]
    v_mfma_f32_16x16x32_bf16 v[56:59], v[32:35], a[132:135], v[56:59]
    v_mfma_f32_16x16x32_bf16 v[60:63], v[32:35], a[196:199], v[60:63]
    v_xor_b32 v7, 16, v6
    s_add_u32 m0, s81, 66560
    s_add_u32 s79, s70, 1024
    buffer_load_dwordx4 v7, s[60:63], s79 offen sc1 lds
    v_mfma_f32_16x16x32_bf16 v[64:67], v[36:39], a[4:7], v[64:67]
    v_mfma_f32_16x16x32_bf16 v[68:71], v[36:39], a[68:71], v[68:71]
    v_mfma_f32_16x16x32_bf16 v[72:75], v[36:39], a[132:135], v[72:75]
    v_mfma_f32_16x16x32_bf16 v[76:79], v[36:39], a[196:199], v[76:79]
    v_mfma_f32_16x16x32_bf16 v[80:83], v[40:43], a[4:7], v[80:83]
    v_mfma_f32_16x16x32_bf16 v[84:87], v[40:43], a[68:71], v[84:87]
    v_mfma_f32_16x16x32_bf16 v[88:91], v[40:43], a[132:135], v[88:91]
    v_mfma_f32_16x16x32_bf16 v[92:95], v[40:43], a[196:199], v[92:95]
    v_mfma_f32_16x16x32_bf16 v[96:99], v[44:47], a[4:7], v[96:99]
    v_mfma_f32_16x16x32_bf16 v[100:103], v[44:47], a[68:71], v[100:103]
    v_mfma_f32_16x16x32_bf16 v[104:107], v[44:47], a[132:135], v[104:107]
    v_mfma_f32_16x16x32_bf16 v[108:111], v[44:47], a[196:199], v[108:111]
    ds_read_b128 v[32:35], v131 offset:0
    ds_read_b128 v[36:39], v131 offset:4096
    ds_read_b128 v[40:43], v131 offset:32768
    ds_read_b128 v[44:47], v131 offset:36864
    s_waitcnt lgkmcnt(4)
    v_mfma_f32_16x16x32_bf16 v[48:51], v[16:19], a[8:11], v[48:51]
    v_mfma_f32_16x16x32_bf16 v[52:55], v[16:19], a[72:75], v[52:55]
    v_mfma_f32_16x16x32_bf16 v[56:59], v[16:19], a[136:139], v[56:59]
    v_mfma_f32_16x16x32_bf16 v[60:63], v[16:19], a[200:203], v[60:63]
    v_xor_b32 v7, 32, v6
    s_add_u32 m0, s81, 67584
    s_add_u32 s79, s70, 2048
    buffer_load_dwordx4 v7, s[60:63], s79 offen sc1 lds
    v_mfma_f32_16x16x32_bf16 v[64:67], v[20:23], a[8:11], v[64:67]
    v_mfma_f32_16x16x32_bf16 v[68:71], v[20:23], a[72:75], v[68:71]
    v_mfma_f32_16x16x32_bf16 v[72:75], v[20:23], a[136:139], v[72:75]
    v_mfma_f32_16x16x32_bf16 v[76:79], v[20:23], a[200:203], v[76:79]
    v_mfma_f32_16x16x32_bf16 v[80:83], v[24:27], a[8:11], v[80:83]
    v_mfma_f32_16x16x32_bf16 v[84:87], v[24:27], a[72:75], v[84:87]
    v_mfma_f32_16x16x32_bf16 v[88:91], v[24:27], a[136:139], v[88:91]
    v_mfma_f32_16x16x32_bf16 v[92:95], v[24:27], a[200:203], v[92:95]
    v_mfma_f32_16x16x32_bf16 v[96:99], v[28:31], a[8:11], v[96:99]
    v_mfma_f32_16x16x32_bf16 v[100:103], v[28:31], a[72:75], v[100:103]
    v_mfma_f32_16x16x32_bf16 v[104:107], v[28:31], a[136:139], v[104:107]
    v_mfma_f32_16x16x32_bf16 v[108:111], v[28:31], a[200:203], v[108:111]
    ds_read_b128 v[16:19], v128 offset:256
    ds_read_b128 v[20:23], v128 offset:4352
    ds_read_b128 v[24:27], v128 offset:33024
    ds_read_b128 v[28:31], v128 offset:37120
    s_waitcnt lgkmcnt(4)
    v_mfma_f32_16x16x32_bf16 v[48:51], v[32:35], a[12:15], v[48:51]
    v_mfma_f32_16x16x32_bf16 v[52:55], v[32:35], a[76:79], v[52:55]
    v_mfma_f32_16x16x32_bf16 v[56:59], v[32:35], a[140:143], v[56:59]
    v_mfma_f32_16x16x32_bf16 v[60:63], v[32:35], a[204:207], v[60:63]
    v_xor_b32 v7, 48, v6
    s_add_u32 m0, s81, 68608
    s_add_u32 s79, s70, 3072
    buffer_load_dwordx4 v7, s[60:63], s79 offen sc1 lds
    v_mfma_f32_16x16x32_bf16 v[64:67], v[36:39], a[12:15], v[64:67]
    v_mfma_f32_16x16x32_bf16 v[68:71], v[36:39], a[76:79], v[68:71]
    v_mfma_f32_16x16x32_bf16 v[72:75], v[36:39], a[140:143], v[72:75]
    v_mfma_f32_16x16x32_bf16 v[76:79], v[36:39], a[204:207], v[76:79]
    v_mfma_f32_16x16x32_bf16 v[80:83], v[40:43], a[12:15], v[80:83]
    v_mfma_f32_16x16x32_bf16 v[84:87], v[40:43], a[76:79], v[84:87]
    v_mfma_f32_16x16x32_bf16 v[88:91], v[40:43], a[140:143], v[88:91]
    v_mfma_f32_16x16x32_bf16 v[92:95], v[40:43], a[204:207], v[92:95]
    v_mfma_f32_16x16x32_bf16 v[96:99], v[44:47], a[12:15], v[96:99]
    v_mfma_f32_16x16x32_bf16 v[100:103], v[44:47], a[76:79], v[100:103]
    v_mfma_f32_16x16x32_bf16 v[104:107], v[44:47], a[140:143], v[104:107]
    v_mfma_f32_16x16x32_bf16 v[108:111], v[44:47], a[204:207], v[108:111]
    ds_read_b128 v[32:35], v129 offset:256
    ds_read_b128 v[36:39], v129 offset:4352
    ds_read_b128 v[40:43], v129 offset:33024
    ds_read_b128 v[44:47], v129 offset:37120
    s_waitcnt lgkmcnt(4)
    v_mfma_f32_16x16x32_bf16 v[48:51], v[16:19], a[16:19], v[48:51]
    v_mfma_f32_16x16x32_bf16 v[52:55], v[16:19], a[80:83], v[52:55]
    v_mfma_f32_16x16x32_bf16 v[56:59], v[16:19], a[144:147], v[56:59]
    v_mfma_f32_16x16x32_bf16 v[60:63], v[16:19], a[208:211], v[60:63]
    v_xor_b32 v7, 64, v6
    s_add_u32 m0, s81, 73728
    s_add_u32 s79, s70, 8192
    buffer_load_dwordx4 v7, s[60:63], s79 offen sc1 lds
    v_mfma_f32_16x16x32_bf16 v[64:67], v[20:23], a[16:19], v[64:67]
    v_mfma_f32_16x16x32_bf16 v[68:71], v[20:23], a[80:83], v[68:71]
    v_mfma_f32_16x16x32_bf16 v[72:75], v[20:23], a[144:147], v[72:75]
    v_mfma_f32_16x16x32_bf16 v[76:79], v[20:23], a[208:211], v[76:79]
    v_mfma_f32_16x16x32_bf16 v[80:83], v[24:27], a[16:19], v[80:83]
    v_mfma_f32_16x16x32_bf16 v[84:87], v[24:27], a[80:83], v[84:87]
    v_mfma_f32_16x16x32_bf16 v[88:91], v[24:27], a[144:147], v[88:91]
    v_mfma_f32_16x16x32_bf16 v[92:95], v[24:27], a[208:211], v[92:95]
    v_mfma_f32_16x16x32_bf16 v[96:99], v[28:31], a[16:19], v[96:99]
    v_mfma_f32_16x16x32_bf16 v[100:103], v[28:31], a[80:83], v[100:103]
    v_mfma_f32_16x16x32_bf16 v[104:107], v[28:31], a[144:147], v[104:107]
    v_mfma_f32_16x16x32_bf16 v[108:111], v[28:31], a[208:211], v[108:111]
    ds_read_b128 v[16:19], v130 offset:256
    ds_read_b128 v[20:23], v130 offset:4352
    ds_read_b128 v[24:27], v130 offset:33024
    ds_read_b128 v[28:31], v130 offset:37120
    s_waitcnt lgkmcnt(4)
    v_mfma_f32_16x16x32_bf16 v[48:51], v[32:35], a[20:23], v[48:51]
    v_mfma_f32_16x16x32_bf16 v[52:55], v[32:35], a[84:87], v[52:55]
    v_mfma_f32_16x16x32_bf16 v[56:59], v[32:35], a[148:151], v[56:59]
    v_mfma_f32_16x16x32_bf16 v[60:63], v[32:35], a[212:215], v[60:63]
    v_xor_b32 v7, 80, v6
    s_add_u32 m0, s81, 74752
    s_add_u32 s79, s70, 9216
    buffer_load_dwordx4 v7, s[60:63], s79 offen sc1 lds
    v_mfma_f32_16x16x32_bf16 v[64:67], v[36:39], a[20:23], v[64:67]
    v_mfma_f32_16x16x32_bf16 v[68:71], v[36:39], a[84:87], v[68:71]
    v_mfma_f32_16x16x32_bf16 v[72:75], v[36:39], a[148:151], v[72:75]
    v_mfma_f32_16x16x32_bf16 v[76:79], v[36:39], a[212:215], v[76:79]
    v_mfma_f32_16x16x32_bf16 v[80:83], v[40:43], a[20:23], v[80:83]
    v_mfma_f32_16x16x32_bf16 v[84:87], v[40:43], a[84:87], v[84:87]
    v_mfma_f32_16x16x32_bf16 v[88:91], v[40:43], a[148:151], v[88:91]
    v_mfma_f32_16x16x32_bf16 v[92:95], v[40:43], a[212:215], v[92:95]
    v_mfma_f32_16x16x32_bf16 v[96:99], v[44:47], a[20:23], v[96:99]
    v_mfma_f32_16x16x32_bf16 v[100:103], v[44:47], a[84:87], v[100:103]
    v_mfma_f32_16x16x32_bf16 v[104:107], v[44:47], a[148:151], v[104:107]
    v_mfma_f32_16x16x32_bf16 v[108:111], v[44:47], a[212:215], v[108:111]
    ds_read_b128 v[32:35], v131 offset:256
    ds_read_b128 v[36:39], v131 offset:4352
    ds_read_b128 v[40:43], v131 offset:33024
    ds_read_b128 v[44:47], v131 offset:37120
    s_waitcnt lgkmcnt(4)
    v_mfma_f32_16x16x32_bf16 v[48:51], v[16:19], a[24:27], v[48:51]
    v_mfma_f32_16x16x32_bf16 v[52:55], v[16:19], a[88:91], v[52:55]
    v_mfma_f32_16x16x32_bf16 v[56:59], v[16:19], a[152:155], v[56:59]
    v_mfma_f32_16x16x32_bf16 v[60:63], v[16:19], a[216:219], v[60:63]
    v_xor_b32 v7, 96, v6
    s_add_u32 m0, s81, 75776
    s_add_u32 s79, s70, 10240
    buffer_load_dwordx4 v7, s[60:63], s79 offen sc1 lds
    v_mfma_f32_16x16x32_bf16 v[64:67], v[20:23], a[24:27], v[64:67]
    v_mfma_f32_16x16x32_bf16 v[68:71], v[20:23], a[88:91], v[68:71]
    v_mfma_f32_16x16x32_bf16 v[72:75], v[20:23], a[152:155], v[72:75]
    v_mfma_f32_16x16x32_bf16 v[76:79], v[20:23], a[216:219], v[76:79]
    v_mfma_f32_16x16x32_bf16 v[80:83], v[24:27], a[24:27], v[80:83]
    v_mfma_f32_16x16x32_bf16 v[84:87], v[24:27], a[88:91], v[84:87]
    v_mfma_f32_16x16x32_bf16 v[88:91], v[24:27], a[152:155], v[88:91]
    v_mfma_f32_16x16x32_bf16 v[92:95], v[24:27], a[216:219], v[92:95]
    v_mfma_f32_16x16x32_bf16 v[96:99], v[28:31], a[24:27], v[96:99]
    v_mfma_f32_16x16x32_bf16 v[100:103], v[28:31], a[88:91], v[100:103]
    v_mfma_f32_16x16x32_bf16 v[104:107], v[28:31], a[152:155], v[104:107]
    v_mfma_f32_16x16x32_bf16 v[108:111], v[28:31], a[216:219], v[108:111]
    ds_read_b128 v[16:19], v128 offset:512
    ds_read_b128 v[20:23], v128 offset:4608
    ds_read_b128 v[24:27], v128 offset:33280
    ds_read_b128 v[28:31], v128 offset:37376
    s_waitcnt lgkmcnt(4)
    v_mfma_f32_16x16x32_bf16 v[48:51], v[32:35], a[28:31], v[48:51]
    v_mfma_f32_16x16x32_bf16 v[52:55], v[32:35], a[92:95], v[52:55]
    v_mfma_f32_16x16x32_bf16 v[56:59], v[32:35], a[156:159], v[56:59]
    v_mfma_f32_16x16x32_bf16 v[60:63], v[32:35], a[220:223], v[60:63]
    v_xor_b32 v7, 112, v6
    s_add_u32 m0, s81, 76800
    s_add_u32 s79, s70, 11264
    buffer_load_dwordx4 v7, s[60:63], s79 offen sc1 lds
    v_mfma_f32_16x16x32_bf16 v[64:67], v[36:39], a[28:31], v[64:67]
    v_mfma_f32_16x16x32_bf16 v[68:71], v[36:39], a[92:95], v[68:71]
    v_mfma_f32_16x16x32_bf16 v[72:75], v[36:39], a[156:159], v[72:75]
    v_mfma_f32_16x16x32_bf16 v[76:79], v[36:39], a[220:223], v[76:79]
    v_mfma_f32_16x16x32_bf16 v[80:83], v[40:43], a[28:31], v[80:83]
    v_mfma_f32_16x16x32_bf16 v[84:87], v[40:43], a[92:95], v[84:87]
    v_mfma_f32_16x16x32_bf16 v[88:91], v[40:43], a[156:159], v[88:91]
    v_mfma_f32_16x16x32_bf16 v[92:95], v[40:43], a[220:223], v[92:95]
    v_mfma_f32_16x16x32_bf16 v[96:99], v[44:47], a[28:31], v[96:99]
    v_mfma_f32_16x16x32_bf16 v[100:103], v[44:47], a[92:95], v[100:103]
    v_mfma_f32_16x16x32_bf16 v[104:107], v[44:47], a[156:159], v[104:107]
    v_mfma_f32_16x16x32_bf16 v[108:111], v[44:47], a[220:223], v[108:111]
    ds_read_b128 v[32:35], v129 offset:512
    ds_read_b128 v[36:39], v129 offset:4608
    ds_read_b128 v[40:43], v129 offset:33280
    ds_read_b128 v[44:47], v129 offset:37376
    s_waitcnt lgkmcnt(4)
    v_mfma_f32_16x16x32_bf16 v[48:51], v[16:19], a[32:35], v[48:51]
    v_mfma_f32_16x16x32_bf16 v[52:55], v[16:19], a[96:99], v[52:55]
    v_mfma_f32_16x16x32_bf16 v[56:59], v[16:19], a[160:163], v[56:59]
    v_mfma_f32_16x16x32_bf16 v[60:63], v[16:19], a[224:227], v[60:63]
    v_xor_b32 v7, 128, v6
    s_add_u32 m0, s81, 81920
    s_add_u32 s79, s70, 16384
    buffer_load_dwordx4 v7, s[60:63], s79 offen sc1 lds
    v_mfma_f32_16x16x32_bf16 v[64:67], v[20:23], a[32:35], v[64:67]
    v_mfma_f32_16x16x32_bf16 v[68:71], v[20:23], a[96:99], v[68:71]
    v_mfma_f32_16x16x32_bf16 v[72:75], v[20:23], a[160:163], v[72:75]
    v_mfma_f32_16x16x32_bf16 v[76:79], v[20:23], a[224:227], v[76:79]
    v_mfma_f32_16x16x32_bf16 v[80:83], v[24:27], a[32:35], v[80:83]
    v_mfma_f32_16x16x32_bf16 v[84:87], v[24:27], a[96:99], v[84:87]
    v_mfma_f32_16x16x32_bf16 v[88:91], v[24:27], a[160:163], v[88:91]
    v_mfma_f32_16x16x32_bf16 v[92:95], v[24:27], a[224:227], v[92:95]
    v_mfma_f32_16x16x32_bf16 v[96:99], v[28:31], a[32:35], v[96:99]
    v_mfma_f32_16x16x32_bf16 v[100:103], v[28:31], a[96:99], v[100:103]
    v_mfma_f32_16x16x32_bf16 v[104:107], v[28:31], a[160:163], v[104:107]
    v_mfma_f32_16x16x32_bf16 v[108:111], v[28:31], a[224:227], v[108:111]
    ds_read_b128 v[16:19], v130 offset:512
    ds_read_b128 v[20:23], v130 offset:4608
    ds_read_b128 v[24:27], v130 offset:33280
    ds_read_b128 v[28:31], v130 offset:37376
    s_waitcnt lgkmcnt(4)
    v_mfma_f32_16x16x32_bf16 v[48:51], v[32:35], a[36:39], v[48:51]
    v_mfma_f32_16x16x32_bf16 v[52:55], v[32:35], a[100:103], v[52:55]
    v_mfma_f32_16x16x32_bf16 v[56:59], v[32:35], a[164:167], v[56:59]
    v_mfma_f32_16x16x32_bf16 v[60:63], v[32:35], a[228:231], v[60:63]
    v_xor_b32 v7, 144, v6
    s_add_u32 m0, s81, 82944
    s_add_u32 s79, s70, 17408
    buffer_load_dwordx4 v7, s[60:63], s79 offen sc1 lds
    v_mfma_f32_16x16x32_bf16 v[64:67], v[36:39], a[36:39], v[64:67]
    v_mfma_f32_16x16x32_bf16 v[68:71], v[36:39], a[100:103], v[68:71]
    v_mfma_f32_16x16x32_bf16 v[72:75], v[36:39], a[164:167], v[72:75]
    v_mfma_f32_16x16x32_bf16 v[76:79], v[36:39], a[228:231], v[76:79]
    v_mfma_f32_16x16x32_bf16 v[80:83], v[40:43], a[36:39], v[80:83]
    v_mfma_f32_16x16x32_bf16 v[84:87], v[40:43], a[100:103], v[84:87]
    v_mfma_f32_16x16x32_bf16 v[88:91], v[40:43], a[164:167], v[88:91]
    v_mfma_f32_16x16x32_bf16 v[92:95], v[40:43], a[228:231], v[92:95]
    v_mfma_f32_16x16x32_bf16 v[96:99], v[44:47], a[36:39], v[96:99]
    v_mfma_f32_16x16x32_bf16 v[100:103], v[44:47], a[100:103], v[100:103]
    v_mfma_f32_16x16x32_bf16 v[104:107], v[44:47], a[164:167], v[104:107]
    v_mfma_f32_16x16x32_bf16 v[108:111], v[44:47], a[228:231], v[108:111]
    ds_read_b128 v[32:35], v131 offset:512
    ds_read_b128 v[36:39], v131 offset:4608
    ds_read_b128 v[40:43], v131 offset:33280
    ds_read_b128 v[44:47], v131 offset:37376
    s_waitcnt lgkmcnt(4)
    v_mfma_f32_16x16x32_bf16 v[48:51], v[16:19], a[40:43], v[48:51]
    v_mfma_f32_16x16x32_bf16 v[52:55], v[16:19], a[104:107], v[52:55]
    v_mfma_f32_16x16x32_bf16 v[56:59], v[16:19], a[168:171], v[56:59]
    v_mfma_f32_16x16x32_bf16 v[60:63], v[16:19], a[232:235], v[60:63]
    v_xor_b32 v7, 160, v6
    s_add_u32 m0, s81, 83968
    s_add_u32 s79, s70, 18432
    buffer_load_dwordx4 v7, s[60:63], s79 offen sc1 lds
    v_mfma_f32_16x16x32_bf16 v[64:67], v[20:23], a[40:43], v[64:67]
    v_mfma_f32_16x16x32_bf16 v[68:71], v[20:23], a[104:107], v[68:71]
    v_mfma_f32_16x16x32_bf16 v[72:75], v[20:23], a[168:171], v[72:75]
    v_mfma_f32_16x16x32_bf16 v[76:79], v[20:23], a[232:235], v[76:79]
    v_mfma_f32_16x16x32_bf16 v[80:83], v[24:27], a[40:43], v[80:83]
    v_mfma_f32_16x16x32_bf16 v[84:87], v[24:27], a[104:107], v[84:87]
    v_mfma_f32_16x16x32_bf16 v[88:91], v[24:27], a[168:171], v[88:91]
    v_mfma_f32_16x16x32_bf16 v[92:95], v[24:27], a[232:235], v[92:95]
    v_mfma_f32_16x16x32_bf16 v[96:99], v[28:31], a[40:43], v[96:99]
    v_mfma_f32_16x16x32_bf16 v[100:103], v[28:31], a[104:107], v[100:103]
    v_mfma_f32_16x16x32_bf16 v[104:107], v[28:31], a[168:171], v[104:107]
    v_mfma_f32_16x16x32_bf16 v[108:111], v[28:31], a[232:235], v[108:111]
    ds_read_b128 v[16:19], v128 offset:768
    ds_read_b128 v[20:23], v128 offset:4864
    ds_read_b128 v[24:27], v128 offset:33536
    ds_read_b128 v[28:31], v128 offset:37632
    s_waitcnt lgkmcnt(4)
    v_mfma_f32_16x16x32_bf16 v[48:51], v[32:35], a[44:47], v[48:51]
    v_mfma_f32_16x16x32_bf16 v[52:55], v[32:35], a[108:111], v[52:55]
    v_mfma_f32_16x16x32_bf16 v[56:59], v[32:35], a[172:175], v[56:59]
    v_mfma_f32_16x16x32_bf16 v[60:63], v[32:35], a[236:239], v[60:63]
    v_xor_b32 v7, 176, v6
    s_add_u32 m0, s81, 84992
    s_add_u32 s79, s70, 19456
    buffer_load_dwordx4 v7, s[60:63], s79 offen sc1 lds
    v_mfma_f32_16x16x32_bf16 v[64:67], v[36:39], a[44:47], v[64:67]
    v_mfma_f32_16x16x32_bf16 v[68:71], v[36:39], a[108:111], v[68:71]
    v_mfma_f32_16x16x32_bf16 v[72:75], v[36:39], a[172:175], v[72:75]
    v_mfma_f32_16x16x32_bf16 v[76:79], v[36:39], a[236:239], v[76:79]
    v_mfma_f32_16x16x32_bf16 v[80:83], v[40:43], a[44:47], v[80:83]
    v_mfma_f32_16x16x32_bf16 v[84:87], v[40:43], a[108:111], v[84:87]
    v_mfma_f32_16x16x32_bf16 v[88:91], v[40:43], a[172:175], v[88:91]
    v_mfma_f32_16x16x32_bf16 v[92:95], v[40:43], a[236:239], v[92:95]
    v_mfma_f32_16x16x32_bf16 v[96:99], v[44:47], a[44:47], v[96:99]
    v_mfma_f32_16x16x32_bf16 v[100:103], v[44:47], a[108:111], v[100:103]
    v_mfma_f32_16x16x32_bf16 v[104:107], v[44:47], a[172:175], v[104:107]
    v_mfma_f32_16x16x32_bf16 v[108:111], v[44:47], a[236:239], v[108:111]
    ds_read_b128 v[32:35], v129 offset:768
    ds_read_b128 v[36:39], v129 offset:4864
    ds_read_b128 v[40:43], v129 offset:33536
    ds_read_b128 v[44:47], v129 offset:37632
    s_waitcnt lgkmcnt(4)
    v_mfma_f32_16x16x32_bf16 v[48:51], v[16:19], a[48:51], v[48:51]
    v_mfma_f32_16x16x32_bf16 v[52:55], v[16:19], a[112:115], v[52:55]
    v_mfma_f32_16x16x32_bf16 v[56:59], v[16:19], a[176:179], v[56:59]
    v_mfma_f32_16x16x32_bf16 v[60:63], v[16:19], a[240:243], v[60:63]
    v_xor_b32 v7, 192, v6
    s_add_u32 m0, s81, 90112
    s_add_u32 s79, s70, 24576
    buffer_load_dwordx4 v7, s[60:63], s79 offen sc1 lds
    v_mfma_f32_16x16x32_bf16 v[64:67], v[20:23], a[48:51], v[64:67]
    v_mfma_f32_16x16x32_bf16 v[68:71], v[20:23], a[112:115], v[68:71]
    v_mfma_f32_16x16x32_bf16 v[72:75], v[20:23], a[176:179], v[72:75]
    v_mfma_f32_16x16x32_bf16 v[76:79], v[20:23], a[240:243], v[76:79]
    v_mfma_f32_16x16x32_bf16 v[80:83], v[24:27], a[48:51], v[80:83]
    v_mfma_f32_16x16x32_bf16 v[84:87], v[24:27], a[112:115], v[84:87]
    v_mfma_f32_16x16x32_bf16 v[88:91], v[24:27], a[176:179], v[88:91]
    v_mfma_f32_16x16x32_bf16 v[92:95], v[24:27], a[240:243], v[92:95]
    v_mfma_f32_16x16x32_bf16 v[96:99], v[28:31], a[48:51], v[96:99]
    v_mfma_f32_16x16x32_bf16 v[100:103], v[28:31], a[112:115], v[100:103]
    v_mfma_f32_16x16x32_bf16 v[104:107], v[28:31], a[176:179], v[104:107]
    v_mfma_f32_16x16x32_bf16 v[108:111], v[28:31], a[240:243], v[108:111]
    ds_read_b128 v[16:19], v130 offset:768
    ds_read_b128 v[20:23], v130 offset:4864
    ds_read_b128 v[24:27], v130 offset:33536
    ds_read_b128 v[28:31], v130 offset:37632
    s_waitcnt lgkmcnt(4)
    v_mfma_f32_16x16x32_bf16 v[48:51], v[32:35], a[52:55], v[48:51]
    v_mfma_f32_16x16x32_bf16 v[52:55], v[32:35], a[116:119], v[52:55]
    v_mfma_f32_16x16x32_bf16 v[56:59], v[32:35], a[180:183], v[56:59]
    v_mfma_f32_16x16x32_bf16 v[60:63], v[32:35], a[244:247], v[60:63]
    v_xor_b32 v7, 208, v6
    s_add_u32 m0, s81, 91136
    s_add_u32 s79, s70, 25600
    buffer_load_dwordx4 v7, s[60:63], s79 offen sc1 lds
    v_mfma_f32_16x16x32_bf16 v[64:67], v[36:39], a[52:55], v[64:67]
    v_mfma_f32_16x16x32_bf16 v[68:71], v[36:39], a[116:119], v[68:71]
    v_mfma_f32_16x16x32_bf16 v[72:75], v[36:39], a[180:183], v[72:75]
    v_mfma_f32_16x16x32_bf16 v[76:79], v[36:39], a[244:247], v[76:79]
    v_mfma_f32_16x16x32_bf16 v[80:83], v[40:43], a[52:55], v[80:83]
    v_mfma_f32_16x16x32_bf16 v[84:87], v[40:43], a[116:119], v[84:87]
    v_mfma_f32_16x16x32_bf16 v[88:91], v[40:43], a[180:183], v[88:91]
    v_mfma_f32_16x16x32_bf16 v[92:95], v[40:43], a[244:247], v[92:95]
    v_mfma_f32_16x16x32_bf16 v[96:99], v[44:47], a[52:55], v[96:99]
    v_mfma_f32_16x16x32_bf16 v[100:103], v[44:47], a[116:119], v[100:103]
    v_mfma_f32_16x16x32_bf16 v[104:107], v[44:47], a[180:183], v[104:107]
    v_mfma_f32_16x16x32_bf16 v[108:111], v[44:47], a[244:247], v[108:111]
    ds_read_b128 v[32:35], v131 offset:768
    ds_read_b128 v[36:39], v131 offset:4864
    ds_read_b128 v[40:43], v131 offset:33536
    ds_read_b128 v[44:47], v131 offset:37632
    s_waitcnt lgkmcnt(4)
    v_mfma_f32_16x16x32_bf16 v[48:51], v[16:19], a[56:59], v[48:51]
    v_mfma_f32_16x16x32_bf16 v[52:55], v[16:19], a[120:123], v[52:55]
    v_mfma_f32_16x16x32_bf16 v[56:59], v[16:19], a[184:187], v[56:59]
    v_mfma_f32_16x16x32_bf16 v[60:63], v[16:19], a[248:251], v[60:63]
    v_xor_b32 v7, 224, v6
    s_add_u32 m0, s81, 92160
    s_add_u32 s79, s70, 26624
    buffer_load_dwordx4 v7, s[60:63], s79 offen sc1 lds
    v_mfma_f32_16x16x32_bf16 v[64:67], v[20:23], a[56:59], v[64:67]
    v_mfma_f32_16x16x32_bf16 v[68:71], v[20:23], a[120:123], v[68:71]
    v_mfma_f32_16x16x32_bf16 v[72:75], v[20:23], a[184:187], v[72:75]
    v_mfma_f32_16x16x32_bf16 v[76:79], v[20:23], a[248:251], v[76:79]
    v_mfma_f32_16x16x32_bf16 v[80:83], v[24:27], a[56:59], v[80:83]
    v_mfma_f32_16x16x32_bf16 v[84:87], v[24:27], a[120:123], v[84:87]
    v_mfma_f32_16x16x32_bf16 v[88:91], v[24:27], a[184:187], v[88:91]
    v_mfma_f32_16x16x32_bf16 v[92:95], v[24:27], a[248:251], v[92:95]
    v_mfma_f32_16x16x32_bf16 v[96:99], v[28:31], a[56:59], v[96:99]
    v_mfma_f32_16x16x32_bf16 v[100:103], v[28:31], a[120:123], v[100:103]
    v_mfma_f32_16x16x32_bf16 v[104:107], v[28:31], a[184:187], v[104:107]
    v_mfma_f32_16x16x32_bf16 v[108:111], v[28:31], a[248:251], v[108:111]
    s_waitcnt lgkmcnt(0)
    v_mfma_f32_16x16x32_bf16 v[48:51], v[32:35], a[60:63], v[48:51]
    v_mfma_f32_16x16x32_bf16 v[52:55], v[32:35], a[124:127], v[52:55]
    v_mfma_f32_16x16x32_bf16 v[56:59], v[32:35], a[188:191], v[56:59]
    v_mfma_f32_16x16x32_bf16 v[60:63], v[32:35], a[252:255], v[60:63]
    v_xor_b32 v7, 240, v6
    s_add_u32 m0, s81, 93184
    s_add_u32 s79, s70, 27648
    buffer_load_dwordx4 v7, s[60:63], s79 offen sc1 lds
    v_mfma_f32_16x16x32_bf16 v[64:67], v[36:39], a[60:63], v[64:67]
    v_mfma_f32_16x16x32_bf16 v[68:71], v[36:39], a[124:127], v[68:71]
    v_mfma_f32_16x16x32_bf16 v[72:75], v[36:39], a[188:191], v[72:75]
    v_mfma_f32_16x16x32_bf16 v[76:79], v[36:39], a[252:255], v[76:79]
    v_mfma_f32_16x16x32_bf16 v[80:83], v[40:43], a[60:63], v[80:83]
    v_mfma_f32_16x16x32_bf16 v[84:87], v[40:43], a[124:127], v[84:87]
    v_mfma_f32_16x16x32_bf16 v[88:91], v[40:43], a[188:191], v[88:91]
    v_mfma_f32_16x16x32_bf16 v[92:95], v[40:43], a[252:255], v[92:95]
    v_mfma_f32_16x16x32_bf16 v[96:99], v[44:47], a[60:63], v[96:99]
    v_mfma_f32_16x16x32_bf16 v[100:103], v[44:47], a[124:127], v[100:103]
    v_mfma_f32_16x16x32_bf16 v[104:107], v[44:47], a[188:191], v[104:107]
    v_mfma_f32_16x16x32_bf16 v[108:111], v[44:47], a[252:255], v[108:111]
    s_add_u32 s70, s70, 65536
    s_add_u32 s77, s73, 0
    v_cvt_pk_bf16_f32 v112, v48, v49
    v_cvt_pk_bf16_f32 v113, v50, v51
    v_cvt_pk_bf16_f32 v114, v64, v65
    v_cvt_pk_bf16_f32 v115, v66, v67
    buffer_store_dwordx4 v[112:115], v1, s[52:55], s77 offen offset:0 sc1
    v_cvt_pk_bf16_f32 v116, v52, v53
    v_cvt_pk_bf16_f32 v117, v54, v55
    v_cvt_pk_bf16_f32 v118, v68, v69
    v_cvt_pk_bf16_f32 v119, v70, v71
    buffer_store_dwordx4 v[116:119], v1, s[52:55], s77 offen offset:128 sc1
    s_add_u32 s77, s73, 131072
    v_cvt_pk_bf16_f32 v112, v56, v57
    v_cvt_pk_bf16_f32 v113, v58, v59
    v_cvt_pk_bf16_f32 v114, v72, v73
    v_cvt_pk_bf16_f32 v115, v74, v75
    buffer_store_dwordx4 v[112:115], v1, s[52:55], s77 offen offset:0 sc1
    v_cvt_pk_bf16_f32 v116, v60, v61
    v_cvt_pk_bf16_f32 v117, v62, v63
    v_cvt_pk_bf16_f32 v118, v76, v77
    v_cvt_pk_bf16_f32 v119, v78, v79
    buffer_store_dwordx4 v[116:119], v1, s[52:55], s77 offen offset:128 sc1
    s_add_u32 s77, s73, 1024
    v_cvt_pk_bf16_f32 v112, v80, v81
    v_cvt_pk_bf16_f32 v113, v82, v83
    v_cvt_pk_bf16_f32 v114, v96, v97
    v_cvt_pk_bf16_f32 v115, v98, v99
    buffer_store_dwordx4 v[112:115], v1, s[52:55], s77 offen offset:0 sc1
    v_cvt_pk_bf16_f32 v116, v84, v85
    v_cvt_pk_bf16_f32 v117, v86, v87
    v_cvt_pk_bf16_f32 v118, v100, v101
    v_cvt_pk_bf16_f32 v119, v102, v103
    buffer_store_dwordx4 v[116:119], v1, s[52:55], s77 offen offset:128 sc1
    s_add_u32 s77, s73, 132096
    v_cvt_pk_bf16_f32 v112, v88, v89
    v_cvt_pk_bf16_f32 v113, v90, v91
    v_cvt_pk_bf16_f32 v114, v104, v105
    v_cvt_pk_bf16_f32 v115, v106, v107
    buffer_store_dwordx4 v[112:115], v1, s[52:55], s77 offen offset:0 sc1
    v_cvt_pk_bf16_f32 v116, v92, v93
    v_cvt_pk_bf16_f32 v117, v94, v95
    v_cvt_pk_bf16_f32 v118, v108, v109
    v_cvt_pk_bf16_f32 v119, v110, v111
    buffer_store_dwordx4 v[116:119], v1, s[52:55], s77 offen offset:128 sc1
    s_add_u32 s73, s73, 2048
    s_waitcnt vmcnt(8)
    s_barrier
    s_cmp_eq_u32 s83, 0
    s_cbranch_scc1 L_wsg_162
    s_cmp_lg_u32 s56, 0
    s_cbranch_scc1 L_wsg_162
    s_mov_b32 s80, 20
    v_mov_b32 v120, 1
    v_mov_b32 v121, s80
    s_mov_b64 exec, 1
    buffer_atomic_add v120, v121, s[48:51], 0 offen
    s_mov_b64 exec, -1
    s_nop 0
L_wsg_162:
    ds_read_b128 v[16:19], v132 offset:0
    ds_read_b128 v[20:23], v132 offset:4096
    ds_read_b128 v[24:27], v132 offset:32768
    ds_read_b128 v[28:31], v132 offset:36864
    ds_read_b128 v[32:35], v133 offset:0
    ds_read_b128 v[36:39], v133 offset:4096
    ds_read_b128 v[40:43], v133 offset:32768
    ds_read_b128 v[44:47], v133 offset:36864
    s_waitcnt lgkmcnt(4)
    v_mfma_f32_16x16x32_bf16 v[48:51], v[16:19], a[0:3], 0
    v_mfma_f32_16x16x32_bf16 v[52:55], v[16:19], a[64:67], 0
    v_mfma_f32_16x16x32_bf16 v[56:59], v[16:19], a[128:131], 0
    v_mfma_f32_16x16x32_bf16 v[60:63], v[16:19], a[192:195], 0
    v_xor_b32 v7, 0, v6
    s_add_u32 m0, s81, 0
    s_add_u32 s79, s70, 0
    buffer_load_dwordx4 v7, s[60:63], s79 offen sc1 lds
    v_mfma_f32_16x16x32_bf16 v[64:67], v[20:23], a[0:3], 0
    v_mfma_f32_16x16x32_bf16 v[68:71], v[20:23], a[64:67], 0
    v_mfma_f32_16x16x32_bf16 v[72:75], v[20:23], a[128:131], 0
    v_mfma_f32_16x16x32_bf16 v[76:79], v[20:23], a[192:195], 0
    v_mfma_f32_16x16x32_bf16 v[80:83], v[24:27], a[0:3], 0
    v_mfma_f32_16x16x32_bf16 v[84:87], v[24:27], a[64:67], 0
    v_mfma_f32_16x16x32_bf16 v[88:91], v[24:27], a[128:131], 0
    v_mfma_f32_16x16x32_bf16 v[92:95], v[24:27], a[192:195], 0
    v_mfma_f32_16x16x32_bf16 v[96:99], v[28:31], a[0:3], 0
    v_mfma_f32_16x16x32_bf16 v[100:103], v[28:31], a[64:67], 0
    v_mfma_f32_16x16x32_bf16 v[104:107], v[28:31], a[128:131], 0
    v_mfma_f32_16x16x32_bf16 v[108:111], v[28:31], a[192:195], 0
    ds_read_b128 v[16:19], v134 offset:0
    ds_read_b128 v[20:23], v134 offset:4096
    ds_read_b128 v[24:27], v134 offset:32768
    ds_read_b128 v[28:31], v134 offset:36864
    s_waitcnt lgkmcnt(4)
    v_mfma_f32_16x16x32_bf16 v[48:51], v[32:35], a[4:7], v[48:51]
    v_mfma_f32_16x16x32_bf16 v[52:55], v[32:35], a[68:71], v[52:55]
    v_mfma_f32_16x16x32_bf16 v[56:59], v[32:35], a[132:135], v[56:59]
    v_mfma_f32_16x16x32_bf16 v[60:63], v[32:35], a[196:199], v[60:63]
    v_xor_b32 v7, 16, v6
    s_add_u32 m0, s81, 1024
    s_add_u32 s79, s70, 1024
    buffer_load_dwordx4 v7, s[60:63], s79 offen sc1 lds
    v_mfma_f32_16x16x32_bf16 v[64:67], v[36:39], a[4:7], v[64:67]
    v_mfma_f32_16x16x32_bf16 v[68:71], v[36:39], a[68:71], v[68:71]
    v_mfma_f32_16x16x32_bf16 v[72:75], v[36:39], a[132:135], v[72:75]
    v_mfma_f32_16x16x32_bf16 v[76:79], v[36:39], a[196:199], v[76:79]
    v_mfma_f32_16x16x32_bf16 v[80:83], v[40:43], a[4:7], v[80:83]
    v_mfma_f32_16x16x32_bf16 v[84:87], v[40:43], a[68:71], v[84:87]
    v_mfma_f32_16x16x32_bf16 v[88:91], v[40:43], a[132:135], v[88:91]
    v_mfma_f32_16x16x32_bf16 v[92:95], v[40:43], a[196:199], v[92:95]
    v_mfma_f32_16x16x32_bf16 v[96:99], v[44:47], a[4:7], v[96:99]
    v_mfma_f32_16x16x32_bf16 v[100:103], v[44:47], a[68:71], v[100:103]
    v_mfma_f32_16x16x32_bf16 v[104:107], v[44:47], a[132:135], v[104:107]
    v_mfma_f32_16x16x32_bf16 v[108:111], v[44:47], a[196:199], v[108:111]
    ds_read_b128 v[32:35], v135 offset:0
    ds_read_b128 v[36:39], v135 offset:4096
    ds_read_b128 v[40:43], v135 offset:32768
    ds_read_b128 v[44:47], v135 offset:36864
    s_waitcnt lgkmcnt(4)
    v_mfma_f32_16x16x32_bf16 v[48:51], v[16:19], a[8:11], v[48:51]
    v_mfma_f32_16x16x32_bf16 v[52:55], v[16:19], a[72:75], v[52:55]
    v_mfma_f32_16x16x32_bf16 v[56:59], v[16:19], a[136:139], v[56:59]
    v_mfma_f32_16x16x32_bf16 v[60:63], v[16:19], a[200:203], v[60:63]
    v_xor_b32 v7, 32, v6
    s_add_u32 m0, s81, 2048
    s_add_u32 s79, s70, 2048
    buffer_load_dwordx4 v7, s[60:63], s79 offen sc1 lds
    v_mfma_f32_16x16x32_bf16 v[64:67], v[20:23], a[8:11], v[64:67]
    v_mfma_f32_16x16x32_bf16 v[68:71], v[20:23], a[72:75], v[68:71]
    v_mfma_f32_16x16x32_bf16 v[72:75], v[20:23], a[136:139], v[72:75]
    v_mfma_f32_16x16x32_bf16 v[76:79], v[20:23], a[200:203], v[76:79]
    v_mfma_f32_16x16x32_bf16 v[80:83], v[24:27], a[8:11], v[80:83]
    v_mfma_f32_16x16x32_bf16 v[84:87], v[24:27], a[72:75], v[84:87]
    v_mfma_f32_16x16x32_bf16 v[88:91], v[24:27], a[136:139], v[88:91]
    v_mfma_f32_16x16x32_bf16 v[92:95], v[24:27], a[200:203], v[92:95]
    v_mfma_f32_16x16x32_bf16 v[96:99], v[28:31], a[8:11], v[96:99]
    v_mfma_f32_16x16x32_bf16 v[100:103], v[28:31], a[72:75], v[100:103]
    v_mfma_f32_16x16x32_bf16 v[104:107], v[28:31], a[136:139], v[104:107]
    v_mfma_f32_16x16x32_bf16 v[108:111], v[28:31], a[200:203], v[108:111]
    ds_read_b128 v[16:19], v132 offset:256
    ds_read_b128 v[20:23], v132 offset:4352
    ds_read_b128 v[24:27], v132 offset:33024
    ds_read_b128 v[28:31], v132 offset:37120
    s_waitcnt lgkmcnt(4)
    v_mfma_f32_16x16x32_bf16 v[48:51], v[32:35], a[12:15], v[48:51]
    v_mfma_f32_16x16x32_bf16 v[52:55], v[32:35], a[76:79], v[52:55]
    v_mfma_f32_16x16x32_bf16 v[56:59], v[32:35], a[140:143], v[56:59]
    v_mfma_f32_16x16x32_bf16 v[60:63], v[32:35], a[204:207], v[60:63]
    v_xor_b32 v7, 48, v6
    s_add_u32 m0, s81, 3072
    s_add_u32 s79, s70, 3072
    buffer_load_dwordx4 v7, s[60:63], s79 offen sc1 lds
    v_mfma_f32_16x16x32_bf16 v[64:67], v[36:39], a[12:15], v[64:67]
    v_mfma_f32_16x16x32_bf16 v[68:71], v[36:39], a[76:79], v[68:71]
    v_mfma_f32_16x16x32_bf16 v[72:75], v[36:39], a[140:143], v[72:75]
    v_mfma_f32_16x16x32_bf16 v[76:79], v[36:39], a[204:207], v[76:79]
    v_mfma_f32_16x16x32_bf16 v[80:83], v[40:43], a[12:15], v[80:83]
    v_mfma_f32_16x16x32_bf16 v[84:87], v[40:43], a[76:79], v[84:87]
    v_mfma_f32_16x16x32_bf16 v[88:91], v[40:43], a[140:143], v[88:91]
    v_mfma_f32_16x16x32_bf16 v[92:95], v[40:43], a[204:207], v[92:95]
    v_mfma_f32_16x16x32_bf16 v[96:99], v[44:47], a[12:15], v[96:99]
    v_mfma_f32_16x16x32_bf16 v[100:103], v[44:47], a[76:79], v[100:103]
    v_mfma_f32_16x16x32_bf16 v[104:107], v[44:47], a[140:143], v[104:107]
    v_mfma_f32_16x16x32_bf16 v[108:111], v[44:47], a[204:207], v[108:111]
    ds_read_b128 v[32:35], v133 offset:256
    ds_read_b128 v[36:39], v133 offset:4352
    ds_read_b128 v[40:43], v133 offset:33024
    ds_read_b128 v[44:47], v133 offset:37120
    s_waitcnt lgkmcnt(4)
    v_mfma_f32_16x16x32_bf16 v[48:51], v[16:19], a[16:19], v[48:51]
    v_mfma_f32_16x16x32_bf16 v[52:55], v[16:19], a[80:83], v[52:55]
    v_mfma_f32_16x16x32_bf16 v[56:59], v[16:19], a[144:147], v[56:59]
    v_mfma_f32_16x16x32_bf16 v[60:63], v[16:19], a[208:211], v[60:63]
    v_xor_b32 v7, 64, v6
    s_add_u32 m0, s81, 8192
    s_add_u32 s79, s70, 8192
    buffer_load_dwordx4 v7, s[60:63], s79 offen sc1 lds
    v_mfma_f32_16x16x32_bf16 v[64:67], v[20:23], a[16:19], v[64:67]
    v_mfma_f32_16x16x32_bf16 v[68:71], v[20:23], a[80:83], v[68:71]
    v_mfma_f32_16x16x32_bf16 v[72:75], v[20:23], a[144:147], v[72:75]
    v_mfma_f32_16x16x32_bf16 v[76:79], v[20:23], a[208:211], v[76:79]
    v_mfma_f32_16x16x32_bf16 v[80:83], v[24:27], a[16:19], v[80:83]
    v_mfma_f32_16x16x32_bf16 v[84:87], v[24:27], a[80:83], v[84:87]
    v_mfma_f32_16x16x32_bf16 v[88:91], v[24:27], a[144:147], v[88:91]
    v_mfma_f32_16x16x32_bf16 v[92:95], v[24:27], a[208:211], v[92:95]
    v_mfma_f32_16x16x32_bf16 v[96:99], v[28:31], a[16:19], v[96:99]
    v_mfma_f32_16x16x32_bf16 v[100:103], v[28:31], a[80:83], v[100:103]
    v_mfma_f32_16x16x32_bf16 v[104:107], v[28:31], a[144:147], v[104:107]
    v_mfma_f32_16x16x32_bf16 v[108:111], v[28:31], a[208:211], v[108:111]
    ds_read_b128 v[16:19], v134 offset:256
    ds_read_b128 v[20:23], v134 offset:4352
    ds_read_b128 v[24:27], v134 offset:33024
    ds_read_b128 v[28:31], v134 offset:37120
    s_waitcnt lgkmcnt(4)
    v_mfma_f32_16x16x32_bf16 v[48:51], v[32:35], a[20:23], v[48:51]
    v_mfma_f32_16x16x32_bf16 v[52:55], v[32:35], a[84:87], v[52:55]
    v_mfma_f32_16x16x32_bf16 v[56:59], v[32:35], a[148:151], v[56:59]
    v_mfma_f32_16x16x32_bf16 v[60:63], v[32:35], a[212:215], v[60:63]
    v_xor_b32 v7, 80, v6
    s_add_u32 m0, s81, 9216
    s_add_u32 s79, s70, 9216
    buffer_load_dwordx4 v7, s[60:63], s79 offen sc1 lds
    v_mfma_f32_16x16x32_bf16 v[64:67], v[36:39], a[20:23], v[64:67]
    v_mfma_f32_16x16x32_bf16 v[68:71], v[36:39], a[84:87], v[68:71]
    v_mfma_f32_16x16x32_bf16 v[72:75], v[36:39], a[148:151], v[72:75]
    v_mfma_f32_16x16x32_bf16 v[76:79], v[36:39], a[212:215], v[76:79]
    v_mfma_f32_16x16x32_bf16 v[80:83], v[40:43], a[20:23], v[80:83]
    v_mfma_f32_16x16x32_bf16 v[84:87], v[40:43], a[84:87], v[84:87]
    v_mfma_f32_16x16x32_bf16 v[88:91], v[40:43], a[148:151], v[88:91]
    v_mfma_f32_16x16x32_bf16 v[92:95], v[40:43], a[212:215], v[92:95]
    v_mfma_f32_16x16x32_bf16 v[96:99], v[44:47], a[20:23], v[96:99]
    v_mfma_f32_16x16x32_bf16 v[100:103], v[44:47], a[84:87], v[100:103]
    v_mfma_f32_16x16x32_bf16 v[104:107], v[44:47], a[148:151], v[104:107]
    v_mfma_f32_16x16x32_bf16 v[108:111], v[44:47], a[212:215], v[108:111]
    ds_read_b128 v[32:35], v135 offset:256
    ds_read_b128 v[36:39], v135 offset:4352
    ds_read_b128 v[40:43], v135 offset:33024
    ds_read_b128 v[44:47], v135 offset:37120
    s_waitcnt lgkmcnt(4)
    v_mfma_f32_16x16x32_bf16 v[48:51], v[16:19], a[24:27], v[48:51]
    v_mfma_f32_16x16x32_bf16 v[52:55], v[16:19], a[88:91], v[52:55]
    v_mfma_f32_16x16x32_bf16 v[56:59], v[16:19], a[152:155], v[56:59]
    v_mfma_f32_16x16x32_bf16 v[60:63], v[16:19], a[216:219], v[60:63]
    v_xor_b32 v7, 96, v6
    s_add_u32 m0, s81, 10240
    s_add_u32 s79, s70, 10240
    buffer_load_dwordx4 v7, s[60:63], s79 offen sc1 lds
    v_mfma_f32_16x16x32_bf16 v[64:67], v[20:23], a[24:27], v[64:67]
    v_mfma_f32_16x16x32_bf16 v[68:71], v[20:23], a[88:91], v[68:71]
    v_mfma_f32_16x16x32_bf16 v[72:75], v[20:23], a[152:155], v[72:75]
    v_mfma_f32_16x16x32_bf16 v[76:79], v[20:23], a[216:219], v[76:79]
    v_mfma_f32_16x16x32_bf16 v[80:83], v[24:27], a[24:27], v[80:83]
    v_mfma_f32_16x16x32_bf16 v[84:87], v[24:27], a[88:91], v[84:87]
    v_mfma_f32_16x16x32_bf16 v[88:91], v[24:27], a[152:155], v[88:91]
    v_mfma_f32_16x16x32_bf16 v[92:95], v[24:27], a[216:219], v[92:95]
    v_mfma_f32_16x16x32_bf16 v[96:99], v[28:31], a[24:27], v[96:99]
    v_mfma_f32_16x16x32_bf16 v[100:103], v[28:31], a[88:91], v[100:103]
    v_mfma_f32_16x16x32_bf16 v[104:107], v[28:31], a[152:155], v[104:107]
    v_mfma_f32_16x16x32_bf16 v[108:111], v[28:31], a[216:219], v[108:111]
    ds_read_b128 v[16:19], v132 offset:512
    ds_read_b128 v[20:23], v132 offset:4608
    ds_read_b128 v[24:27], v132 offset:33280
    ds_read_b128 v[28:31], v132 offset:37376
    s_waitcnt lgkmcnt(4)
    v_mfma_f32_16x16x32_bf16 v[48:51], v[32:35], a[28:31], v[48:51]
    v_mfma_f32_16x16x32_bf16 v[52:55], v[32:35], a[92:95], v[52:55]
    v_mfma_f32_16x16x32_bf16 v[56:59], v[32:35], a[156:159], v[56:59]
    v_mfma_f32_16x16x32_bf16 v[60:63], v[32:35], a[220:223], v[60:63]
    v_xor_b32 v7, 112, v6
    s_add_u32 m0, s81, 11264
    s_add_u32 s79, s70, 11264
    buffer_load_dwordx4 v7, s[60:63], s79 offen sc1 lds
    v_mfma_f32_16x16x32_bf16 v[64:67], v[36:39], a[28:31], v[64:67]
    v_mfma_f32_16x16x32_bf16 v[68:71], v[36:39], a[92:95], v[68:71]
    v_mfma_f32_16x16x32_bf16 v[72:75], v[36:39], a[156:159], v[72:75]
    v_mfma_f32_16x16x32_bf16 v[76:79], v[36:39], a[220:223], v[76:79]
    v_mfma_f32_16x16x32_bf16 v[80:83], v[40:43], a[28:31], v[80:83]
    v_mfma_f32_16x16x32_bf16 v[84:87], v[40:43], a[92:95], v[84:87]
    v_mfma_f32_16x16x32_bf16 v[88:91], v[40:43], a[156:159], v[88:91]
    v_mfma_f32_16x16x32_bf16 v[92:95], v[40:43], a[220:223], v[92:95]
    v_mfma_f32_16x16x32_bf16 v[96:99], v[44:47], a[28:31], v[96:99]
    v_mfma_f32_16x16x32_bf16 v[100:103], v[44:47], a[92:95], v[100:103]
    v_mfma_f32_16x16x32_bf16 v[104:107], v[44:47], a[156:159], v[104:107]
    v_mfma_f32_16x16x32_bf16 v[108:111], v[44:47], a[220:223], v[108:111]
    ds_read_b128 v[32:35], v133 offset:512
    ds_read_b128 v[36:39], v133 offset:4608
    ds_read_b128 v[40:43], v133 offset:33280
    ds_read_b128 v[44:47], v133 offset:37376
    s_waitcnt lgkmcnt(4)
    v_mfma_f32_16x16x32_bf16 v[48:51], v[16:19], a[32:35], v[48:51]
    v_mfma_f32_16x16x32_bf16 v[52:55], v[16:19], a[96:99], v[52:55]
    v_mfma_f32_16x16x32_bf16 v[56:59], v[16:19], a[160:163], v[56:59]
    v_mfma_f32_16x16x32_bf16 v[60:63], v[16:19], a[224:227], v[60:63]
    v_xor_b32 v7, 128, v6
    s_add_u32 m0, s81, 16384
    s_add_u32 s79, s70, 16384
    buffer_load_dwordx4 v7, s[60:63], s79 offen sc1 lds
    v_mfma_f32_16x16x32_bf16 v[64:67], v[20:23], a[32:35], v[64:67]
    v_mfma_f32_16x16x32_bf16 v[68:71], v[20:23], a[96:99], v[68:71]
    v_mfma_f32_16x16x32_bf16 v[72:75], v[20:23], a[160:163], v[72:75]
    v_mfma_f32_16x16x32_bf16 v[76:79], v[20:23], a[224:227], v[76:79]
    v_mfma_f32_16x16x32_bf16 v[80:83], v[24:27], a[32:35], v[80:83]
    v_mfma_f32_16x16x32_bf16 v[84:87], v[24:27], a[96:99], v[84:87]
    v_mfma_f32_16x16x32_bf16 v[88:91], v[24:27], a[160:163], v[88:91]
    v_mfma_f32_16x16x32_bf16 v[92:95], v[24:27], a[224:227], v[92:95]
    v_mfma_f32_16x16x32_bf16 v[96:99], v[28:31], a[32:35], v[96:99]
    v_mfma_f32_16x16x32_bf16 v[100:103], v[28:31], a[96:99], v[100:103]
    v_mfma_f32_16x16x32_bf16 v[104:107], v[28:31], a[160:163], v[104:107]
    v_mfma_f32_16x16x32_bf16 v[108:111], v[28:31], a[224:227], v[108:111]
    ds_read_b128 v[16:19], v134 offset:512
    ds_read_b128 v[20:23], v134 offset:4608
    ds_read_b128 v[24:27], v134 offset:33280
    ds_read_b128 v[28:31], v134 offset:37376
    s_waitcnt lgkmcnt(4)
    v_mfma_f32_16x16x32_bf16 v[48:51], v[32:35], a[36:39], v[48:51]
    v_mfma_f32_16x16x32_bf16 v[52:55], v[32:35], a[100:103], v[52:55]
    v_mfma_f32_16x16x32_bf16 v[56:59], v[32:35], a[164:167], v[56:59]
    v_mfma_f32_16x16x32_bf16 v[60:63], v[32:35], a[228:231], v[60:63]
    v_xor_b32 v7, 144, v6
    s_add_u32 m0, s81, 17408
    s_add_u32 s79, s70, 17408
    buffer_load_dwordx4 v7, s[60:63], s79 offen sc1 lds
    v_mfma_f32_16x16x32_bf16 v[64:67], v[36:39], a[36:39], v[64:67]
    v_mfma_f32_16x16x32_bf16 v[68:71], v[36:39], a[100:103], v[68:71]
    v_mfma_f32_16x16x32_bf16 v[72:75], v[36:39], a[164:167], v[72:75]
    v_mfma_f32_16x16x32_bf16 v[76:79], v[36:39], a[228:231], v[76:79]
    v_mfma_f32_16x16x32_bf16 v[80:83], v[40:43], a[36:39], v[80:83]
    v_mfma_f32_16x16x32_bf16 v[84:87], v[40:43], a[100:103], v[84:87]
    v_mfma_f32_16x16x32_bf16 v[88:91], v[40:43], a[164:167], v[88:91]
    v_mfma_f32_16x16x32_bf16 v[92:95], v[40:43], a[228:231], v[92:95]
    v_mfma_f32_16x16x32_bf16 v[96:99], v[44:47], a[36:39], v[96:99]
    v_mfma_f32_16x16x32_bf16 v[100:103], v[44:47], a[100:103], v[100:103]
    v_mfma_f32_16x16x32_bf16 v[104:107], v[44:47], a[164:167], v[104:107]
    v_mfma_f32_16x16x32_bf16 v[108:111], v[44:47], a[228:231], v[108:111]
    ds_read_b128 v[32:35], v135 offset:512
    ds_read_b128 v[36:39], v135 offset:4608
    ds_read_b128 v[40:43], v135 offset:33280
    ds_read_b128 v[44:47], v135 offset:37376
    s_waitcnt lgkmcnt(4)
    v_mfma_f32_16x16x32_bf16 v[48:51], v[16:19], a[40:43], v[48:51]
    v_mfma_f32_16x16x32_bf16 v[52:55], v[16:19], a[104:107], v[52:55]
    v_mfma_f32_16x16x32_bf16 v[56:59], v[16:19], a[168:171], v[56:59]
    v_mfma_f32_16x16x32_bf16 v[60:63], v[16:19], a[232:235], v[60:63]
    v_xor_b32 v7, 160, v6
    s_add_u32 m0, s81, 18432
    s_add_u32 s79, s70, 18432
    buffer_load_dwordx4 v7, s[60:63], s79 offen sc1 lds
    v_mfma_f32_16x16x32_bf16 v[64:67], v[20:23], a[40:43], v[64:67]
    v_mfma_f32_16x16x32_bf16 v[68:71], v[20:23], a[104:107], v[68:71]
    v_mfma_f32_16x16x32_bf16 v[72:75], v[20:23], a[168:171], v[72:75]
    v_mfma_f32_16x16x32_bf16 v[76:79], v[20:23], a[232:235], v[76:79]
    v_mfma_f32_16x16x32_bf16 v[80:83], v[24:27], a[40:43], v[80:83]
    v_mfma_f32_16x16x32_bf16 v[84:87], v[24:27], a[104:107], v[84:87]
    v_mfma_f32_16x16x32_bf16 v[88:91], v[24:27], a[168:171], v[88:91]
    v_mfma_f32_16x16x32_bf16 v[92:95], v[24:27], a[232:235], v[92:95]
    v_mfma_f32_16x16x32_bf16 v[96:99], v[28:31], a[40:43], v[96:99]
    v_mfma_f32_16x16x32_bf16 v[100:103], v[28:31], a[104:107], v[100:103]
    v_mfma_f32_16x16x32_bf16 v[104:107], v[28:31], a[168:171], v[104:107]
    v_mfma_f32_16x16x32_bf16 v[108:111], v[28:31], a[232:235], v[108:111]
    ds_read_b128 v[16:19], v132 offset:768
    ds_read_b128 v[20:23], v132 offset:4864
    ds_read_b128 v[24:27], v132 offset:33536
    ds_read_b128 v[28:31], v132 offset:37632
    s_waitcnt lgkmcnt(4)
    v_mfma_f32_16x16x32_bf16 v[48:51], v[32:35], a[44:47], v[48:51]
    v_mfma_f32_16x16x32_bf16 v[52:55], v[32:35], a[108:111], v[52:55]
    v_mfma_f32_16x16x32_bf16 v[56:59], v[32:35], a[172:175], v[56:59]
    v_mfma_f32_16x16x32_bf16 v[60:63], v[32:35], a[236:239], v[60:63]
    v_xor_b32 v7, 176, v6
    s_add_u32 m0, s81, 19456
    s_add_u32 s79, s70, 19456
    buffer_load_dwordx4 v7, s[60:63], s79 offen sc1 lds
    v_mfma_f32_16x16x32_bf16 v[64:67], v[36:39], a[44:47], v[64:67]
    v_mfma_f32_16x16x32_bf16 v[68:71], v[36:39], a[108:111], v[68:71]
    v_mfma_f32_16x16x32_bf16 v[72:75], v[36:39], a[172:175], v[72:75]
    v_mfma_f32_16x16x32_bf16 v[76:79], v[36:39], a[236:239], v[76:79]
    v_mfma_f32_16x16x32_bf16 v[80:83], v[40:43], a[44:47], v[80:83]
    v_mfma_f32_16x16x32_bf16 v[84:87], v[40:43], a[108:111], v[84:87]
    v_mfma_f32_16x16x32_bf16 v[88:91], v[40:43], a[172:175], v[88:91]
    v_mfma_f32_16x16x32_bf16 v[92:95], v[40:43], a[236:239], v[92:95]
    v_mfma_f32_16x16x32_bf16 v[96:99], v[44:47], a[44:47], v[96:99]
    v_mfma_f32_16x16x32_bf16 v[100:103], v[44:47], a[108:111], v[100:103]
    v_mfma_f32_16x16x32_bf16 v[104:107], v[44:47], a[172:175], v[104:107]
    v_mfma_f32_16x16x32_bf16 v[108:111], v[44:47], a[236:239], v[108:111]
    ds_read_b128 v[32:35], v133 offset:768
    ds_read_b128 v[36:39], v133 offset:4864
    ds_read_b128 v[40:43], v133 offset:33536
    ds_read_b128 v[44:47], v133 offset:37632
    s_waitcnt lgkmcnt(4)
    v_mfma_f32_16x16x32_bf16 v[48:51], v[16:19], a[48:51], v[48:51]
    v_mfma_f32_16x16x32_bf16 v[52:55], v[16:19], a[112:115], v[52:55]
    v_mfma_f32_16x16x32_bf16 v[56:59], v[16:19], a[176:179], v[56:59]
    v_mfma_f32_16x16x32_bf16 v[60:63], v[16:19], a[240:243], v[60:63]
    v_xor_b32 v7, 192, v6
    s_add_u32 m0, s81, 24576
    s_add_u32 s79, s70, 24576
    buffer_load_dwordx4 v7, s[60:63], s79 offen sc1 lds
    v_mfma_f32_16x16x32_bf16 v[64:67], v[20:23], a[48:51], v[64:67]
    v_mfma_f32_16x16x32_bf16 v[68:71], v[20:23], a[112:115], v[68:71]
    v_mfma_f32_16x16x32_bf16 v[72:75], v[20:23], a[176:179], v[72:75]
    v_mfma_f32_16x16x32_bf16 v[76:79], v[20:23], a[240:243], v[76:79]
    v_mfma_f32_16x16x32_bf16 v[80:83], v[24:27], a[48:51], v[80:83]
    v_mfma_f32_16x16x32_bf16 v[84:87], v[24:27], a[112:115], v[84:87]
    v_mfma_f32_16x16x32_bf16 v[88:91], v[24:27], a[176:179], v[88:91]
    v_mfma_f32_16x16x32_bf16 v[92:95], v[24:27], a[240:243], v[92:95]
    v_mfma_f32_16x16x32_bf16 v[96:99], v[28:31], a[48:51], v[96:99]
    v_mfma_f32_16x16x32_bf16 v[100:103], v[28:31], a[112:115], v[100:103]
    v_mfma_f32_16x16x32_bf16 v[104:107], v[28:31], a[176:179], v[104:107]
    v_mfma_f32_16x16x32_bf16 v[108:111], v[28:31], a[240:243], v[108:111]
    ds_read_b128 v[16:19], v134 offset:768
    ds_read_b128 v[20:23], v134 offset:4864
    ds_read_b128 v[24:27], v134 offset:33536
    ds_read_b128 v[28:31], v134 offset:37632
    s_waitcnt lgkmcnt(4)
    v_mfma_f32_16x16x32_bf16 v[48:51], v[32:35], a[52:55], v[48:51]
    v_mfma_f32_16x16x32_bf16 v[52:55], v[32:35], a[116:119], v[52:55]
    v_mfma_f32_16x16x32_bf16 v[56:59], v[32:35], a[180:183], v[56:59]
    v_mfma_f32_16x16x32_bf16 v[60:63], v[32:35], a[244:247], v[60:63]
    v_xor_b32 v7, 208, v6
    s_add_u32 m0, s81, 25600
    s_add_u32 s79, s70, 25600
    buffer_load_dwordx4 v7, s[60:63], s79 offen sc1 lds
    v_mfma_f32_16x16x32_bf16 v[64:67], v[36:39], a[52:55], v[64:67]
    v_mfma_f32_16x16x32_bf16 v[68:71], v[36:39], a[116:119], v[68:71]
    v_mfma_f32_16x16x32_bf16 v[72:75], v[36:39], a[180:183], v[72:75]
    v_mfma_f32_16x16x32_bf16 v[76:79], v[36:39], a[244:247], v[76:79]
    v_mfma_f32_16x16x32_bf16 v[80:83], v[40:43], a[52:55], v[80:83]
    v_mfma_f32_16x16x32_bf16 v[84:87], v[40:43], a[116:119], v[84:87]
    v_mfma_f32_16x16x32_bf16 v[88:91], v[40:43], a[180:183], v[88:91]
    v_mfma_f32_16x16x32_bf16 v[92:95], v[40:43], a[244:247], v[92:95]
    v_mfma_f32_16x16x32_bf16 v[96:99], v[44:47], a[52:55], v[96:99]
    v_mfma_f32_16x16x32_bf16 v[100:103], v[44:47], a[116:119], v[100:103]
    v_mfma_f32_16x16x32_bf16 v[104:107], v[44:47], a[180:183], v[104:107]
    v_mfma_f32_16x16x32_bf16 v[108:111], v[44:47], a[244:247], v[108:111]
    ds_read_b128 v[32:35], v135 offset:768
    ds_read_b128 v[36:39], v135 offset:4864
    ds_read_b128 v[40:43], v135 offset:33536
    ds_read_b128 v[44:47], v135 offset:37632
    s_waitcnt lgkmcnt(4)
    v_mfma_f32_16x16x32_bf16 v[48:51], v[16:19], a[56:59], v[48:51]
    v_mfma_f32_16x16x32_bf16 v[52:55], v[16:19], a[120:123], v[52:55]
    v_mfma_f32_16x16x32_bf16 v[56:59], v[16:19], a[184:187], v[56:59]
    v_mfma_f32_16x16x32_bf16 v[60:63], v[16:19], a[248:251], v[60:63]
    v_xor_b32 v7, 224, v6
    s_add_u32 m0, s81, 26624
    s_add_u32 s79, s70, 26624
    buffer_load_dwordx4 v7, s[60:63], s79 offen sc1 lds
    v_mfma_f32_16x16x32_bf16 v[64:67], v[20:23], a[56:59], v[64:67]
    v_mfma_f32_16x16x32_bf16 v[68:71], v[20:23], a[120:123], v[68:71]
    v_mfma_f32_16x16x32_bf16 v[72:75], v[20:23], a[184:187], v[72:75]
    v_mfma_f32_16x16x32_bf16 v[76:79], v[20:23], a[248:251], v[76:79]
    v_mfma_f32_16x16x32_bf16 v[80:83], v[24:27], a[56:59], v[80:83]
    v_mfma_f32_16x16x32_bf16 v[84:87], v[24:27], a[120:123], v[84:87]
    v_mfma_f32_16x16x32_bf16 v[88:91], v[24:27], a[184:187], v[88:91]
    v_mfma_f32_16x16x32_bf16 v[92:95], v[24:27], a[248:251], v[92:95]
    v_mfma_f32_16x16x32_bf16 v[96:99], v[28:31], a[56:59], v[96:99]
    v_mfma_f32_16x16x32_bf16 v[100:103], v[28:31], a[120:123], v[100:103]
    v_mfma_f32_16x16x32_bf16 v[104:107], v[28:31], a[184:187], v[104:107]
    v_mfma_f32_16x16x32_bf16 v[108:111], v[28:31], a[248:251], v[108:111]
    s_waitcnt lgkmcnt(0)
    v_mfma_f32_16x16x32_bf16 v[48:51], v[32:35], a[60:63], v[48:51]
    v_mfma_f32_16x16x32_bf16 v[52:55], v[32:35], a[124:127], v[52:55]
    v_mfma_f32_16x16x32_bf16 v[56:59], v[32:35], a[188:191], v[56:59]
    v_mfma_f32_16x16x32_bf16 v[60:63], v[32:35], a[252:255], v[60:63]
    v_xor_b32 v7, 240, v6
    s_add_u32 m0, s81, 27648
    s_add_u32 s79, s70, 27648
    buffer_load_dwordx4 v7, s[60:63], s79 offen sc1 lds
    v_mfma_f32_16x16x32_bf16 v[64:67], v[36:39], a[60:63], v[64:67]
    v_mfma_f32_16x16x32_bf16 v[68:71], v[36:39], a[124:127], v[68:71]
    v_mfma_f32_16x16x32_bf16 v[72:75], v[36:39], a[188:191], v[72:75]
    v_mfma_f32_16x16x32_bf16 v[76:79], v[36:39], a[252:255], v[76:79]
    v_mfma_f32_16x16x32_bf16 v[80:83], v[40:43], a[60:63], v[80:83]
    v_mfma_f32_16x16x32_bf16 v[84:87], v[40:43], a[124:127], v[84:87]
    v_mfma_f32_16x16x32_bf16 v[88:91], v[40:43], a[188:191], v[88:91]
    v_mfma_f32_16x16x32_bf16 v[92:95], v[40:43], a[252:255], v[92:95]
    v_mfma_f32_16x16x32_bf16 v[96:99], v[44:47], a[60:63], v[96:99]
    v_mfma_f32_16x16x32_bf16 v[100:103], v[44:47], a[124:127], v[100:103]
    v_mfma_f32_16x16x32_bf16 v[104:107], v[44:47], a[188:191], v[104:107]
    v_mfma_f32_16x16x32_bf16 v[108:111], v[44:47], a[252:255], v[108:111]
    s_add_u32 s70, s70, 65536
    s_add_u32 s77, s73, 0
    v_cvt_pk_bf16_f32 v112, v48, v49
    v_cvt_pk_bf16_f32 v113, v50, v51
    v_cvt_pk_bf16_f32 v114, v64, v65
    v_cvt_pk_bf16_f32 v115, v66, v67
    buffer_store_dwordx4 v[112:115], v1, s[52:55], s77 offen offset:0 sc1
    v_cvt_pk_bf16_f32 v116, v52, v53
    v_cvt_pk_bf16_f32 v117, v54, v55
    v_cvt_pk_bf16_f32 v118, v68, v69
    v_cvt_pk_bf16_f32 v119, v70, v71
    buffer_store_dwordx4 v[116:119], v1, s[52:55], s77 offen offset:128 sc1
    s_add_u32 s77, s73, 131072
    v_cvt_pk_bf16_f32 v112, v56, v57
    v_cvt_pk_bf16_f32 v113, v58, v59
    v_cvt_pk_bf16_f32 v114, v72, v73
    v_cvt_pk_bf16_f32 v115, v74, v75
    buffer_store_dwordx4 v[112:115], v1, s[52:55], s77 offen offset:0 sc1
    v_cvt_pk_bf16_f32 v116, v60, v61
    v_cvt_pk_bf16_f32 v117, v62, v63
    v_cvt_pk_bf16_f32 v118, v76, v77
    v_cvt_pk_bf16_f32 v119, v78, v79
    buffer_store_dwordx4 v[116:119], v1, s[52:55], s77 offen offset:128 sc1
    s_add_u32 s77, s73, 1024
    v_cvt_pk_bf16_f32 v112, v80, v81
    v_cvt_pk_bf16_f32 v113, v82, v83
    v_cvt_pk_bf16_f32 v114, v96, v97
    v_cvt_pk_bf16_f32 v115, v98, v99
    buffer_store_dwordx4 v[112:115], v1, s[52:55], s77 offen offset:0 sc1
    v_cvt_pk_bf16_f32 v116, v84, v85
    v_cvt_pk_bf16_f32 v117, v86, v87
    v_cvt_pk_bf16_f32 v118, v100, v101
    v_cvt_pk_bf16_f32 v119, v102, v103
    buffer_store_dwordx4 v[116:119], v1, s[52:55], s77 offen offset:128 sc1
    s_add_u32 s77, s73, 132096
    v_cvt_pk_bf16_f32 v112, v88, v89
    v_cvt_pk_bf16_f32 v113, v90, v91
    v_cvt_pk_bf16_f32 v114, v104, v105
    v_cvt_pk_bf16_f32 v115, v106, v107
    buffer_store_dwordx4 v[112:115], v1, s[52:55], s77 offen offset:0 sc1
    v_cvt_pk_bf16_f32 v116, v92, v93
    v_cvt_pk_bf16_f32 v117, v94, v95
    v_cvt_pk_bf16_f32 v118, v108, v109
    v_cvt_pk_bf16_f32 v119, v110, v111
    buffer_store_dwordx4 v[116:119], v1, s[52:55], s77 offen offset:128 sc1
    s_add_u32 s73, s73, 2048
    s_add_u32 s83, s83, 1
    s_cmp_lt_u32 s83, s72
    s_cbranch_scc1 L_wsg2n_161
    s_waitcnt vmcnt(0)
    s_barrier
    s_cmp_lg_u32 s56, 0
    s_cbranch_scc1 L_wsg_163
    s_mov_b32 s80, 20
    v_mov_b32 v120, 1
    v_mov_b32 v121, s80
    s_mov_b64 exec, 1
    buffer_atomic_add v120, v121, s[48:51], 0 offen
    s_mov_b64 exec, -1
L_wsg_163:
    s_branch L_next
L_task_g3:
    s_sub_u32 s78, s88, 664
    s_lshr_b32 s89, s78, 2
    s_and_b32 s90, s78, 3
    v_mov_b32 v121, 24
L_wt_164:
    buffer_load_dword v120, v121, s[48:51], 0 offen sc1
    s_waitcnt vmcnt(0)
    v_readfirstlane_b32 s77, v120
    s_nop 0
    s_cmp_ge_u32 s77, 256
    s_cbranch_scc1 L_wd_165
    s_sleep 32
    s_branch L_wt_164
L_wd_165:
    s_mov_b32 s60, s52
    s_mov_b32 s61, s53
    s_mov_b32 s62, s54
    s_mov_b32 s63, s55
    s_mov_b32 s64, s16
    s_mov_b32 s65, s17
    s_mov_b32 s66, s18
    s_mov_b32 s67, s19
    s_mov_b32 s68, 1024
    s_mov_b32 s69, 1024
    s_mov_b32 s72, 2
    s_lshl_b32 s70, s89, 17
    s_add_u32 s70, s70, 90177536
    s_lshl_b32 s71, s90, 8
    v_and_b32 v10, 63, v0
    v_lshrrev_b32 v11, 3, v10
    v_and_b32 v12, 7, v10
    v_and_b32 v13, 3, v11
    v_xor_b32 v12, v12, v13
    s_mul_i32 s77, s56, 32
    v_add_u32 v11, s77, v11
    v_mul_lo_u32 v11, v11, s68
    v_lshl_add_u32 v2, v12, 4, v11
    v_xor_b32 v3, 64, v2
    v_lshrrev_b32 v11, 4, v10
    v_and_b32 v12, 15, v10
    v_lshlrev_b32 v13, 2, v11
    v_xor_b32 v12, v12, v13
    s_lshl_b32 s77, s56, 4
    v_add_u32 v11, s77, v11
    v_mul_lo_u32 v11, v11, s69
    v_lshl_add_u32 v4, v12, 4, v11
    s_lshl_b32 s83, s68, 3
    s_lshl_b32 s84, s69, 2
    s_mul_i32 s81, s56, 4096
    s_lshl_b32 s82, s56, 12
    s_add_u32 s82, s82, 16384
    v_and_b32 v11, 15, v10
    v_lshrrev_b32 v12, 4, v10
    v_lshrrev_b32 v13, 2, v11
    v_and_b32 v14, 3, v11
    v_lshl_add_u32 v15, v13, 3, v14
    s_lshr_b32 s77, s56, 1
    s_mul_i32 s77, s77, 64
    v_add_u32 v15, s77, v15
    v_and_b32 v7, 1, v13
    v_lshl_add_u32 v7, v7, 2, v14
    v_xor_b32 v7, v7, v12
    v_lshlrev_b32 v7, 4, v7
    v_lshl_add_u32 v5, v15, 7, v7
    v_xor_b32 v6, 64, v5
    v_lshl_add_u32 v15, v12, 3, v13
    s_and_b32 s77, s56, 1
    s_mul_i32 s77, s77, 2
    s_add_u32 s78, s77, 0
    v_xor_b32 v7, s78, v13
    v_lshl_add_u32 v7, v7, 2, v14
    v_lshlrev_b32 v7, 4, v7
    v_lshl_add_u32 v8, v15, 8, v7
    v_add_u32 v8, 16384, v8
    s_add_u32 s78, s77, 1
    v_xor_b32 v7, s78, v13
    v_lshl_add_u32 v7, v7, 2, v14
    v_lshlrev_b32 v7, 4, v7
    v_lshl_add_u32 v9, v15, 8, v7
    v_add_u32 v9, 16384, v9
    v_add_u32 v105, 65536, v5
    v_add_u32 v106, 65536, v6
    v_add_u32 v108, 65536, v8
    v_add_u32 v109, 65536, v9
    v_accvgpr_write_b32 a0, 0
    v_accvgpr_write_b32 a1, 0
    v_accvgpr_write_b32 a2, 0
    v_accvgpr_write_b32 a3, 0
    v_accvgpr_write_b32 a4, 0
    v_accvgpr_write_b32 a5, 0
    v_accvgpr_write_b32 a6, 0
    v_accvgpr_write_b32 a7, 0
    v_accvgpr_write_b32 a8, 0
    v_accvgpr_write_b32 a9, 0
    v_accvgpr_write_b32 a10, 0
    v_accvgpr_write_b32 a11, 0
    v_accvgpr_write_b32 a12, 0
    v_accvgpr_write_b32 a13, 0
    v_accvgpr_write_b32 a14, 0
    v_accvgpr_write_b32 a15, 0
    v_accvgpr_write_b32 a16, 0
    v_accvgpr_write_b32 a17, 0
    v_accvgpr_write_b32 a18, 0
    v_accvgpr_write_b32 a19, 0
    v_accvgpr_write_b32 a20, 0
    v_accvgpr_write_b32 a21, 0
    v_accvgpr_write_b32 a22, 0
    v_accvgpr_write_b32 a23, 0
    v_accvgpr_write_b32 a24, 0
    v_accvgpr_write_b32 a25, 0
    v_accvgpr_write_b32 a26, 0
    v_accvgpr_write_b32 a27, 0
    v_accvgpr_write_b32 a28, 0
    v_accvgpr_write_b32 a29, 0
    v_accvgpr_write_b32 a30, 0
    v_accvgpr_write_b32 a31, 0
    v_accvgpr_write_b32 a32, 0
    v_accvgpr_write_b32 a33, 0
    v_accvgpr_write_b32 a34, 0
    v_accvgpr_write_b32 a35, 0
    v_accvgpr_write_b32 a36, 0
    v_accvgpr_write_b32 a37, 0
    v_accvgpr_write_b32 a38, 0
    v_accvgpr_write_b32 a39, 0
    v_accvgpr_write_b32 a40, 0
    v_accvgpr_write_b32 a41, 0
    v_accvgpr_write_b32 a42, 0
    v_accvgpr_write_b32 a43, 0
    v_accvgpr_write_b32 a44, 0
    v_accvgpr_write_b32 a45, 0
    v_accvgpr_write_b32 a46, 0
    v_accvgpr_write_b32 a47, 0
    v_accvgpr_write_b32 a48, 0
    v_accvgpr_write_b32 a49, 0
    v_accvgpr_write_b32 a50, 0
    v_accvgpr_write_b32 a51, 0
    v_accvgpr_write_b32 a52, 0
    v_accvgpr_write_b32 a53, 0
    v_accvgpr_write_b32 a54, 0
    v_accvgpr_write_b32 a55, 0
    v_accvgpr_write_b32 a56, 0
    v_accvgpr_write_b32 a57, 0
    v_accvgpr_write_b32 a58, 0
    v_accvgpr_write_b32 a59, 0
    v_accvgpr_write_b32 a60, 0
    v_accvgpr_write_b32 a61, 0
    v_accvgpr_write_b32 a62, 0
    v_accvgpr_write_b32 a63, 0
    s_barrier
    s_mov_b32 s79, s70
    s_add_u32 m0, s81, 0
    s_nop 0
    buffer_load_dwordx4 v2, s[60:63], s79 offen sc1 lds
    s_add_u32 s79, s79, s83
    s_add_u32 m0, s81, 1024
    s_nop 0
    buffer_load_dwordx4 v3, s[60:63], s79 offen sc1 lds
    s_add_u32 s79, s79, s83
    s_add_u32 m0, s81, 2048
    s_nop 0
    buffer_load_dwordx4 v2, s[60:63], s79 offen sc1 lds
    s_add_u32 s79, s79, s83
    s_add_u32 m0, s81, 3072
    s_nop 0
    buffer_load_dwordx4 v3, s[60:63], s79 offen sc1 lds
    s_mov_b32 s79, s71
    s_add_u32 m0, s82, 0
    s_nop 0
    buffer_load_dwordx4 v4, s[64:67], s79 offen lds
    s_add_u32 s79, s79, s84
    s_add_u32 m0, s82, 1024
    s_nop 0
    buffer_load_dwordx4 v4, s[64:67], s79 offen lds
    s_add_u32 s79, s79, s84
    s_add_u32 m0, s82, 2048
    s_nop 0
    buffer_load_dwordx4 v4, s[64:67], s79 offen lds
    s_add_u32 s79, s79, s84
    s_add_u32 m0, s82, 3072
    s_nop 0
    buffer_load_dwordx4 v4, s[64:67], s79 offen lds
    s_add_u32 s70, s70, 128
    s_lshl_b32 s79, s69, 6
    s_add_u32 s71, s71, s79
    s_mov_b32 s79, s70
    s_add_u32 m0, s81, 32768
    s_nop 0
    buffer_load_dwordx4 v2, s[60:63], s79 offen sc1 lds
    s_add_u32 s79, s79, s83
    s_add_u32 m0, s81, 33792
    s_nop 0
    buffer_load_dwordx4 v3, s[60:63], s79 offen sc1 lds
    s_add_u32 s79, s79, s83
    s_add_u32 m0, s81, 34816
    s_nop 0
    buffer_load_dwordx4 v2, s[60:63], s79 offen sc1 lds
    s_add_u32 s79, s79, s83
    s_add_u32 m0, s81, 35840
    s_nop 0
    buffer_load_dwordx4 v3, s[60:63], s79 offen sc1 lds
    s_mov_b32 s79, s71
    s_add_u32 m0, s82, 32768
    s_nop 0
    buffer_load_dwordx4 v4, s[64:67], s79 offen lds
    s_add_u32 s79, s79, s84
    s_add_u32 m0, s82, 33792
    s_nop 0
    buffer_load_dwordx4 v4, s[64:67], s79 offen lds
    s_add_u32 s79, s79, s84
    s_add_u32 m0, s82, 34816
    s_nop 0
    buffer_load_dwordx4 v4, s[64:67], s79 offen lds
    s_add_u32 s79, s79, s84
    s_add_u32 m0, s82, 35840
    s_nop 0
    buffer_load_dwordx4 v4, s[64:67], s79 offen lds
    s_add_u32 s70, s70, 128
    s_lshl_b32 s79, s69, 6
    s_add_u32 s71, s71, s79
    s_mov_b32 s79, s70
    s_add_u32 m0, s81, 65536
    s_nop 0
    buffer_load_dwordx4 v2, s[60:63], s79 offen sc1 lds
    s_add_u32 s79, s79, s83
    s_add_u32 m0, s81, 66560
    s_nop 0
    buffer_load_dwordx4 v3, s[60:63], s79 offen sc1 lds
    s_add_u32 s79, s79, s83
    s_add_u32 m0, s81, 67584
    s_nop 0
    buffer_load_dwordx4 v2, s[60:63], s79 offen sc1 lds
    s_add_u32 s79, s79, s83
    s_add_u32 m0, s81, 68608
    s_nop 0
    buffer_load_dwordx4 v3, s[60:63], s79 offen sc1 lds
    s_mov_b32 s79, s71
    s_add_u32 m0, s82, 65536
    s_nop 0
    buffer_load_dwordx4 v4, s[64:67], s79 offen lds
    s_add_u32 s79, s79, s84
    s_add_u32 m0, s82, 66560
    s_nop 0
    buffer_load_dwordx4 v4, s[64:67], s79 offen lds
    s_add_u32 s79, s79, s84
    s_add_u32 m0, s82, 67584
    s_nop 0
    buffer_load_dwordx4 v4, s[64:67], s79 offen lds
    s_add_u32 s79, s79, s84
    s_add_u32 m0, s82, 68608
    s_nop 0
    buffer_load_dwordx4 v4, s[64:67], s79 offen lds
    s_add_u32 s70, s70, 128
    s_lshl_b32 s79, s69, 6
    s_add_u32 s71, s71, s79
L_g128T_166:
    s_waitcnt vmcnt(16)
    s_barrier
    ds_read_b128 v[16:19], v5 offset:0
    ds_read_b128 v[20:23], v5 offset:512
    ds_read_b128 v[24:27], v5 offset:4096
    ds_read_b128 v[28:31], v5 offset:4608
    ds_read_b64_tr_b16 v[48:49], v8 offset:0
    ds_read_b64_tr_b16 v[50:51], v8 offset:1024
    ds_read_b64_tr_b16 v[52:53], v8 offset:8
    ds_read_b64_tr_b16 v[54:55], v8 offset:1032
    ds_read_b64_tr_b16 v[56:57], v9 offset:0
    ds_read_b64_tr_b16 v[58:59], v9 offset:1024
    ds_read_b64_tr_b16 v[60:61], v9 offset:8
    ds_read_b64_tr_b16 v[62:63], v9 offset:1032
    s_mov_b32 s79, s70
    s_add_u32 m0, s81, 98304
    s_nop 0
    buffer_load_dwordx4 v2, s[60:63], s79 offen sc1 lds
    s_add_u32 s79, s79, s83
    s_add_u32 m0, s81, 99328
    s_nop 0
    buffer_load_dwordx4 v3, s[60:63], s79 offen sc1 lds
    s_add_u32 s79, s79, s83
    s_add_u32 m0, s81, 100352
    s_nop 0
    buffer_load_dwordx4 v2, s[60:63], s79 offen sc1 lds
    s_add_u32 s79, s79, s83
    s_add_u32 m0, s81, 101376
    s_nop 0
    buffer_load_dwordx4 v3, s[60:63], s79 offen sc1 lds
    s_mov_b32 s79, s71
    s_add_u32 m0, s82, 98304
    s_nop 0
    buffer_load_dwordx4 v4, s[64:67], s79 offen lds
    s_add_u32 s79, s79, s84
    s_add_u32 m0, s82, 99328
    s_nop 0
    buffer_load_dwordx4 v4, s[64:67], s79 offen lds
    s_add_u32 s79, s79, s84
    s_add_u32 m0, s82, 100352
    s_nop 0
    buffer_load_dwordx4 v4, s[64:67], s79 offen lds
    s_add_u32 s79, s79, s84
    s_add_u32 m0, s82, 101376
    s_nop 0
    buffer_load_dwordx4 v4, s[64:67], s79 offen lds
    s_add_u32 s70, s70, 128
    s_lshl_b32 s79, s69, 6
    s_add_u32 s71, s71, s79
    ds_read_b128 v[32:35], v6 offset:0
    ds_read_b128 v[36:39], v6 offset:512
    ds_read_b128 v[40:43], v6 offset:4096
    ds_read_b128 v[44:47], v6 offset:4608
    ds_read_b64_tr_b16 v[64:65], v8 offset:8192
    ds_read_b64_tr_b16 v[66:67], v8 offset:9216
    ds_read_b64_tr_b16 v[68:69], v8 offset:8200
    ds_read_b64_tr_b16 v[70:71], v8 offset:9224
    ds_read_b64_tr_b16 v[72:73], v9 offset:8192
    ds_read_b64_tr_b16 v[74:75], v9 offset:9216
    ds_read_b64_tr_b16 v[76:77], v9 offset:8200
    ds_read_b64_tr_b16 v[78:79], v9 offset:9224
    s_waitcnt lgkmcnt(12)
    v_mfma_f32_16x16x32_bf16 a[0:3], v[48:51], v[16:19], a[0:3]
    v_mfma_f32_16x16x32_bf16 a[4:7], v[52:55], v[16:19], a[4:7]
    v_mfma_f32_16x16x32_bf16 a[8:11], v[56:59], v[16:19], a[8:11]
    v_mfma_f32_16x16x32_bf16 a[12:15], v[60:63], v[16:19], a[12:15]
    v_mfma_f32_16x16x32_bf16 a[16:19], v[48:51], v[20:23], a[16:19]
    v_mfma_f32_16x16x32_bf16 a[20:23], v[52:55], v[20:23], a[20:23]
    v_mfma_f32_16x16x32_bf16 a[24:27], v[56:59], v[20:23], a[24:27]
    v_mfma_f32_16x16x32_bf16 a[28:31], v[60:63], v[20:23], a[28:31]
    v_mfma_f32_16x16x32_bf16 a[32:35], v[48:51], v[24:27], a[32:35]
    v_mfma_f32_16x16x32_bf16 a[36:39], v[52:55], v[24:27], a[36:39]
    v_mfma_f32_16x16x32_bf16 a[40:43], v[56:59], v[24:27], a[40:43]
    v_mfma_f32_16x16x32_bf16 a[44:47], v[60:63], v[24:27], a[44:47]
    v_mfma_f32_16x16x32_bf16 a[48:51], v[48:51], v[28:31], a[48:51]
    v_mfma_f32_16x16x32_bf16 a[52:55], v[52:55], v[28:31], a[52:55]
    v_mfma_f32_16x16x32_bf16 a[56:59], v[56:59], v[28:31], a[56:59]
    v_mfma_f32_16x16x32_bf16 a[60:63], v[60:63], v[28:31], a[60:63]
    s_waitcnt lgkmcnt(0)
    v_mfma_f32_16x16x32_bf16 a[0:3], v[64:67], v[32:35], a[0:3]
    v_mfma_f32_16x16x32_bf16 a[4:7], v[68:71], v[32:35], a[4:7]
    v_mfma_f32_16x16x32_bf16 a[8:11], v[72:75], v[32:35], a[8:11]
    v_mfma_f32_16x16x32_bf16 a[12:15], v[76:79], v[32:35], a[12:15]
    v_mfma_f32_16x16x32_bf16 a[16:19], v[64:67], v[36:39], a[16:19]
    v_mfma_f32_16x16x32_bf16 a[20:23], v[68:71], v[36:39], a[20:23]
    v_mfma_f32_16x16x32_bf16 a[24:27], v[72:75], v[36:39], a[24:27]
    v_mfma_f32_16x16x32_bf16 a[28:31], v[76:79], v[36:39], a[28:31]
    v_mfma_f32_16x16x32_bf16 a[32:35], v[64:67], v[40:43], a[32:35]
    v_mfma_f32_16x16x32_bf16 a[36:39], v[68:71], v[40:43], a[36:39]
    v_mfma_f32_16x16x32_bf16 a[40:43], v[72:75], v[40:43], a[40:43]
    v_mfma_f32_16x16x32_bf16 a[44:47], v[76:79], v[40:43], a[44:47]
    v_mfma_f32_16x16x32_bf16 a[48:51], v[64:67], v[44:47], a[48:51]
    v_mfma_f32_16x16x32_bf16 a[52:55], v[68:71], v[44:47], a[52:55]
    v_mfma_f32_16x16x32_bf16 a[56:59], v[72:75], v[44:47], a[56:59]
    v_mfma_f32_16x16x32_bf16 a[60:63], v[76:79], v[44:47], a[60:63]
    s_waitcnt vmcnt(16)
    s_barrier
    ds_read_b128 v[16:19], v5 offset:32768
    ds_read_b128 v[20:23], v5 offset:33280
    ds_read_b128 v[24:27], v5 offset:36864
    ds_read_b128 v[28:31], v5 offset:37376
    ds_read_b64_tr_b16 v[48:49], v8 offset:32768
    ds_read_b64_tr_b16 v[50:51], v8 offset:33792
    ds_read_b64_tr_b16 v[52:53], v8 offset:32776
    ds_read_b64_tr_b16 v[54:55], v8 offset:33800
    ds_read_b64_tr_b16 v[56:57], v9 offset:32768
    ds_read_b64_tr_b16 v[58:59], v9 offset:33792
    ds_read_b64_tr_b16 v[60:61], v9 offset:32776
    ds_read_b64_tr_b16 v[62:63], v9 offset:33800
    s_mov_b32 s79, s70
    s_add_u32 m0, s81, 0
    s_nop 0
    buffer_load_dwordx4 v2, s[60:63], s79 offen sc1 lds
    s_add_u32 s79, s79, s83
    s_add_u32 m0, s81, 1024
    s_nop 0
    buffer_load_dwordx4 v3, s[60:63], s79 offen sc1 lds
    s_add_u32 s79, s79, s83
    s_add_u32 m0, s81, 2048
    s_nop 0
    buffer_load_dwordx4 v2, s[60:63], s79 offen sc1 lds
    s_add_u32 s79, s79, s83
    s_add_u32 m0, s81, 3072
    s_nop 0
    buffer_load_dwordx4 v3, s[60:63], s79 offen sc1 lds
    s_mov_b32 s79, s71
    s_add_u32 m0, s82, 0
    s_nop 0
    buffer_load_dwordx4 v4, s[64:67], s79 offen lds
    s_add_u32 s79, s79, s84
    s_add_u32 m0, s82, 1024
    s_nop 0
    buffer_load_dwordx4 v4, s[64:67], s79 offen lds
    s_add_u32 s79, s79, s84
    s_add_u32 m0, s82, 2048
    s_nop 0
    buffer_load_dwordx4 v4, s[64:67], s79 offen lds
    s_add_u32 s79, s79, s84
    s_add_u32 m0, s82, 3072
    s_nop 0
    buffer_load_dwordx4 v4, s[64:67], s79 offen lds
    s_add_u32 s70, s70, 128
    s_lshl_b32 s79, s69, 6
    s_add_u32 s71, s71, s79
    ds_read_b128 v[32:35], v6 offset:32768
    ds_read_b128 v[36:39], v6 offset:33280
    ds_read_b128 v[40:43], v6 offset:36864
    ds_read_b128 v[44:47], v6 offset:37376
    ds_read_b64_tr_b16 v[64:65], v8 offset:40960
    ds_read_b64_tr_b16 v[66:67], v8 offset:41984
    ds_read_b64_tr_b16 v[68:69], v8 offset:40968
    ds_read_b64_tr_b16 v[70:71], v8 offset:41992
    ds_read_b64_tr_b16 v[72:73], v9 offset:40960
    ds_read_b64_tr_b16 v[74:75], v9 offset:41984
    ds_read_b64_tr_b16 v[76:77], v9 offset:40968
    ds_read_b64_tr_b16 v[78:79], v9 offset:41992
    s_waitcnt lgkmcnt(12)
    v_mfma_f32_16x16x32_bf16 a[0:3], v[48:51], v[16:19], a[0:3]
    v_mfma_f32_16x16x32_bf16 a[4:7], v[52:55], v[16:19], a[4:7]
    v_mfma_f32_16x16x32_bf16 a[8:11], v[56:59], v[16:19], a[8:11]
    v_mfma_f32_16x16x32_bf16 a[12:15], v[60:63], v[16:19], a[12:15]
    v_mfma_f32_16x16x32_bf16 a[16:19], v[48:51], v[20:23], a[16:19]
    v_mfma_f32_16x16x32_bf16 a[20:23], v[52:55], v[20:23], a[20:23]
    v_mfma_f32_16x16x32_bf16 a[24:27], v[56:59], v[20:23], a[24:27]
    v_mfma_f32_16x16x32_bf16 a[28:31], v[60:63], v[20:23], a[28:31]
    v_mfma_f32_16x16x32_bf16 a[32:35], v[48:51], v[24:27], a[32:35]
    v_mfma_f32_16x16x32_bf16 a[36:39], v[52:55], v[24:27], a[36:39]
    v_mfma_f32_16x16x32_bf16 a[40:43], v[56:59], v[24:27], a[40:43]
    v_mfma_f32_16x16x32_bf16 a[44:47], v[60:63], v[24:27], a[44:47]
    v_mfma_f32_16x16x32_bf16 a[48:51], v[48:51], v[28:31], a[48:51]
    v_mfma_f32_16x16x32_bf16 a[52:55], v[52:55], v[28:31], a[52:55]
    v_mfma_f32_16x16x32_bf16 a[56:59], v[56:59], v[28:31], a[56:59]
    v_mfma_f32_16x16x32_bf16 a[60:63], v[60:63], v[28:31], a[60:63]
    s_waitcnt lgkmcnt(0)
    v_mfma_f32_16x16x32_bf16 a[0:3], v[64:67], v[32:35], a[0:3]
    v_mfma_f32_16x16x32_bf16 a[4:7], v[68:71], v[32:35], a[4:7]
    v_mfma_f32_16x16x32_bf16 a[8:11], v[72:75], v[32:35], a[8:11]
    v_mfma_f32_16x16x32_bf16 a[12:15], v[76:79], v[32:35], a[12:15]
    v_mfma_f32_16x16x32_bf16 a[16:19], v[64:67], v[36:39], a[16:19]
    v_mfma_f32_16x16x32_bf16 a[20:23], v[68:71], v[36:39], a[20:23]
    v_mfma_f32_16x16x32_bf16 a[24:27], v[72:75], v[36:39], a[24:27]
    v_mfma_f32_16x16x32_bf16 a[28:31], v[76:79], v[36:39], a[28:31]
    v_mfma_f32_16x16x32_bf16 a[32:35], v[64:67], v[40:43], a[32:35]
    v_mfma_f32_16x16x32_bf16 a[36:39], v[68:71], v[40:43], a[36:39]
    v_mfma_f32_16x16x32_bf16 a[40:43], v[72:75], v[40:43], a[40:43]
    v_mfma_f32_16x16x32_bf16 a[44:47], v[76:79], v[40:43], a[44:47]
    v_mfma_f32_16x16x32_bf16 a[48:51], v[64:67], v[44:47], a[48:51]
    v_mfma_f32_16x16x32_bf16 a[52:55], v[68:71], v[44:47], a[52:55]
    v_mfma_f32_16x16x32_bf16 a[56:59], v[72:75], v[44:47], a[56:59]
    v_mfma_f32_16x16x32_bf16 a[60:63], v[76:79], v[44:47], a[60:63]
    s_waitcnt vmcnt(16)
    s_barrier
    ds_read_b128 v[16:19], v105 offset:0
    ds_read_b128 v[20:23], v105 offset:512
    ds_read_b128 v[24:27], v105 offset:4096
    ds_read_b128 v[28:31], v105 offset:4608
    ds_read_b64_tr_b16 v[48:49], v108 offset:0
    ds_read_b64_tr_b16 v[50:51], v108 offset:1024
    ds_read_b64_tr_b16 v[52:53], v108 offset:8
    ds_read_b64_tr_b16 v[54:55], v108 offset:1032
    ds_read_b64_tr_b16 v[56:57], v109 offset:0
    ds_read_b64_tr_b16 v[58:59], v109 offset:1024
    ds_read_b64_tr_b16 v[60:61], v109 offset:8
    ds_read_b64_tr_b16 v[62:63], v109 offset:1032
    s_mov_b32 s79, s70
    s_add_u32 m0, s81, 32768
    s_nop 0
    buffer_load_dwordx4 v2, s[60:63], s79 offen sc1 lds
    s_add_u32 s79, s79, s83
    s_add_u32 m0, s81, 33792
    s_nop 0
    buffer_load_dwordx4 v3, s[60:63], s79 offen sc1 lds
    s_add_u32 s79, s79, s83
    s_add_u32 m0, s81, 34816
    s_nop 0
    buffer_load_dwordx4 v2, s[60:63], s79 offen sc1 lds
    s_add_u32 s79, s79, s83
    s_add_u32 m0, s81, 35840
    s_nop 0
    buffer_load_dwordx4 v3, s[60:63], s79 offen sc1 lds
    s_mov_b32 s79, s71
    s_add_u32 m0, s82, 32768
    s_nop 0
    buffer_load_dwordx4 v4, s[64:67], s79 offen lds
    s_add_u32 s79, s79, s84
    s_add_u32 m0, s82, 33792
    s_nop 0
    buffer_load_dwordx4 v4, s[64:67], s79 offen lds
    s_add_u32 s79, s79, s84
    s_add_u32 m0, s82, 34816
    s_nop 0
    buffer_load_dwordx4 v4, s[64:67], s79 offen lds
    s_add_u32 s79, s79, s84
    s_add_u32 m0, s82, 35840
    s_nop 0
    buffer_load_dwordx4 v4, s[64:67], s79 offen lds
    s_add_u32 s70, s70, 128
    s_lshl_b32 s79, s69, 6
    s_add_u32 s71, s71, s79
    ds_read_b128 v[32:35], v106 offset:0
    ds_read_b128 v[36:39], v106 offset:512
    ds_read_b128 v[40:43], v106 offset:4096
    ds_read_b128 v[44:47], v106 offset:4608
    ds_read_b64_tr_b16 v[64:65], v108 offset:8192
    ds_read_b64_tr_b16 v[66:67], v108 offset:9216
    ds_read_b64_tr_b16 v[68:69], v108 offset:8200
    ds_read_b64_tr_b16 v[70:71], v108 offset:9224
    ds_read_b64_tr_b16 v[72:73], v109 offset:8192
    ds_read_b64_tr_b16 v[74:75], v109 offset:9216
    ds_read_b64_tr_b16 v[76:77], v109 offset:8200
    ds_read_b64_tr_b16 v[78:79], v109 offset:9224
    s_waitcnt lgkmcnt(12)
    v_mfma_f32_16x16x32_bf16 a[0:3], v[48:51], v[16:19], a[0:3]
    v_mfma_f32_16x16x32_bf16 a[4:7], v[52:55], v[16:19], a[4:7]
    v_mfma_f32_16x16x32_bf16 a[8:11], v[56:59], v[16:19], a[8:11]
    v_mfma_f32_16x16x32_bf16 a[12:15], v[60:63], v[16:19], a[12:15]
    v_mfma_f32_16x16x32_bf16 a[16:19], v[48:51], v[20:23], a[16:19]
    v_mfma_f32_16x16x32_bf16 a[20:23], v[52:55], v[20:23], a[20:23]
    v_mfma_f32_16x16x32_bf16 a[24:27], v[56:59], v[20:23], a[24:27]
    v_mfma_f32_16x16x32_bf16 a[28:31], v[60:63], v[20:23], a[28:31]
    v_mfma_f32_16x16x32_bf16 a[32:35], v[48:51], v[24:27], a[32:35]
    v_mfma_f32_16x16x32_bf16 a[36:39], v[52:55], v[24:27], a[36:39]
    v_mfma_f32_16x16x32_bf16 a[40:43], v[56:59], v[24:27], a[40:43]
    v_mfma_f32_16x16x32_bf16 a[44:47], v[60:63], v[24:27], a[44:47]
    v_mfma_f32_16x16x32_bf16 a[48:51], v[48:51], v[28:31], a[48:51]
    v_mfma_f32_16x16x32_bf16 a[52:55], v[52:55], v[28:31], a[52:55]
    v_mfma_f32_16x16x32_bf16 a[56:59], v[56:59], v[28:31], a[56:59]
    v_mfma_f32_16x16x32_bf16 a[60:63], v[60:63], v[28:31], a[60:63]
    s_waitcnt lgkmcnt(0)
    v_mfma_f32_16x16x32_bf16 a[0:3], v[64:67], v[32:35], a[0:3]
    v_mfma_f32_16x16x32_bf16 a[4:7], v[68:71], v[32:35], a[4:7]
    v_mfma_f32_16x16x32_bf16 a[8:11], v[72:75], v[32:35], a[8:11]
    v_mfma_f32_16x16x32_bf16 a[12:15], v[76:79], v[32:35], a[12:15]
    v_mfma_f32_16x16x32_bf16 a[16:19], v[64:67], v[36:39], a[16:19]
    v_mfma_f32_16x16x32_bf16 a[20:23], v[68:71], v[36:39], a[20:23]
    v_mfma_f32_16x16x32_bf16 a[24:27], v[72:75], v[36:39], a[24:27]
    v_mfma_f32_16x16x32_bf16 a[28:31], v[76:79], v[36:39], a[28:31]
    v_mfma_f32_16x16x32_bf16 a[32:35], v[64:67], v[40:43], a[32:35]
    v_mfma_f32_16x16x32_bf16 a[36:39], v[68:71], v[40:43], a[36:39]
    v_mfma_f32_16x16x32_bf16 a[40:43], v[72:75], v[40:43], a[40:43]
    v_mfma_f32_16x16x32_bf16 a[44:47], v[76:79], v[40:43], a[44:47]
    v_mfma_f32_16x16x32_bf16 a[48:51], v[64:67], v[44:47], a[48:51]
    v_mfma_f32_16x16x32_bf16 a[52:55], v[68:71], v[44:47], a[52:55]
    v_mfma_f32_16x16x32_bf16 a[56:59], v[72:75], v[44:47], a[56:59]
    v_mfma_f32_16x16x32_bf16 a[60:63], v[76:79], v[44:47], a[60:63]
    s_waitcnt vmcnt(16)
    s_barrier
    ds_read_b128 v[16:19], v105 offset:32768
    ds_read_b128 v[20:23], v105 offset:33280
    ds_read_b128 v[24:27], v105 offset:36864
    ds_read_b128 v[28:31], v105 offset:37376
    ds_read_b64_tr_b16 v[48:49], v108 offset:32768
    ds_read_b64_tr_b16 v[50:51], v108 offset:33792
    ds_read_b64_tr_b16 v[52:53], v108 offset:32776
    ds_read_b64_tr_b16 v[54:55], v108 offset:33800
    ds_read_b64_tr_b16 v[56:57], v109 offset:32768
    ds_read_b64_tr_b16 v[58:59], v109 offset:33792
    ds_read_b64_tr_b16 v[60:61], v109 offset:32776
    ds_read_b64_tr_b16 v[62:63], v109 offset:33800
    s_mov_b32 s79, s70
    s_add_u32 m0, s81, 65536
    s_nop 0
    buffer_load_dwordx4 v2, s[60:63], s79 offen sc1 lds
    s_add_u32 s79, s79, s83
    s_add_u32 m0, s81, 66560
    s_nop 0
    buffer_load_dwordx4 v3, s[60:63], s79 offen sc1 lds
    s_add_u32 s79, s79, s83
    s_add_u32 m0, s81, 67584
    s_nop 0
    buffer_load_dwordx4 v2, s[60:63], s79 offen sc1 lds
    s_add_u32 s79, s79, s83
    s_add_u32 m0, s81, 68608
    s_nop 0
    buffer_load_dwordx4 v3, s[60:63], s79 offen sc1 lds
    s_mov_b32 s79, s71
    s_add_u32 m0, s82, 65536
    s_nop 0
    buffer_load_dwordx4 v4, s[64:67], s79 offen lds
    s_add_u32 s79, s79, s84
    s_add_u32 m0, s82, 66560
    s_nop 0
    buffer_load_dwordx4 v4, s[64:67], s79 offen lds
    s_add_u32 s79, s79, s84
    s_add_u32 m0, s82, 67584
    s_nop 0
    buffer_load_dwordx4 v4, s[64:67], s79 offen lds
    s_add_u32 s79, s79, s84
    s_add_u32 m0, s82, 68608
    s_nop 0
    buffer_load_dwordx4 v4, s[64:67], s79 offen lds
    s_add_u32 s70, s70, 128
    s_lshl_b32 s79, s69, 6
    s_add_u32 s71, s71, s79
    ds_read_b128 v[32:35], v106 offset:32768
    ds_read_b128 v[36:39], v106 offset:33280
    ds_read_b128 v[40:43], v106 offset:36864
    ds_read_b128 v[44:47], v106 offset:37376
    ds_read_b64_tr_b16 v[64:65], v108 offset:40960
    ds_read_b64_tr_b16 v[66:67], v108 offset:41984
    ds_read_b64_tr_b16 v[68:69], v108 offset:40968
    ds_read_b64_tr_b16 v[70:71], v108 offset:41992
    ds_read_b64_tr_b16 v[72:73], v109 offset:40960
    ds_read_b64_tr_b16 v[74:75], v109 offset:41984
    ds_read_b64_tr_b16 v[76:77], v109 offset:40968
    ds_read_b64_tr_b16 v[78:79], v109 offset:41992
    s_waitcnt lgkmcnt(12)
    v_mfma_f32_16x16x32_bf16 a[0:3], v[48:51], v[16:19], a[0:3]
    v_mfma_f32_16x16x32_bf16 a[4:7], v[52:55], v[16:19], a[4:7]
    v_mfma_f32_16x16x32_bf16 a[8:11], v[56:59], v[16:19], a[8:11]
    v_mfma_f32_16x16x32_bf16 a[12:15], v[60:63], v[16:19], a[12:15]
    v_mfma_f32_16x16x32_bf16 a[16:19], v[48:51], v[20:23], a[16:19]
    v_mfma_f32_16x16x32_bf16 a[20:23], v[52:55], v[20:23], a[20:23]
    v_mfma_f32_16x16x32_bf16 a[24:27], v[56:59], v[20:23], a[24:27]
    v_mfma_f32_16x16x32_bf16 a[28:31], v[60:63], v[20:23], a[28:31]
    v_mfma_f32_16x16x32_bf16 a[32:35], v[48:51], v[24:27], a[32:35]
    v_mfma_f32_16x16x32_bf16 a[36:39], v[52:55], v[24:27], a[36:39]
    v_mfma_f32_16x16x32_bf16 a[40:43], v[56:59], v[24:27], a[40:43]
    v_mfma_f32_16x16x32_bf16 a[44:47], v[60:63], v[24:27], a[44:47]
    v_mfma_f32_16x16x32_bf16 a[48:51], v[48:51], v[28:31], a[48:51]
    v_mfma_f32_16x16x32_bf16 a[52:55], v[52:55], v[28:31], a[52:55]
    v_mfma_f32_16x16x32_bf16 a[56:59], v[56:59], v[28:31], a[56:59]
    v_mfma_f32_16x16x32_bf16 a[60:63], v[60:63], v[28:31], a[60:63]
    s_waitcnt lgkmcnt(0)
    v_mfma_f32_16x16x32_bf16 a[0:3], v[64:67], v[32:35], a[0:3]
    v_mfma_f32_16x16x32_bf16 a[4:7], v[68:71], v[32:35], a[4:7]
    v_mfma_f32_16x16x32_bf16 a[8:11], v[72:75], v[32:35], a[8:11]
    v_mfma_f32_16x16x32_bf16 a[12:15], v[76:79], v[32:35], a[12:15]
    v_mfma_f32_16x16x32_bf16 a[16:19], v[64:67], v[36:39], a[16:19]
    v_mfma_f32_16x16x32_bf16 a[20:23], v[68:71], v[36:39], a[20:23]
    v_mfma_f32_16x16x32_bf16 a[24:27], v[72:75], v[36:39], a[24:27]
    v_mfma_f32_16x16x32_bf16 a[28:31], v[76:79], v[36:39], a[28:31]
    v_mfma_f32_16x16x32_bf16 a[32:35], v[64:67], v[40:43], a[32:35]
    v_mfma_f32_16x16x32_bf16 a[36:39], v[68:71], v[40:43], a[36:39]
    v_mfma_f32_16x16x32_bf16 a[40:43], v[72:75], v[40:43], a[40:43]
    v_mfma_f32_16x16x32_bf16 a[44:47], v[76:79], v[40:43], a[44:47]
    v_mfma_f32_16x16x32_bf16 a[48:51], v[64:67], v[44:47], a[48:51]
    v_mfma_f32_16x16x32_bf16 a[52:55], v[68:71], v[44:47], a[52:55]
    v_mfma_f32_16x16x32_bf16 a[56:59], v[72:75], v[44:47], a[56:59]
    v_mfma_f32_16x16x32_bf16 a[60:63], v[76:79], v[44:47], a[60:63]
    s_sub_u32 s72, s72, 1
    s_cmp_lg_u32 s72, 0
    s_cbranch_scc1 L_g128T_166
    s_waitcnt vmcnt(0)
    s_nop 7
    s_lshl_b32 s73, s89, 18
    s_lshl_b32 s77, s90, 8
    s_add_u32 s73, s73, s77
    v_and_b32 v10, 63, v0
    v_and_b32 v11, 15, v10
    v_lshrrev_b32 v12, 4, v10
    v_lshrrev_b32 v13, 2, v11
    v_and_b32 v14, 3, v11
    v_lshl_add_u32 v13, v13, 3, v14
    v_lshlrev_b32 v13, 11, v13
    v_lshl_add_u32 v13, v12, 4, v13
    s_lshr_b32 s77, s56, 1
    s_lshl_b32 s77, s77, 17
    s_add_u32 s73, s73, s77
    s_and_b32 s77, s56, 1
    s_lshl_b32 s77, s77, 7
    s_add_u32 s73, s73, s77
    s_add_u32 s77, s73, 0
    v_accvgpr_read_b32 v120, a0
    v_accvgpr_read_b32 v121, a1
    v_accvgpr_read_b32 v122, a2
    v_accvgpr_read_b32 v123, a3
    v_accvgpr_read_b32 v124, a4
    v_accvgpr_read_b32 v125, a5
    v_accvgpr_read_b32 v126, a6
    v_accvgpr_read_b32 v127, a7
    v_cvt_pk_bf16_f32 v16, v120, v121
    v_cvt_pk_bf16_f32 v17, v122, v123
    v_cvt_pk_bf16_f32 v18, v124, v125
    v_cvt_pk_bf16_f32 v19, v126, v127
    buffer_store_dwordx4 v[16:19], v13, s[44:47], s77 offen offset:0
    v_accvgpr_read_b32 v120, a8
    v_accvgpr_read_b32 v121, a9
    v_accvgpr_read_b32 v122, a10
    v_accvgpr_read_b32 v123, a11
    v_accvgpr_read_b32 v124, a12
    v_accvgpr_read_b32 v125, a13
    v_accvgpr_read_b32 v126, a14
    v_accvgpr_read_b32 v127, a15
    v_cvt_pk_bf16_f32 v20, v120, v121
    v_cvt_pk_bf16_f32 v21, v122, v123
    v_cvt_pk_bf16_f32 v22, v124, v125
    v_cvt_pk_bf16_f32 v23, v126, v127
    buffer_store_dwordx4 v[20:23], v13, s[44:47], s77 offen offset:64
    s_add_u32 s77, s73, 8192
    v_accvgpr_read_b32 v120, a16
    v_accvgpr_read_b32 v121, a17
    v_accvgpr_read_b32 v122, a18
    v_accvgpr_read_b32 v123, a19
    v_accvgpr_read_b32 v124, a20
    v_accvgpr_read_b32 v125, a21
    v_accvgpr_read_b32 v126, a22
    v_accvgpr_read_b32 v127, a23
    v_cvt_pk_bf16_f32 v24, v120, v121
    v_cvt_pk_bf16_f32 v25, v122, v123
    v_cvt_pk_bf16_f32 v26, v124, v125
    v_cvt_pk_bf16_f32 v27, v126, v127
    buffer_store_dwordx4 v[24:27], v13, s[44:47], s77 offen offset:0
    v_accvgpr_read_b32 v120, a24
    v_accvgpr_read_b32 v121, a25
    v_accvgpr_read_b32 v122, a26
    v_accvgpr_read_b32 v123, a27
    v_accvgpr_read_b32 v124, a28
    v_accvgpr_read_b32 v125, a29
    v_accvgpr_read_b32 v126, a30
    v_accvgpr_read_b32 v127, a31
    v_cvt_pk_bf16_f32 v28, v120, v121
    v_cvt_pk_bf16_f32 v29, v122, v123
    v_cvt_pk_bf16_f32 v30, v124, v125
    v_cvt_pk_bf16_f32 v31, v126, v127
    buffer_store_dwordx4 v[28:31], v13, s[44:47], s77 offen offset:64
    s_add_u32 s77, s73, 65536
    v_accvgpr_read_b32 v120, a32
    v_accvgpr_read_b32 v121, a33
    v_accvgpr_read_b32 v122, a34
    v_accvgpr_read_b32 v123, a35
    v_accvgpr_read_b32 v124, a36
    v_accvgpr_read_b32 v125, a37
    v_accvgpr_read_b32 v126, a38
    v_accvgpr_read_b32 v127, a39
    v_cvt_pk_bf16_f32 v32, v120, v121
    v_cvt_pk_bf16_f32 v33, v122, v123
    v_cvt_pk_bf16_f32 v34, v124, v125
    v_cvt_pk_bf16_f32 v35, v126, v127
    buffer_store_dwordx4 v[32:35], v13, s[44:47], s77 offen offset:0
    v_accvgpr_read_b32 v120, a40
    v_accvgpr_read_b32 v121, a41
    v_accvgpr_read_b32 v122, a42
    v_accvgpr_read_b32 v123, a43
    v_accvgpr_read_b32 v124, a44
    v_accvgpr_read_b32 v125, a45
    v_accvgpr_read_b32 v126, a46
    v_accvgpr_read_b32 v127, a47
    v_cvt_pk_bf16_f32 v36, v120, v121
    v_cvt_pk_bf16_f32 v37, v122, v123
    v_cvt_pk_bf16_f32 v38, v124, v125
    v_cvt_pk_bf16_f32 v39, v126, v127
    buffer_store_dwordx4 v[36:39], v13, s[44:47], s77 offen offset:64
    s_add_u32 s77, s73, 73728
    v_accvgpr_read_b32 v120, a48
    v_accvgpr_read_b32 v121, a49
    v_accvgpr_read_b32 v122, a50
    v_accvgpr_read_b32 v123, a51
    v_accvgpr_read_b32 v124, a52
    v_accvgpr_read_b32 v125, a53
    v_accvgpr_read_b32 v126, a54
    v_accvgpr_read_b32 v127, a55
    v_cvt_pk_bf16_f32 v40, v120, v121
    v_cvt_pk_bf16_f32 v41, v122, v123
    v_cvt_pk_bf16_f32 v42, v124, v125
    v_cvt_pk_bf16_f32 v43, v126, v127
    buffer_store_dwordx4 v[40:43], v13, s[44:47], s77 offen offset:0
    v_accvgpr_read_b32 v120, a56
    v_accvgpr_read_b32 v121, a57
    v_accvgpr_read_b32 v122, a58
    v_accvgpr_read_b32 v123, a59
    v_accvgpr_read_b32 v124, a60
    v_accvgpr_read_b32 v125, a61
    v_accvgpr_read_b32 v126, a62
    v_accvgpr_read_b32 v127, a63
    v_cvt_pk_bf16_f32 v44, v120, v121
    v_cvt_pk_bf16_f32 v45, v122, v123
    v_cvt_pk_bf16_f32 v46, v124, v125
    v_cvt_pk_bf16_f32 v47, v126, v127
    buffer_store_dwordx4 v[44:47], v13, s[44:47], s77 offen offset:64
    s_branch L_next
L_task_at:
    s_sub_u32 s78, s88, 408
    s_lshr_b32 s89, s78, 3
    s_and_b32 s90, s78, 7
    v_mov_b32 v121, 20
L_wt_167:
    buffer_load_dword v120, v121, s[48:51], 0 offen sc1
    s_waitcnt vmcnt(0)
    v_readfirstlane_b32 s77, v120
    s_nop 0
    s_cmp_ge_u32 s77, 96
    s_cbranch_scc1 L_wd_168
    s_sleep 32
    s_branch L_wt_167
L_wd_168:
    s_lshl_b32 s90, s90, 2
    s_add_u32 s90, s90, s56
    s_lshl_b32 s89, s89, 1
    s_mov_b32 s91, 2
    v_and_b32 v10, 63, v0
    v_lshlrev_b32 v11, 4, v10
    v_and_b32 v12, 31, v10
    v_lshrrev_b32 v13, 5, v10
    v_lshl_add_u32 v14, v13, 4, v12
    v_lshlrev_b32 v14, 4, v14
    v_lshlrev_b32 v9, 3, v13
    v_sub_u32 v9, v12, v9
    v_mov_b32 v15, 0xff800000
    v_lshlrev_b32 v8, 10, v12
    v_lshl_add_u32 v8, v13, 4, v8
    v_cmp_eq_u32 vcc, 16, v12
    v_cmp_eq_u32 s[98:99], 20, v12
    s_nop 0
    s_or_b64 vcc, vcc, s[98:99]
    v_mov_b32 v7, 0x3f803f80
    v_cndmask_b32 v7, 0, v7, vcc
    v_mov_b32 v56, v7
    v_mov_b32 v57, v7
    v_mov_b32 v58, v7
    v_mov_b32 v59, v7
    v_mov_b32 v60, v7
    v_mov_b32 v61, v7
    v_mov_b32 v62, v7
    v_mov_b32 v63, v7
    v_mov_b32 v64, v7
    v_mov_b32 v65, v7
    v_mov_b32 v66, v7
    v_mov_b32 v67, v7
    v_mov_b32 v68, v7
    v_mov_b32 v69, v7
    v_mov_b32 v70, v7
    v_mov_b32 v71, v7
    v_mov_b32 v72, v7
    v_mov_b32 v73, v7
    v_mov_b32 v74, v7
    v_mov_b32 v75, v7
    v_mov_b32 v76, v7
    v_mov_b32 v77, v7
    v_mov_b32 v78, v7
    v_mov_b32 v79, v7
    v_mov_b32 v80, v7
    v_mov_b32 v81, v7
    v_mov_b32 v82, v7
    v_mov_b32 v83, v7
    v_mov_b32 v84, v7
    v_mov_b32 v85, v7
    v_mov_b32 v86, v7
    v_mov_b32 v87, v7
    v_mov_b32 v88, v7
    v_mov_b32 v89, v7
    v_mov_b32 v90, v7
    v_mov_b32 v91, v7
    v_mov_b32 v92, v7
    v_mov_b32 v93, v7
    v_mov_b32 v94, v7
    v_mov_b32 v95, v7
    v_mov_b32 v96, v7
    v_mov_b32 v97, v7
    v_mov_b32 v98, v7
    v_mov_b32 v99, v7
    v_mov_b32 v100, v7
    v_mov_b32 v101, v7
    v_mov_b32 v102, v7
    v_mov_b32 v103, v7
    v_mov_b32 v104, v7
    v_mov_b32 v105, v7
    v_mov_b32 v106, v7
    v_mov_b32 v107, v7
    v_mov_b32 v108, v7
    v_mov_b32 v109, v7
    v_mov_b32 v110, v7
    v_mov_b32 v111, v7
    v_mov_b32 v112, v7
    v_mov_b32 v113, v7
    v_mov_b32 v114, v7
    v_mov_b32 v115, v7
    v_mov_b32 v116, v7
    v_mov_b32 v117, v7
    v_mov_b32 v118, v7
    v_mov_b32 v119, v7
    v_mov_b32 v120, v7
    v_mov_b32 v121, v7
    v_mov_b32 v122, v7
    v_mov_b32 v123, v7
    v_mov_b32 v124, v7
    v_mov_b32 v125, v7
    v_mov_b32 v126, v7
    v_mov_b32 v127, v7
    s_mov_b32 s98, 0x0000ffff
    s_mov_b32 s99, 0x0000ffff
    s_mov_b32 s76, 1052289595
L_at_loop:
    s_lshl_b32 s73, s90, 6
    s_add_u32 s73, s73, s89
    s_lshl_b32 s73, s73, 10
    s_add_u32 s77, s73, 83886080
    buffer_load_dwordx4 v[16:19], v11, s[52:55], s77 offen sc1
    s_cmp_lt_u32 s89, 8
    s_cbranch_scc1 L_atl_169
    s_add_u32 s77, s73, 85983232
    s_sub_u32 s77, s77, 8192
    buffer_load_dwordx4 v[20:23], v11, s[52:55], s77 offen sc1
    s_add_u32 s77, s77, 2097152
    s_mov_b64 exec, s[98:99]
    buffer_load_dwordx4 v[56:59], v14, s[52:55], s77 offen sc1
    buffer_load_dwordx4 v[60:63], v14, s[52:55], s77 offen offset:512 sc1
    s_mov_b64 exec, -1
L_atl_169:
    s_cmp_lt_u32 s89, 7
    s_cbranch_scc1 L_atl_170
    s_add_u32 s77, s73, 85983232
    s_sub_u32 s77, s77, 7168
    buffer_load_dwordx4 v[24:27], v11, s[52:55], s77 offen sc1
    s_add_u32 s77, s77, 2097152
    s_mov_b64 exec, s[98:99]
    buffer_load_dwordx4 v[64:67], v14, s[52:55], s77 offen sc1
    buffer_load_dwordx4 v[68:71], v14, s[52:55], s77 offen offset:512 sc1
    s_mov_b64 exec, -1
L_atl_170:
    s_cmp_lt_u32 s89, 6
    s_cbranch_scc1 L_atl_171
    s_add_u32 s77, s73, 85983232
    s_sub_u32 s77, s77, 6144
    buffer_load_dwordx4 v[28:31], v11, s[52:55], s77 offen sc1
    s_add_u32 s77, s77, 2097152
    s_mov_b64 exec, s[98:99]
    buffer_load_dwordx4 v[72:75], v14, s[52:55], s77 offen sc1
    buffer_load_dwordx4 v[76:79], v14, s[52:55], s77 offen offset:512 sc1
    s_mov_b64 exec, -1
L_atl_171:
    s_cmp_lt_u32 s89, 5
    s_cbranch_scc1 L_atl_172
    s_add_u32 s77, s73, 85983232
    s_sub_u32 s77, s77, 5120
    buffer_load_dwordx4 v[32:35], v11, s[52:55], s77 offen sc1
    s_add_u32 s77, s77, 2097152
    s_mov_b64 exec, s[98:99]
    buffer_load_dwordx4 v[80:83], v14, s[52:55], s77 offen sc1
    buffer_load_dwordx4 v[84:87], v14, s[52:55], s77 offen offset:512 sc1
    s_mov_b64 exec, -1
L_atl_172:
    s_cmp_lt_u32 s89, 4
    s_cbranch_scc1 L_atl_173
    s_add_u32 s77, s73, 85983232
    s_sub_u32 s77, s77, 4096
    buffer_load_dwordx4 v[36:39], v11, s[52:55], s77 offen sc1
    s_add_u32 s77, s77, 2097152
    s_mov_b64 exec, s[98:99]
    buffer_load_dwordx4 v[88:91], v14, s[52:55], s77 offen sc1
    buffer_load_dwordx4 v[92:95], v14, s[52:55], s77 offen offset:512 sc1
    s_mov_b64 exec, -1
L_atl_173:
    s_cmp_lt_u32 s89, 3
    s_cbranch_scc1 L_atl_174
    s_add_u32 s77, s73, 85983232
    s_sub_u32 s77, s77, 3072
    buffer_load_dwordx4 v[40:43], v11, s[52:55], s77 offen sc1
    s_add_u32 s77, s77, 2097152
    s_mov_b64 exec, s[98:99]
    buffer_load_dwordx4 v[96:99], v14, s[52:55], s77 offen sc1
    buffer_load_dwordx4 v[100:103], v14, s[52:55], s77 offen offset:512 sc1
    s_mov_b64 exec, -1
L_atl_174:
    s_cmp_lt_u32 s89, 2
    s_cbranch_scc1 L_atl_175
    s_add_u32 s77, s73, 85983232
    s_sub_u32 s77, s77, 2048
    buffer_load_dwordx4 v[44:47], v11, s[52:55], s77 offen sc1
    s_add_u32 s77, s77, 2097152
    s_mov_b64 exec, s[98:99]
    buffer_load_dwordx4 v[104:107], v14, s[52:55], s77 offen sc1
    buffer_load_dwordx4 v[108:111], v14, s[52:55], s77 offen offset:512 sc1
    s_mov_b64 exec, -1
L_atl_175:
    s_cmp_lt_u32 s89, 1
    s_cbranch_scc1 L_atl_176
    s_add_u32 s77, s73, 85983232
    s_sub_u32 s77, s77, 1024
    buffer_load_dwordx4 v[48:51], v11, s[52:55], s77 offen sc1
    s_add_u32 s77, s77, 2097152
    s_mov_b64 exec, s[98:99]
    buffer_load_dwordx4 v[112:115], v14, s[52:55], s77 offen sc1
    buffer_load_dwordx4 v[116:119], v14, s[52:55], s77 offen offset:512 sc1
    s_mov_b64 exec, -1
L_atl_176:
    s_add_u32 s77, s73, 85983232
    s_sub_u32 s77, s77, 0
    buffer_load_dwordx4 v[52:55], v11, s[52:55], s77 offen sc1
    s_add_u32 s77, s77, 2097152
    s_mov_b64 exec, s[98:99]
    buffer_load_dwordx4 v[120:123], v14, s[52:55], s77 offen sc1
    buffer_load_dwordx4 v[124:127], v14, s[52:55], s77 offen offset:512 sc1
    s_mov_b64 exec, -1
    s_waitcnt vmcnt(0)
    s_cmp_lt_u32 s89, 8
    s_cbranch_scc1 L_ats_177
    v_mfma_f32_32x32x16_bf16 v[128:143], v[20:23], v[16:19], 0
    s_branch L_atv_178
L_ats_177:
    v_mov_b32 v128, v15
    v_mov_b32 v129, v15
    v_mov_b32 v130, v15
    v_mov_b32 v131, v15
    v_mov_b32 v132, v15
    v_mov_b32 v133, v15
    v_mov_b32 v134, v15
    v_mov_b32 v135, v15
    v_mov_b32 v136, v15
    v_mov_b32 v137, v15
    v_mov_b32 v138, v15
    v_mov_b32 v139, v15
    v_mov_b32 v140, v15
    v_mov_b32 v141, v15
    v_mov_b32 v142, v15
    v_mov_b32 v143, v15
L_atv_178:
    s_cmp_lt_u32 s89, 7
    s_cbranch_scc1 L_ats_179
    v_mfma_f32_32x32x16_bf16 v[144:159], v[24:27], v[16:19], 0
    s_branch L_atv_180
L_ats_179:
    v_mov_b32 v144, v15
    v_mov_b32 v145, v15
    v_mov_b32 v146, v15
    v_mov_b32 v147, v15
    v_mov_b32 v148, v15
    v_mov_b32 v149, v15
    v_mov_b32 v150, v15
    v_mov_b32 v151, v15
    v_mov_b32 v152, v15
    v_mov_b32 v153, v15
    v_mov_b32 v154, v15
    v_mov_b32 v155, v15
    v_mov_b32 v156, v15
    v_mov_b32 v157, v15
    v_mov_b32 v158, v15
    v_mov_b32 v159, v15
L_atv_180:
    s_cmp_lt_u32 s89, 6
    s_cbranch_scc1 L_ats_181
    v_mfma_f32_32x32x16_bf16 v[160:175], v[28:31], v[16:19], 0
    s_branch L_atv_182
L_ats_181:
    v_mov_b32 v160, v15
    v_mov_b32 v161, v15
    v_mov_b32 v162, v15
    v_mov_b32 v163, v15
    v_mov_b32 v164, v15
    v_mov_b32 v165, v15
    v_mov_b32 v166, v15
    v_mov_b32 v167, v15
    v_mov_b32 v168, v15
    v_mov_b32 v169, v15
    v_mov_b32 v170, v15
    v_mov_b32 v171, v15
    v_mov_b32 v172, v15
    v_mov_b32 v173, v15
    v_mov_b32 v174, v15
    v_mov_b32 v175, v15
L_atv_182:
    s_cmp_lt_u32 s89, 5
    s_cbranch_scc1 L_ats_183
    v_mfma_f32_32x32x16_bf16 v[176:191], v[32:35], v[16:19], 0
    s_branch L_atv_184
L_ats_183:
    v_mov_b32 v176, v15
    v_mov_b32 v177, v15
    v_mov_b32 v178, v15
    v_mov_b32 v179, v15
    v_mov_b32 v180, v15
    v_mov_b32 v181, v15
    v_mov_b32 v182, v15
    v_mov_b32 v183, v15
    v_mov_b32 v184, v15
    v_mov_b32 v185, v15
    v_mov_b32 v186, v15
    v_mov_b32 v187, v15
    v_mov_b32 v188, v15
    v_mov_b32 v189, v15
    v_mov_b32 v190, v15
    v_mov_b32 v191, v15
L_atv_184:
    s_cmp_lt_u32 s89, 4
    s_cbranch_scc1 L_ats_185
    v_mfma_f32_32x32x16_bf16 v[192:207], v[36:39], v[16:19], 0
    s_branch L_atv_186
L_ats_185:
    v_mov_b32 v192, v15
    v_mov_b32 v193, v15
    v_mov_b32 v194, v15
    v_mov_b32 v195, v15
    v_mov_b32 v196, v15
    v_mov_b32 v197, v15
    v_mov_b32 v198, v15
    v_mov_b32 v199, v15
    v_mov_b32 v200, v15
    v_mov_b32 v201, v15
    v_mov_b32 v202, v15
    v_mov_b32 v203, v15
    v_mov_b32 v204, v15
    v_mov_b32 v205, v15
    v_mov_b32 v206, v15
    v_mov_b32 v207, v15
L_atv_186:
    s_cmp_lt_u32 s89, 3
    s_cbranch_scc1 L_ats_187
    v_mfma_f32_32x32x16_bf16 v[208:223], v[40:43], v[16:19], 0
    s_branch L_atv_188
L_ats_187:
    v_mov_b32 v208, v15
    v_mov_b32 v209, v15
    v_mov_b32 v210, v15
    v_mov_b32 v211, v15
    v_mov_b32 v212, v15
    v_mov_b32 v213, v15
    v_mov_b32 v214, v15
    v_mov_b32 v215, v15
    v_mov_b32 v216, v15
    v_mov_b32 v217, v15
    v_mov_b32 v218, v15
    v_mov_b32 v219, v15
    v_mov_b32 v220, v15
    v_mov_b32 v221, v15
    v_mov_b32 v222, v15
    v_mov_b32 v223, v15
L_atv_188:
    s_cmp_lt_u32 s89, 2
    s_cbranch_scc1 L_ats_189
    v_mfma_f32_32x32x16_bf16 v[224:239], v[44:47], v[16:19], 0
    s_branch L_atv_190
L_ats_189:
    v_mov_b32 v224, v15
    v_mov_b32 v225, v15
    v_mov_b32 v226, v15
    v_mov_b32 v227, v15
    v_mov_b32 v228, v15
    v_mov_b32 v229, v15
    v_mov_b32 v230, v15
    v_mov_b32 v231, v15
    v_mov_b32 v232, v15
    v_mov_b32 v233, v15
    v_mov_b32 v234, v15
    v_mov_b32 v235, v15
    v_mov_b32 v236, v15
    v_mov_b32 v237, v15
    v_mov_b32 v238, v15
    v_mov_b32 v239, v15
L_atv_190:
    s_cmp_lt_u32 s89, 1
    s_cbranch_scc1 L_ats_191
    v_mfma_f32_32x32x16_bf16 v[240:255], v[48:51], v[16:19], 0
    s_branch L_atv_192
L_ats_191:
    v_mov_b32 v240, v15
    v_mov_b32 v241, v15
    v_mov_b32 v242, v15
    v_mov_b32 v243, v15
    v_mov_b32 v244, v15
    v_mov_b32 v245, v15
    v_mov_b32 v246, v15
    v_mov_b32 v247, v15
    v_mov_b32 v248, v15
    v_mov_b32 v249, v15
    v_mov_b32 v250, v15
    v_mov_b32 v251, v15
    v_mov_b32 v252, v15
    v_mov_b32 v253, v15
    v_mov_b32 v254, v15
    v_mov_b32 v255, v15
L_atv_192:
    v_mfma_f32_32x32x16_bf16 v[20:35], v[52:55], v[16:19], 0
    s_nop 7
    s_nop 7
    v_cmp_gt_i32 vcc, 0, v9
    s_nop 1
    v_cndmask_b32 v128, v15, v128, vcc
    v_cndmask_b32 v20, v20, v15, vcc
    v_cmp_gt_i32 vcc, 1, v9
    s_nop 1
    v_cndmask_b32 v129, v15, v129, vcc
    v_cndmask_b32 v21, v21, v15, vcc
    v_cmp_gt_i32 vcc, 2, v9
    s_nop 1
    v_cndmask_b32 v130, v15, v130, vcc
    v_cndmask_b32 v22, v22, v15, vcc
    v_cmp_gt_i32 vcc, 3, v9
    s_nop 1
    v_cndmask_b32 v131, v15, v131, vcc
    v_cndmask_b32 v23, v23, v15, vcc
    v_cmp_gt_i32 vcc, 4, v9
    s_nop 1
    v_cndmask_b32 v132, v15, v132, vcc
    v_cndmask_b32 v24, v24, v15, vcc
    v_cmp_gt_i32 vcc, 5, v9
    s_nop 1
    v_cndmask_b32 v133, v15, v133, vcc
    v_cndmask_b32 v25, v25, v15, vcc
    v_cmp_gt_i32 vcc, 6, v9
    s_nop 1
    v_cndmask_b32 v134, v15, v134, vcc
    v_cndmask_b32 v26, v26, v15, vcc
    v_cmp_gt_i32 vcc, 7, v9
    s_nop 1
    v_cndmask_b32 v135, v15, v135, vcc
    v_cndmask_b32 v27, v27, v15, vcc
    v_cmp_gt_i32 vcc, 16, v9
    s_nop 1
    v_cndmask_b32 v136, v15, v136, vcc
    v_cndmask_b32 v28, v28, v15, vcc
    v_cmp_gt_i32 vcc, 17, v9
    s_nop 1
    v_cndmask_b32 v137, v15, v137, vcc
    v_cndmask_b32 v29, v29, v15, vcc
    v_cmp_gt_i32 vcc, 18, v9
    s_nop 1
    v_cndmask_b32 v138, v15, v138, vcc
    v_cndmask_b32 v30, v30, v15, vcc
    v_cmp_gt_i32 vcc, 19, v9
    s_nop 1
    v_cndmask_b32 v139, v15, v139, vcc
    v_cndmask_b32 v31, v31, v15, vcc
    v_cmp_gt_i32 vcc, 20, v9
    s_nop 1
    v_cndmask_b32 v140, v15, v140, vcc
    v_cndmask_b32 v32, v32, v15, vcc
    v_cmp_gt_i32 vcc, 21, v9
    s_nop 1
    v_cndmask_b32 v141, v15, v141, vcc
    v_cndmask_b32 v33, v33, v15, vcc
    v_cmp_gt_i32 vcc, 22, v9
    s_nop 1
    v_cndmask_b32 v142, v15, v142, vcc
    v_cndmask_b32 v34, v34, v15, vcc
    v_cmp_gt_i32 vcc, 23, v9
    s_nop 1
    v_cndmask_b32 v143, v15, v143, vcc
    v_cndmask_b32 v35, v35, v15, vcc
    v_max3_f32 v2, v128, v129, v130
    v_max3_f32 v3, v131, v132, v133
    v_max3_f32 v2, v2, v134, v135
    v_max3_f32 v3, v3, v136, v137
    v_max3_f32 v2, v2, v138, v139
    v_max3_f32 v3, v3, v140, v141
    v_max3_f32 v2, v2, v142, v143
    v_max3_f32 v3, v3, v144, v145
    v_max3_f32 v2, v2, v146, v147
    v_max3_f32 v3, v3, v148, v149
    v_max3_f32 v2, v2, v150, v151
    v_max3_f32 v3, v3, v152, v153
    v_max3_f32 v2, v2, v154, v155
    v_max3_f32 v3, v3, v156, v157
    v_max3_f32 v2, v2, v158, v159
    v_max3_f32 v3, v3, v160, v161
    v_max3_f32 v2, v2, v162, v163
    v_max3_f32 v3, v3, v164, v165
    v_max3_f32 v2, v2, v166, v167
    v_max3_f32 v3, v3, v168, v169
    v_max3_f32 v2, v2, v170, v171
    v_max3_f32 v3, v3, v172, v173
    v_max3_f32 v2, v2, v174, v175
    v_max3_f32 v3, v3, v176, v177
    v_max3_f32 v2, v2, v178, v179
    v_max3_f32 v3, v3, v180, v181
    v_max3_f32 v2, v2, v182, v183
    v_max3_f32 v3, v3, v184, v185
    v_max3_f32 v2, v2, v186, v187
    v_max3_f32 v3, v3, v188, v189
    v_max3_f32 v2, v2, v190, v191
    v_max3_f32 v3, v3, v192, v193
    v_max3_f32 v2, v2, v194, v195
    v_max3_f32 v3, v3, v196, v197
    v_max3_f32 v2, v2, v198, v199
    v_max3_f32 v3, v3, v200, v201
    v_max3_f32 v2, v2, v202, v203
    v_max3_f32 v3, v3, v204, v205
    v_max3_f32 v2, v2, v206, v207
    v_max3_f32 v3, v3, v208, v209
    v_max3_f32 v2, v2, v210, v211
    v_max3_f32 v3, v3, v212, v213
    v_max3_f32 v2, v2, v214, v215
    v_max3_f32 v3, v3, v216, v217
    v_max3_f32 v2, v2, v218, v219
    v_max3_f32 v3, v3, v220, v221
    v_max3_f32 v2, v2, v222, v223
    v_max3_f32 v3, v3, v224, v225
    v_max3_f32 v2, v2, v226, v227
    v_max3_f32 v3, v3, v228, v229
    v_max3_f32 v2, v2, v230, v231
    v_max3_f32 v3, v3, v232, v233
    v_max3_f32 v2, v2, v234, v235
    v_max3_f32 v3, v3, v236, v237
    v_max3_f32 v2, v2, v238, v239
    v_max3_f32 v3, v3, v240, v241
    v_max3_f32 v2, v2, v242, v243
    v_max3_f32 v3, v3, v244, v245
    v_max3_f32 v2, v2, v246, v247
    v_max3_f32 v3, v3, v248, v249
    v_max3_f32 v2, v2, v250, v251
    v_max3_f32 v3, v3, v252, v253
    v_max3_f32 v2, v2, v254, v255
    v_max3_f32 v3, v3, v20, v21
    v_max3_f32 v2, v2, v22, v23
    v_max3_f32 v3, v3, v24, v25
    v_max3_f32 v2, v2, v26, v27
    v_max3_f32 v3, v3, v28, v29
    v_max3_f32 v2, v2, v30, v31
    v_max3_f32 v3, v3, v32, v33
    v_max3_f32 v2, v2, v34, v35
    v_max_f32 v2, v2, v3
    v_mov_b32 v3, v2
    s_nop 1
    v_permlane32_swap_b32 v2, v3
    v_max_f32 v2, v2, v3
    v_mul_f32 v2, s76, v2
    v_accvgpr_write_b32 a0, 0
    v_accvgpr_write_b32 a1, 0
    v_accvgpr_write_b32 a2, 0
    v_accvgpr_write_b32 a3, 0
    v_accvgpr_write_b32 a4, 0
    v_accvgpr_write_b32 a5, 0
    v_accvgpr_write_b32 a6, 0
    v_accvgpr_write_b32 a7, 0
    v_accvgpr_write_b32 a8, 0
    v_accvgpr_write_b32 a9, 0
    v_accvgpr_write_b32 a10, 0
    v_accvgpr_write_b32 a11, 0
    v_accvgpr_write_b32 a12, 0
    v_accvgpr_write_b32 a13, 0
    v_accvgpr_write_b32 a14, 0
    v_accvgpr_write_b32 a15, 0
    s_cmp_lt_u32 s89, 8
    s_cbranch_scc1 L_atp_193
    v_fma_f32 v128, v128, s76, -v2
    v_fma_f32 v129, v129, s76, -v2
    v_fma_f32 v130, v130, s76, -v2
    v_fma_f32 v131, v131, s76, -v2
    v_fma_f32 v132, v132, s76, -v2
    v_fma_f32 v133, v133, s76, -v2
    v_fma_f32 v134, v134, s76, -v2
    v_fma_f32 v135, v135, s76, -v2
    v_fma_f32 v136, v136, s76, -v2
    v_fma_f32 v137, v137, s76, -v2
    v_fma_f32 v138, v138, s76, -v2
    v_fma_f32 v139, v139, s76, -v2
    v_fma_f32 v140, v140, s76, -v2
    v_fma_f32 v141, v141, s76, -v2
    v_fma_f32 v142, v142, s76, -v2
    v_fma_f32 v143, v143, s76, -v2
    v_exp_f32 v128, v128
    v_exp_f32 v129, v129
    v_exp_f32 v130, v130
    v_exp_f32 v131, v131
    v_exp_f32 v132, v132
    v_exp_f32 v133, v133
    v_exp_f32 v134, v134
    v_exp_f32 v135, v135
    v_exp_f32 v136, v136
    v_exp_f32 v137, v137
    v_exp_f32 v138, v138
    v_exp_f32 v139, v139
    v_exp_f32 v140, v140
    v_exp_f32 v141, v141
    v_exp_f32 v142, v142
    v_exp_f32 v143, v143
    v_cvt_pk_bf16_f32 v128, v128, v129
    v_cvt_pk_bf16_f32 v129, v130, v131
    v_cvt_pk_bf16_f32 v130, v132, v133
    v_cvt_pk_bf16_f32 v131, v134, v135
    v_cvt_pk_bf16_f32 v132, v136, v137
    v_cvt_pk_bf16_f32 v133, v138, v139
    v_cvt_pk_bf16_f32 v134, v140, v141
    v_cvt_pk_bf16_f32 v135, v142, v143
    v_mfma_f32_32x32x16_bf16 a[0:15], v[56:59], v[128:131], a[0:15]
    s_nop 0
    v_mfma_f32_32x32x16_bf16 a[0:15], v[60:63], v[132:135], a[0:15]
L_atp_193:
    s_cmp_lt_u32 s89, 7
    s_cbranch_scc1 L_atp_194
    v_fma_f32 v144, v144, s76, -v2
    v_fma_f32 v145, v145, s76, -v2
    v_fma_f32 v146, v146, s76, -v2
    v_fma_f32 v147, v147, s76, -v2
    v_fma_f32 v148, v148, s76, -v2
    v_fma_f32 v149, v149, s76, -v2
    v_fma_f32 v150, v150, s76, -v2
    v_fma_f32 v151, v151, s76, -v2
    v_fma_f32 v152, v152, s76, -v2
    v_fma_f32 v153, v153, s76, -v2
    v_fma_f32 v154, v154, s76, -v2
    v_fma_f32 v155, v155, s76, -v2
    v_fma_f32 v156, v156, s76, -v2
    v_fma_f32 v157, v157, s76, -v2
    v_fma_f32 v158, v158, s76, -v2
    v_fma_f32 v159, v159, s76, -v2
    v_exp_f32 v144, v144
    v_exp_f32 v145, v145
    v_exp_f32 v146, v146
    v_exp_f32 v147, v147
    v_exp_f32 v148, v148
    v_exp_f32 v149, v149
    v_exp_f32 v150, v150
    v_exp_f32 v151, v151
    v_exp_f32 v152, v152
    v_exp_f32 v153, v153
    v_exp_f32 v154, v154
    v_exp_f32 v155, v155
    v_exp_f32 v156, v156
    v_exp_f32 v157, v157
    v_exp_f32 v158, v158
    v_exp_f32 v159, v159
    v_cvt_pk_bf16_f32 v144, v144, v145
    v_cvt_pk_bf16_f32 v145, v146, v147
    v_cvt_pk_bf16_f32 v146, v148, v149
    v_cvt_pk_bf16_f32 v147, v150, v151
    v_cvt_pk_bf16_f32 v148, v152, v153
    v_cvt_pk_bf16_f32 v149, v154, v155
    v_cvt_pk_bf16_f32 v150, v156, v157
    v_cvt_pk_bf16_f32 v151, v158, v159
    v_mfma_f32_32x32x16_bf16 a[0:15], v[64:67], v[144:147], a[0:15]
    s_nop 0
    v_mfma_f32_32x32x16_bf16 a[0:15], v[68:71], v[148:151], a[0:15]
L_atp_194:
    s_cmp_lt_u32 s89, 6
    s_cbranch_scc1 L_atp_195
    v_fma_f32 v160, v160, s76, -v2
    v_fma_f32 v161, v161, s76, -v2
    v_fma_f32 v162, v162, s76, -v2
    v_fma_f32 v163, v163, s76, -v2
    v_fma_f32 v164, v164, s76, -v2
    v_fma_f32 v165, v165, s76, -v2
    v_fma_f32 v166, v166, s76, -v2
    v_fma_f32 v167, v167, s76, -v2
    v_fma_f32 v168, v168, s76, -v2
    v_fma_f32 v169, v169, s76, -v2
    v_fma_f32 v170, v170, s76, -v2
    v_fma_f32 v171, v171, s76, -v2
    v_fma_f32 v172, v172, s76, -v2
    v_fma_f32 v173, v173, s76, -v2
    v_fma_f32 v174, v174, s76, -v2
    v_fma_f32 v175, v175, s76, -v2
    v_exp_f32 v160, v160
    v_exp_f32 v161, v161
    v_exp_f32 v162, v162
    v_exp_f32 v163, v163
    v_exp_f32 v164, v164
    v_exp_f32 v165, v165
    v_exp_f32 v166, v166
    v_exp_f32 v167, v167
    v_exp_f32 v168, v168
    v_exp_f32 v169, v169
    v_exp_f32 v170, v170
    v_exp_f32 v171, v171
    v_exp_f32 v172, v172
    v_exp_f32 v173, v173
    v_exp_f32 v174, v174
    v_exp_f32 v175, v175
    v_cvt_pk_bf16_f32 v160, v160, v161
    v_cvt_pk_bf16_f32 v161, v162, v163
    v_cvt_pk_bf16_f32 v162, v164, v165
    v_cvt_pk_bf16_f32 v163, v166, v167
    v_cvt_pk_bf16_f32 v164, v168, v169
    v_cvt_pk_bf16_f32 v165, v170, v171
    v_cvt_pk_bf16_f32 v166, v172, v173
    v_cvt_pk_bf16_f32 v167, v174, v175
    v_mfma_f32_32x32x16_bf16 a[0:15], v[72:75], v[160:163], a[0:15]
    s_nop 0
    v_mfma_f32_32x32x16_bf16 a[0:15], v[76:79], v[164:167], a[0:15]
L_atp_195:
    s_cmp_lt_u32 s89, 5
    s_cbranch_scc1 L_atp_196
    v_fma_f32 v176, v176, s76, -v2
    v_fma_f32 v177, v177, s76, -v2
    v_fma_f32 v178, v178, s76, -v2
    v_fma_f32 v179, v179, s76, -v2
    v_fma_f32 v180, v180, s76, -v2
    v_fma_f32 v181, v181, s76, -v2
    v_fma_f32 v182, v182, s76, -v2
    v_fma_f32 v183, v183, s76, -v2
    v_fma_f32 v184, v184, s76, -v2
    v_fma_f32 v185, v185, s76, -v2
    v_fma_f32 v186, v186, s76, -v2
    v_fma_f32 v187, v187, s76, -v2
    v_fma_f32 v188, v188, s76, -v2
    v_fma_f32 v189, v189, s76, -v2
    v_fma_f32 v190, v190, s76, -v2
    v_fma_f32 v191, v191, s76, -v2
    v_exp_f32 v176, v176
    v_exp_f32 v177, v177
    v_exp_f32 v178, v178
    v_exp_f32 v179, v179
    v_exp_f32 v180, v180
    v_exp_f32 v181, v181
    v_exp_f32 v182, v182
    v_exp_f32 v183, v183
    v_exp_f32 v184, v184
    v_exp_f32 v185, v185
    v_exp_f32 v186, v186
    v_exp_f32 v187, v187
    v_exp_f32 v188, v188
    v_exp_f32 v189, v189
    v_exp_f32 v190, v190
    v_exp_f32 v191, v191
    v_cvt_pk_bf16_f32 v176, v176, v177
    v_cvt_pk_bf16_f32 v177, v178, v179
    v_cvt_pk_bf16_f32 v178, v180, v181
    v_cvt_pk_bf16_f32 v179, v182, v183
    v_cvt_pk_bf16_f32 v180, v184, v185
    v_cvt_pk_bf16_f32 v181, v186, v187
    v_cvt_pk_bf16_f32 v182, v188, v189
    v_cvt_pk_bf16_f32 v183, v190, v191
    v_mfma_f32_32x32x16_bf16 a[0:15], v[80:83], v[176:179], a[0:15]
    s_nop 0
    v_mfma_f32_32x32x16_bf16 a[0:15], v[84:87], v[180:183], a[0:15]
L_atp_196:
    s_cmp_lt_u32 s89, 4
    s_cbranch_scc1 L_atp_197
    v_fma_f32 v192, v192, s76, -v2
    v_fma_f32 v193, v193, s76, -v2
    v_fma_f32 v194, v194, s76, -v2
    v_fma_f32 v195, v195, s76, -v2
    v_fma_f32 v196, v196, s76, -v2
    v_fma_f32 v197, v197, s76, -v2
    v_fma_f32 v198, v198, s76, -v2
    v_fma_f32 v199, v199, s76, -v2
    v_fma_f32 v200, v200, s76, -v2
    v_fma_f32 v201, v201, s76, -v2
    v_fma_f32 v202, v202, s76, -v2
    v_fma_f32 v203, v203, s76, -v2
    v_fma_f32 v204, v204, s76, -v2
    v_fma_f32 v205, v205, s76, -v2
    v_fma_f32 v206, v206, s76, -v2
    v_fma_f32 v207, v207, s76, -v2
    v_exp_f32 v192, v192
    v_exp_f32 v193, v193
    v_exp_f32 v194, v194
    v_exp_f32 v195, v195
    v_exp_f32 v196, v196
    v_exp_f32 v197, v197
    v_exp_f32 v198, v198
    v_exp_f32 v199, v199
    v_exp_f32 v200, v200
    v_exp_f32 v201, v201
    v_exp_f32 v202, v202
    v_exp_f32 v203, v203
    v_exp_f32 v204, v204
    v_exp_f32 v205, v205
    v_exp_f32 v206, v206
    v_exp_f32 v207, v207
    v_cvt_pk_bf16_f32 v192, v192, v193
    v_cvt_pk_bf16_f32 v193, v194, v195
    v_cvt_pk_bf16_f32 v194, v196, v197
    v_cvt_pk_bf16_f32 v195, v198, v199
    v_cvt_pk_bf16_f32 v196, v200, v201
    v_cvt_pk_bf16_f32 v197, v202, v203
    v_cvt_pk_bf16_f32 v198, v204, v205
    v_cvt_pk_bf16_f32 v199, v206, v207
    v_mfma_f32_32x32x16_bf16 a[0:15], v[88:91], v[192:195], a[0:15]
    s_nop 0
    v_mfma_f32_32x32x16_bf16 a[0:15], v[92:95], v[196:199], a[0:15]
L_atp_197:
    s_cmp_lt_u32 s89, 3
    s_cbranch_scc1 L_atp_198
    v_fma_f32 v208, v208, s76, -v2
    v_fma_f32 v209, v209, s76, -v2
    v_fma_f32 v210, v210, s76, -v2
    v_fma_f32 v211, v211, s76, -v2
    v_fma_f32 v212, v212, s76, -v2
    v_fma_f32 v213, v213, s76, -v2
    v_fma_f32 v214, v214, s76, -v2
    v_fma_f32 v215, v215, s76, -v2
    v_fma_f32 v216, v216, s76, -v2
    v_fma_f32 v217, v217, s76, -v2
    v_fma_f32 v218, v218, s76, -v2
    v_fma_f32 v219, v219, s76, -v2
    v_fma_f32 v220, v220, s76, -v2
    v_fma_f32 v221, v221, s76, -v2
    v_fma_f32 v222, v222, s76, -v2
    v_fma_f32 v223, v223, s76, -v2
    v_exp_f32 v208, v208
    v_exp_f32 v209, v209
    v_exp_f32 v210, v210
    v_exp_f32 v211, v211
    v_exp_f32 v212, v212
    v_exp_f32 v213, v213
    v_exp_f32 v214, v214
    v_exp_f32 v215, v215
    v_exp_f32 v216, v216
    v_exp_f32 v217, v217
    v_exp_f32 v218, v218
    v_exp_f32 v219, v219
    v_exp_f32 v220, v220
    v_exp_f32 v221, v221
    v_exp_f32 v222, v222
    v_exp_f32 v223, v223
    v_cvt_pk_bf16_f32 v208, v208, v209
    v_cvt_pk_bf16_f32 v209, v210, v211
    v_cvt_pk_bf16_f32 v210, v212, v213
    v_cvt_pk_bf16_f32 v211, v214, v215
    v_cvt_pk_bf16_f32 v212, v216, v217
    v_cvt_pk_bf16_f32 v213, v218, v219
    v_cvt_pk_bf16_f32 v214, v220, v221
    v_cvt_pk_bf16_f32 v215, v222, v223
    v_mfma_f32_32x32x16_bf16 a[0:15], v[96:99], v[208:211], a[0:15]
    s_nop 0
    v_mfma_f32_32x32x16_bf16 a[0:15], v[100:103], v[212:215], a[0:15]
L_atp_198:
    s_cmp_lt_u32 s89, 2
    s_cbranch_scc1 L_atp_199
    v_fma_f32 v224, v224, s76, -v2
    v_fma_f32 v225, v225, s76, -v2
    v_fma_f32 v226, v226, s76, -v2
    v_fma_f32 v227, v227, s76, -v2
    v_fma_f32 v228, v228, s76, -v2
    v_fma_f32 v229, v229, s76, -v2
    v_fma_f32 v230, v230, s76, -v2
    v_fma_f32 v231, v231, s76, -v2
    v_fma_f32 v232, v232, s76, -v2
    v_fma_f32 v233, v233, s76, -v2
    v_fma_f32 v234, v234, s76, -v2
    v_fma_f32 v235, v235, s76, -v2
    v_fma_f32 v236, v236, s76, -v2
    v_fma_f32 v237, v237, s76, -v2
    v_fma_f32 v238, v238, s76, -v2
    v_fma_f32 v239, v239, s76, -v2
    v_exp_f32 v224, v224
    v_exp_f32 v225, v225
    v_exp_f32 v226, v226
    v_exp_f32 v227, v227
    v_exp_f32 v228, v228
    v_exp_f32 v229, v229
    v_exp_f32 v230, v230
    v_exp_f32 v231, v231
    v_exp_f32 v232, v232
    v_exp_f32 v233, v233
    v_exp_f32 v234, v234
    v_exp_f32 v235, v235
    v_exp_f32 v236, v236
    v_exp_f32 v237, v237
    v_exp_f32 v238, v238
    v_exp_f32 v239, v239
    v_cvt_pk_bf16_f32 v224, v224, v225
    v_cvt_pk_bf16_f32 v225, v226, v227
    v_cvt_pk_bf16_f32 v226, v228, v229
    v_cvt_pk_bf16_f32 v227, v230, v231
    v_cvt_pk_bf16_f32 v228, v232, v233
    v_cvt_pk_bf16_f32 v229, v234, v235
    v_cvt_pk_bf16_f32 v230, v236, v237
    v_cvt_pk_bf16_f32 v231, v238, v239
    v_mfma_f32_32x32x16_bf16 a[0:15], v[104:107], v[224:227], a[0:15]
    s_nop 0
    v_mfma_f32_32x32x16_bf16 a[0:15], v[108:111], v[228:231], a[0:15]
L_atp_199:
    s_cmp_lt_u32 s89, 1
    s_cbranch_scc1 L_atp_200
    v_fma_f32 v240, v240, s76, -v2
    v_fma_f32 v241, v241, s76, -v2
    v_fma_f32 v242, v242, s76, -v2
    v_fma_f32 v243, v243, s76, -v2
    v_fma_f32 v244, v244, s76, -v2
    v_fma_f32 v245, v245, s76, -v2
    v_fma_f32 v246, v246, s76, -v2
    v_fma_f32 v247, v247, s76, -v2
    v_fma_f32 v248, v248, s76, -v2
    v_fma_f32 v249, v249, s76, -v2
    v_fma_f32 v250, v250, s76, -v2
    v_fma_f32 v251, v251, s76, -v2
    v_fma_f32 v252, v252, s76, -v2
    v_fma_f32 v253, v253, s76, -v2
    v_fma_f32 v254, v254, s76, -v2
    v_fma_f32 v255, v255, s76, -v2
    v_exp_f32 v240, v240
    v_exp_f32 v241, v241
    v_exp_f32 v242, v242
    v_exp_f32 v243, v243
    v_exp_f32 v244, v244
    v_exp_f32 v245, v245
    v_exp_f32 v246, v246
    v_exp_f32 v247, v247
    v_exp_f32 v248, v248
    v_exp_f32 v249, v249
    v_exp_f32 v250, v250
    v_exp_f32 v251, v251
    v_exp_f32 v252, v252
    v_exp_f32 v253, v253
    v_exp_f32 v254, v254
    v_exp_f32 v255, v255
    v_cvt_pk_bf16_f32 v240, v240, v241
    v_cvt_pk_bf16_f32 v241, v242, v243
    v_cvt_pk_bf16_f32 v242, v244, v245
    v_cvt_pk_bf16_f32 v243, v246, v247
    v_cvt_pk_bf16_f32 v244, v248, v249
    v_cvt_pk_bf16_f32 v245, v250, v251
    v_cvt_pk_bf16_f32 v246, v252, v253
    v_cvt_pk_bf16_f32 v247, v254, v255
    v_mfma_f32_32x32x16_bf16 a[0:15], v[112:115], v[240:243], a[0:15]
    s_nop 0
    v_mfma_f32_32x32x16_bf16 a[0:15], v[116:119], v[244:247], a[0:15]
L_atp_200:
    v_fma_f32 v20, v20, s76, -v2
    v_fma_f32 v21, v21, s76, -v2
    v_fma_f32 v22, v22, s76, -v2
    v_fma_f32 v23, v23, s76, -v2
    v_fma_f32 v24, v24, s76, -v2
    v_fma_f32 v25, v25, s76, -v2
    v_fma_f32 v26, v26, s76, -v2
    v_fma_f32 v27, v27, s76, -v2
    v_fma_f32 v28, v28, s76, -v2
    v_fma_f32 v29, v29, s76, -v2
    v_fma_f32 v30, v30, s76, -v2
    v_fma_f32 v31, v31, s76, -v2
    v_fma_f32 v32, v32, s76, -v2
    v_fma_f32 v33, v33, s76, -v2
    v_fma_f32 v34, v34, s76, -v2
    v_fma_f32 v35, v35, s76, -v2
    v_exp_f32 v20, v20
    v_exp_f32 v21, v21
    v_exp_f32 v22, v22
    v_exp_f32 v23, v23
    v_exp_f32 v24, v24
    v_exp_f32 v25, v25
    v_exp_f32 v26, v26
    v_exp_f32 v27, v27
    v_exp_f32 v28, v28
    v_exp_f32 v29, v29
    v_exp_f32 v30, v30
    v_exp_f32 v31, v31
    v_exp_f32 v32, v32
    v_exp_f32 v33, v33
    v_exp_f32 v34, v34
    v_exp_f32 v35, v35
    v_cvt_pk_bf16_f32 v20, v20, v21
    v_cvt_pk_bf16_f32 v21, v22, v23
    v_cvt_pk_bf16_f32 v22, v24, v25
    v_cvt_pk_bf16_f32 v23, v26, v27
    v_cvt_pk_bf16_f32 v24, v28, v29
    v_cvt_pk_bf16_f32 v25, v30, v31
    v_cvt_pk_bf16_f32 v26, v32, v33
    v_cvt_pk_bf16_f32 v27, v34, v35
    v_mfma_f32_32x32x16_bf16 a[0:15], v[120:123], v[20:23], a[0:15]
    s_nop 0
    v_mfma_f32_32x32x16_bf16 a[0:15], v[124:127], v[24:27], a[0:15]
    s_nop 7
    s_nop 7
    v_accvgpr_read_b32 v128, a0
    v_accvgpr_read_b32 v129, a1
    v_accvgpr_read_b32 v130, a2
    v_accvgpr_read_b32 v131, a3
    v_accvgpr_read_b32 v132, a4
    v_accvgpr_read_b32 v133, a5
    v_accvgpr_read_b32 v134, a6
    v_accvgpr_read_b32 v135, a7
    v_accvgpr_read_b32 v136, a8
    v_rcp_f32 v2, v136
    s_nop 0
    v_mul_f32 v128, v128, v2
    v_mul_f32 v129, v129, v2
    v_mul_f32 v130, v130, v2
    v_mul_f32 v131, v131, v2
    v_mul_f32 v132, v132, v2
    v_mul_f32 v133, v133, v2
    v_mul_f32 v134, v134, v2
    v_mul_f32 v135, v135, v2
    v_cvt_pk_bf16_f32 v144, v128, v129
    v_cvt_pk_bf16_f32 v145, v130, v131
    v_cvt_pk_bf16_f32 v146, v132, v133
    v_cvt_pk_bf16_f32 v147, v134, v135
    s_lshl_b32 s77, s89, 15
    s_lshl_b32 s78, s90, 5
    s_add_u32 s77, s77, s78
    s_add_u32 s77, s77, 90177536
    buffer_store_dwordx4 v[144:147], v8, s[52:55], s77 offen sc1
    s_add_u32 s89, s89, 1
    s_sub_u32 s91, s91, 1
    s_cmp_lg_u32 s91, 0
    s_cbranch_scc1 L_at_loop
    s_waitcnt vmcnt(0)
    s_barrier
    s_cmp_lg_u32 s56, 0
    s_cbranch_scc1 L_sig_201
    v_mov_b32 v120, 1
    v_mov_b32 v121, 24
    s_mov_b64 exec, 1
    buffer_atomic_add v120, v121, s[48:51], 0 offen
    s_mov_b64 exec, -1
L_sig_201:
    s_branch L_next
L_task_sv:
    s_sub_u32 s77, s88, 280
    s_lshr_b32 s89, s77, 4
    s_bfe_u32 s90, s77, 0x30001
    s_and_b32 s91, s77, 1
    s_mov_b32 s64, s40
    s_mov_b32 s65, s41
    s_mov_b32 s66, s42
    s_mov_b32 s67, s43
    s_mov_b32 s69, 1024
    s_lshl_b32 s71, s90, 19
    s_lshl_b32 s77, s91, 9
    s_add_u32 s71, s71, s77
    v_and_b32 v10, 63, v0
    v_lshrrev_b32 v11, 5, v10
    v_and_b32 v12, 31, v10
    s_lshl_b32 s77, s56, 4
    v_add_u32 v13, s77, v11
    v_mul_lo_u32 v13, v13, s69
    v_lshlrev_b32 v14, 2, v11
    v_xor_b32 v14, v14, v12
    v_lshl_add_u32 v2, v14, 4, v13
    v_xor_b32 v3, 128, v2
    s_lshl_b32 s84, s69, 1
    s_lshl_b32 s82, s56, 13
    v_and_b32 v11, 15, v10
    v_lshrrev_b32 v12, 4, v10
    v_lshrrev_b32 v13, 2, v11
    v_and_b32 v14, 3, v11
    v_lshl_add_u32 v15, v12, 3, v13
    s_lshl_b32 s77, s56, 1
    s_add_u32 s77, s77, 0
    v_xor_b32 v9, s77, v13
    v_lshl_add_u32 v9, v9, 2, v14
    v_lshlrev_b32 v9, 4, v9
    v_lshl_add_u32 v4, v15, 9, v9
    s_lshl_b32 s77, s56, 1
    s_add_u32 s77, s77, 1
    v_xor_b32 v9, s77, v13
    v_lshl_add_u32 v9, v9, 2, v14
    v_lshlrev_b32 v9, 4, v9
    v_lshl_add_u32 v5, v15, 9, v9
    v_add_u32 v128, 65536, v4
    v_add_u32 v129, 65536, v5
    s_barrier
    s_mov_b32 s79, s71
    s_add_u32 m0, s82, 0
    s_nop 0
    buffer_load_dwordx4 v2, s[64:67], s79 offen lds
    s_add_u32 s79, s79, s84
    s_add_u32 m0, s82, 1024
    s_nop 0
    buffer_load_dwordx4 v3, s[64:67], s79 offen lds
    s_add_u32 s79, s79, s84
    s_add_u32 m0, s82, 2048
    s_nop 0
    buffer_load_dwordx4 v2, s[64:67], s79 offen lds
    s_add_u32 s79, s79, s84
    s_add_u32 m0, s82, 3072
    s_nop 0
    buffer_load_dwordx4 v3, s[64:67], s79 offen lds
    s_add_u32 s79, s79, s84
    s_add_u32 m0, s82, 4096
    s_nop 0
    buffer_load_dwordx4 v2, s[64:67], s79 offen lds
    s_add_u32 s79, s79, s84
    s_add_u32 m0, s82, 5120
    s_nop 0
    buffer_load_dwordx4 v3, s[64:67], s79 offen lds
    s_add_u32 s79, s79, s84
    s_add_u32 m0, s82, 6144
    s_nop 0
    buffer_load_dwordx4 v2, s[64:67], s79 offen lds
    s_add_u32 s79, s79, s84
    s_add_u32 m0, s82, 7168
    s_nop 0
    buffer_load_dwordx4 v3, s[64:67], s79 offen lds
    s_lshl_b32 s79, s69, 6
    s_add_u32 s71, s71, s79
    s_mov_b32 s79, s71
    s_add_u32 m0, s82, 32768
    s_nop 0
    buffer_load_dwordx4 v2, s[64:67], s79 offen lds
    s_add_u32 s79, s79, s84
    s_add_u32 m0, s82, 33792
    s_nop 0
    buffer_load_dwordx4 v3, s[64:67], s79 offen lds
    s_add_u32 s79, s79, s84
    s_add_u32 m0, s82, 34816
    s_nop 0
    buffer_load_dwordx4 v2, s[64:67], s79 offen lds
    s_add_u32 s79, s79, s84
    s_add_u32 m0, s82, 35840
    s_nop 0
    buffer_load_dwordx4 v3, s[64:67], s79 offen lds
    s_add_u32 s79, s79, s84
    s_add_u32 m0, s82, 36864
    s_nop 0
    buffer_load_dwordx4 v2, s[64:67], s79 offen lds
    s_add_u32 s79, s79, s84
    s_add_u32 m0, s82, 37888
    s_nop 0
    buffer_load_dwordx4 v3, s[64:67], s79 offen lds
    s_add_u32 s79, s79, s84
    s_add_u32 m0, s82, 38912
    s_nop 0
    buffer_load_dwordx4 v2, s[64:67], s79 offen lds
    s_add_u32 s79, s79, s84
    s_add_u32 m0, s82, 39936
    s_nop 0
    buffer_load_dwordx4 v3, s[64:67], s79 offen lds
    s_lshl_b32 s79, s69, 6
    s_add_u32 s71, s71, s79
    s_mov_b32 s79, s71
    s_add_u32 m0, s82, 65536
    s_nop 0
    buffer_load_dwordx4 v2, s[64:67], s79 offen lds
    s_add_u32 s79, s79, s84
    s_add_u32 m0, s82, 66560
    s_nop 0
    buffer_load_dwordx4 v3, s[64:67], s79 offen lds
    s_add_u32 s79, s79, s84
    s_add_u32 m0, s82, 67584
    s_nop 0
    buffer_load_dwordx4 v2, s[64:67], s79 offen lds
    s_add_u32 s79, s79, s84
    s_add_u32 m0, s82, 68608
    s_nop 0
    buffer_load_dwordx4 v3, s[64:67], s79 offen lds
    s_add_u32 s79, s79, s84
    s_add_u32 m0, s82, 69632
    s_nop 0
    buffer_load_dwordx4 v2, s[64:67], s79 offen lds
    s_add_u32 s79, s79, s84
    s_add_u32 m0, s82, 70656
    s_nop 0
    buffer_load_dwordx4 v3, s[64:67], s79 offen lds
    s_add_u32 s79, s79, s84
    s_add_u32 m0, s82, 71680
    s_nop 0
    buffer_load_dwordx4 v2, s[64:67], s79 offen lds
    s_add_u32 s79, s79, s84
    s_add_u32 m0, s82, 72704
    s_nop 0
    buffer_load_dwordx4 v3, s[64:67], s79 offen lds
    s_lshl_b32 s79, s69, 6
    s_add_u32 s71, s71, s79
    s_waitcnt vmcnt(16)
    s_barrier
    s_mov_b32 s79, s71
    s_add_u32 m0, s82, 98304
    s_nop 0
    buffer_load_dwordx4 v2, s[64:67], s79 offen lds
    s_add_u32 s79, s79, s84
    s_add_u32 m0, s82, 99328
    s_nop 0
    buffer_load_dwordx4 v3, s[64:67], s79 offen lds
    s_add_u32 s79, s79, s84
    s_add_u32 m0, s82, 100352
    s_nop 0
    buffer_load_dwordx4 v2, s[64:67], s79 offen lds
    s_add_u32 s79, s79, s84
    s_add_u32 m0, s82, 101376
    s_nop 0
    buffer_load_dwordx4 v3, s[64:67], s79 offen lds
    s_add_u32 s79, s79, s84
    s_add_u32 m0, s82, 102400
    s_nop 0
    buffer_load_dwordx4 v2, s[64:67], s79 offen lds
    s_add_u32 s79, s79, s84
    s_add_u32 m0, s82, 103424
    s_nop 0
    buffer_load_dwordx4 v3, s[64:67], s79 offen lds
    s_add_u32 s79, s79, s84
    s_add_u32 m0, s82, 104448
    s_nop 0
    buffer_load_dwordx4 v2, s[64:67], s79 offen lds
    s_add_u32 s79, s79, s84
    s_add_u32 m0, s82, 105472
    s_nop 0
    buffer_load_dwordx4 v3, s[64:67], s79 offen lds
    s_lshl_b32 s79, s69, 6
    s_add_u32 s71, s71, s79
    ds_read_b64_tr_b16 a[0:1], v4 offset:0
    ds_read_b64_tr_b16 a[2:3], v4 offset:2048
    ds_read_b64_tr_b16 a[64:65], v4 offset:8
    ds_read_b64_tr_b16 a[66:67], v4 offset:2056
    ds_read_b64_tr_b16 a[128:129], v5 offset:0
    ds_read_b64_tr_b16 a[130:131], v5 offset:2048
    ds_read_b64_tr_b16 a[192:193], v5 offset:8
    ds_read_b64_tr_b16 a[194:195], v5 offset:2056
    ds_read_b64_tr_b16 a[4:5], v4 offset:16384
    ds_read_b64_tr_b16 a[6:7], v4 offset:18432
    ds_read_b64_tr_b16 a[68:69], v4 offset:16392
    ds_read_b64_tr_b16 a[70:71], v4 offset:18440
    ds_read_b64_tr_b16 a[132:133], v5 offset:16384
    ds_read_b64_tr_b16 a[134:135], v5 offset:18432
    ds_read_b64_tr_b16 a[196:197], v5 offset:16392
    ds_read_b64_tr_b16 a[198:199], v5 offset:18440
    s_waitcnt lgkmcnt(0)
    s_waitcnt vmcnt(16)
    s_barrier
    s_mov_b32 s79, s71
    s_add_u32 m0, s82, 0
    s_nop 0
    buffer_load_dwordx4 v2, s[64:67], s79 offen lds
    s_add_u32 s79, s79, s84
    s_add_u32 m0, s82, 1024
    s_nop 0
    buffer_load_dwordx4 v3, s[64:67], s79 offen lds
    s_add_u32 s79, s79, s84
    s_add_u32 m0, s82, 2048
    s_nop 0
    buffer_load_dwordx4 v2, s[64:67], s79 offen lds
    s_add_u32 s79, s79, s84
    s_add_u32 m0, s82, 3072
    s_nop 0
    buffer_load_dwordx4 v3, s[64:67], s79 offen lds
    s_add_u32 s79, s79, s84
    s_add_u32 m0, s82, 4096
    s_nop 0
    buffer_load_dwordx4 v2, s[64:67], s79 offen lds
    s_add_u32 s79, s79, s84
    s_add_u32 m0, s82, 5120
    s_nop 0
    buffer_load_dwordx4 v3, s[64:67], s79 offen lds
    s_add_u32 s79, s79, s84
    s_add_u32 m0, s82, 6144
    s_nop 0
    buffer_load_dwordx4 v2, s[64:67], s79 offen lds
    s_add_u32 s79, s79, s84
    s_add_u32 m0, s82, 7168
    s_nop 0
    buffer_load_dwordx4 v3, s[64:67], s79 offen lds
    s_lshl_b32 s79, s69, 6
    s_add_u32 s71, s71, s79
    ds_read_b64_tr_b16 a[8:9], v4 offset:32768
    ds_read_b64_tr_b16 a[10:11], v4 offset:34816
    ds_read_b64_tr_b16 a[72:73], v4 offset:32776
    ds_read_b64_tr_b16 a[74:75], v4 offset:34824
    ds_read_b64_tr_b16 a[136:137], v5 offset:32768
    ds_read_b64_tr_b16 a[138:139], v5 offset:34816
    ds_read_b64_tr_b16 a[200:201], v5 offset:32776
    ds_read_b64_tr_b16 a[202:203], v5 offset:34824
    ds_read_b64_tr_b16 a[12:13], v4 offset:49152
    ds_read_b64_tr_b16 a[14:15], v4 offset:51200
    ds_read_b64_tr_b16 a[76:77], v4 offset:49160
    ds_read_b64_tr_b16 a[78:79], v4 offset:51208
    ds_read_b64_tr_b16 a[140:141], v5 offset:49152
    ds_read_b64_tr_b16 a[142:143], v5 offset:51200
    ds_read_b64_tr_b16 a[204:205], v5 offset:49160
    ds_read_b64_tr_b16 a[206:207], v5 offset:51208
    s_waitcnt lgkmcnt(0)
    s_waitcnt vmcnt(16)
    s_barrier
    s_mov_b32 s79, s71
    s_add_u32 m0, s82, 32768
    s_nop 0
    buffer_load_dwordx4 v2, s[64:67], s79 offen lds
    s_add_u32 s79, s79, s84
    s_add_u32 m0, s82, 33792
    s_nop 0
    buffer_load_dwordx4 v3, s[64:67], s79 offen lds
    s_add_u32 s79, s79, s84
    s_add_u32 m0, s82, 34816
    s_nop 0
    buffer_load_dwordx4 v2, s[64:67], s79 offen lds
    s_add_u32 s79, s79, s84
    s_add_u32 m0, s82, 35840
    s_nop 0
    buffer_load_dwordx4 v3, s[64:67], s79 offen lds
    s_add_u32 s79, s79, s84
    s_add_u32 m0, s82, 36864
    s_nop 0
    buffer_load_dwordx4 v2, s[64:67], s79 offen lds
    s_add_u32 s79, s79, s84
    s_add_u32 m0, s82, 37888
    s_nop 0
    buffer_load_dwordx4 v3, s[64:67], s79 offen lds
    s_add_u32 s79, s79, s84
    s_add_u32 m0, s82, 38912
    s_nop 0
    buffer_load_dwordx4 v2, s[64:67], s79 offen lds
    s_add_u32 s79, s79, s84
    s_add_u32 m0, s82, 39936
    s_nop 0
    buffer_load_dwordx4 v3, s[64:67], s79 offen lds
    s_lshl_b32 s79, s69, 6
    s_add_u32 s71, s71, s79
    ds_read_b64_tr_b16 a[16:17], v128 offset:0
    ds_read_b64_tr_b16 a[18:19], v128 offset:2048
    ds_read_b64_tr_b16 a[80:81], v128 offset:8
    ds_read_b64_tr_b16 a[82:83], v128 offset:2056
    ds_read_b64_tr_b16 a[144:145], v129 offset:0
    ds_read_b64_tr_b16 a[146:147], v129 offset:2048
    ds_read_b64_tr_b16 a[208:209], v129 offset:8
    ds_read_b64_tr_b16 a[210:211], v129 offset:2056
    ds_read_b64_tr_b16 a[20:21], v128 offset:16384
    ds_read_b64_tr_b16 a[22:23], v128 offset:18432
    ds_read_b64_tr_b16 a[84:85], v128 offset:16392
    ds_read_b64_tr_b16 a[86:87], v128 offset:18440
    ds_read_b64_tr_b16 a[148:149], v129 offset:16384
    ds_read_b64_tr_b16 a[150:151], v129 offset:18432
    ds_read_b64_tr_b16 a[212:213], v129 offset:16392
    ds_read_b64_tr_b16 a[214:215], v129 offset:18440
    s_waitcnt lgkmcnt(0)
    s_waitcnt vmcnt(16)
    s_barrier
    s_mov_b32 s79, s71
    s_add_u32 m0, s82, 65536
    s_nop 0
    buffer_load_dwordx4 v2, s[64:67], s79 offen lds
    s_add_u32 s79, s79, s84
    s_add_u32 m0, s82, 66560
    s_nop 0
    buffer_load_dwordx4 v3, s[64:67], s79 offen lds
    s_add_u32 s79, s79, s84
    s_add_u32 m0, s82, 67584
    s_nop 0
    buffer_load_dwordx4 v2, s[64:67], s79 offen lds
    s_add_u32 s79, s79, s84
    s_add_u32 m0, s82, 68608
    s_nop 0
    buffer_load_dwordx4 v3, s[64:67], s79 offen lds
    s_add_u32 s79, s79, s84
    s_add_u32 m0, s82, 69632
    s_nop 0
    buffer_load_dwordx4 v2, s[64:67], s79 offen lds
    s_add_u32 s79, s79, s84
    s_add_u32 m0, s82, 70656
    s_nop 0
    buffer_load_dwordx4 v3, s[64:67], s79 offen lds
    s_add_u32 s79, s79, s84
    s_add_u32 m0, s82, 71680
    s_nop 0
    buffer_load_dwordx4 v2, s[64:67], s79 offen lds
    s_add_u32 s79, s79, s84
    s_add_u32 m0, s82, 72704
    s_nop 0
    buffer_load_dwordx4 v3, s[64:67], s79 offen lds
    s_lshl_b32 s79, s69, 6
    s_add_u32 s71, s71, s79
    ds_read_b64_tr_b16 a[24:25], v128 offset:32768
    ds_read_b64_tr_b16 a[26:27], v128 offset:34816
    ds_read_b64_tr_b16 a[88:89], v128 offset:32776
    ds_read_b64_tr_b16 a[90:91], v128 offset:34824
    ds_read_b64_tr_b16 a[152:153], v129 offset:32768
    ds_read_b64_tr_b16 a[154:155], v129 offset:34816
    ds_read_b64_tr_b16 a[216:217], v129 offset:32776
    ds_read_b64_tr_b16 a[218:219], v129 offset:34824
    ds_read_b64_tr_b16 a[28:29], v128 offset:49152
    ds_read_b64_tr_b16 a[30:31], v128 offset:51200
    ds_read_b64_tr_b16 a[92:93], v128 offset:49160
    ds_read_b64_tr_b16 a[94:95], v128 offset:51208
    ds_read_b64_tr_b16 a[156:157], v129 offset:49152
    ds_read_b64_tr_b16 a[158:159], v129 offset:51200
    ds_read_b64_tr_b16 a[220:221], v129 offset:49160
    ds_read_b64_tr_b16 a[222:223], v129 offset:51208
    s_waitcnt lgkmcnt(0)
    s_waitcnt vmcnt(16)
    s_barrier
    s_mov_b32 s79, s71
    s_add_u32 m0, s82, 98304
    s_nop 0
    buffer_load_dwordx4 v2, s[64:67], s79 offen lds
    s_add_u32 s79, s79, s84
    s_add_u32 m0, s82, 99328
    s_nop 0
    buffer_load_dwordx4 v3, s[64:67], s79 offen lds
    s_add_u32 s79, s79, s84
    s_add_u32 m0, s82, 100352
    s_nop 0
    buffer_load_dwordx4 v2, s[64:67], s79 offen lds
    s_add_u32 s79, s79, s84
    s_add_u32 m0, s82, 101376
    s_nop 0
    buffer_load_dwordx4 v3, s[64:67], s79 offen lds
    s_add_u32 s79, s79, s84
    s_add_u32 m0, s82, 102400
    s_nop 0
    buffer_load_dwordx4 v2, s[64:67], s79 offen lds
    s_add_u32 s79, s79, s84
    s_add_u32 m0, s82, 103424
    s_nop 0
    buffer_load_dwordx4 v3, s[64:67], s79 offen lds
    s_add_u32 s79, s79, s84
    s_add_u32 m0, s82, 104448
    s_nop 0
    buffer_load_dwordx4 v2, s[64:67], s79 offen lds
    s_add_u32 s79, s79, s84
    s_add_u32 m0, s82, 105472
    s_nop 0
    buffer_load_dwordx4 v3, s[64:67], s79 offen lds
    s_lshl_b32 s79, s69, 6
    s_add_u32 s71, s71, s79
    ds_read_b64_tr_b16 a[32:33], v4 offset:0
    ds_read_b64_tr_b16 a[34:35], v4 offset:2048
    ds_read_b64_tr_b16 a[96:97], v4 offset:8
    ds_read_b64_tr_b16 a[98:99], v4 offset:2056
    ds_read_b64_tr_b16 a[160:161], v5 offset:0
    ds_read_b64_tr_b16 a[162:163], v5 offset:2048
    ds_read_b64_tr_b16 a[224:225], v5 offset:8
    ds_read_b64_tr_b16 a[226:227], v5 offset:2056
    ds_read_b64_tr_b16 a[36:37], v4 offset:16384
    ds_read_b64_tr_b16 a[38:39], v4 offset:18432
    ds_read_b64_tr_b16 a[100:101], v4 offset:16392
    ds_read_b64_tr_b16 a[102:103], v4 offset:18440
    ds_read_b64_tr_b16 a[164:165], v5 offset:16384
    ds_read_b64_tr_b16 a[166:167], v5 offset:18432
    ds_read_b64_tr_b16 a[228:229], v5 offset:16392
    ds_read_b64_tr_b16 a[230:231], v5 offset:18440
    s_waitcnt lgkmcnt(0)
    s_waitcnt vmcnt(16)
    s_barrier
    ds_read_b64_tr_b16 a[40:41], v4 offset:32768
    ds_read_b64_tr_b16 a[42:43], v4 offset:34816
    ds_read_b64_tr_b16 a[104:105], v4 offset:32776
    ds_read_b64_tr_b16 a[106:107], v4 offset:34824
    ds_read_b64_tr_b16 a[168:169], v5 offset:32768
    ds_read_b64_tr_b16 a[170:171], v5 offset:34816
    ds_read_b64_tr_b16 a[232:233], v5 offset:32776
    ds_read_b64_tr_b16 a[234:235], v5 offset:34824
    ds_read_b64_tr_b16 a[44:45], v4 offset:49152
    ds_read_b64_tr_b16 a[46:47], v4 offset:51200
    ds_read_b64_tr_b16 a[108:109], v4 offset:49160
    ds_read_b64_tr_b16 a[110:111], v4 offset:51208
    ds_read_b64_tr_b16 a[172:173], v5 offset:49152
    ds_read_b64_tr_b16 a[174:175], v5 offset:51200
    ds_read_b64_tr_b16 a[236:237], v5 offset:49160
    ds_read_b64_tr_b16 a[238:239], v5 offset:51208
    s_waitcnt lgkmcnt(0)
    s_waitcnt vmcnt(8)
    s_barrier
    ds_read_b64_tr_b16 a[48:49], v128 offset:0
    ds_read_b64_tr_b16 a[50:51], v128 offset:2048
    ds_read_b64_tr_b16 a[112:113], v128 offset:8
    ds_read_b64_tr_b16 a[114:115], v128 offset:2056
    ds_read_b64_tr_b16 a[176:177], v129 offset:0
    ds_read_b64_tr_b16 a[178:179], v129 offset:2048
    ds_read_b64_tr_b16 a[240:241], v129 offset:8
    ds_read_b64_tr_b16 a[242:243], v129 offset:2056
    ds_read_b64_tr_b16 a[52:53], v128 offset:16384
    ds_read_b64_tr_b16 a[54:55], v128 offset:18432
    ds_read_b64_tr_b16 a[116:117], v128 offset:16392
    ds_read_b64_tr_b16 a[118:119], v128 offset:18440
    ds_read_b64_tr_b16 a[180:181], v129 offset:16384
    ds_read_b64_tr_b16 a[182:183], v129 offset:18432
    ds_read_b64_tr_b16 a[244:245], v129 offset:16392
    ds_read_b64_tr_b16 a[246:247], v129 offset:18440
    s_waitcnt lgkmcnt(0)
    s_waitcnt vmcnt(0)
    s_barrier
    ds_read_b64_tr_b16 a[56:57], v128 offset:32768
    ds_read_b64_tr_b16 a[58:59], v128 offset:34816
    ds_read_b64_tr_b16 a[120:121], v128 offset:32776
    ds_read_b64_tr_b16 a[122:123], v128 offset:34824
    ds_read_b64_tr_b16 a[184:185], v129 offset:32768
    ds_read_b64_tr_b16 a[186:187], v129 offset:34816
    ds_read_b64_tr_b16 a[248:249], v129 offset:32776
    ds_read_b64_tr_b16 a[250:251], v129 offset:34824
    ds_read_b64_tr_b16 a[60:61], v128 offset:49152
    ds_read_b64_tr_b16 a[62:63], v128 offset:51200
    ds_read_b64_tr_b16 a[124:125], v128 offset:49160
    ds_read_b64_tr_b16 a[126:127], v128 offset:51208
    ds_read_b64_tr_b16 a[188:189], v129 offset:49152
    ds_read_b64_tr_b16 a[190:191], v129 offset:51200
    ds_read_b64_tr_b16 a[252:253], v129 offset:49160
    ds_read_b64_tr_b16 a[254:255], v129 offset:51208
    s_waitcnt lgkmcnt(0)
    s_barrier
    v_and_b32 v10, 63, v0
    s_lshr_b32 s77, s56, 1
    s_lshl_b32 s77, s77, 15
    s_and_b32 s78, s56, 1
    s_lshl_b32 s78, s78, 12
    s_add_u32 s81, s77, s78
    v_lshlrev_b32 v6, 4, v10
    v_add_u32 v6, s81, v6
    v_and_b32 v11, 15, v10
    v_lshrrev_b32 v12, 4, v10
    v_lshrrev_b32 v13, 2, v11
    v_and_b32 v14, 3, v11
    v_lshl_add_u32 v15, v13, 3, v14
    v_lshlrev_b32 v15, 10, v15
    v_add_u32 v9, 0, v12
    v_xor_b32 v9, v9, v11
    v_lshl_add_u32 v128, v9, 4, v15
    v_add_u32 v132, 65536, v128
    v_add_u32 v9, 4, v12
    v_xor_b32 v9, v9, v11
    v_lshl_add_u32 v129, v9, 4, v15
    v_add_u32 v133, 65536, v129
    v_add_u32 v9, 8, v12
    v_xor_b32 v9, v9, v11
    v_lshl_add_u32 v130, v9, 4, v15
    v_add_u32 v134, 65536, v130
    v_add_u32 v9, 12, v12
    v_xor_b32 v9, v9, v11
    v_lshl_add_u32 v131, v9, 4, v15
    v_add_u32 v135, 65536, v131
    s_lshl_b32 s92, s90, 2
    s_add_u32 s92, s92, s56
    v_mov_b32 v121, 12
L_wt_202:
    buffer_load_dword v120, v121, s[48:51], 0 offen sc1
    s_waitcnt vmcnt(0)
    v_readfirstlane_b32 s77, v120
    s_nop 0
    s_cmp_ge_u32 s77, 32
    s_cbranch_scc1 L_wd_203
    s_sleep 32
    s_branch L_wt_202
L_wd_203:
    v_mov_b32 v121, 32
L_wt_204:
    buffer_load_dword v120, v121, s[48:51], 0 offen sc1
    s_waitcnt vmcnt(0)
    v_readfirstlane_b32 s77, v120
    s_nop 0
    s_cmp_ge_u32 s77, 1048608
    s_cbranch_scc1 L_wd_205
    s_sleep 32
    s_branch L_wt_204
L_wd_205:
    v_and_b32 v10, 63, v0
    v_and_b32 v11, 15, v10
    v_lshrrev_b32 v12, 4, v10
    v_lshlrev_b32 v108, 4, v10
    v_lshrrev_b32 v14, 2, v11
    v_and_b32 v15, 1, v11
    v_lshl_add_u32 v14, v14, 1, v15
    v_lshlrev_b32 v14, 8, v14
    v_lshl_add_u32 v109, v12, 4, v14
    v_lshrrev_b32 v14, 2, v11
    v_and_b32 v15, 3, v11
    v_lshl_add_u32 v14, v14, 3, v15
    v_lshlrev_b32 v9, 3, v12
    v_sub_u32 v111, v14, v9
    v_lshlrev_b32 v9, 4, v14
    v_lshl_add_u32 v110, v12, 2, v9
    v_lshlrev_b32 v13, 10, v14
    s_lshl_b32 s77, s56, 8
    v_add_u32 v13, s77, v13
    v_add_u32 v9, 0, v12
    v_xor_b32 v9, v9, v11
    v_lshl_add_u32 v113, v9, 4, v13
    v_add_u32 v9, 4, v12
    v_xor_b32 v9, v9, v11
    v_lshl_add_u32 v114, v9, 4, v13
    v_add_u32 v9, 8, v12
    v_xor_b32 v9, v9, v11
    v_lshl_add_u32 v115, v9, 4, v13
    v_add_u32 v9, 12, v12
    v_xor_b32 v9, v9, v11
    v_lshl_add_u32 v116, v9, 4, v13
    v_lshlrev_b32 v13, 11, v14
    s_lshl_b32 s77, s56, 7
    v_add_u32 v13, s77, v13
    v_lshl_add_u32 v117, v12, 4, v13
    v_mov_b32 v112, 0xff800000
    v_mov_b32 v248, 0x3f803f80
    v_mov_b32 v249, 0x3f803f80
    v_mov_b32 v250, 0x3f803f80
    v_mov_b32 v251, 0x3f803f80
    s_mov_b32 s76, 1040356334
    s_lshr_b32 s80, s89, 2
    s_lshl_b32 s80, s80, 2
    s_add_u32 s80, s80, 32
    v_mov_b32 v121, s80
L_wt_206:
    buffer_load_dword v120, v121, s[48:51], 0 offen sc1
    s_waitcnt vmcnt(0)
    v_readfirstlane_b32 s77, v120
    s_nop 0
    s_cmp_ge_u32 s77, 1048608
    s_cbranch_scc1 L_wd_207
    s_sleep 16
    s_branch L_wt_206
L_wd_207:
    s_lshl_b32 s78, s89, 5
    s_add_u32 s78, s78, s92
    s_lshl_b32 s77, s78, 13
    s_add_u32 s77, s77, 0
    buffer_load_dwordx4 v[136:139], v108, s[52:55], s77 offen offset:0 sc1
    buffer_load_dwordx4 v[140:143], v108, s[52:55], s77 offen offset:1024 sc1
    buffer_load_dwordx4 v[144:147], v108, s[52:55], s77 offen offset:2048 sc1
    buffer_load_dwordx4 v[148:151], v108, s[52:55], s77 offen offset:3072 sc1
    s_add_u32 s77, s77, 4096
    buffer_load_dwordx4 v[152:155], v108, s[52:55], s77 offen offset:0 sc1
    buffer_load_dwordx4 v[156:159], v108, s[52:55], s77 offen offset:1024 sc1
    buffer_load_dwordx4 v[160:163], v108, s[52:55], s77 offen offset:2048 sc1
    buffer_load_dwordx4 v[164:167], v108, s[52:55], s77 offen offset:3072 sc1
    s_lshl_b32 s77, s78, 14
    s_add_u32 s77, s77, 16777216
    buffer_load_dwordx4 v[168:171], v108, s[52:55], s77 offen offset:0 sc1
    buffer_load_dwordx4 v[172:175], v108, s[52:55], s77 offen offset:1024 sc1
    buffer_load_dwordx4 v[176:179], v108, s[52:55], s77 offen offset:2048 sc1
    buffer_load_dwordx4 v[180:183], v108, s[52:55], s77 offen offset:3072 sc1
    s_add_u32 s77, s77, 4096
    buffer_load_dwordx4 v[184:187], v108, s[52:55], s77 offen offset:0 sc1
    buffer_load_dwordx4 v[188:191], v108, s[52:55], s77 offen offset:1024 sc1
    buffer_load_dwordx4 v[192:195], v108, s[52:55], s77 offen offset:2048 sc1
    buffer_load_dwordx4 v[196:199], v108, s[52:55], s77 offen offset:3072 sc1
    s_add_u32 s77, s77, 4096
    buffer_load_dwordx4 v[200:203], v108, s[52:55], s77 offen offset:0 sc1
    buffer_load_dwordx4 v[204:207], v108, s[52:55], s77 offen offset:1024 sc1
    buffer_load_dwordx4 v[208:211], v108, s[52:55], s77 offen offset:2048 sc1
    buffer_load_dwordx4 v[212:215], v108, s[52:55], s77 offen offset:3072 sc1
    s_add_u32 s77, s77, 4096
    buffer_load_dwordx4 v[216:219], v108, s[52:55], s77 offen offset:0 sc1
    buffer_load_dwordx4 v[220:223], v108, s[52:55], s77 offen offset:1024 sc1
    buffer_load_dwordx4 v[224:227], v108, s[52:55], s77 offen offset:2048 sc1
    buffer_load_dwordx4 v[228:231], v108, s[52:55], s77 offen offset:3072 sc1
L_sv_loop:
    s_lshl_b32 s73, s89, 5
    s_add_u32 s73, s73, s92
    s_waitcnt vmcnt(0)
    v_mfma_f32_16x16x32_bf16 v[32:35], v[168:171], v[136:139], 0
    v_mfma_f32_16x16x32_bf16 v[32:35], v[184:187], v[144:147], v[32:35]
    v_mfma_f32_16x16x32_bf16 v[32:35], v[200:203], v[152:155], v[32:35]
    v_mfma_f32_16x16x32_bf16 v[32:35], v[216:219], v[160:163], v[32:35]
    v_mfma_f32_16x16x32_bf16 v[36:39], v[172:175], v[136:139], 0
    v_mfma_f32_16x16x32_bf16 v[36:39], v[188:191], v[144:147], v[36:39]
    v_mfma_f32_16x16x32_bf16 v[36:39], v[204:207], v[152:155], v[36:39]
    v_mfma_f32_16x16x32_bf16 v[36:39], v[220:223], v[160:163], v[36:39]
    v_mfma_f32_16x16x32_bf16 v[44:47], v[168:171], v[140:143], 0
    v_mfma_f32_16x16x32_bf16 v[44:47], v[184:187], v[148:151], v[44:47]
    v_mfma_f32_16x16x32_bf16 v[44:47], v[200:203], v[156:159], v[44:47]
    v_mfma_f32_16x16x32_bf16 v[44:47], v[216:219], v[164:167], v[44:47]
    v_mfma_f32_16x16x32_bf16 v[48:51], v[172:175], v[140:143], 0
    v_mfma_f32_16x16x32_bf16 v[48:51], v[188:191], v[148:151], v[48:51]
    v_mfma_f32_16x16x32_bf16 v[48:51], v[204:207], v[156:159], v[48:51]
    v_mfma_f32_16x16x32_bf16 v[48:51], v[220:223], v[164:167], v[48:51]
    s_lshl_b32 s80, s92, 7
    s_add_u32 s80, s80, 95420416
    s_add_u32 s74, s89, 1
    v_mov_b32 v121, s80
L_wt_208:
    buffer_load_dword v120, v121, s[52:55], 0 offen sc1
    s_waitcnt vmcnt(0)
    v_readfirstlane_b32 s77, v120
    s_nop 0
    s_cmp_ge_u32 s77, s74
    s_cbranch_scc1 L_wd_209
    s_sub_u32 s77, s74, s77
    s_cmp_lt_u32 s77, 2
    s_cbranch_scc1 L_wf_210
    s_sleep 24
    s_cmp_lt_u32 s77, 3
    s_cbranch_scc1 L_wf_210
    s_sleep 48
L_wf_210:
    s_sleep 2
    s_branch L_wt_208
L_wd_209:
    s_lshl_b32 s77, s73, 12
    s_add_u32 s77, s77, 67108864
    buffer_load_dwordx4 v[232:235], v108, s[52:55], s77 offen offset:0 sc1
    buffer_load_dwordx4 v[236:239], v108, s[52:55], s77 offen offset:1024 sc1
    buffer_load_dwordx4 v[240:243], v108, s[52:55], s77 offen offset:2048 sc1
    buffer_load_dwordx4 v[244:247], v108, s[52:55], s77 offen offset:3072 sc1
    s_lshl_b32 s77, s73, 12
    s_add_u32 s77, s77, 100663296
    buffer_load_dwordx4 v[16:19], v108, s[52:55], s77 offen offset:0 sc1
    buffer_load_dwordx4 v[20:23], v108, s[52:55], s77 offen offset:1024 sc1
    buffer_load_dwordx4 v[24:27], v108, s[52:55], s77 offen offset:2048 sc1
    buffer_load_dwordx4 v[28:31], v108, s[52:55], s77 offen offset:3072 sc1
    v_cmp_gt_i32 vcc, 0, v111
    s_nop 1
    v_cndmask_b32 v32, v32, v112, vcc
    v_cmp_gt_i32 vcc, 1, v111
    s_nop 1
    v_cndmask_b32 v33, v33, v112, vcc
    v_cmp_gt_i32 vcc, 2, v111
    s_nop 1
    v_cndmask_b32 v34, v34, v112, vcc
    v_cmp_gt_i32 vcc, 3, v111
    s_nop 1
    v_cndmask_b32 v35, v35, v112, vcc
    v_cmp_gt_i32 vcc, 4, v111
    s_nop 1
    v_cndmask_b32 v36, v36, v112, vcc
    v_cmp_gt_i32 vcc, 5, v111
    s_nop 1
    v_cndmask_b32 v37, v37, v112, vcc
    v_cmp_gt_i32 vcc, 6, v111
    s_nop 1
    v_cndmask_b32 v38, v38, v112, vcc
    v_cmp_gt_i32 vcc, 7, v111
    s_nop 1
    v_cndmask_b32 v39, v39, v112, vcc
    v_cmp_gt_i32 vcc, -4, v111
    s_nop 1
    v_cndmask_b32 v44, v44, v112, vcc
    v_cmp_gt_i32 vcc, -3, v111
    s_nop 1
    v_cndmask_b32 v45, v45, v112, vcc
    v_cmp_gt_i32 vcc, -2, v111
    s_nop 1
    v_cndmask_b32 v46, v46, v112, vcc
    v_cmp_gt_i32 vcc, -1, v111
    s_nop 1
    v_cndmask_b32 v47, v47, v112, vcc
    v_cmp_gt_i32 vcc, 0, v111
    s_nop 1
    v_cndmask_b32 v48, v48, v112, vcc
    v_cmp_gt_i32 vcc, 1, v111
    s_nop 1
    v_cndmask_b32 v49, v49, v112, vcc
    v_cmp_gt_i32 vcc, 2, v111
    s_nop 1
    v_cndmask_b32 v50, v50, v112, vcc
    v_cmp_gt_i32 vcc, 3, v111
    s_nop 1
    v_cndmask_b32 v51, v51, v112, vcc
    s_waitcnt vmcnt(4)
    v_mfma_f32_16x16x32_bf16 v[40:43], v[232:235], v[136:139], 0
    v_mfma_f32_16x16x32_bf16 v[40:43], v[236:239], v[144:147], v[40:43]
    v_mfma_f32_16x16x32_bf16 v[40:43], v[240:243], v[152:155], v[40:43]
    v_mfma_f32_16x16x32_bf16 v[40:43], v[244:247], v[160:163], v[40:43]
    v_mfma_f32_16x16x32_bf16 v[52:55], v[232:235], v[140:143], 0
    v_mfma_f32_16x16x32_bf16 v[52:55], v[236:239], v[148:151], v[52:55]
    v_mfma_f32_16x16x32_bf16 v[52:55], v[240:243], v[156:159], v[52:55]
    v_mfma_f32_16x16x32_bf16 v[52:55], v[244:247], v[164:167], v[52:55]
    s_barrier
    v_max3_f32 v2, v32, v33, v34
    v_max3_f32 v3, v35, v36, v37
    v_max3_f32 v2, v2, v38, v39
    v_max3_f32 v3, v3, v40, v41
    v_max_f32 v2, v2, v3
    v_mov_b32 v3, v2
    s_nop 1
    v_permlane16_swap_b32 v2, v3
    v_max_f32 v2, v2, v3
    v_mov_b32 v3, v2
    s_nop 1
    v_permlane32_swap_b32 v2, v3
    v_max_f32 v2, v2, v3
    v_mul_f32 v2, s76, v2
    v_fma_f32 v32, v32, s76, -v2
    v_fma_f32 v33, v33, s76, -v2
    v_fma_f32 v34, v34, s76, -v2
    v_fma_f32 v35, v35, s76, -v2
    v_fma_f32 v36, v36, s76, -v2
    v_fma_f32 v37, v37, s76, -v2
    v_fma_f32 v38, v38, s76, -v2
    v_fma_f32 v39, v39, s76, -v2
    v_fma_f32 v40, v40, s76, -v2
    v_fma_f32 v41, v41, s76, -v2
    v_exp_f32 v32, v32
    v_exp_f32 v33, v33
    v_exp_f32 v34, v34
    v_exp_f32 v35, v35
    v_exp_f32 v36, v36
    v_exp_f32 v37, v37
    v_exp_f32 v38, v38
    v_exp_f32 v39, v39
    v_exp_f32 v40, v40
    v_exp_f32 v41, v41
    v_cvt_pk_bf16_f32 v56, v32, v33
    v_cvt_pk_bf16_f32 v57, v34, v35
    v_cvt_pk_bf16_f32 v58, v36, v37
    v_cvt_pk_bf16_f32 v59, v38, v39
    v_cvt_pk_bf16_f32 v60, v40, v41
    v_mov_b32 v61, 0
    s_waitcnt vmcnt(0)
    v_mfma_f32_16x16x32_bf16 v[104:107], v[248:251], v[56:59], 0
    v_mfma_f32_16x16x32_bf16 v[72:75], v[176:179], v[56:59], 0
    v_mfma_f32_16x16x32_bf16 v[76:79], v[180:183], v[56:59], 0
    v_mfma_f32_16x16x32_bf16 v[80:83], v[192:195], v[56:59], 0
    v_mfma_f32_16x16x32_bf16 v[84:87], v[196:199], v[56:59], 0
    v_mfma_f32_16x16x32_bf16 v[88:91], v[208:211], v[56:59], 0
    v_mfma_f32_16x16x32_bf16 v[92:95], v[212:215], v[56:59], 0
    v_mfma_f32_16x16x32_bf16 v[96:99], v[224:227], v[56:59], 0
    v_mfma_f32_16x16x32_bf16 v[100:103], v[228:231], v[56:59], 0
    v_mfma_f32_16x16x16_bf16 v[104:107], v[248:249], v[60:61], v[104:107]
    v_mfma_f32_16x16x16_bf16 v[72:75], v[16:17], v[60:61], v[72:75]
    v_mfma_f32_16x16x16_bf16 v[76:79], v[18:19], v[60:61], v[76:79]
    v_mfma_f32_16x16x16_bf16 v[80:83], v[20:21], v[60:61], v[80:83]
    v_mfma_f32_16x16x16_bf16 v[84:87], v[22:23], v[60:61], v[84:87]
    v_mfma_f32_16x16x16_bf16 v[88:91], v[24:25], v[60:61], v[88:91]
    v_mfma_f32_16x16x16_bf16 v[92:95], v[26:27], v[60:61], v[92:95]
    v_mfma_f32_16x16x16_bf16 v[96:99], v[28:29], v[60:61], v[96:99]
    v_mfma_f32_16x16x16_bf16 v[100:103], v[30:31], v[60:61], v[100:103]
    v_rcp_f32 v2, v104
    s_nop 0
    v_mul_f32 v72, v72, v2
    v_mul_f32 v73, v73, v2
    v_mul_f32 v74, v74, v2
    v_mul_f32 v75, v75, v2
    v_mul_f32 v76, v76, v2
    v_mul_f32 v77, v77, v2
    v_mul_f32 v78, v78, v2
    v_mul_f32 v79, v79, v2
    v_mul_f32 v80, v80, v2
    v_mul_f32 v81, v81, v2
    v_mul_f32 v82, v82, v2
    v_mul_f32 v83, v83, v2
    v_mul_f32 v84, v84, v2
    v_mul_f32 v85, v85, v2
    v_mul_f32 v86, v86, v2
    v_mul_f32 v87, v87, v2
    v_mul_f32 v88, v88, v2
    v_mul_f32 v89, v89, v2
    v_mul_f32 v90, v90, v2
    v_mul_f32 v91, v91, v2
    v_mul_f32 v92, v92, v2
    v_mul_f32 v93, v93, v2
    v_mul_f32 v94, v94, v2
    v_mul_f32 v95, v95, v2
    v_mul_f32 v96, v96, v2
    v_mul_f32 v97, v97, v2
    v_mul_f32 v98, v98, v2
    v_mul_f32 v99, v99, v2
    v_mul_f32 v100, v100, v2
    v_mul_f32 v101, v101, v2
    v_mul_f32 v102, v102, v2
    v_mul_f32 v103, v103, v2
    v_cvt_pk_bf16_f32 v72, v72, v73
    v_cvt_pk_bf16_f32 v73, v74, v75
    v_cvt_pk_bf16_f32 v74, v76, v77
    v_cvt_pk_bf16_f32 v75, v78, v79
    ds_write_b128 v113, v[72:75] offset:0
    v_cvt_pk_bf16_f32 v80, v80, v81
    v_cvt_pk_bf16_f32 v81, v82, v83
    v_cvt_pk_bf16_f32 v82, v84, v85
    v_cvt_pk_bf16_f32 v83, v86, v87
    ds_write_b128 v114, v[80:83] offset:0
    v_cvt_pk_bf16_f32 v88, v88, v89
    v_cvt_pk_bf16_f32 v89, v90, v91
    v_cvt_pk_bf16_f32 v90, v92, v93
    v_cvt_pk_bf16_f32 v91, v94, v95
    ds_write_b128 v115, v[88:91] offset:0
    v_cvt_pk_bf16_f32 v96, v96, v97
    v_cvt_pk_bf16_f32 v97, v98, v99
    v_cvt_pk_bf16_f32 v98, v100, v101
    v_cvt_pk_bf16_f32 v99, v102, v103
    ds_write_b128 v116, v[96:99] offset:0
    v_max3_f32 v2, v44, v45, v46
    v_max3_f32 v3, v47, v48, v49
    v_max3_f32 v2, v2, v50, v51
    v_max3_f32 v3, v3, v52, v53
    v_max_f32 v2, v2, v3
    v_mov_b32 v3, v2
    s_nop 1
    v_permlane16_swap_b32 v2, v3
    v_max_f32 v2, v2, v3
    v_mov_b32 v3, v2
    s_nop 1
    v_permlane32_swap_b32 v2, v3
    v_max_f32 v2, v2, v3
    v_mul_f32 v2, s76, v2
    v_fma_f32 v44, v44, s76, -v2
    v_fma_f32 v45, v45, s76, -v2
    v_fma_f32 v46, v46, s76, -v2
    v_fma_f32 v47, v47, s76, -v2
    v_fma_f32 v48, v48, s76, -v2
    v_fma_f32 v49, v49, s76, -v2
    v_fma_f32 v50, v50, s76, -v2
    v_fma_f32 v51, v51, s76, -v2
    v_fma_f32 v52, v52, s76, -v2
    v_fma_f32 v53, v53, s76, -v2
    v_exp_f32 v44, v44
    v_exp_f32 v45, v45
    v_exp_f32 v46, v46
    v_exp_f32 v47, v47
    v_exp_f32 v48, v48
    v_exp_f32 v49, v49
    v_exp_f32 v50, v50
    v_exp_f32 v51, v51
    v_exp_f32 v52, v52
    v_exp_f32 v53, v53
    v_cvt_pk_bf16_f32 v64, v44, v45
    v_cvt_pk_bf16_f32 v65, v46, v47
    v_cvt_pk_bf16_f32 v66, v48, v49
    v_cvt_pk_bf16_f32 v67, v50, v51
    v_cvt_pk_bf16_f32 v68, v52, v53
    v_mov_b32 v69, 0
    v_mfma_f32_16x16x32_bf16 v[104:107], v[248:251], v[64:67], 0
    v_mfma_f32_16x16x32_bf16 v[72:75], v[176:179], v[64:67], 0
    v_mfma_f32_16x16x32_bf16 v[76:79], v[180:183], v[64:67], 0
    v_mfma_f32_16x16x32_bf16 v[80:83], v[192:195], v[64:67], 0
    v_mfma_f32_16x16x32_bf16 v[84:87], v[196:199], v[64:67], 0
    v_mfma_f32_16x16x32_bf16 v[88:91], v[208:211], v[64:67], 0
    v_mfma_f32_16x16x32_bf16 v[92:95], v[212:215], v[64:67], 0
    v_mfma_f32_16x16x32_bf16 v[96:99], v[224:227], v[64:67], 0
    v_mfma_f32_16x16x32_bf16 v[100:103], v[228:231], v[64:67], 0
    v_mfma_f32_16x16x16_bf16 v[104:107], v[248:249], v[68:69], v[104:107]
    v_mfma_f32_16x16x16_bf16 v[72:75], v[16:17], v[68:69], v[72:75]
    v_mfma_f32_16x16x16_bf16 v[76:79], v[18:19], v[68:69], v[76:79]
    v_mfma_f32_16x16x16_bf16 v[80:83], v[20:21], v[68:69], v[80:83]
    v_mfma_f32_16x16x16_bf16 v[84:87], v[22:23], v[68:69], v[84:87]
    v_mfma_f32_16x16x16_bf16 v[88:91], v[24:25], v[68:69], v[88:91]
    v_mfma_f32_16x16x16_bf16 v[92:95], v[26:27], v[68:69], v[92:95]
    v_mfma_f32_16x16x16_bf16 v[96:99], v[28:29], v[68:69], v[96:99]
    v_mfma_f32_16x16x16_bf16 v[100:103], v[30:31], v[68:69], v[100:103]
    v_rcp_f32 v2, v104
    s_nop 0
    v_mul_f32 v72, v72, v2
    v_mul_f32 v73, v73, v2
    v_mul_f32 v74, v74, v2
    v_mul_f32 v75, v75, v2
    v_mul_f32 v76, v76, v2
    v_mul_f32 v77, v77, v2
    v_mul_f32 v78, v78, v2
    v_mul_f32 v79, v79, v2
    v_mul_f32 v80, v80, v2
    v_mul_f32 v81, v81, v2
    v_mul_f32 v82, v82, v2
    v_mul_f32 v83, v83, v2
    v_mul_f32 v84, v84, v2
    v_mul_f32 v85, v85, v2
    v_mul_f32 v86, v86, v2
    v_mul_f32 v87, v87, v2
    v_mul_f32 v88, v88, v2
    v_mul_f32 v89, v89, v2
    v_mul_f32 v90, v90, v2
    v_mul_f32 v91, v91, v2
    v_mul_f32 v92, v92, v2
    v_mul_f32 v93, v93, v2
    v_mul_f32 v94, v94, v2
    v_mul_f32 v95, v95, v2
    v_mul_f32 v96, v96, v2
    v_mul_f32 v97, v97, v2
    v_mul_f32 v98, v98, v2
    v_mul_f32 v99, v99, v2
    v_mul_f32 v100, v100, v2
    v_mul_f32 v101, v101, v2
    v_mul_f32 v102, v102, v2
    v_mul_f32 v103, v103, v2
    v_cvt_pk_bf16_f32 v72, v72, v73
    v_cvt_pk_bf16_f32 v73, v74, v75
    v_cvt_pk_bf16_f32 v74, v76, v77
    v_cvt_pk_bf16_f32 v75, v78, v79
    ds_write_b128 v113, v[72:75] offset:4096
    v_cvt_pk_bf16_f32 v80, v80, v81
    v_cvt_pk_bf16_f32 v81, v82, v83
    v_cvt_pk_bf16_f32 v82, v84, v85
    v_cvt_pk_bf16_f32 v83, v86, v87
    ds_write_b128 v114, v[80:83] offset:4096
    v_cvt_pk_bf16_f32 v88, v88, v89
    v_cvt_pk_bf16_f32 v89, v90, v91
    v_cvt_pk_bf16_f32 v90, v92, v93
    v_cvt_pk_bf16_f32 v91, v94, v95
    ds_write_b128 v115, v[88:91] offset:4096
    v_cvt_pk_bf16_f32 v96, v96, v97
    v_cvt_pk_bf16_f32 v97, v98, v99
    v_cvt_pk_bf16_f32 v98, v100, v101
    v_cvt_pk_bf16_f32 v99, v102, v103
    ds_write_b128 v116, v[96:99] offset:4096
    s_waitcnt lgkmcnt(0)
    s_barrier
    ds_read_b128 v[16:19], v128 offset:0
    ds_read_b128 v[20:23], v128 offset:4096
    ds_read_b128 v[32:35], v129 offset:0
    ds_read_b128 v[36:39], v129 offset:4096
    s_waitcnt lgkmcnt(2)
    v_mfma_f32_16x16x32_bf16 v[48:51], a[0:3], v[16:19], 0
    v_mfma_f32_16x16x32_bf16 v[52:55], a[64:67], v[16:19], 0
    v_mfma_f32_16x16x32_bf16 v[56:59], a[128:131], v[16:19], 0
    v_mfma_f32_16x16x32_bf16 v[60:63], a[192:195], v[16:19], 0
    v_mfma_f32_16x16x32_bf16 v[64:67], a[0:3], v[20:23], 0
    v_mfma_f32_16x16x32_bf16 v[68:71], a[64:67], v[20:23], 0
    v_mfma_f32_16x16x32_bf16 v[72:75], a[128:131], v[20:23], 0
    v_mfma_f32_16x16x32_bf16 v[76:79], a[192:195], v[20:23], 0
    ds_read_b128 v[16:19], v130 offset:0
    ds_read_b128 v[20:23], v130 offset:4096
    s_waitcnt lgkmcnt(2)
    v_mfma_f32_16x16x32_bf16 v[48:51], a[4:7], v[32:35], v[48:51]
    v_mfma_f32_16x16x32_bf16 v[52:55], a[68:71], v[32:35], v[52:55]
    v_mfma_f32_16x16x32_bf16 v[56:59], a[132:135], v[32:35], v[56:59]
    v_mfma_f32_16x16x32_bf16 v[60:63], a[196:199], v[32:35], v[60:63]
    v_mfma_f32_16x16x32_bf16 v[64:67], a[4:7], v[36:39], v[64:67]
    v_mfma_f32_16x16x32_bf16 v[68:71], a[68:71], v[36:39], v[68:71]
    v_mfma_f32_16x16x32_bf16 v[72:75], a[132:135], v[36:39], v[72:75]
    v_mfma_f32_16x16x32_bf16 v[76:79], a[196:199], v[36:39], v[76:79]
    ds_read_b128 v[32:35], v131 offset:0
    ds_read_b128 v[36:39], v131 offset:4096
    s_waitcnt lgkmcnt(2)
    v_mfma_f32_16x16x32_bf16 v[48:51], a[8:11], v[16:19], v[48:51]
    v_mfma_f32_16x16x32_bf16 v[52:55], a[72:75], v[16:19], v[52:55]
    v_mfma_f32_16x16x32_bf16 v[56:59], a[136:139], v[16:19], v[56:59]
    v_mfma_f32_16x16x32_bf16 v[60:63], a[200:203], v[16:19], v[60:63]
    v_mfma_f32_16x16x32_bf16 v[64:67], a[8:11], v[20:23], v[64:67]
    v_mfma_f32_16x16x32_bf16 v[68:71], a[72:75], v[20:23], v[68:71]
    v_mfma_f32_16x16x32_bf16 v[72:75], a[136:139], v[20:23], v[72:75]
    v_mfma_f32_16x16x32_bf16 v[76:79], a[200:203], v[20:23], v[76:79]
    ds_read_b128 v[16:19], v128 offset:256
    ds_read_b128 v[20:23], v128 offset:4352
    s_waitcnt lgkmcnt(2)
    v_mfma_f32_16x16x32_bf16 v[48:51], a[12:15], v[32:35], v[48:51]
    v_mfma_f32_16x16x32_bf16 v[52:55], a[76:79], v[32:35], v[52:55]
    v_mfma_f32_16x16x32_bf16 v[56:59], a[140:143], v[32:35], v[56:59]
    v_mfma_f32_16x16x32_bf16 v[60:63], a[204:207], v[32:35], v[60:63]
    v_mfma_f32_16x16x32_bf16 v[64:67], a[12:15], v[36:39], v[64:67]
    v_mfma_f32_16x16x32_bf16 v[68:71], a[76:79], v[36:39], v[68:71]
    v_mfma_f32_16x16x32_bf16 v[72:75], a[140:143], v[36:39], v[72:75]
    v_mfma_f32_16x16x32_bf16 v[76:79], a[204:207], v[36:39], v[76:79]
    ds_read_b128 v[32:35], v129 offset:256
    ds_read_b128 v[36:39], v129 offset:4352
    s_waitcnt lgkmcnt(2)
    v_mfma_f32_16x16x32_bf16 v[48:51], a[16:19], v[16:19], v[48:51]
    v_mfma_f32_16x16x32_bf16 v[52:55], a[80:83], v[16:19], v[52:55]
    v_mfma_f32_16x16x32_bf16 v[56:59], a[144:147], v[16:19], v[56:59]
    v_mfma_f32_16x16x32_bf16 v[60:63], a[208:211], v[16:19], v[60:63]
    v_mfma_f32_16x16x32_bf16 v[64:67], a[16:19], v[20:23], v[64:67]
    v_mfma_f32_16x16x32_bf16 v[68:71], a[80:83], v[20:23], v[68:71]
    v_mfma_f32_16x16x32_bf16 v[72:75], a[144:147], v[20:23], v[72:75]
    v_mfma_f32_16x16x32_bf16 v[76:79], a[208:211], v[20:23], v[76:79]
    ds_read_b128 v[16:19], v130 offset:256
    ds_read_b128 v[20:23], v130 offset:4352
    s_waitcnt lgkmcnt(2)
    v_mfma_f32_16x16x32_bf16 v[48:51], a[20:23], v[32:35], v[48:51]
    v_mfma_f32_16x16x32_bf16 v[52:55], a[84:87], v[32:35], v[52:55]
    v_mfma_f32_16x16x32_bf16 v[56:59], a[148:151], v[32:35], v[56:59]
    v_mfma_f32_16x16x32_bf16 v[60:63], a[212:215], v[32:35], v[60:63]
    v_mfma_f32_16x16x32_bf16 v[64:67], a[20:23], v[36:39], v[64:67]
    v_mfma_f32_16x16x32_bf16 v[68:71], a[84:87], v[36:39], v[68:71]
    v_mfma_f32_16x16x32_bf16 v[72:75], a[148:151], v[36:39], v[72:75]
    v_mfma_f32_16x16x32_bf16 v[76:79], a[212:215], v[36:39], v[76:79]
    ds_read_b128 v[32:35], v131 offset:256
    ds_read_b128 v[36:39], v131 offset:4352
    s_waitcnt lgkmcnt(2)
    v_mfma_f32_16x16x32_bf16 v[48:51], a[24:27], v[16:19], v[48:51]
    v_mfma_f32_16x16x32_bf16 v[52:55], a[88:91], v[16:19], v[52:55]
    v_mfma_f32_16x16x32_bf16 v[56:59], a[152:155], v[16:19], v[56:59]
    v_mfma_f32_16x16x32_bf16 v[60:63], a[216:219], v[16:19], v[60:63]
    v_mfma_f32_16x16x32_bf16 v[64:67], a[24:27], v[20:23], v[64:67]
    v_mfma_f32_16x16x32_bf16 v[68:71], a[88:91], v[20:23], v[68:71]
    v_mfma_f32_16x16x32_bf16 v[72:75], a[152:155], v[20:23], v[72:75]
    v_mfma_f32_16x16x32_bf16 v[76:79], a[216:219], v[20:23], v[76:79]
    ds_read_b128 v[16:19], v128 offset:512
    ds_read_b128 v[20:23], v128 offset:4608
    s_waitcnt lgkmcnt(2)
    v_mfma_f32_16x16x32_bf16 v[48:51], a[28:31], v[32:35], v[48:51]
    v_mfma_f32_16x16x32_bf16 v[52:55], a[92:95], v[32:35], v[52:55]
    v_mfma_f32_16x16x32_bf16 v[56:59], a[156:159], v[32:35], v[56:59]
    v_mfma_f32_16x16x32_bf16 v[60:63], a[220:223], v[32:35], v[60:63]
    v_mfma_f32_16x16x32_bf16 v[64:67], a[28:31], v[36:39], v[64:67]
    v_mfma_f32_16x16x32_bf16 v[68:71], a[92:95], v[36:39], v[68:71]
    v_mfma_f32_16x16x32_bf16 v[72:75], a[156:159], v[36:39], v[72:75]
    v_mfma_f32_16x16x32_bf16 v[76:79], a[220:223], v[36:39], v[76:79]
    ds_read_b128 v[32:35], v129 offset:512
    ds_read_b128 v[36:39], v129 offset:4608
    s_waitcnt lgkmcnt(2)
    v_mfma_f32_16x16x32_bf16 v[48:51], a[32:35], v[16:19], v[48:51]
    v_mfma_f32_16x16x32_bf16 v[52:55], a[96:99], v[16:19], v[52:55]
    v_mfma_f32_16x16x32_bf16 v[56:59], a[160:163], v[16:19], v[56:59]
    v_mfma_f32_16x16x32_bf16 v[60:63], a[224:227], v[16:19], v[60:63]
    v_mfma_f32_16x16x32_bf16 v[64:67], a[32:35], v[20:23], v[64:67]
    v_mfma_f32_16x16x32_bf16 v[68:71], a[96:99], v[20:23], v[68:71]
    v_mfma_f32_16x16x32_bf16 v[72:75], a[160:163], v[20:23], v[72:75]
    v_mfma_f32_16x16x32_bf16 v[76:79], a[224:227], v[20:23], v[76:79]
    ds_read_b128 v[16:19], v130 offset:512
    ds_read_b128 v[20:23], v130 offset:4608
    s_waitcnt lgkmcnt(2)
    v_mfma_f32_16x16x32_bf16 v[48:51], a[36:39], v[32:35], v[48:51]
    v_mfma_f32_16x16x32_bf16 v[52:55], a[100:103], v[32:35], v[52:55]
    v_mfma_f32_16x16x32_bf16 v[56:59], a[164:167], v[32:35], v[56:59]
    v_mfma_f32_16x16x32_bf16 v[60:63], a[228:231], v[32:35], v[60:63]
    v_mfma_f32_16x16x32_bf16 v[64:67], a[36:39], v[36:39], v[64:67]
    v_mfma_f32_16x16x32_bf16 v[68:71], a[100:103], v[36:39], v[68:71]
    v_mfma_f32_16x16x32_bf16 v[72:75], a[164:167], v[36:39], v[72:75]
    v_mfma_f32_16x16x32_bf16 v[76:79], a[228:231], v[36:39], v[76:79]
    ds_read_b128 v[32:35], v131 offset:512
    ds_read_b128 v[36:39], v131 offset:4608
    s_waitcnt lgkmcnt(2)
    v_mfma_f32_16x16x32_bf16 v[48:51], a[40:43], v[16:19], v[48:51]
    v_mfma_f32_16x16x32_bf16 v[52:55], a[104:107], v[16:19], v[52:55]
    v_mfma_f32_16x16x32_bf16 v[56:59], a[168:171], v[16:19], v[56:59]
    v_mfma_f32_16x16x32_bf16 v[60:63], a[232:235], v[16:19], v[60:63]
    v_mfma_f32_16x16x32_bf16 v[64:67], a[40:43], v[20:23], v[64:67]
    v_mfma_f32_16x16x32_bf16 v[68:71], a[104:107], v[20:23], v[68:71]
    v_mfma_f32_16x16x32_bf16 v[72:75], a[168:171], v[20:23], v[72:75]
    v_mfma_f32_16x16x32_bf16 v[76:79], a[232:235], v[20:23], v[76:79]
    ds_read_b128 v[16:19], v128 offset:768
    ds_read_b128 v[20:23], v128 offset:4864
    s_waitcnt lgkmcnt(2)
    v_mfma_f32_16x16x32_bf16 v[48:51], a[44:47], v[32:35], v[48:51]
    v_mfma_f32_16x16x32_bf16 v[52:55], a[108:111], v[32:35], v[52:55]
    v_mfma_f32_16x16x32_bf16 v[56:59], a[172:175], v[32:35], v[56:59]
    v_mfma_f32_16x16x32_bf16 v[60:63], a[236:239], v[32:35], v[60:63]
    v_mfma_f32_16x16x32_bf16 v[64:67], a[44:47], v[36:39], v[64:67]
    v_mfma_f32_16x16x32_bf16 v[68:71], a[108:111], v[36:39], v[68:71]
    v_mfma_f32_16x16x32_bf16 v[72:75], a[172:175], v[36:39], v[72:75]
    v_mfma_f32_16x16x32_bf16 v[76:79], a[236:239], v[36:39], v[76:79]
    ds_read_b128 v[32:35], v129 offset:768
    ds_read_b128 v[36:39], v129 offset:4864
    s_waitcnt lgkmcnt(2)
    v_mfma_f32_16x16x32_bf16 v[48:51], a[48:51], v[16:19], v[48:51]
    v_mfma_f32_16x16x32_bf16 v[52:55], a[112:115], v[16:19], v[52:55]
    v_mfma_f32_16x16x32_bf16 v[56:59], a[176:179], v[16:19], v[56:59]
    v_mfma_f32_16x16x32_bf16 v[60:63], a[240:243], v[16:19], v[60:63]
    v_mfma_f32_16x16x32_bf16 v[64:67], a[48:51], v[20:23], v[64:67]
    v_mfma_f32_16x16x32_bf16 v[68:71], a[112:115], v[20:23], v[68:71]
    v_mfma_f32_16x16x32_bf16 v[72:75], a[176:179], v[20:23], v[72:75]
    v_mfma_f32_16x16x32_bf16 v[76:79], a[240:243], v[20:23], v[76:79]
    ds_read_b128 v[16:19], v130 offset:768
    ds_read_b128 v[20:23], v130 offset:4864
    s_waitcnt lgkmcnt(2)
    v_mfma_f32_16x16x32_bf16 v[48:51], a[52:55], v[32:35], v[48:51]
    v_mfma_f32_16x16x32_bf16 v[52:55], a[116:119], v[32:35], v[52:55]
    v_mfma_f32_16x16x32_bf16 v[56:59], a[180:183], v[32:35], v[56:59]
    v_mfma_f32_16x16x32_bf16 v[60:63], a[244:247], v[32:35], v[60:63]
    v_mfma_f32_16x16x32_bf16 v[64:67], a[52:55], v[36:39], v[64:67]
    v_mfma_f32_16x16x32_bf16 v[68:71], a[116:119], v[36:39], v[68:71]
    v_mfma_f32_16x16x32_bf16 v[72:75], a[180:183], v[36:39], v[72:75]
    v_mfma_f32_16x16x32_bf16 v[76:79], a[244:247], v[36:39], v[76:79]
    ds_read_b128 v[32:35], v131 offset:768
    ds_read_b128 v[36:39], v131 offset:4864
    s_waitcnt lgkmcnt(2)
    v_mfma_f32_16x16x32_bf16 v[48:51], a[56:59], v[16:19], v[48:51]
    v_mfma_f32_16x16x32_bf16 v[52:55], a[120:123], v[16:19], v[52:55]
    v_mfma_f32_16x16x32_bf16 v[56:59], a[184:187], v[16:19], v[56:59]
    v_mfma_f32_16x16x32_bf16 v[60:63], a[248:251], v[16:19], v[60:63]
    v_mfma_f32_16x16x32_bf16 v[64:67], a[56:59], v[20:23], v[64:67]
    v_mfma_f32_16x16x32_bf16 v[68:71], a[120:123], v[20:23], v[68:71]
    v_mfma_f32_16x16x32_bf16 v[72:75], a[184:187], v[20:23], v[72:75]
    v_mfma_f32_16x16x32_bf16 v[76:79], a[248:251], v[20:23], v[76:79]
    s_waitcnt lgkmcnt(0)
    v_mfma_f32_16x16x32_bf16 v[48:51], a[60:63], v[32:35], v[48:51]
    v_mfma_f32_16x16x32_bf16 v[52:55], a[124:127], v[32:35], v[52:55]
    v_mfma_f32_16x16x32_bf16 v[56:59], a[188:191], v[32:35], v[56:59]
    v_mfma_f32_16x16x32_bf16 v[60:63], a[252:255], v[32:35], v[60:63]
    v_mfma_f32_16x16x32_bf16 v[64:67], a[60:63], v[36:39], v[64:67]
    v_mfma_f32_16x16x32_bf16 v[68:71], a[124:127], v[36:39], v[68:71]
    v_mfma_f32_16x16x32_bf16 v[72:75], a[188:191], v[36:39], v[72:75]
    v_mfma_f32_16x16x32_bf16 v[76:79], a[252:255], v[36:39], v[76:79]
    s_lshl_b32 s75, s89, 1
    s_add_u32 s75, s75, s91
    s_lshl_b32 s74, s75, 18
    s_add_u32 s74, s74, 134217728
    s_lshl_b32 s77, s56, 13
    s_add_u32 s74, s74, s77
    s_lshl_b32 s77, s90, 15
    s_add_u32 s77, s77, s74
    buffer_store_dwordx4 v[48:51], v108, s[52:55], s77 offen offset:0 sc1
    buffer_store_dwordx4 v[52:55], v108, s[52:55], s77 offen offset:1024 sc1
    buffer_store_dwordx4 v[56:59], v108, s[52:55], s77 offen offset:2048 sc1
    buffer_store_dwordx4 v[60:63], v108, s[52:55], s77 offen offset:3072 sc1
    s_add_u32 s77, s77, 4096
    buffer_store_dwordx4 v[64:67], v108, s[52:55], s77 offen offset:0 sc1
    buffer_store_dwordx4 v[68:71], v108, s[52:55], s77 offen offset:1024 sc1
    buffer_store_dwordx4 v[72:75], v108, s[52:55], s77 offen offset:2048 sc1
    buffer_store_dwordx4 v[76:79], v108, s[52:55], s77 offen offset:3072 sc1
    s_lshl_b32 s80, s75, 7
    s_add_u32 s80, s80, 94371840
    s_waitcnt vmcnt(0)
    s_barrier
    s_cmp_lg_u32 s56, 0
    s_cbranch_scc1 L_sig_211
    v_mov_b32 v120, 1
    v_mov_b32 v121, s80
    s_mov_b64 exec, 1
    buffer_atomic_add v120, v121, s[52:55], 0 offen
    s_mov_b64 exec, -1
L_sig_211:
    v_mov_b32 v121, s80
L_wt_212:
    buffer_load_dword v120, v121, s[52:55], 0 offen sc1
    s_waitcnt vmcnt(0)
    v_readfirstlane_b32 s77, v120
    s_nop 0
    s_cmp_ge_u32 s77, 8
    s_cbranch_scc1 L_wd_213
    s_sleep 1
    s_branch L_wt_212
L_wd_213:
    s_lshl_b32 s77, s90, 10
    s_add_u32 s77, s77, s74
    buffer_load_dwordx4 v[72:75], v108, s[52:55], s77 offen sc1
    s_add_u32 s77, s77, 32768
    buffer_load_dwordx4 v[76:79], v108, s[52:55], s77 offen sc1
    s_add_u32 s77, s77, 32768
    buffer_load_dwordx4 v[80:83], v108, s[52:55], s77 offen sc1
    s_add_u32 s77, s77, 32768
    buffer_load_dwordx4 v[84:87], v108, s[52:55], s77 offen sc1
    s_add_u32 s77, s77, 32768
    buffer_load_dwordx4 v[88:91], v108, s[52:55], s77 offen sc1
    s_add_u32 s77, s77, 32768
    buffer_load_dwordx4 v[92:95], v108, s[52:55], s77 offen sc1
    s_add_u32 s77, s77, 32768
    buffer_load_dwordx4 v[96:99], v108, s[52:55], s77 offen sc1
    s_add_u32 s77, s77, 32768
    buffer_load_dwordx4 v[100:103], v108, s[52:55], s77 offen sc1
    s_waitcnt vmcnt(0)
    v_add_f32 v72, v72, v88
    v_add_f32 v73, v73, v89
    v_add_f32 v74, v74, v90
    v_add_f32 v75, v75, v91
    v_add_f32 v76, v76, v92
    v_add_f32 v77, v77, v93
    v_add_f32 v78, v78, v94
    v_add_f32 v79, v79, v95
    v_add_f32 v80, v80, v96
    v_add_f32 v81, v81, v97
    v_add_f32 v82, v82, v98
    v_add_f32 v83, v83, v99
    v_add_f32 v84, v84, v100
    v_add_f32 v85, v85, v101
    v_add_f32 v86, v86, v102
    v_add_f32 v87, v87, v103
    v_add_f32 v72, v72, v80
    v_add_f32 v73, v73, v81
    v_add_f32 v74, v74, v82
    v_add_f32 v75, v75, v83
    v_add_f32 v76, v76, v84
    v_add_f32 v77, v77, v85
    v_add_f32 v78, v78, v86
    v_add_f32 v79, v79, v87
    v_add_f32 v72, v72, v76
    v_add_f32 v73, v73, v77
    v_add_f32 v74, v74, v78
    v_add_f32 v75, v75, v79
    v_cvt_pk_bf16_f32 v76, v72, v73
    v_cvt_pk_bf16_f32 v77, v74, v75
    s_lshl_b32 s77, s89, 16
    s_lshr_b32 s78, s90, 2
    s_lshl_b32 s78, s78, 13
    s_add_u32 s77, s77, s78
    s_lshl_b32 s78, s91, 9
    s_add_u32 s77, s77, s78
    s_add_u32 s77, s77, 1024
    s_bfe_u32 s78, s90, 0x10001
    s_lshl_b32 s78, s78, 6
    s_add_u32 s77, s77, s78
    s_and_b32 s78, s90, 1
    s_lshl_b32 s78, s78, 3
    s_add_u32 s77, s77, s78
    buffer_store_dwordx2 v[76:77], v117, s[44:47], s77 offen
    s_add_u32 s89, s89, 8
    s_cmp_ge_u32 s89, 64
    s_cbranch_scc1 L_next
    s_lshr_b32 s80, s89, 2
    s_lshl_b32 s80, s80, 2
    s_add_u32 s80, s80, 32
    v_mov_b32 v121, s80
L_wt_214:
    buffer_load_dword v120, v121, s[48:51], 0 offen sc1
    s_waitcnt vmcnt(0)
    v_readfirstlane_b32 s77, v120
    s_nop 0
    s_cmp_ge_u32 s77, 1048608
    s_cbranch_scc1 L_wd_215
    s_sleep 16
    s_branch L_wt_214
L_wd_215:
    s_lshl_b32 s78, s89, 5
    s_add_u32 s78, s78, s92
    s_lshl_b32 s77, s78, 13
    s_add_u32 s77, s77, 0
    buffer_load_dwordx4 v[136:139], v108, s[52:55], s77 offen offset:0 sc1
    buffer_load_dwordx4 v[140:143], v108, s[52:55], s77 offen offset:1024 sc1
    buffer_load_dwordx4 v[144:147], v108, s[52:55], s77 offen offset:2048 sc1
    buffer_load_dwordx4 v[148:151], v108, s[52:55], s77 offen offset:3072 sc1
    s_add_u32 s77, s77, 4096
    buffer_load_dwordx4 v[152:155], v108, s[52:55], s77 offen offset:0 sc1
    buffer_load_dwordx4 v[156:159], v108, s[52:55], s77 offen offset:1024 sc1
    buffer_load_dwordx4 v[160:163], v108, s[52:55], s77 offen offset:2048 sc1
    buffer_load_dwordx4 v[164:167], v108, s[52:55], s77 offen offset:3072 sc1
    s_lshl_b32 s77, s78, 14
    s_add_u32 s77, s77, 16777216
    buffer_load_dwordx4 v[168:171], v108, s[52:55], s77 offen offset:0 sc1
    buffer_load_dwordx4 v[172:175], v108, s[52:55], s77 offen offset:1024 sc1
    buffer_load_dwordx4 v[176:179], v108, s[52:55], s77 offen offset:2048 sc1
    buffer_load_dwordx4 v[180:183], v108, s[52:55], s77 offen offset:3072 sc1
    s_add_u32 s77, s77, 4096
    buffer_load_dwordx4 v[184:187], v108, s[52:55], s77 offen offset:0 sc1
    buffer_load_dwordx4 v[188:191], v108, s[52:55], s77 offen offset:1024 sc1
    buffer_load_dwordx4 v[192:195], v108, s[52:55], s77 offen offset:2048 sc1
    buffer_load_dwordx4 v[196:199], v108, s[52:55], s77 offen offset:3072 sc1
    s_add_u32 s77, s77, 4096
    buffer_load_dwordx4 v[200:203], v108, s[52:55], s77 offen offset:0 sc1
    buffer_load_dwordx4 v[204:207], v108, s[52:55], s77 offen offset:1024 sc1
    buffer_load_dwordx4 v[208:211], v108, s[52:55], s77 offen offset:2048 sc1
    buffer_load_dwordx4 v[212:215], v108, s[52:55], s77 offen offset:3072 sc1
    s_add_u32 s77, s77, 4096
    buffer_load_dwordx4 v[216:219], v108, s[52:55], s77 offen offset:0 sc1
    buffer_load_dwordx4 v[220:223], v108, s[52:55], s77 offen offset:1024 sc1
    buffer_load_dwordx4 v[224:227], v108, s[52:55], s77 offen offset:2048 sc1
    buffer_load_dwordx4 v[228:231], v108, s[52:55], s77 offen offset:3072 sc1
    s_branch L_sv_loop
L_end0:
L_end:
    s_endpgm
.section .rodata,"a"
.p2align 6
.amdhsa_kernel concat_heads__sliding_block__memory_aug_recurrent_mem_tr__prompt_kernel
  .amdhsa_next_free_vgpr 512
  .amdhsa_next_free_sgpr 102
  .amdhsa_accum_offset 256
  .amdhsa_group_segment_fixed_size 0
  .amdhsa_kernarg_size 104
  .amdhsa_user_sgpr_count 2
  .amdhsa_user_sgpr_kernarg_segment_ptr 1
  .amdhsa_system_sgpr_workgroup_id_x 1
.end_amdhsa_kernel
```
